```python
import torch

def _softmax(x, axis=-1):
    return torch.softmax(x, dim=axis)
def _gelu(x):
    return torch.nn.functional.gelu(x, approximate="tanh")
def _silu(x):
    return torch.nn.functional.silu(x)
def _sigmoid(x):
    return torch.sigmoid(x)
def _layernorm(x, axis=-1, eps=1e-5):
    m = x.mean(dim=axis, keepdim=True)
    v = x.var(dim=axis, keepdim=True, unbiased=False)
    return (x - m) / torch.sqrt(v + eps)
def _scatter_add(tgt, idx, src, axis=0):
    return tgt.clone().index_add_(axis, idx, src)
def _segment_sum(src, seg, n):
    out = torch.zeros((n,) + src.shape[1:], dtype=src.dtype)
    return out.index_add_(0, seg, src)
def _pad(x, pw):
    flat = tuple(v for pair in reversed(pw) for v in pair)
    return torch.nn.functional.pad(x, flat)

kernel_name = 'standalone__mha_block_cached__near_ridge'

def setup_inputs():

    _w = (lambda a: (lambda t: t.to(torch.bfloat16) if t.is_floating_point() else t)(torch.as_tensor(a)))
    B, Sq, D = 16, 160, 448
    H, Sk, Dh = 16, 512, 256
    return {
        "x": _w((lambda *s: torch.randn(*s, dtype=torch.bfloat16) * 0.8)(B, Sq, D)),
        "k_cache": _w((lambda *s: torch.randn(*s, dtype=torch.bfloat16) * 0.8)(B, H, Sk, Dh)),
        "v_cache": _w((lambda *s: torch.randn(*s, dtype=torch.bfloat16) * 0.05)(B, H, Sk, Dh)),
        "wq": _w((lambda *s: torch.randn(*s, dtype=torch.bfloat16) * 0.8)(D, H * Dh) * (D ** -0.5)),
        "wo": _w((lambda *s: torch.randn(*s, dtype=torch.bfloat16) * 0.05)(H * Dh, D) * ((H * Dh) ** -0.5)),
    }

def reference(x, k_cache, v_cache, wq, wo):
    B, Sq, D = x.shape
    H, Dh = 16, 256
    q = (lambda x, *d: x.permute(*d))((x @ wq).reshape(B, Sq, H, Dh), 0, 2, 1, 3)
    scores = torch.einsum("bhqd,bhkd->bhqk", q, k_cache) * (Dh ** -0.5)
    p = _softmax(scores, axis=-1)
    o = torch.einsum("bhqk,bhkd->bhqd", p, v_cache)
    return (lambda x, *d: x.permute(*d))(o, 0, 2, 1, 3).reshape(B, Sq, H * Dh) @ wo
```

```asm
; @launch grid=(256,1,1) block=(256,1,1) lds=163840
.amdgcn_target "amdgcn-amd-amdhsa--gfx950"
.text
.globl standalone__mha_block_cached__near_ridge_kernel
.p2align 8
.type standalone__mha_block_cached__near_ridge_kernel,@function
standalone__mha_block_cached__near_ridge_kernel:
    s_cmp_ge_u32 s2, 256
    s_cbranch_scc1 L_end
    s_load_dwordx4 s[4:7], s[0:1], 0
    s_load_dwordx4 s[8:11], s[0:1], 16
    s_load_dwordx4 s[12:15], s[0:1], 32
    s_load_dwordx4 s[72:75], s[0:1], 48
    s_and_b32 s18, s2, 7
    s_lshr_b32 s19, s2, 3
    s_lshr_b32 s16, s18, 1
    s_lshl_b32 s16, s16, 2
    s_lshr_b32 s68, s19, 3
    s_add_u32 s16, s16, s68
    s_and_b32 s17, s18, 1
    s_lshl_b32 s17, s17, 3
    s_and_b32 s68, s19, 7
    s_add_u32 s17, s17, s68
    v_lshrrev_b32 v36, 6, v0
    v_and_b32 v37, 63, v0
    v_bfe_u32 v38, v0, 5, 1
    v_readfirstlane_b32 s20, v36
    v_lshlrev_b32 v39, 1, v38
    v_xor_b32 v39, v39, v0
    v_and_b32 v39, 31, v39
    v_lshlrev_b32 v41, 4, v39
    v_bfe_u32 v39, v0, 6, 1
    v_lshl_add_u32 v39, v39, 4, v38
    v_lshrrev_b32 v40, 7, v0
    v_lshl_add_u32 v39, v40, 2, v39
    v_lshl_add_u32 v6, v39, 13, v41
    v_add_u32 v7, 15296, v6
    v_add_u32 v8, 63360, v6
    v_add_u32 v9, 78656, v6
    v_lshrrev_b32 v39, 3, v0
    v_mul_u32_u24 v39, 896, v39
    v_lshrrev_b32 v40, 4, v0
    v_xor_b32 v40, v40, v0
    v_and_b32 v40, 7, v40
    v_lshl_add_u32 v14, v40, 4, v39
    s_mul_i32 s21, s20, 4352
    s_lshl_b32 s60, s20, 12
    s_lshl_b32 s61, s20, 10
    s_lshl_b32 s18, s17, 1
    s_add_u32 s18, s18, s16
    s_mul_i32 s19, s18, 37
    s_lshr_b32 s19, s19, 8
    s_mul_i32 s19, s19, 7
    s_sub_u32 s89, s18, s19
    s_lshl_b32 s89, s89, 7
    s_add_u32 s90, s89, 128
    s_cmp_eq_u32 s90, 896
    s_cselect_b32 s90, 0, s90
    s_add_u32 s91, s90, 128
    s_cmp_eq_u32 s91, 896
    s_cselect_b32 s91, 0, s91
    s_add_u32 s92, s91, 128
    s_cmp_eq_u32 s92, 896
    s_cselect_b32 s92, 0, s92
    s_add_u32 s93, s92, 128
    s_cmp_eq_u32 s93, 896
    s_cselect_b32 s93, 0, s93
    s_add_u32 s94, s93, 128
    s_cmp_eq_u32 s94, 896
    s_cselect_b32 s94, 0, s94
    s_add_u32 s95, s94, 128
    s_cmp_eq_u32 s95, 896
    s_cselect_b32 s95, 0, s95
    s_cmp_lt_u32 s20, 2
    s_cselect_b32 s96, s94, s95
    s_lshl_b32 s96, s96, 12
    s_waitcnt lgkmcnt(0)
    s_lshl_b32 s18, s17, 9
    s_add_u32 s28, s10, s18
    s_addc_u32 s29, s11, 0
    s_sub_u32 s30, 3670016, s18
    s_mov_b32 s31, 0x20000
    s_mul_i32 s18, s16, 143360
    s_add_u32 s24, s4, s18
    s_addc_u32 s25, s5, 0
    s_mov_b32 s26, 143360
    s_mov_b32 s27, 0x20000
    s_add_u32 m0, s21, 0
    s_lshl_b32 s22, s89, 12
    buffer_load_dwordx4 v6, s[28:31], s22 offen lds
    buffer_load_dwordx4 v7, s[28:31], s22 offen offset:1088 lds
    buffer_load_dwordx4 v8, s[28:31], s22 offen offset:2176 lds
    buffer_load_dwordx4 v9, s[28:31], s22 offen offset:3264 lds
    s_add_u32 m0, s61, 143360
    s_add_u32 s22, s89, 0
    buffer_load_dwordx4 v14, s[24:27], s22 offen lds
    s_add_u32 m0, s61, 147456
    s_add_u32 s22, s89, 28672
    buffer_load_dwordx4 v14, s[24:27], s22 offen lds
    s_add_u32 m0, s61, 151552
    s_add_u32 s22, s89, 57344
    buffer_load_dwordx4 v14, s[24:27], s22 offen lds
    s_add_u32 m0, s61, 155648
    s_add_u32 s22, s89, 86016
    buffer_load_dwordx4 v14, s[24:27], s22 offen lds
    s_add_u32 m0, s61, 159744
    s_add_u32 s22, s89, 114688
    buffer_load_dwordx4 v14, s[24:27], s22 offen lds
    s_add_u32 m0, s21, 17408
    s_lshl_b32 s22, s89, 12
    s_bitset1_b32 s22, 18
    buffer_load_dwordx4 v6, s[28:31], s22 offen lds
    buffer_load_dwordx4 v7, s[28:31], s22 offen offset:1088 lds
    buffer_load_dwordx4 v8, s[28:31], s22 offen offset:2176 lds
    buffer_load_dwordx4 v9, s[28:31], s22 offen offset:3264 lds
    s_getpc_b64 s[76:77]
L_pc:
    s_sub_u32 s76, s76, L_pc-standalone__mha_block_cached__near_ridge_kernel
    s_subb_u32 s77, s77, 0
    s_lshr_b32 s78, s2, 3
    s_and_b32 s78, s78, 7
    v_lshl_add_u32 v56, v0, 3, s78
    v_lshlrev_b32 v56, 7, v56
    v_min_u32 v56, L_end-standalone__mha_block_cached__near_ridge_kernel, v56
    v_mov_b32 v57, s77
    v_add_co_u32 v56, vcc, s76, v56
    v_addc_co_u32 v57, vcc, 0, v57, vcc
    global_load_dword v58, v[56:57], off
    s_add_u32 s64, s14, s18
    s_addc_u32 s65, s15, 0
    s_mov_b32 s66, 143360
    s_mov_b32 s67, 0x20000
    s_lshl_b32 s18, s16, 4
    s_add_u32 s18, s18, s17
    s_lshl_b32 s19, s18, 18
    s_add_u32 s32, s6, s19
    s_addc_u32 s33, s7, 0
    s_mov_b32 s34, 262144
    s_mov_b32 s35, 0x20000
    s_add_u32 s36, s8, s19
    s_addc_u32 s37, s9, 0
    s_mov_b32 s38, 262144
    s_mov_b32 s39, 0x20000
    s_mul_i32 s19, s17, 229376
    s_add_u32 s40, s12, s19
    s_addc_u32 s41, s13, 0
    s_mov_b32 s42, 229376
    s_mov_b32 s43, 0x20000
    s_mul_i32 s19, s18, 143360
    s_add_u32 s19, s19, 0
    s_add_u32 s44, s74, s19
    s_addc_u32 s45, s75, 0
    s_mov_b32 s46, 143360
    s_mov_b32 s47, 0x20000
    s_mul_i32 s19, s16, 2293760
    s_add_u32 s19, s19, 0
    s_add_u32 s48, s74, s19
    s_addc_u32 s49, s75, 0
    s_mov_b32 s50, 2293760
    s_mov_b32 s51, 0x20000
    s_mul_i32 s19, s16, 1024
    s_add_u32 s19, s19, 37748736
    s_add_u32 s52, s74, s19
    s_addc_u32 s53, s75, 0
    s_mov_b32 s54, 1024
    s_mov_b32 s55, 0x20000
    s_lshl_b32 s19, s16, 2
    s_add_u32 s19, s19, 128
    s_add_u32 s56, s72, s19
    s_addc_u32 s57, s73, 0
    s_mov_b32 s58, 4
    s_mov_b32 s59, 0x20000
    s_xor_b32 s19, s17, 1
    s_mul_i32 s19, s19, 229376
    s_add_u32 s80, s12, s19
    s_addc_u32 s81, s13, 0
    s_mov_b32 s82, 229376
    s_mov_b32 s83, 0x20000
    s_mul_i32 s62, s20, 5120
    s_add_u32 s63, s62, 4096
    s_mov_b32 s23, 0x3db8aa3b
    s_mov_b32 s76, s23
    s_mov_b32 s77, s23
    v_lshrrev_b32 v39, 5, v0
    v_lshl_add_u32 v2, v39, 9, v41
    v_add_u32 v3, 3008, v2
    v_add_u32 v4, 6016, v2
    v_add_u32 v5, 9024, v2
    v_and_b32 v42, 15, v0
    v_bfe_u32 v43, v0, 4, 2
    v_bfe_u32 v44, v0, 2, 2
    v_and_b32 v45, 3, v0
    v_bfe_u32 v46, v0, 6, 1
    v_lshlrev_b32 v47, 1, v43
    v_xor_b32 v47, v47, v0
    v_and_b32 v47, 7, v47
    v_lshlrev_b32 v47, 4, v47
    v_bfe_u32 v39, v0, 3, 3
    v_mul_u32_u24 v39, 1088, v39
    v_lshl_add_u32 v39, v45, 3, v39
    v_lshl_add_u32 v39, v46, 6, v39
    v_and_b32 v40, 1, v44
    v_lshl_add_u32 v39, v40, 9, v39
    v_lshl_add_u32 v15, v40, 5, v39
    v_xor_b32 v40, 1, v40
    v_lshl_add_u32 v16, v40, 5, v39
    v_lshrrev_b32 v39, 7, v0
    v_mul_u32_u24 v39, 80, v39
    v_add_u32 v39, v39, v42
    v_lshlrev_b32 v39, 7, v39
    v_lshrrev_b32 v40, 1, v42
    v_xor_b32 v40, v40, v43
    v_lshl_add_u32 v19, v40, 4, v39
    v_xor_b32 v20, 64, v19
    v_bfe_u32 v39, v0, 2, 4
    v_lshlrev_b32 v39, 7, v39
    v_lshl_add_u32 v39, v45, 3, v39
    v_bfe_u32 v40, v0, 3, 2
    v_lshlrev_b32 v18, 1, v46
    v_xor_b32 v40, v40, v18
    v_lshl_add_u32 v17, v40, 5, v39
    v_xor_b32 v18, 32, v17
    v_bfe_u32 v39, v0, 3, 2
    v_lshl_add_u32 v39, v38, 3, v39
    v_lshl_add_u32 v39, v46, 5, v39
    v_lshl_add_u32 v26, v39, 13, v47
    v_add_u32 v27, 130048, v26
    v_add_u32 v28, 30720, v26
    v_add_u32 v29, 160768, v26
    v_lshrrev_b32 v39, 1, v42
    v_lshl_add_u32 v39, v46, 3, v39
    v_mul_u32_u24 v39, 1088, v39
    v_and_b32 v40, 1, v42
    v_lshl_add_u32 v39, v40, 9, v39
    v_lshlrev_b32 v40, 1, v40
    v_xor_b32 v40, v40, v43
    v_lshl_add_u32 v39, v40, 4, v39
    v_lshl_add_u32 v24, v46, 6, v39
    v_xor_b32 v40, 1, v46
    v_lshl_add_u32 v25, v40, 6, v39
    v_mul_u32_u24 v39, 5120, v36
    v_lshl_add_u32 v22, v37, 4, v39
    v_lshl_add_u32 v39, v42, 4, v39
    v_lshl_add_u32 v39, v38, 8, v39
    v_and_b32 v40, 1, v43
    v_lshl_add_u32 v21, v40, 3, v39
    v_xor_b32 v39, 1, v36
    v_mul_u32_u24 v39, 5120, v39
    v_lshl_add_u32 v23, v37, 4, v39
    s_or_b32 s18, s17, s20
    s_lshl_b32 s18, s18, 24
    v_mul_u32_u24 v31, 256, v43
    v_lshl_add_u32 v31, v42, 2, v31
    v_add_u32 v31, s18, v31
    v_mov_b32 v32, 0
    s_mov_b32 s18, 0
    buffer_store_dword v32, v31, s[52:55], s18 offen sc1
    s_waitcnt vmcnt(6)
    s_barrier
    ds_read_b64_tr_b16 a[200:201], v15
    ds_read_b64_tr_b16 a[202:203], v15 offset:8704
    ds_read_b64_tr_b16 a[204:205], v16
    ds_read_b64_tr_b16 a[206:207], v16 offset:8704
    v_add_u32 v19, 0x23000, v19
    ds_read_b128 a[160:163], v19
    ds_read_b128 a[164:167], v19 offset:2048
    ds_read_b128 a[168:171], v19 offset:4096
    ds_read_b128 a[172:175], v19 offset:6144
    ds_read_b128 a[176:179], v19 offset:8192
    s_waitcnt lgkmcnt(4)
    v_mfma_f32_16x16x32_bf16 v[96:99], a[200:203], a[160:163], 0
    ds_read_b64_tr_b16 a[208:209], v15 offset:128
    s_waitcnt lgkmcnt(4)
    v_mfma_f32_16x16x32_bf16 v[100:103], a[200:203], a[164:167], 0
    ds_read_b64_tr_b16 a[210:211], v15 offset:8832
    s_waitcnt lgkmcnt(4)
    v_mfma_f32_16x16x32_bf16 v[104:107], a[200:203], a[168:171], 0
    s_add_u32 m0, s61, 121856
    s_add_u32 s22, s90, 0
    buffer_load_dwordx4 v14, s[24:27], s22 offen lds
    s_waitcnt lgkmcnt(3)
    v_mfma_f32_16x16x32_bf16 v[108:111], a[200:203], a[172:175], 0
    s_add_u32 m0, s61, 125952
    s_add_u32 s22, s90, 28672
    buffer_load_dwordx4 v14, s[24:27], s22 offen lds
    s_waitcnt lgkmcnt(2)
    v_mfma_f32_16x16x32_bf16 v[112:115], a[200:203], a[176:179], 0
    s_add_u32 m0, s61, 130048
    s_add_u32 s22, s90, 57344
    buffer_load_dwordx4 v14, s[24:27], s22 offen lds
    v_mfma_f32_16x16x32_bf16 v[116:119], a[204:207], a[160:163], 0
    ds_read_b64_tr_b16 a[212:213], v16 offset:128
    ds_read_b64_tr_b16 a[214:215], v16 offset:8832
    v_mfma_f32_16x16x32_bf16 v[120:123], a[204:207], a[164:167], 0
    s_add_u32 m0, s61, 134144
    s_add_u32 s22, s90, 86016
    buffer_load_dwordx4 v14, s[24:27], s22 offen lds
    v_mfma_f32_16x16x32_bf16 v[124:127], a[204:207], a[168:171], 0
    s_add_u32 m0, s61, 138240
    s_add_u32 s22, s90, 114688
    buffer_load_dwordx4 v14, s[24:27], s22 offen lds
    v_mfma_f32_16x16x32_bf16 v[128:131], a[204:207], a[172:175], 0
    ds_read_b64_tr_b16 a[216:217], v15 offset:256
    ds_read_b64_tr_b16 a[218:219], v15 offset:8960
    v_mfma_f32_16x16x32_bf16 v[132:135], a[204:207], a[176:179], 0
    s_add_u32 m0, s21, 34816
    s_lshl_b32 s22, s90, 12
    buffer_load_dwordx4 v6, s[28:31], s22 offen lds
    s_waitcnt lgkmcnt(4)
    v_mfma_f32_16x16x32_bf16 v[136:139], a[208:211], a[160:163], 0
    ds_read_b64_tr_b16 a[220:221], v16 offset:256
    ds_read_b64_tr_b16 a[222:223], v16 offset:8960
    v_mfma_f32_16x16x32_bf16 v[140:143], a[208:211], a[164:167], 0
    buffer_load_dwordx4 v7, s[28:31], s22 offen offset:1088 lds
    v_add_u32 v20, 0x23000, v20
    ds_read_b128 a[180:183], v20
    v_mfma_f32_16x16x32_bf16 v[144:147], a[208:211], a[168:171], 0
    ds_read_b64_tr_b16 a[200:201], v15 offset:384
    ds_read_b64_tr_b16 a[202:203], v15 offset:9088
    v_mfma_f32_16x16x32_bf16 v[148:151], a[208:211], a[172:175], 0
    buffer_load_dwordx4 v8, s[28:31], s22 offen offset:2176 lds
    ds_read_b128 a[184:187], v20 offset:2048
    v_mfma_f32_16x16x32_bf16 v[152:155], a[208:211], a[176:179], 0
    ds_read_b128 a[188:191], v20 offset:4096
    s_waitcnt lgkmcnt(9)
    v_mfma_f32_16x16x32_bf16 v[156:159], a[212:215], a[160:163], 0
    buffer_load_dwordx4 v9, s[28:31], s22 offen offset:3264 lds
    ds_read_b64_tr_b16 a[204:205], v16 offset:384
    v_mfma_f32_16x16x32_bf16 v[160:163], a[212:215], a[164:167], 0
    ds_read_b64_tr_b16 a[206:207], v16 offset:9088
    ds_read_b128 a[192:195], v20 offset:6144
    v_mfma_f32_16x16x32_bf16 v[164:167], a[212:215], a[168:171], 0
    s_add_u32 m0, s60, 69632
    s_add_u32 s22, s96, 384
    buffer_load_dwordx4 v26, s[28:31], s22 offen lds
    v_mfma_f32_16x16x32_bf16 v[168:171], a[212:215], a[172:175], 0
    ds_read_b128 a[196:199], v20 offset:8192
    v_mfma_f32_16x16x32_bf16 v[172:175], a[212:215], a[176:179], 0
    buffer_load_dwordx4 v27, s[28:31], s22 offen offset:1024 lds
    s_waitcnt lgkmcnt(11)
    v_mfma_f32_16x16x32_bf16 v[176:179], a[216:219], a[160:163], 0
    v_mfma_f32_16x16x32_bf16 v[180:183], a[216:219], a[164:167], 0
    buffer_load_dwordx4 v28, s[28:31], s22 offen offset:2048 lds
    v_mfma_f32_16x16x32_bf16 v[184:187], a[216:219], a[168:171], 0
    v_mfma_f32_16x16x32_bf16 v[188:191], a[216:219], a[172:175], 0
    buffer_load_dwordx4 v29, s[28:31], s22 offen offset:3072 lds
    v_mfma_f32_16x16x32_bf16 v[192:195], a[216:219], a[176:179], 0
    s_waitcnt lgkmcnt(9)
    v_mfma_f32_16x16x32_bf16 v[196:199], a[220:223], a[160:163], 0
    s_add_u32 m0, s21, 52224
    s_lshl_b32 s22, s90, 12
    s_bitset1_b32 s22, 18
    buffer_load_dwordx4 v6, s[28:31], s22 offen lds
    v_mfma_f32_16x16x32_bf16 v[200:203], a[220:223], a[164:167], 0
    v_mfma_f32_16x16x32_bf16 v[204:207], a[220:223], a[168:171], 0
    buffer_load_dwordx4 v7, s[28:31], s22 offen offset:1088 lds
    v_mfma_f32_16x16x32_bf16 v[208:211], a[220:223], a[172:175], 0
    v_mfma_f32_16x16x32_bf16 v[212:215], a[220:223], a[176:179], 0
    s_waitcnt vmcnt(10) lgkmcnt(0)
    s_barrier
    v_mfma_f32_16x16x32_bf16 v[216:219], a[200:203], a[160:163], 0
    ds_read_b64_tr_b16 a[208:209], v15 offset:17408
    ds_read_b64_tr_b16 a[210:211], v15 offset:26112
    v_mfma_f32_16x16x32_bf16 v[220:223], a[200:203], a[164:167], 0
    buffer_load_dwordx4 v8, s[28:31], s22 offen offset:2176 lds
    buffer_load_dwordx4 v9, s[28:31], s22 offen offset:3264 lds
    v_mfma_f32_16x16x32_bf16 v[224:227], a[200:203], a[168:171], 0
    ds_read_b64_tr_b16 a[212:213], v16 offset:17408
    ds_read_b64_tr_b16 a[214:215], v16 offset:26112
    v_mfma_f32_16x16x32_bf16 v[228:231], a[200:203], a[172:175], 0
    s_add_u32 m0, s60, 87040
    s_add_u32 s22, s96, 256
    buffer_load_dwordx4 v26, s[28:31], s22 offen lds
    v_mfma_f32_16x16x32_bf16 v[232:235], a[200:203], a[176:179], 0
    ds_read_b64_tr_b16 a[216:217], v15 offset:17536
    ds_read_b64_tr_b16 a[218:219], v15 offset:26240
    v_mfma_f32_16x16x32_bf16 v[236:239], a[204:207], a[160:163], 0
    buffer_load_dwordx4 v27, s[28:31], s22 offen offset:1024 lds
    ds_read_b64_tr_b16 a[220:221], v16 offset:17536
    v_mfma_f32_16x16x32_bf16 v[240:243], a[204:207], a[164:167], 0
    ds_read_b64_tr_b16 a[222:223], v16 offset:26240
    v_add_u32 v19, 0xffffac00, v19
    ds_read_b128 a[120:123], v19
    v_mfma_f32_16x16x32_bf16 v[244:247], a[204:207], a[168:171], 0
    buffer_load_dwordx4 v28, s[28:31], s22 offen offset:2048 lds
    ds_read_b64_tr_b16 a[200:201], v15 offset:17664
    v_mfma_f32_16x16x32_bf16 v[248:251], a[204:207], a[172:175], 0
    ds_read_b64_tr_b16 a[202:203], v15 offset:26368
    ds_read_b128 a[124:127], v19 offset:2048
    v_mfma_f32_16x16x32_bf16 v[252:255], a[204:207], a[176:179], 0
    buffer_load_dwordx4 v29, s[28:31], s22 offen offset:3072 lds
    s_waitcnt lgkmcnt(10)
    v_mfma_f32_16x16x32_bf16 v[96:99], a[208:211], a[180:183], v[96:99]
    ds_read_b128 a[128:131], v19 offset:4096
    ds_read_b128 a[132:135], v19 offset:6144
    v_mfma_f32_16x16x32_bf16 v[100:103], a[208:211], a[184:187], v[100:103]
    s_add_u32 m0, s60, 104448
    s_add_u32 s22, s96, 128
    buffer_load_dwordx4 v26, s[28:31], s22 offen lds
    v_mfma_f32_16x16x32_bf16 v[104:107], a[208:211], a[188:191], v[104:107]
    ds_read_b64_tr_b16 a[204:205], v16 offset:17664
    ds_read_b64_tr_b16 a[206:207], v16 offset:26368
    v_mfma_f32_16x16x32_bf16 v[108:111], a[208:211], a[192:195], v[108:111]
    buffer_load_dwordx4 v27, s[28:31], s22 offen offset:1024 lds
    ds_read_b128 a[136:139], v19 offset:8192
    v_mfma_f32_16x16x32_bf16 v[112:115], a[208:211], a[196:199], v[112:115]
    v_add_u32 v20, 0xffffac00, v20
    ds_read_b128 a[140:143], v20
    s_waitcnt lgkmcnt(14)
    v_mfma_f32_16x16x32_bf16 v[116:119], a[212:215], a[180:183], v[116:119]
    buffer_load_dwordx4 v28, s[28:31], s22 offen offset:2048 lds
    ds_read_b128 a[144:147], v20 offset:2048
    v_mfma_f32_16x16x32_bf16 v[120:123], a[212:215], a[184:187], v[120:123]
    ds_read_b128 a[148:151], v20 offset:4096
    ds_read_b128 a[152:155], v20 offset:6144
    v_mfma_f32_16x16x32_bf16 v[124:127], a[212:215], a[188:191], v[124:127]
    buffer_load_dwordx4 v29, s[28:31], s22 offen offset:3072 lds
    ds_read_b64_tr_b16 a[208:209], v15 offset:17792
    v_mfma_f32_16x16x32_bf16 v[128:131], a[212:215], a[192:195], v[128:131]
    ds_read_b64_tr_b16 a[210:211], v15 offset:26496
    ds_read_b128 a[156:159], v20 offset:8192
    v_mfma_f32_16x16x32_bf16 v[132:135], a[212:215], a[196:199], v[132:135]
    s_waitcnt lgkmcnt(15)
    v_mfma_f32_16x16x32_bf16 v[136:139], a[216:219], a[180:183], v[136:139]
    v_mfma_f32_16x16x32_bf16 v[140:143], a[216:219], a[184:187], v[140:143]
    s_add_u32 m0, s61, 143360
    s_add_u32 s22, s91, 0
    buffer_load_dwordx4 v14, s[24:27], s22 offen lds
    v_mfma_f32_16x16x32_bf16 v[144:147], a[216:219], a[188:191], v[144:147]
    ds_read_b64_tr_b16 a[212:213], v16 offset:17792
    ds_read_b64_tr_b16 a[214:215], v16 offset:26496
    v_mfma_f32_16x16x32_bf16 v[148:151], a[216:219], a[192:195], v[148:151]
    v_mfma_f32_16x16x32_bf16 v[152:155], a[216:219], a[196:199], v[152:155]
    v_mfma_f32_16x16x32_bf16 v[156:159], a[220:223], a[180:183], v[156:159]
    s_add_u32 m0, s61, 147456
    s_add_u32 s22, s91, 28672
    buffer_load_dwordx4 v14, s[24:27], s22 offen lds
    v_mfma_f32_16x16x32_bf16 v[160:163], a[220:223], a[184:187], v[160:163]
    v_mfma_f32_16x16x32_bf16 v[164:167], a[220:223], a[188:191], v[164:167]
    v_mfma_f32_16x16x32_bf16 v[168:171], a[220:223], a[192:195], v[168:171]
    v_mfma_f32_16x16x32_bf16 v[172:175], a[220:223], a[196:199], v[172:175]
    s_add_u32 m0, s61, 151552
    s_add_u32 s22, s91, 57344
    buffer_load_dwordx4 v14, s[24:27], s22 offen lds
    s_waitcnt lgkmcnt(15)
    v_mfma_f32_16x16x32_bf16 v[176:179], a[200:203], a[180:183], v[176:179]
    v_mfma_f32_16x16x32_bf16 v[180:183], a[200:203], a[184:187], v[180:183]
    v_mfma_f32_16x16x32_bf16 v[184:187], a[200:203], a[188:191], v[184:187]
    v_mfma_f32_16x16x32_bf16 v[188:191], a[200:203], a[192:195], v[188:191]
    s_add_u32 m0, s61, 155648
    s_add_u32 s22, s91, 86016
    buffer_load_dwordx4 v14, s[24:27], s22 offen lds
    v_mfma_f32_16x16x32_bf16 v[192:195], a[200:203], a[196:199], v[192:195]
    s_waitcnt lgkmcnt(10)
    v_mfma_f32_16x16x32_bf16 v[196:199], a[204:207], a[180:183], v[196:199]
    v_mfma_f32_16x16x32_bf16 v[200:203], a[204:207], a[184:187], v[200:203]
    v_mfma_f32_16x16x32_bf16 v[204:207], a[204:207], a[188:191], v[204:207]
    s_add_u32 m0, s61, 159744
    s_add_u32 s22, s91, 114688
    buffer_load_dwordx4 v14, s[24:27], s22 offen lds
    v_mfma_f32_16x16x32_bf16 v[208:211], a[204:207], a[192:195], v[208:211]
    v_mfma_f32_16x16x32_bf16 v[212:215], a[204:207], a[196:199], v[212:215]
    s_waitcnt vmcnt(17) lgkmcnt(0)
    s_barrier
    v_mfma_f32_16x16x32_bf16 v[216:219], a[208:211], a[180:183], v[216:219]
    ds_read_b64_tr_b16 a[216:217], v15 offset:34816
    ds_read_b64_tr_b16 a[218:219], v15 offset:43520
    v_mfma_f32_16x16x32_bf16 v[220:223], a[208:211], a[184:187], v[220:223]
    v_add_u32 v17, 0x11000, v17
    ds_read_b64_tr_b16 a[80:81], v17
    v_mfma_f32_16x16x32_bf16 v[224:227], a[208:211], a[188:191], v[224:227]
    s_add_u32 m0, s21, 0
    s_lshl_b32 s22, s91, 12
    buffer_load_dwordx4 v6, s[28:31], s22 offen lds
    v_mfma_f32_16x16x32_bf16 v[228:231], a[208:211], a[192:195], v[228:231]
    ds_read_b64_tr_b16 a[82:83], v17 offset:2048
    ds_read_b64_tr_b16 a[220:221], v16 offset:34816
    v_mfma_f32_16x16x32_bf16 v[232:235], a[208:211], a[196:199], v[232:235]
    ds_read_b64_tr_b16 a[222:223], v16 offset:43520
    v_add_u32 v18, 0x11000, v18
    ds_read_b64_tr_b16 a[84:85], v18
    v_mfma_f32_16x16x32_bf16 v[236:239], a[212:215], a[180:183], v[236:239]
    buffer_load_dwordx4 v7, s[28:31], s22 offen offset:1088 lds
    ds_read_b64_tr_b16 a[86:87], v18 offset:2048
    v_mfma_f32_16x16x32_bf16 v[240:243], a[212:215], a[184:187], v[240:243]
    ds_read_b64_tr_b16 a[200:201], v15 offset:34944
    ds_read_b64_tr_b16 a[202:203], v15 offset:43648
    v_mfma_f32_16x16x32_bf16 v[244:247], a[212:215], a[188:191], v[244:247]
    ds_read_b64_tr_b16 a[88:89], v17 offset:4096
    ds_read_b64_tr_b16 a[90:91], v17 offset:6144
    v_mfma_f32_16x16x32_bf16 v[248:251], a[212:215], a[192:195], v[248:251]
    ds_read_b64_tr_b16 a[92:93], v18 offset:4096
    ds_read_b64_tr_b16 a[204:205], v16 offset:34944
    v_mfma_f32_16x16x32_bf16 v[252:255], a[212:215], a[196:199], v[252:255]
    buffer_load_dwordx4 v8, s[28:31], s22 offen offset:2176 lds
    s_waitcnt lgkmcnt(12)
    v_mfma_f32_16x16x32_bf16 v[96:99], a[216:219], a[120:123], v[96:99]
    ds_read_b64_tr_b16 a[206:207], v16 offset:43648
    ds_read_b64_tr_b16 a[94:95], v18 offset:6144
    v_mfma_f32_16x16x32_bf16 v[100:103], a[216:219], a[124:127], v[100:103]
    ds_read_b64_tr_b16 a[96:97], v17 offset:8192
    ds_read_b64_tr_b16 a[98:99], v17 offset:10240
    v_mfma_f32_16x16x32_bf16 v[104:107], a[216:219], a[128:131], v[104:107]
    ds_read_b64_tr_b16 a[208:209], v15 offset:35072
    ds_read_b64_tr_b16 a[210:211], v15 offset:43776
    v_mfma_f32_16x16x32_bf16 v[108:111], a[216:219], a[132:135], v[108:111]
    buffer_load_dwordx4 v9, s[28:31], s22 offen offset:3264 lds
    ds_read_b64_tr_b16 a[100:101], v18 offset:8192
    v_mfma_f32_16x16x32_bf16 v[112:115], a[216:219], a[136:139], v[112:115]
    ds_read_b64_tr_b16 a[102:103], v18 offset:10240
    s_waitcnt lgkmcnt(15)
    v_mfma_f32_16x16x32_bf16 v[116:119], a[220:223], a[120:123], v[116:119]
    ds_read_b64_tr_b16 a[212:213], v16 offset:35072
    ds_read_b64_tr_b16 a[214:215], v16 offset:43776
    v_mfma_f32_16x16x32_bf16 v[120:123], a[220:223], a[124:127], v[120:123]
    ds_read_b64_tr_b16 a[104:105], v17 offset:12288
    ds_read_b64_tr_b16 a[106:107], v17 offset:14336
    v_mfma_f32_16x16x32_bf16 v[124:127], a[220:223], a[128:131], v[124:127]
    s_add_u32 m0, s61, 121856
    s_add_u32 s22, s92, 0
    buffer_load_dwordx4 v14, s[24:27], s22 offen lds
    v_mfma_f32_16x16x32_bf16 v[128:131], a[220:223], a[132:135], v[128:131]
    ds_read_b64_tr_b16 a[108:109], v18 offset:12288
    ds_read_b64_tr_b16 a[216:217], v15 offset:35200
    v_mfma_f32_16x16x32_bf16 v[132:135], a[220:223], a[136:139], v[132:135]
    ds_read_b64_tr_b16 a[218:219], v15 offset:43904
    s_waitcnt lgkmcnt(15)
    v_mfma_f32_16x16x32_bf16 v[136:139], a[200:203], a[120:123], v[136:139]
    ds_read_b64_tr_b16 a[110:111], v18 offset:14336
    v_mfma_f32_16x16x32_bf16 v[140:143], a[200:203], a[124:127], v[140:143]
    s_add_u32 m0, s61, 125952
    s_add_u32 s22, s92, 28672
    buffer_load_dwordx4 v14, s[24:27], s22 offen lds
    v_mfma_f32_16x16x32_bf16 v[144:147], a[200:203], a[128:131], v[144:147]
    ds_read_b64_tr_b16 a[220:221], v16 offset:35200
    ds_read_b64_tr_b16 a[222:223], v16 offset:43904
    v_mfma_f32_16x16x32_bf16 v[148:151], a[200:203], a[132:135], v[148:151]
    v_mfma_f32_16x16x32_bf16 v[152:155], a[200:203], a[136:139], v[152:155]
    s_waitcnt lgkmcnt(15)
    v_mfma_f32_16x16x32_bf16 v[156:159], a[204:207], a[120:123], v[156:159]
    s_add_u32 m0, s61, 130048
    s_add_u32 s22, s92, 57344
    buffer_load_dwordx4 v14, s[24:27], s22 offen lds
    v_mfma_f32_16x16x32_bf16 v[160:163], a[204:207], a[124:127], v[160:163]
    v_mfma_f32_16x16x32_bf16 v[164:167], a[204:207], a[128:131], v[164:167]
    v_mfma_f32_16x16x32_bf16 v[168:171], a[204:207], a[132:135], v[168:171]
    v_mfma_f32_16x16x32_bf16 v[172:175], a[204:207], a[136:139], v[172:175]
    s_add_u32 m0, s61, 134144
    s_add_u32 s22, s92, 86016
    buffer_load_dwordx4 v14, s[24:27], s22 offen lds
    s_waitcnt lgkmcnt(12)
    v_mfma_f32_16x16x32_bf16 v[176:179], a[208:211], a[120:123], v[176:179]
    v_mfma_f32_16x16x32_bf16 v[180:183], a[208:211], a[124:127], v[180:183]
    v_mfma_f32_16x16x32_bf16 v[184:187], a[208:211], a[128:131], v[184:187]
    v_mfma_f32_16x16x32_bf16 v[188:191], a[208:211], a[132:135], v[188:191]
    s_add_u32 m0, s61, 138240
    s_add_u32 s22, s92, 114688
    buffer_load_dwordx4 v14, s[24:27], s22 offen lds
    v_mfma_f32_16x16x32_bf16 v[192:195], a[208:211], a[136:139], v[192:195]
    s_waitcnt lgkmcnt(8)
    v_mfma_f32_16x16x32_bf16 v[196:199], a[212:215], a[120:123], v[196:199]
    v_mfma_f32_16x16x32_bf16 v[200:203], a[212:215], a[124:127], v[200:203]
    v_mfma_f32_16x16x32_bf16 v[204:207], a[212:215], a[128:131], v[204:207]
    s_add_u32 m0, s21, 17408
    s_lshl_b32 s22, s91, 12
    s_bitset1_b32 s22, 18
    buffer_load_dwordx4 v6, s[28:31], s22 offen lds
    v_mfma_f32_16x16x32_bf16 v[208:211], a[212:215], a[132:135], v[208:211]
    v_mfma_f32_16x16x32_bf16 v[212:215], a[212:215], a[136:139], v[212:215]
    s_waitcnt vmcnt(10) lgkmcnt(0)
    s_barrier
    v_mfma_f32_16x16x32_bf16 v[216:219], a[216:219], a[120:123], v[216:219]
    ds_read_b64_tr_b16 a[200:201], v15 offset:52224
    ds_read_b64_tr_b16 a[202:203], v15 offset:60928
    v_mfma_f32_16x16x32_bf16 v[220:223], a[216:219], a[124:127], v[220:223]
    ds_read_b64_tr_b16 a[40:41], v17 offset:17408
    buffer_load_dwordx4 v7, s[28:31], s22 offen offset:1088 lds
    v_mfma_f32_16x16x32_bf16 v[224:227], a[216:219], a[128:131], v[224:227]
    ds_read_b64_tr_b16 a[42:43], v17 offset:19456
    ds_read_b64_tr_b16 a[204:205], v16 offset:52224
    v_mfma_f32_16x16x32_bf16 v[228:231], a[216:219], a[132:135], v[228:231]
    ds_read_b64_tr_b16 a[206:207], v16 offset:60928
    ds_read_b64_tr_b16 a[44:45], v18 offset:17408
    v_mfma_f32_16x16x32_bf16 v[232:235], a[216:219], a[136:139], v[232:235]
    ds_read_b64_tr_b16 a[46:47], v18 offset:19456
    ds_read_b64_tr_b16 a[208:209], v15 offset:52352
    v_mfma_f32_16x16x32_bf16 v[236:239], a[220:223], a[120:123], v[236:239]
    buffer_load_dwordx4 v8, s[28:31], s22 offen offset:2176 lds
    ds_read_b64_tr_b16 a[210:211], v15 offset:61056
    v_mfma_f32_16x16x32_bf16 v[240:243], a[220:223], a[124:127], v[240:243]
    ds_read_b64_tr_b16 a[48:49], v17 offset:21504
    ds_read_b64_tr_b16 a[50:51], v17 offset:23552
    v_mfma_f32_16x16x32_bf16 v[244:247], a[220:223], a[128:131], v[244:247]
    ds_read_b64_tr_b16 a[52:53], v18 offset:21504
    ds_read_b64_tr_b16 a[212:213], v16 offset:52352
    v_mfma_f32_16x16x32_bf16 v[248:251], a[220:223], a[132:135], v[248:251]
    ds_read_b64_tr_b16 a[214:215], v16 offset:61056
    ds_read_b64_tr_b16 a[54:55], v18 offset:23552
    v_mfma_f32_16x16x32_bf16 v[252:255], a[220:223], a[136:139], v[252:255]
    buffer_load_dwordx4 v9, s[28:31], s22 offen offset:3264 lds
    s_waitcnt lgkmcnt(14)
    v_mfma_f32_16x16x32_bf16 v[96:99], a[200:203], a[140:143], v[96:99]
    ds_read_b64_tr_b16 a[56:57], v17 offset:25600
    ds_read_b64_tr_b16 a[58:59], v17 offset:27648
    v_mfma_f32_16x16x32_bf16 v[100:103], a[200:203], a[144:147], v[100:103]
    ds_read_b64_tr_b16 a[216:217], v15 offset:52480
    ds_read_b64_tr_b16 a[218:219], v15 offset:61184
    v_mfma_f32_16x16x32_bf16 v[104:107], a[200:203], a[148:151], v[104:107]
    ds_read_b64_tr_b16 a[60:61], v18 offset:25600
    ds_read_b64_tr_b16 a[62:63], v18 offset:27648
    v_mfma_f32_16x16x32_bf16 v[108:111], a[200:203], a[152:155], v[108:111]
    s_add_u32 m0, s21, 34816
    s_lshl_b32 s22, s92, 12
    buffer_load_dwordx4 v6, s[28:31], s22 offen lds
    v_mfma_f32_16x16x32_bf16 v[112:115], a[200:203], a[156:159], v[112:115]
    ds_read_b64_tr_b16 a[220:221], v16 offset:52480
    s_waitcnt lgkmcnt(15)
    v_mfma_f32_16x16x32_bf16 v[116:119], a[204:207], a[140:143], v[116:119]
    ds_read_b64_tr_b16 a[222:223], v16 offset:61184
    ds_read_b64_tr_b16 a[64:65], v17 offset:29696
    v_mfma_f32_16x16x32_bf16 v[120:123], a[204:207], a[144:147], v[120:123]
    ds_read_b64_tr_b16 a[66:67], v17 offset:31744
    ds_read_b128 a[160:163], v19 offset:21504
    v_mfma_f32_16x16x32_bf16 v[124:127], a[204:207], a[148:151], v[124:127]
    buffer_load_dwordx4 v7, s[28:31], s22 offen offset:1088 lds
    ds_read_b128 a[164:167], v19 offset:23552
    v_mfma_f32_16x16x32_bf16 v[128:131], a[204:207], a[152:155], v[128:131]
    ds_read_b128 a[168:171], v19 offset:25600
    ds_read_b128 a[172:175], v19 offset:27648
    v_mfma_f32_16x16x32_bf16 v[132:135], a[204:207], a[156:159], v[132:135]
    ds_read_b64_tr_b16 a[68:69], v18 offset:29696
    s_waitcnt lgkmcnt(15)
    v_mfma_f32_16x16x32_bf16 v[136:139], a[208:211], a[140:143], v[136:139]
    ds_read_b128 a[176:179], v19 offset:29696
    ds_read_b128 a[180:183], v20 offset:21504
    v_mfma_f32_16x16x32_bf16 v[140:143], a[208:211], a[144:147], v[140:143]
    buffer_load_dwordx4 v8, s[28:31], s22 offen offset:2176 lds
    ds_read_b64_tr_b16 a[200:201], v15 offset:52608
    v_mfma_f32_16x16x32_bf16 v[144:147], a[208:211], a[148:151], v[144:147]
    ds_read_b64_tr_b16 a[202:203], v15 offset:61312
    ds_read_b128 a[184:187], v20 offset:23552
    v_mfma_f32_16x16x32_bf16 v[148:151], a[208:211], a[152:155], v[148:151]
    ds_read_b128 a[188:191], v20 offset:25600
    ds_read_b64_tr_b16 a[204:205], v16 offset:52608
    v_mfma_f32_16x16x32_bf16 v[152:155], a[208:211], a[156:159], v[152:155]
    ds_read_b64_tr_b16 a[206:207], v16 offset:61312
    ds_read_b64_tr_b16 a[70:71], v18 offset:31744
    v_mfma_f32_16x16x32_bf16 v[156:159], a[212:215], a[140:143], v[156:159]
    buffer_load_dwordx4 v9, s[28:31], s22 offen offset:3264 lds
    ds_read_b128 a[192:195], v20 offset:27648
    v_mfma_f32_16x16x32_bf16 v[160:163], a[212:215], a[144:147], v[160:163]
    ds_read_b128 a[196:199], v20 offset:29696
    v_mfma_f32_16x16x32_bf16 v[164:167], a[212:215], a[148:151], v[164:167]
    v_mfma_f32_16x16x32_bf16 v[168:171], a[212:215], a[152:155], v[168:171]
    v_mfma_f32_16x16x32_bf16 v[172:175], a[212:215], a[156:159], v[172:175]
    s_add_u32 m0, s21, 69632
    s_lshl_b32 s22, s92, 12
    s_bitset1_b32 s22, 18
    buffer_load_dwordx4 v6, s[28:31], s22 offen lds
    s_waitcnt lgkmcnt(15)
    v_mfma_f32_16x16x32_bf16 v[176:179], a[216:219], a[140:143], v[176:179]
    v_mfma_f32_16x16x32_bf16 v[180:183], a[216:219], a[144:147], v[180:183]
    v_mfma_f32_16x16x32_bf16 v[184:187], a[216:219], a[148:151], v[184:187]
    v_mfma_f32_16x16x32_bf16 v[188:191], a[216:219], a[152:155], v[188:191]
    buffer_load_dwordx4 v7, s[28:31], s22 offen offset:1088 lds
    v_mfma_f32_16x16x32_bf16 v[192:195], a[216:219], a[156:159], v[192:195]
    v_mfma_f32_16x16x32_bf16 v[196:199], a[220:223], a[140:143], v[196:199]
    v_mfma_f32_16x16x32_bf16 v[200:203], a[220:223], a[144:147], v[200:203]
    v_mfma_f32_16x16x32_bf16 v[204:207], a[220:223], a[148:151], v[204:207]
    buffer_load_dwordx4 v8, s[28:31], s22 offen offset:2176 lds
    v_mfma_f32_16x16x32_bf16 v[208:211], a[220:223], a[152:155], v[208:211]
    v_mfma_f32_16x16x32_bf16 v[212:215], a[220:223], a[156:159], v[212:215]
    s_waitcnt vmcnt(11) lgkmcnt(0)
    s_barrier
    v_mfma_f32_16x16x32_bf16 v[216:219], a[200:203], a[140:143], v[216:219]
    ds_read_b64_tr_b16 a[208:209], v15
    ds_read_b64_tr_b16 a[210:211], v15 offset:8704
    v_mfma_f32_16x16x32_bf16 v[220:223], a[200:203], a[144:147], v[220:223]
    ds_read_b64_tr_b16 v[48:49], v17 offset:34816
    buffer_load_dwordx4 v9, s[28:31], s22 offen offset:3264 lds
    v_mfma_f32_16x16x32_bf16 v[224:227], a[200:203], a[148:151], v[224:227]
    ds_read_b64_tr_b16 v[50:51], v17 offset:36864
    ds_read_b64_tr_b16 a[212:213], v16
    v_mfma_f32_16x16x32_bf16 v[228:231], a[200:203], a[152:155], v[228:231]
    ds_read_b64_tr_b16 a[214:215], v16 offset:8704
    ds_read_b64_tr_b16 v[52:53], v18 offset:34816
    v_mfma_f32_16x16x32_bf16 v[232:235], a[200:203], a[156:159], v[232:235]
    ds_read_b64_tr_b16 v[54:55], v18 offset:36864
    ds_read_b64_tr_b16 a[216:217], v15 offset:128
    v_mfma_f32_16x16x32_bf16 v[236:239], a[204:207], a[140:143], v[236:239]
    s_add_u32 m0, s61, 143360
    s_add_u32 s22, s93, 0
    buffer_load_dwordx4 v14, s[24:27], s22 offen lds
    v_mfma_f32_16x16x32_bf16 v[240:243], a[204:207], a[144:147], v[240:243]
    ds_read_b64_tr_b16 a[218:219], v15 offset:8832
    ds_read_b64_tr_b16 v[88:89], v17 offset:38912
    v_mfma_f32_16x16x32_bf16 v[244:247], a[204:207], a[148:151], v[244:247]
    ds_read_b64_tr_b16 v[90:91], v17 offset:40960
    ds_read_b64_tr_b16 v[92:93], v18 offset:38912
    v_mfma_f32_16x16x32_bf16 v[248:251], a[204:207], a[152:155], v[248:251]
    ds_read_b64_tr_b16 a[220:221], v16 offset:128
    ds_read_b64_tr_b16 a[222:223], v16 offset:8832
    v_mfma_f32_16x16x32_bf16 v[252:255], a[204:207], a[156:159], v[252:255]
    s_add_u32 m0, s61, 147456
    s_add_u32 s22, s93, 28672
    buffer_load_dwordx4 v14, s[24:27], s22 offen lds
    s_waitcnt lgkmcnt(13)
    v_mfma_f32_16x16x32_bf16 v[96:99], a[208:211], a[160:163], v[96:99]
    ds_read_b64_tr_b16 v[94:95], v18 offset:40960
    ds_read_b64_tr_b16 a[72:73], v17 offset:43008
    v_mfma_f32_16x16x32_bf16 v[100:103], a[208:211], a[164:167], v[100:103]
    v_mov_b32 v32, 1
    buffer_store_dword v32, v31, s[56:59], 0 offen sc1
    v_mfma_f32_16x16x32_bf16 v[104:107], a[208:211], a[168:171], v[104:107]
    ds_read_b64_tr_b16 a[74:75], v17 offset:45056
    ds_read_b64_tr_b16 a[200:201], v15 offset:256
    v_mfma_f32_16x16x32_bf16 v[108:111], a[208:211], a[172:175], v[108:111]
    s_add_u32 m0, s61, 151552
    s_add_u32 s22, s93, 57344
    buffer_load_dwordx4 v14, s[24:27], s22 offen lds
    v_mfma_f32_16x16x32_bf16 v[112:115], a[208:211], a[176:179], v[112:115]
    ds_read_b64_tr_b16 a[202:203], v15 offset:8960
    s_waitcnt lgkmcnt(14)
    v_mfma_f32_16x16x32_bf16 v[116:119], a[212:215], a[160:163], v[116:119]
    ds_read_b64_tr_b16 a[76:77], v18 offset:43008
    ds_read_b64_tr_b16 a[78:79], v18 offset:45056
    v_mfma_f32_16x16x32_bf16 v[120:123], a[212:215], a[164:167], v[120:123]
    ds_read_b64_tr_b16 a[204:205], v16 offset:256
    ds_read_b64_tr_b16 a[206:207], v16 offset:8960
    v_mfma_f32_16x16x32_bf16 v[124:127], a[212:215], a[168:171], v[124:127]
    s_add_u32 m0, s61, 155648
    s_add_u32 s22, s93, 86016
    buffer_load_dwordx4 v14, s[24:27], s22 offen lds
    v_mfma_f32_16x16x32_bf16 v[128:131], a[212:215], a[172:175], v[128:131]
    ds_read_b64_tr_b16 a[112:113], v17 offset:47104
    ds_read_b64_tr_b16 a[114:115], v17 offset:49152
    v_mfma_f32_16x16x32_bf16 v[132:135], a[212:215], a[176:179], v[132:135]
    ds_read_b128 a[120:123], v19
    s_waitcnt lgkmcnt(15)
    v_mfma_f32_16x16x32_bf16 v[136:139], a[216:219], a[160:163], v[136:139]
    ds_read_b128 a[124:127], v19 offset:2048
    ds_read_b128 a[128:131], v19 offset:4096
    v_mfma_f32_16x16x32_bf16 v[140:143], a[216:219], a[164:167], v[140:143]
    s_add_u32 m0, s61, 159744
    s_add_u32 s22, s93, 114688
    buffer_load_dwordx4 v14, s[24:27], s22 offen lds
    v_mfma_f32_16x16x32_bf16 v[144:147], a[216:219], a[168:171], v[144:147]
    ds_read_b128 a[132:135], v19 offset:6144
    ds_read_b64_tr_b16 a[116:117], v18 offset:47104
    v_mfma_f32_16x16x32_bf16 v[148:151], a[216:219], a[172:175], v[148:151]
    ds_read_b128 a[136:139], v19 offset:8192
    ds_read_b128 a[140:143], v20
    v_mfma_f32_16x16x32_bf16 v[152:155], a[216:219], a[176:179], v[152:155]
    ds_read_b64_tr_b16 a[208:209], v15 offset:384
    s_waitcnt lgkmcnt(15)
    v_mfma_f32_16x16x32_bf16 v[156:159], a[220:223], a[160:163], v[156:159]
    s_add_u32 m0, s21, 87040
    s_lshl_b32 s22, s93, 12
    buffer_load_dwordx4 v6, s[28:31], s22 offen lds
    v_mfma_f32_16x16x32_bf16 v[160:163], a[220:223], a[164:167], v[160:163]
    ds_read_b64_tr_b16 a[210:211], v15 offset:9088
    ds_read_b128 a[144:147], v20 offset:2048
    v_mfma_f32_16x16x32_bf16 v[164:167], a[220:223], a[168:171], v[164:167]
    ds_read_b128 a[148:151], v20 offset:4096
    ds_read_b64_tr_b16 a[212:213], v16 offset:384
    v_mfma_f32_16x16x32_bf16 v[168:171], a[220:223], a[172:175], v[168:171]
    ds_read_b64_tr_b16 a[214:215], v16 offset:9088
    ds_read_b64_tr_b16 a[118:119], v18 offset:49152
    v_mfma_f32_16x16x32_bf16 v[172:175], a[220:223], a[176:179], v[172:175]
    buffer_load_dwordx4 v7, s[28:31], s22 offen offset:1088 lds
    s_waitcnt lgkmcnt(15)
    v_mfma_f32_16x16x32_bf16 v[176:179], a[200:203], a[160:163], v[176:179]
    ds_read_b128 a[152:155], v20 offset:6144
    ds_read_b128 a[156:159], v20 offset:8192
    v_mfma_f32_16x16x32_bf16 v[180:183], a[200:203], a[164:167], v[180:183]
    v_mfma_f32_16x16x32_bf16 v[184:187], a[200:203], a[168:171], v[184:187]
    v_mfma_f32_16x16x32_bf16 v[188:191], a[200:203], a[172:175], v[188:191]
    buffer_load_dwordx4 v8, s[28:31], s22 offen offset:2176 lds
    v_mfma_f32_16x16x32_bf16 v[192:195], a[200:203], a[176:179], v[192:195]
    v_mfma_f32_16x16x32_bf16 v[196:199], a[204:207], a[160:163], v[196:199]
    v_mfma_f32_16x16x32_bf16 v[200:203], a[204:207], a[164:167], v[200:203]
    v_mfma_f32_16x16x32_bf16 v[204:207], a[204:207], a[168:171], v[204:207]
    buffer_load_dwordx4 v9, s[28:31], s22 offen offset:3264 lds
    v_mfma_f32_16x16x32_bf16 v[208:211], a[204:207], a[172:175], v[208:211]
    v_mfma_f32_16x16x32_bf16 v[212:215], a[204:207], a[176:179], v[212:215]
    s_waitcnt vmcnt(18) lgkmcnt(0)
    s_barrier
    v_mfma_f32_16x16x32_bf16 v[216:219], a[208:211], a[160:163], v[216:219]
    ds_read_b64_tr_b16 a[216:217], v15 offset:17408
    ds_read_b64_tr_b16 a[218:219], v15 offset:26112
    v_mfma_f32_16x16x32_bf16 v[220:223], a[208:211], a[164:167], v[220:223]
    s_add_u32 m0, s21, 0
    s_mov_b32 s22, 0
    buffer_load_dwordx4 v2, s[32:35], s22 offen nt lds
    v_mfma_f32_16x16x32_bf16 v[224:227], a[208:211], a[168:171], v[224:227]
    s_add_u32 m0, s21, 52224
    s_lshl_b32 s22, s93, 12
    s_bitset1_b32 s22, 18
    buffer_load_dwordx4 v6, s[28:31], s22 offen lds
    v_mfma_f32_16x16x32_bf16 v[228:231], a[208:211], a[172:175], v[228:231]
    ds_read_b64_tr_b16 a[220:221], v16 offset:17408
    ds_read_b64_tr_b16 a[222:223], v16 offset:26112
    v_mfma_f32_16x16x32_bf16 v[232:235], a[208:211], a[176:179], v[232:235]
    ds_read_b64_tr_b16 a[200:201], v15 offset:17536
    ds_read_b64_tr_b16 a[202:203], v15 offset:26240
    v_mfma_f32_16x16x32_bf16 v[236:239], a[212:215], a[160:163], v[236:239]
    buffer_load_dwordx4 v7, s[28:31], s22 offen offset:1088 lds
    ds_read_b64_tr_b16 a[204:205], v16 offset:17536
    v_mfma_f32_16x16x32_bf16 v[240:243], a[212:215], a[164:167], v[240:243]
    ds_read_b64_tr_b16 a[206:207], v16 offset:26240
    v_mfma_f32_16x16x32_bf16 v[244:247], a[212:215], a[168:171], v[244:247]
    s_add_u32 m0, s21, 0
    s_mov_b32 s22, 0
    buffer_load_dwordx4 v3, s[32:35], s22 offen offset:1088 nt lds
    v_mfma_f32_16x16x32_bf16 v[248:251], a[212:215], a[172:175], v[248:251]
    ds_read_b64_tr_b16 a[208:209], v15 offset:17664
    ds_read_b64_tr_b16 a[210:211], v15 offset:26368
    v_mfma_f32_16x16x32_bf16 v[252:255], a[212:215], a[176:179], v[252:255]
    s_add_u32 m0, s21, 52224
    s_lshl_b32 s22, s93, 12
    s_bitset1_b32 s22, 18
    buffer_load_dwordx4 v8, s[28:31], s22 offen offset:2176 lds
    s_waitcnt lgkmcnt(8)
    v_mfma_f32_16x16x32_bf16 v[96:99], a[216:219], a[180:183], v[96:99]
    v_mfma_f32_16x16x32_bf16 v[100:103], a[216:219], a[184:187], v[100:103]
    v_mfma_f32_16x16x32_bf16 v[104:107], a[216:219], a[188:191], v[104:107]
    ds_read_b64_tr_b16 a[212:213], v16 offset:17664
    ds_read_b64_tr_b16 a[214:215], v16 offset:26368
    v_mfma_f32_16x16x32_bf16 v[108:111], a[216:219], a[192:195], v[108:111]
    buffer_load_dwordx4 v9, s[28:31], s22 offen offset:3264 lds
    v_mfma_f32_16x16x32_bf16 v[112:115], a[216:219], a[196:199], v[112:115]
    s_waitcnt lgkmcnt(8)
    v_mfma_f32_16x16x32_bf16 v[116:119], a[220:223], a[180:183], v[116:119]
    s_add_u32 m0, s21, 0
    s_mov_b32 s22, 0
    buffer_load_dwordx4 v4, s[32:35], s22 offen offset:2176 nt lds
    v_mfma_f32_16x16x32_bf16 v[120:123], a[220:223], a[184:187], v[120:123]
    v_mfma_f32_16x16x32_bf16 v[124:127], a[220:223], a[188:191], v[124:127]
    s_add_u32 m0, s61, 121856
    s_add_u32 s22, s94, 0
    buffer_load_dwordx4 v14, s[24:27], s22 offen lds
    v_mfma_f32_16x16x32_bf16 v[128:131], a[220:223], a[192:195], v[128:131]
    ds_read_b64_tr_b16 a[216:217], v15 offset:17792
    ds_read_b64_tr_b16 a[218:219], v15 offset:26496
    v_mfma_f32_16x16x32_bf16 v[132:135], a[220:223], a[196:199], v[132:135]
    s_waitcnt lgkmcnt(8)
    v_mfma_f32_16x16x32_bf16 v[136:139], a[200:203], a[180:183], v[136:139]
    v_mfma_f32_16x16x32_bf16 v[140:143], a[200:203], a[184:187], v[140:143]
    s_add_u32 m0, s61, 125952
    s_add_u32 s22, s94, 28672
    buffer_load_dwordx4 v14, s[24:27], s22 offen lds
    v_mfma_f32_16x16x32_bf16 v[144:147], a[200:203], a[188:191], v[144:147]
    ds_read_b64_tr_b16 a[220:221], v16 offset:17792
    ds_read_b64_tr_b16 a[222:223], v16 offset:26496
    v_mfma_f32_16x16x32_bf16 v[148:151], a[200:203], a[192:195], v[148:151]
    s_add_u32 m0, s21, 0
    s_mov_b32 s22, 0
    buffer_load_dwordx4 v5, s[32:35], s22 offen offset:3264 nt lds
    v_mfma_f32_16x16x32_bf16 v[152:155], a[200:203], a[196:199], v[152:155]
    v_bfe_u32 v39, v0, 3, 3
    s_waitcnt lgkmcnt(8)
    v_mfma_f32_16x16x32_bf16 v[156:159], a[204:207], a[180:183], v[156:159]
    s_add_u32 m0, s61, 130048
    s_add_u32 s22, s94, 57344
    buffer_load_dwordx4 v14, s[24:27], s22 offen lds
    v_mfma_f32_16x16x32_bf16 v[160:163], a[204:207], a[184:187], v[160:163]
    v_mul_u32_u24 v39, 1088, v39
    v_lshl_add_u32 v39, v45, 3, v39
    v_mfma_f32_16x16x32_bf16 v[164:167], a[204:207], a[188:191], v[164:167]
    v_lshl_add_u32 v39, v46, 6, v39
    v_and_b32 v40, 1, v44
    v_mfma_f32_16x16x32_bf16 v[168:171], a[204:207], a[192:195], v[168:171]
    v_lshl_add_u32 v39, v40, 9, v39
    v_lshl_add_u32 v10, v40, 5, v39
    v_mfma_f32_16x16x32_bf16 v[172:175], a[204:207], a[196:199], v[172:175]
    s_add_u32 m0, s61, 134144
    s_add_u32 s22, s94, 86016
    buffer_load_dwordx4 v14, s[24:27], s22 offen lds
    s_waitcnt lgkmcnt(6)
    v_mfma_f32_16x16x32_bf16 v[176:179], a[208:211], a[180:183], v[176:179]
    v_xor_b32 v40, 1, v40
    v_lshl_add_u32 v11, v40, 5, v39
    v_mfma_f32_16x16x32_bf16 v[180:183], a[208:211], a[184:187], v[180:183]
    v_xor_b32 v40, 1, v46
    v_mul_u32_u24 v40, 8704, v40
    v_mfma_f32_16x16x32_bf16 v[184:187], a[208:211], a[188:191], v[184:187]
    v_mul_u32_u24 v39, 8704, v46
    v_add_u32 v12, v40, v10
    v_mfma_f32_16x16x32_bf16 v[188:191], a[208:211], a[192:195], v[188:191]
    s_add_u32 m0, s61, 138240
    s_add_u32 s22, s94, 114688
    buffer_load_dwordx4 v14, s[24:27], s22 offen lds
    v_mfma_f32_16x16x32_bf16 v[192:195], a[208:211], a[196:199], v[192:195]
    v_add_u32 v10, v39, v10
    s_waitcnt lgkmcnt(4)
    v_mfma_f32_16x16x32_bf16 v[196:199], a[212:215], a[180:183], v[196:199]
    v_add_u32 v13, v40, v11
    v_add_u32 v11, v39, v11
    v_mfma_f32_16x16x32_bf16 v[200:203], a[212:215], a[184:187], v[200:203]
    v_mfma_f32_16x16x32_bf16 v[204:207], a[212:215], a[188:191], v[204:207]
    s_add_u32 m0, s60, 104448
    s_add_u32 s22, s96, 0
    buffer_load_dwordx4 v26, s[28:31], s22 offen lds
    v_mfma_f32_16x16x32_bf16 v[208:211], a[212:215], a[192:195], v[208:211]
    v_mfma_f32_16x16x32_bf16 v[212:215], a[212:215], a[196:199], v[212:215]
    s_waitcnt vmcnt(18) lgkmcnt(0)
    s_barrier
    v_mfma_f32_16x16x32_bf16 v[216:219], a[216:219], a[180:183], v[216:219]
    ds_read_b64_tr_b16 a[200:201], v15 offset:34816
    ds_read_b64_tr_b16 a[202:203], v15 offset:43520
    v_mfma_f32_16x16x32_bf16 v[220:223], a[216:219], a[184:187], v[220:223]
    s_add_u32 m0, s21, 17408
    s_mov_b32 s22, 0
    buffer_load_dwordx4 v2, s[36:39], s22 offen nt lds
    v_mfma_f32_16x16x32_bf16 v[224:227], a[216:219], a[188:191], v[224:227]
    s_add_u32 m0, s60, 104448
    s_add_u32 s22, s96, 0
    buffer_load_dwordx4 v27, s[28:31], s22 offen offset:1024 lds
    v_mfma_f32_16x16x32_bf16 v[228:231], a[216:219], a[192:195], v[228:231]
    ds_read_b64_tr_b16 a[204:205], v16 offset:34816
    ds_read_b64_tr_b16 a[206:207], v16 offset:43520
    v_mfma_f32_16x16x32_bf16 v[232:235], a[216:219], a[196:199], v[232:235]
    ds_read_b64_tr_b16 a[208:209], v15 offset:34944
    ds_read_b64_tr_b16 a[210:211], v15 offset:43648
    v_mfma_f32_16x16x32_bf16 v[236:239], a[220:223], a[180:183], v[236:239]
    buffer_load_dwordx4 v28, s[28:31], s22 offen offset:2048 lds
    ds_read_b64_tr_b16 a[212:213], v16 offset:34944
    v_mfma_f32_16x16x32_bf16 v[240:243], a[220:223], a[184:187], v[240:243]
    ds_read_b64_tr_b16 a[214:215], v16 offset:43648
    ds_read_b128 a[0:3], v19 offset:21504
    v_mfma_f32_16x16x32_bf16 v[244:247], a[220:223], a[188:191], v[244:247]
    s_add_u32 m0, s21, 17408
    s_mov_b32 s22, 0
    buffer_load_dwordx4 v3, s[36:39], s22 offen offset:1088 nt lds
    v_mfma_f32_16x16x32_bf16 v[248:251], a[220:223], a[192:195], v[248:251]
    ds_read_b64_tr_b16 a[216:217], v15 offset:35072
    ds_read_b64_tr_b16 a[218:219], v15 offset:43776
    v_mfma_f32_16x16x32_bf16 v[252:255], a[220:223], a[196:199], v[252:255]
    s_add_u32 m0, s60, 104448
    s_add_u32 s22, s96, 0
    buffer_load_dwordx4 v29, s[28:31], s22 offen offset:3072 lds
    s_waitcnt lgkmcnt(9)
    v_mfma_f32_16x16x32_bf16 v[96:99], a[200:203], a[120:123], v[96:99]
    ds_read_b128 a[4:7], v19 offset:23552
    ds_read_b128 a[8:11], v19 offset:25600
    v_mfma_f32_16x16x32_bf16 v[100:103], a[200:203], a[124:127], v[100:103]
    ds_read_b128 a[12:15], v19 offset:27648
    ds_read_b128 a[16:19], v19 offset:29696
    v_mfma_f32_16x16x32_bf16 v[104:107], a[200:203], a[128:131], v[104:107]
    ds_read_b64_tr_b16 a[220:221], v16 offset:35072
    ds_read_b64_tr_b16 a[222:223], v16 offset:43776
    v_mfma_f32_16x16x32_bf16 v[108:111], a[200:203], a[132:135], v[108:111]
    ds_read_b128 a[20:23], v20 offset:21504
    ds_read_b128 a[24:27], v20 offset:23552
    v_mfma_f32_16x16x32_bf16 v[112:115], a[200:203], a[136:139], v[112:115]
    ds_read_b128 a[28:31], v20 offset:25600
    s_waitcnt lgkmcnt(15)
    v_mfma_f32_16x16x32_bf16 v[116:119], a[204:207], a[120:123], v[116:119]
    s_add_u32 m0, s21, 17408
    s_mov_b32 s22, 0
    buffer_load_dwordx4 v4, s[36:39], s22 offen offset:2176 nt lds
    v_mfma_f32_16x16x32_bf16 v[120:123], a[204:207], a[124:127], v[120:123]
    ds_read_b128 a[32:35], v20 offset:27648
    ds_read_b128 a[36:39], v20 offset:29696
    v_mfma_f32_16x16x32_bf16 v[124:127], a[204:207], a[128:131], v[124:127]
    ds_read_b64_tr_b16 a[200:201], v15 offset:35200
    ds_read_b64_tr_b16 a[202:203], v15 offset:43904
    v_mfma_f32_16x16x32_bf16 v[128:131], a[204:207], a[132:135], v[128:131]
    v_mfma_f32_16x16x32_bf16 v[132:135], a[204:207], a[136:139], v[132:135]
    s_waitcnt lgkmcnt(15)
    v_mfma_f32_16x16x32_bf16 v[136:139], a[208:211], a[120:123], v[136:139]
    v_mfma_f32_16x16x32_bf16 v[140:143], a[208:211], a[124:127], v[140:143]
    v_mfma_f32_16x16x32_bf16 v[144:147], a[208:211], a[128:131], v[144:147]
    ds_read_b64_tr_b16 a[204:205], v16 offset:35200
    ds_read_b64_tr_b16 a[206:207], v16 offset:43904
    v_mfma_f32_16x16x32_bf16 v[148:151], a[208:211], a[132:135], v[148:151]
    buffer_load_dwordx4 v5, s[36:39], s22 offen offset:3264 nt lds
    v_mfma_f32_16x16x32_bf16 v[152:155], a[208:211], a[136:139], v[152:155]
    v_mfma_f32_16x16x32_bf16 v[156:159], a[212:215], a[120:123], v[156:159]
    v_mfma_f32_16x16x32_bf16 v[160:163], a[212:215], a[124:127], v[160:163]
    v_mfma_f32_16x16x32_bf16 v[164:167], a[212:215], a[128:131], v[164:167]
    v_mfma_f32_16x16x32_bf16 v[168:171], a[212:215], a[132:135], v[168:171]
    v_mfma_f32_16x16x32_bf16 v[172:175], a[212:215], a[136:139], v[172:175]
    s_waitcnt lgkmcnt(15)
    v_mfma_f32_16x16x32_bf16 v[176:179], a[216:219], a[120:123], v[176:179]
    v_mfma_f32_16x16x32_bf16 v[180:183], a[216:219], a[124:127], v[180:183]
    v_mfma_f32_16x16x32_bf16 v[184:187], a[216:219], a[128:131], v[184:187]
    v_mfma_f32_16x16x32_bf16 v[188:191], a[216:219], a[132:135], v[188:191]
    v_mfma_f32_16x16x32_bf16 v[192:195], a[216:219], a[136:139], v[192:195]
    s_waitcnt lgkmcnt(9)
    v_mfma_f32_16x16x32_bf16 v[196:199], a[220:223], a[120:123], v[196:199]
    v_mfma_f32_16x16x32_bf16 v[200:203], a[220:223], a[124:127], v[200:203]
    v_mfma_f32_16x16x32_bf16 v[204:207], a[220:223], a[128:131], v[204:207]
    v_mfma_f32_16x16x32_bf16 v[208:211], a[220:223], a[132:135], v[208:211]
    v_mfma_f32_16x16x32_bf16 v[212:215], a[220:223], a[136:139], v[212:215]
    s_waitcnt lgkmcnt(0)
    s_barrier
    v_mfma_f32_16x16x32_bf16 v[216:219], a[200:203], a[120:123], v[216:219]
    v_add_u32 v15, 0x11000, v15
    ds_read_b64_tr_b16 a[208:209], v15
    v_mfma_f32_16x16x32_bf16 v[220:223], a[200:203], a[124:127], v[220:223]
    ds_read_b64_tr_b16 a[210:211], v15 offset:8704
    s_add_u32 m0, s61, 143360
    s_add_u32 s22, s95, 0
    buffer_load_dwordx4 v14, s[24:27], s22 offen lds
    v_mfma_f32_16x16x32_bf16 v[224:227], a[200:203], a[128:131], v[224:227]
    v_add_u32 v16, 0x11000, v16
    ds_read_b64_tr_b16 a[212:213], v16
    v_mfma_f32_16x16x32_bf16 v[228:231], a[200:203], a[132:135], v[228:231]
    s_add_u32 m0, s61, 147456
    s_add_u32 s22, s95, 28672
    buffer_load_dwordx4 v14, s[24:27], s22 offen lds
    v_mfma_f32_16x16x32_bf16 v[232:235], a[200:203], a[136:139], v[232:235]
    ds_read_b64_tr_b16 a[214:215], v16 offset:8704
    ds_read_b64_tr_b16 a[216:217], v15 offset:128
    v_mfma_f32_16x16x32_bf16 v[236:239], a[204:207], a[120:123], v[236:239]
    ds_read_b64_tr_b16 a[218:219], v15 offset:8832
    ds_read_b64_tr_b16 a[220:221], v16 offset:128
    v_mfma_f32_16x16x32_bf16 v[240:243], a[204:207], a[124:127], v[240:243]
    ds_read_b64_tr_b16 a[222:223], v16 offset:8832
    v_mfma_f32_16x16x32_bf16 v[244:247], a[204:207], a[128:131], v[244:247]
    s_add_u32 m0, s61, 151552
    s_add_u32 s22, s95, 57344
    buffer_load_dwordx4 v14, s[24:27], s22 offen lds
    v_mfma_f32_16x16x32_bf16 v[248:251], a[204:207], a[132:135], v[248:251]
    s_add_u32 m0, s21, 34816
    s_mov_b32 s22, 16384
    buffer_load_dwordx4 v2, s[32:35], s22 offen nt lds
    v_mfma_f32_16x16x32_bf16 v[252:255], a[204:207], a[136:139], v[252:255]
    ds_read_b64_tr_b16 a[200:201], v15 offset:256
    s_waitcnt lgkmcnt(7)
    v_mfma_f32_16x16x32_bf16 v[96:99], a[208:211], a[140:143], v[96:99]
    ds_read_b64_tr_b16 a[202:203], v15 offset:8960
    v_mfma_f32_16x16x32_bf16 v[100:103], a[208:211], a[144:147], v[100:103]
    s_add_u32 m0, s61, 155648
    s_add_u32 s22, s95, 86016
    buffer_load_dwordx4 v14, s[24:27], s22 offen lds
    v_mfma_f32_16x16x32_bf16 v[104:107], a[208:211], a[148:151], v[104:107]
    ds_read_b64_tr_b16 a[204:205], v16 offset:256
    ds_read_b64_tr_b16 a[206:207], v16 offset:8960
    v_mfma_f32_16x16x32_bf16 v[108:111], a[208:211], a[152:155], v[108:111]
    v_mfma_f32_16x16x32_bf16 v[112:115], a[208:211], a[156:159], v[112:115]
    s_waitcnt lgkmcnt(8)
    v_mfma_f32_16x16x32_bf16 v[116:119], a[212:215], a[140:143], v[116:119]
    s_add_u32 m0, s61, 159744
    s_add_u32 s22, s95, 114688
    buffer_load_dwordx4 v14, s[24:27], s22 offen lds
    v_mfma_f32_16x16x32_bf16 v[120:123], a[212:215], a[144:147], v[120:123]
    v_mfma_f32_16x16x32_bf16 v[124:127], a[212:215], a[148:151], v[124:127]
    ds_read_b64_tr_b16 a[208:209], v15 offset:384
    ds_read_b64_tr_b16 a[210:211], v15 offset:9088
    v_mfma_f32_16x16x32_bf16 v[128:131], a[212:215], a[152:155], v[128:131]
    s_add_u32 m0, s21, 34816
    s_mov_b32 s22, 16384
    buffer_load_dwordx4 v3, s[32:35], s22 offen offset:1088 nt lds
    v_mfma_f32_16x16x32_bf16 v[132:135], a[212:215], a[156:159], v[132:135]
    s_waitcnt lgkmcnt(8)
    v_mfma_f32_16x16x32_bf16 v[136:139], a[216:219], a[140:143], v[136:139]
    v_mfma_f32_16x16x32_bf16 v[140:143], a[216:219], a[144:147], v[140:143]
    v_mfma_f32_16x16x32_bf16 v[144:147], a[216:219], a[148:151], v[144:147]
    ds_read_b64_tr_b16 a[212:213], v16 offset:384
    ds_read_b64_tr_b16 a[214:215], v16 offset:9088
    v_mfma_f32_16x16x32_bf16 v[148:151], a[216:219], a[152:155], v[148:151]
    v_mfma_f32_16x16x32_bf16 v[152:155], a[216:219], a[156:159], v[152:155]
    s_waitcnt lgkmcnt(8)
    v_mfma_f32_16x16x32_bf16 v[156:159], a[220:223], a[140:143], v[156:159]
    v_mfma_f32_16x16x32_bf16 v[160:163], a[220:223], a[144:147], v[160:163]
    v_mfma_f32_16x16x32_bf16 v[164:167], a[220:223], a[148:151], v[164:167]
    v_mfma_f32_16x16x32_bf16 v[168:171], a[220:223], a[152:155], v[168:171]
    v_mfma_f32_16x16x32_bf16 v[172:175], a[220:223], a[156:159], v[172:175]
    buffer_load_dwordx4 v4, s[32:35], s22 offen offset:2176 nt lds
    s_waitcnt lgkmcnt(6)
    v_mfma_f32_16x16x32_bf16 v[176:179], a[200:203], a[140:143], v[176:179]
    v_mfma_f32_16x16x32_bf16 v[180:183], a[200:203], a[144:147], v[180:183]
    v_mfma_f32_16x16x32_bf16 v[184:187], a[200:203], a[148:151], v[184:187]
    v_mfma_f32_16x16x32_bf16 v[188:191], a[200:203], a[152:155], v[188:191]
    v_mfma_f32_16x16x32_bf16 v[192:195], a[200:203], a[156:159], v[192:195]
    s_waitcnt lgkmcnt(4)
    v_mfma_f32_16x16x32_bf16 v[196:199], a[204:207], a[140:143], v[196:199]
    v_mfma_f32_16x16x32_bf16 v[200:203], a[204:207], a[144:147], v[200:203]
    v_mfma_f32_16x16x32_bf16 v[204:207], a[204:207], a[148:151], v[204:207]
    v_mfma_f32_16x16x32_bf16 v[208:211], a[204:207], a[152:155], v[208:211]
    v_mfma_f32_16x16x32_bf16 v[212:215], a[204:207], a[156:159], v[212:215]
    s_waitcnt vmcnt(16) lgkmcnt(0)
    s_barrier
    v_mfma_f32_16x16x32_bf16 v[216:219], a[208:211], a[140:143], v[216:219]
    ds_read_b64_tr_b16 a[216:217], v15 offset:17408
    ds_read_b64_tr_b16 a[218:219], v15 offset:26112
    v_mfma_f32_16x16x32_bf16 v[220:223], a[208:211], a[144:147], v[220:223]
    buffer_load_dwordx4 v5, s[32:35], s22 offen offset:3264 nt lds
    ds_read_b128 v[56:59], v24
    v_mfma_f32_16x16x32_bf16 v[224:227], a[208:211], a[148:151], v[224:227]
    ds_read_b64_tr_b16 a[220:221], v16 offset:17408
    ds_read_b64_tr_b16 a[222:223], v16 offset:26112
    v_mfma_f32_16x16x32_bf16 v[228:231], a[208:211], a[152:155], v[228:231]
    ds_read_b128 v[60:63], v25
    ds_read_b64_tr_b16 a[200:201], v15 offset:17536
    v_mfma_f32_16x16x32_bf16 v[232:235], a[208:211], a[156:159], v[232:235]
    ds_read_b64_tr_b16 a[202:203], v15 offset:26240
    ds_read_b128 v[64:67], v24 offset:128
    v_mfma_f32_16x16x32_bf16 v[236:239], a[212:215], a[140:143], v[236:239]
    ds_read_b64_tr_b16 a[204:205], v16 offset:17536
    ds_read_b64_tr_b16 a[206:207], v16 offset:26240
    v_mfma_f32_16x16x32_bf16 v[240:243], a[212:215], a[144:147], v[240:243]
    ds_read_b128 v[68:71], v25 offset:128
    ds_read_b128 v[72:75], v24 offset:256
    v_mfma_f32_16x16x32_bf16 v[244:247], a[212:215], a[148:151], v[244:247]
    ds_read_b64_tr_b16 a[208:209], v15 offset:17664
    ds_read_b64_tr_b16 a[210:211], v15 offset:26368
    v_mfma_f32_16x16x32_bf16 v[248:251], a[212:215], a[152:155], v[248:251]
    ds_read_b128 v[76:79], v25 offset:256
    ds_read_b128 a[160:163], v19
    v_mfma_f32_16x16x32_bf16 v[252:255], a[212:215], a[156:159], v[252:255]
    ds_read_b128 a[164:167], v19 offset:2048
    s_waitcnt lgkmcnt(15)
    v_mfma_f32_16x16x32_bf16 v[96:99], a[216:219], a[0:3], v[96:99]
    ds_read_b128 v[80:83], v24 offset:384
    ds_read_b128 a[168:171], v19 offset:4096
    v_mfma_f32_16x16x32_bf16 v[100:103], a[216:219], a[4:7], v[100:103]
    s_add_u32 m0, s21, 69632
    s_mov_b32 s22, 32768
    buffer_load_dwordx4 v2, s[32:35], s22 offen nt lds
    v_mfma_f32_16x16x32_bf16 v[104:107], a[216:219], a[8:11], v[104:107]
    ds_read_b64_tr_b16 a[212:213], v16 offset:17664
    ds_read_b64_tr_b16 a[214:215], v16 offset:26368
    v_mfma_f32_16x16x32_bf16 v[108:111], a[216:219], a[12:15], v[108:111]
    ds_read_b128 a[172:175], v19 offset:6144
    ds_read_b128 a[176:179], v19 offset:8192
    v_mfma_f32_16x16x32_bf16 v[112:115], a[216:219], a[16:19], v[112:115]
    ds_read_b128 a[180:183], v20
    s_waitcnt lgkmcnt(15)
    v_mfma_f32_16x16x32_bf16 v[116:119], a[220:223], a[0:3], v[116:119]
    ds_read_b128 a[184:187], v20 offset:2048
    ds_read_b128 a[188:191], v20 offset:4096
    v_mfma_f32_16x16x32_bf16 v[120:123], a[220:223], a[4:7], v[120:123]
    ds_read_b128 a[192:195], v20 offset:6144
    ds_read_b128 a[196:199], v20 offset:8192
    v_mfma_f32_16x16x32_bf16 v[124:127], a[220:223], a[8:11], v[124:127]
    ds_read_b64_tr_b16 a[216:217], v15 offset:17792
    ds_read_b64_tr_b16 a[218:219], v15 offset:26496
    v_mfma_f32_16x16x32_bf16 v[128:131], a[220:223], a[12:15], v[128:131]
    ds_read_b128 v[84:87], v25 offset:384
    v_mfma_f32_16x16x32_bf16 v[132:135], a[220:223], a[16:19], v[132:135]
    v_mfma_f32_16x16x32_bf16 v[136:139], a[200:203], a[0:3], v[136:139]
    v_mfma_f32_16x16x32_bf16 v[140:143], a[200:203], a[4:7], v[140:143]
    v_mfma_f32_16x16x32_bf16 v[144:147], a[200:203], a[8:11], v[144:147]
    buffer_load_dwordx4 v3, s[32:35], s22 offen offset:1088 nt lds
    ds_read_b64_tr_b16 a[220:221], v16 offset:17792
    v_mfma_f32_16x16x32_bf16 v[148:151], a[200:203], a[12:15], v[148:151]
    ds_read_b64_tr_b16 a[222:223], v16 offset:26496
    v_mfma_f32_16x16x32_bf16 v[152:155], a[200:203], a[16:19], v[152:155]
    s_waitcnt lgkmcnt(15)
    v_mfma_f32_16x16x32_bf16 v[156:159], a[204:207], a[0:3], v[156:159]
    v_mfma_f32_16x16x32_bf16 v[160:163], a[204:207], a[4:7], v[160:163]
    v_mfma_f32_16x16x32_bf16 v[164:167], a[204:207], a[8:11], v[164:167]
    v_mfma_f32_16x16x32_bf16 v[168:171], a[204:207], a[12:15], v[168:171]
    v_mfma_f32_16x16x32_bf16 v[172:175], a[204:207], a[16:19], v[172:175]
    v_mfma_f32_16x16x32_bf16 v[176:179], a[208:211], a[0:3], v[176:179]
    v_mfma_f32_16x16x32_bf16 v[180:183], a[208:211], a[4:7], v[180:183]
    v_mfma_f32_16x16x32_bf16 v[184:187], a[208:211], a[8:11], v[184:187]
    v_mfma_f32_16x16x32_bf16 v[188:191], a[208:211], a[12:15], v[188:191]
    buffer_load_dwordx4 v4, s[32:35], s22 offen offset:2176 nt lds
    v_mfma_f32_16x16x32_bf16 v[192:195], a[208:211], a[16:19], v[192:195]
    s_waitcnt lgkmcnt(12)
    v_mfma_f32_16x16x32_bf16 v[196:199], a[212:215], a[0:3], v[196:199]
    v_mfma_f32_16x16x32_bf16 v[200:203], a[212:215], a[4:7], v[200:203]
    v_mfma_f32_16x16x32_bf16 v[204:207], a[212:215], a[8:11], v[204:207]
    v_mfma_f32_16x16x32_bf16 v[208:211], a[212:215], a[12:15], v[208:211]
    v_mfma_f32_16x16x32_bf16 v[212:215], a[212:215], a[16:19], v[212:215]
    s_waitcnt vmcnt(6) lgkmcnt(0)
    s_barrier
    v_mfma_f32_16x16x32_bf16 v[216:219], a[216:219], a[0:3], v[216:219]
    v_add_u32 v15, 0xffffbc00, v15
    ds_read_b64_tr_b16 a[200:201], v15
    v_mfma_f32_16x16x32_bf16 v[220:223], a[216:219], a[4:7], v[220:223]
    ds_read_b64_tr_b16 a[202:203], v15 offset:8704
    ds_read_b64_tr_b16 a[224:225], v10 offset:17408
    v_mfma_f32_16x16x32_bf16 v[224:227], a[216:219], a[8:11], v[224:227]
    ds_read_b64_tr_b16 a[226:227], v12 offset:17408
    v_add_u32 v16, 0xffffbc00, v16
    ds_read_b64_tr_b16 a[204:205], v16
    v_mfma_f32_16x16x32_bf16 v[228:231], a[216:219], a[12:15], v[228:231]
    ds_read_b64_tr_b16 a[206:207], v16 offset:8704
    ds_read_b64_tr_b16 a[228:229], v11 offset:17408
    v_mfma_f32_16x16x32_bf16 v[232:235], a[216:219], a[16:19], v[232:235]
    buffer_load_dwordx4 v5, s[32:35], s22 offen offset:3264 nt lds
    ds_read_b64_tr_b16 a[230:231], v13 offset:17408
    v_mfma_f32_16x16x32_bf16 v[236:239], a[220:223], a[0:3], v[236:239]
    ds_read_b64_tr_b16 a[208:209], v15 offset:128
    ds_read_b64_tr_b16 a[210:211], v15 offset:8832
    v_mfma_f32_16x16x32_bf16 v[240:243], a[220:223], a[4:7], v[240:243]
    ds_read_b64_tr_b16 a[232:233], v10 offset:17536
    ds_read_b64_tr_b16 a[234:235], v12 offset:17536
    v_mfma_f32_16x16x32_bf16 v[244:247], a[220:223], a[8:11], v[244:247]
    ds_read_b64_tr_b16 a[236:237], v11 offset:17536
    ds_read_b64_tr_b16 a[212:213], v16 offset:128
    v_mfma_f32_16x16x32_bf16 v[248:251], a[220:223], a[12:15], v[248:251]
    ds_read_b64_tr_b16 a[214:215], v16 offset:8832
    ds_read_b64_tr_b16 a[238:239], v13 offset:17536
    v_mfma_f32_16x16x32_bf16 v[252:255], a[220:223], a[16:19], v[252:255]
    ds_read_b64_tr_b16 a[240:241], v10 offset:17664
    s_waitcnt lgkmcnt(15)
    v_mfma_f32_16x16x32_bf16 v[96:99], a[200:203], a[20:23], v[96:99]
    ds_read_b64_tr_b16 a[242:243], v12 offset:17664
    ds_read_b64_tr_b16 a[216:217], v15 offset:256
    v_mfma_f32_16x16x32_bf16 v[100:103], a[200:203], a[24:27], v[100:103]
    ds_read_b64_tr_b16 a[218:219], v15 offset:8960
    ds_read_b64_tr_b16 a[244:245], v11 offset:17664
    v_mfma_f32_16x16x32_bf16 v[104:107], a[200:203], a[28:31], v[104:107]
    ds_read_b64_tr_b16 a[246:247], v13 offset:17664
    ds_read_b64_tr_b16 a[220:221], v16 offset:256
    v_mfma_f32_16x16x32_bf16 v[108:111], a[200:203], a[32:35], v[108:111]
    ds_read_b64_tr_b16 a[222:223], v16 offset:8960
    ds_read_b64_tr_b16 a[248:249], v10 offset:17792
    v_mfma_f32_16x16x32_bf16 v[112:115], a[200:203], a[36:39], v[112:115]
    ds_read_b128 a[120:123], v19 offset:21504
    s_waitcnt lgkmcnt(15)
    v_mfma_f32_16x16x32_bf16 v[116:119], a[204:207], a[20:23], v[116:119]
    s_add_u32 m0, s21, 87040
    s_mov_b32 s22, 49152
    buffer_load_dwordx4 v2, s[32:35], s22 offen nt lds
    v_mfma_f32_16x16x32_bf16 v[120:123], a[204:207], a[24:27], v[120:123]
    ds_read_b128 a[124:127], v19 offset:23552
    ds_read_b64_tr_b16 a[250:251], v12 offset:17792
    v_mfma_f32_16x16x32_bf16 v[124:127], a[204:207], a[28:31], v[124:127]
    ds_read_b128 a[128:131], v19 offset:25600
    ds_read_b128 a[132:135], v19 offset:27648
    v_mfma_f32_16x16x32_bf16 v[128:131], a[204:207], a[32:35], v[128:131]
    ds_read_b128 a[136:139], v19 offset:29696
    ds_read_b128 a[140:143], v20 offset:21504
    v_mfma_f32_16x16x32_bf16 v[132:135], a[204:207], a[36:39], v[132:135]
    ds_read_b64_tr_b16 a[252:253], v11 offset:17792
    ds_read_b64_tr_b16 a[200:201], v15 offset:384
    v_mfma_f32_16x16x32_bf16 v[136:139], a[208:211], a[20:23], v[136:139]
    ds_read_b64_tr_b16 a[202:203], v15 offset:9088
    ds_read_b128 a[144:147], v20 offset:23552
    v_mfma_f32_16x16x32_bf16 v[140:143], a[208:211], a[24:27], v[140:143]
    ds_read_b128 a[148:151], v20 offset:25600
    ds_read_b128 a[152:155], v20 offset:27648
    v_mfma_f32_16x16x32_bf16 v[144:147], a[208:211], a[28:31], v[144:147]
    ds_read_b64_tr_b16 a[204:205], v16 offset:384
    ds_read_b64_tr_b16 a[206:207], v16 offset:9088
    v_mfma_f32_16x16x32_bf16 v[148:151], a[208:211], a[32:35], v[148:151]
    ds_read_b128 a[156:159], v20 offset:29696
    ds_read_b64_tr_b16 a[254:255], v13 offset:17792
    v_mfma_f32_16x16x32_bf16 v[152:155], a[208:211], a[36:39], v[152:155]
    s_waitcnt lgkmcnt(15)
    v_mfma_f32_16x16x32_bf16 v[156:159], a[212:215], a[20:23], v[156:159]
    v_mfma_f32_16x16x32_bf16 v[160:163], a[212:215], a[24:27], v[160:163]
    buffer_load_dwordx4 v3, s[32:35], s22 offen offset:1088 nt lds
    v_mfma_f32_16x16x32_bf16 v[164:167], a[212:215], a[28:31], v[164:167]
    v_mfma_f32_16x16x32_bf16 v[168:171], a[212:215], a[32:35], v[168:171]
    v_mfma_f32_16x16x32_bf16 v[172:175], a[212:215], a[36:39], v[172:175]
    v_mfma_f32_16x16x32_bf16 v[176:179], a[216:219], a[20:23], v[176:179]
    v_mfma_f32_16x16x32_bf16 v[180:183], a[216:219], a[24:27], v[180:183]
    v_mfma_f32_16x16x32_bf16 v[184:187], a[216:219], a[28:31], v[184:187]
    v_mfma_f32_16x16x32_bf16 v[188:191], a[216:219], a[32:35], v[188:191]
    v_mfma_f32_16x16x32_bf16 v[192:195], a[216:219], a[36:39], v[192:195]
    v_mfma_f32_16x16x32_bf16 v[196:199], a[220:223], a[20:23], v[196:199]
    v_mfma_f32_16x16x32_bf16 v[200:203], a[220:223], a[24:27], v[200:203]
    v_mfma_f32_16x16x32_bf16 v[204:207], a[220:223], a[28:31], v[204:207]
    buffer_load_dwordx4 v4, s[32:35], s22 offen offset:2176 nt lds
    v_mfma_f32_16x16x32_bf16 v[208:211], a[220:223], a[32:35], v[208:211]
    v_mfma_f32_16x16x32_bf16 v[212:215], a[220:223], a[36:39], v[212:215]
    s_waitcnt lgkmcnt(0)
    s_barrier
    v_mfma_f32_16x16x32_bf16 v[216:219], a[200:203], a[20:23], v[216:219]
    s_and_b32 s18, s16, 3
    s_mov_b32 s19, 106181136
    s_cmp_eq_u32 s18, 1
    s_cselect_b32 s19, 40190721, s19
    v_mfma_f32_16x16x32_bf16 v[220:223], a[200:203], a[24:27], v[220:223]
    ds_read_b64_tr_b16 a[208:209], v17 offset:34816
    ds_read_b64_tr_b16 a[210:211], v17 offset:36864
    v_mfma_f32_16x16x32_bf16 v[224:227], a[200:203], a[28:31], v[224:227]
    s_nop 0
    s_cmp_eq_u32 s18, 2
    s_cselect_b32 s19, 52843536, s19
    s_nop 0
    s_cmp_eq_u32 s18, 3
    s_cselect_b32 s19, 70411521, s19
    v_mfma_f32_16x16x32_bf16 v[228:231], a[200:203], a[32:35], v[228:231]
    s_lshr_b32 s18, s16, 2
    s_mul_i32 s18, s18, 0
    v_mfma_f32_16x16x32_bf16 v[232:235], a[200:203], a[36:39], v[232:235]
    s_bfe_u32 s89, s19, 262144
    s_add_u32 s89, s89, s18
    v_mfma_f32_16x16x32_bf16 v[236:239], a[204:207], a[20:23], v[236:239]
    s_lshl_b32 s89, s89, 7
    ds_read_b64_tr_b16 a[212:213], v18 offset:34816
    v_mfma_f32_16x16x32_bf16 v[240:243], a[204:207], a[24:27], v[240:243]
    ds_read_b64_tr_b16 a[214:215], v18 offset:36864
    s_sub_u32 s90, s89, 896
    v_mfma_f32_16x16x32_bf16 v[244:247], a[204:207], a[28:31], v[244:247]
    s_min_u32 s89, s89, s90
    s_bfe_u32 s90, s19, 262148
    v_mfma_f32_16x16x32_bf16 v[248:251], a[204:207], a[32:35], v[248:251]
    s_add_u32 s90, s90, s18
    s_lshl_b32 s90, s90, 7
    v_mfma_f32_16x16x32_bf16 v[252:255], a[204:207], a[36:39], v[252:255]
    s_sub_u32 s91, s90, 896
    s_waitcnt lgkmcnt(2)
    v_mfma_f32_16x16x32_bf16 v[96:99], a[208:211], a[160:163], v[96:99]
    s_min_u32 s90, s90, s91
    buffer_load_dwordx4 v5, s[32:35], s22 offen offset:3264 nt lds
    v_mfma_f32_16x16x32_bf16 v[100:103], a[208:211], a[164:167], v[100:103]
    ds_read_b64_tr_b16 a[216:217], v17 offset:38912
    ds_read_b64_tr_b16 a[218:219], v17 offset:40960
    v_mfma_f32_16x16x32_bf16 v[104:107], a[208:211], a[168:171], v[104:107]
    s_bfe_u32 s91, s19, 262152
    s_add_u32 s91, s91, s18
    v_mfma_f32_16x16x32_bf16 v[108:111], a[208:211], a[172:175], v[108:111]
    s_lshl_b32 s91, s91, 7
    s_sub_u32 s92, s91, 896
    v_mfma_f32_16x16x32_bf16 v[112:115], a[208:211], a[176:179], v[112:115]
    s_min_u32 s91, s91, s92
    s_waitcnt lgkmcnt(2)
    v_mfma_f32_16x16x32_bf16 v[116:119], a[212:215], a[160:163], v[116:119]
    s_bfe_u32 s92, s19, 262156
    ds_read_b64_tr_b16 a[220:221], v18 offset:38912
    v_mfma_f32_16x16x32_bf16 v[120:123], a[212:215], a[164:167], v[120:123]
    ds_read_b64_tr_b16 a[222:223], v18 offset:40960
    s_add_u32 s92, s92, s18
    v_mfma_f32_16x16x32_bf16 v[124:127], a[212:215], a[168:171], v[124:127]
    s_lshl_b32 s92, s92, 7
    s_sub_u32 s93, s92, 896
    v_mfma_f32_16x16x32_bf16 v[128:131], a[212:215], a[172:175], v[128:131]
    s_min_u32 s92, s92, s93
    s_bfe_u32 s93, s19, 262160
    v_mfma_f32_16x16x32_bf16 v[132:135], a[212:215], a[176:179], v[132:135]
    s_add_u32 s93, s93, s18
    s_waitcnt lgkmcnt(2)
    v_mfma_f32_16x16x32_bf16 v[96:99], a[216:219], a[180:183], v[96:99]
    s_lshl_b32 s93, s93, 7
    ds_read_b64_tr_b16 a[200:201], v17 offset:43008
    v_mfma_f32_16x16x32_bf16 v[100:103], a[216:219], a[184:187], v[100:103]
    ds_read_b64_tr_b16 a[202:203], v17 offset:45056
    s_sub_u32 s94, s93, 896
    v_mfma_f32_16x16x32_bf16 v[104:107], a[216:219], a[188:191], v[104:107]
    s_add_u32 m0, s21, 0
    s_mov_b32 s22, 16384
    buffer_load_dwordx4 v2, s[36:39], s22 offen nt lds
    v_mfma_f32_16x16x32_bf16 v[108:111], a[216:219], a[192:195], v[108:111]
    s_min_u32 s93, s93, s94
    s_bfe_u32 s94, s19, 262164
    v_mfma_f32_16x16x32_bf16 v[112:115], a[216:219], a[196:199], v[112:115]
    s_add_u32 s94, s94, s18
    s_waitcnt lgkmcnt(2)
    v_mfma_f32_16x16x32_bf16 v[116:119], a[220:223], a[180:183], v[116:119]
    s_lshl_b32 s94, s94, 7
    s_sub_u32 s95, s94, 896
    v_mfma_f32_16x16x32_bf16 v[120:123], a[220:223], a[184:187], v[120:123]
    ds_read_b64_tr_b16 a[204:205], v18 offset:43008
    ds_read_b64_tr_b16 a[206:207], v18 offset:45056
    v_mfma_f32_16x16x32_bf16 v[124:127], a[220:223], a[188:191], v[124:127]
    s_min_u32 s94, s94, s95
    s_bfe_u32 s95, s19, 262168
    v_mfma_f32_16x16x32_bf16 v[128:131], a[220:223], a[192:195], v[128:131]
    s_add_u32 s95, s95, s18
    s_lshl_b32 s95, s95, 7
    v_mfma_f32_16x16x32_bf16 v[132:135], a[220:223], a[196:199], v[132:135]
    s_sub_u32 s19, s95, 896
    s_waitcnt lgkmcnt(2)
    v_mfma_f32_16x16x32_bf16 v[96:99], a[200:203], a[120:123], v[96:99]
    s_min_u32 s95, s95, s19
    v_bfe_u32 v39, v0, 2, 4
    v_mfma_f32_16x16x32_bf16 v[100:103], a[200:203], a[124:127], v[100:103]
    ds_read_b64_tr_b16 a[208:209], v17 offset:47104
    ds_read_b64_tr_b16 a[210:211], v17 offset:49152
    v_mfma_f32_16x16x32_bf16 v[104:107], a[200:203], a[128:131], v[104:107]
    v_lshlrev_b32 v39, 7, v39
    ds_read_b64_tr_b16 a[212:213], v18 offset:47104
    v_mfma_f32_16x16x32_bf16 v[108:111], a[200:203], a[132:135], v[108:111]
    ds_read_b64_tr_b16 a[214:215], v18 offset:49152
    v_lshl_add_u32 v39, v45, 3, v39
    v_bfe_u32 v40, v0, 3, 2
    buffer_load_dwordx4 v3, s[36:39], s22 offen offset:1088 nt lds
    v_mfma_f32_16x16x32_bf16 v[112:115], a[200:203], a[136:139], v[112:115]
    v_lshlrev_b32 v16, 1, v46
    s_waitcnt lgkmcnt(4)
    v_mfma_f32_16x16x32_bf16 v[116:119], a[204:207], a[120:123], v[116:119]
    v_xor_b32 v40, v40, v16
    v_lshl_add_u32 v15, v40, 5, v39
    v_mfma_f32_16x16x32_bf16 v[120:123], a[204:207], a[124:127], v[120:123]
    v_xor_b32 v16, 32, v15
    v_lshl_add_u32 v15, v46, 12, v15
    v_mfma_f32_16x16x32_bf16 v[124:127], a[204:207], a[128:131], v[124:127]
    v_lshl_add_u32 v16, v46, 12, v16
    v_bfe_u32 v39, v0, 3, 3
    v_mfma_f32_16x16x32_bf16 v[128:131], a[204:207], a[132:135], v[128:131]
    v_lshl_add_u32 v39, v36, 5, v39
    v_mul_u32_u24 v39, 896, v39
    v_mfma_f32_16x16x32_bf16 v[132:135], a[204:207], a[136:139], v[132:135]
    s_waitcnt lgkmcnt(0)
    s_barrier
    v_mfma_f32_16x16x32_bf16 v[96:99], a[208:211], a[140:143], v[96:99]
    v_add_u32 v6, v39, v47
    v_add_u32 v7, 6144, v6
    v_mfma_f32_16x16x32_bf16 v[100:103], a[208:211], a[144:147], v[100:103]
    v_add_u32 v8, 12288, v6
    v_add_u32 v9, 18432, v6
    v_mfma_f32_16x16x32_bf16 v[104:107], a[208:211], a[148:151], v[104:107]
    v_mul_u32_u24 v39, 2560, v36
    buffer_load_dwordx4 v4, s[36:39], s22 offen offset:2176 nt lds
    v_mfma_f32_16x16x32_bf16 v[108:111], a[208:211], a[152:155], v[108:111]
    v_cvt_pk_bf16_f32 v96, v96, v97
    v_cvt_pk_bf16_f32 v97, v98, v99
    v_mfma_f32_16x16x32_bf16 v[112:115], a[208:211], a[156:159], v[112:115]
    v_lshl_add_u32 v14, v37, 3, v39
    v_xor_b32 v39, 1, v36
    v_mfma_f32_16x16x32_bf16 v[116:119], a[212:215], a[140:143], v[116:119]
    v_cvt_pk_bf16_f32 v100, v100, v101
    v_mul_u32_u24 v39, 2560, v39
    v_mfma_f32_16x16x32_bf16 v[120:123], a[212:215], a[144:147], v[120:123]
    v_lshl_add_u32 v19, v37, 3, v39
    v_cvt_pk_bf16_f32 v101, v102, v103
    v_mfma_f32_16x16x32_bf16 v[124:127], a[212:215], a[148:151], v[124:127]
    v_lshl_add_u32 v39, v42, 2, v43
    v_cvt_pk_bf16_f32 v104, v104, v105
    v_mfma_f32_16x16x32_bf16 v[128:131], a[212:215], a[152:155], v[128:131]
    v_add_u32 v21, 0x23000, v21
    ds_write_b64 v21, v[96:97]
    v_mfma_f32_16x16x32_bf16 v[132:135], a[212:215], a[156:159], v[132:135]
    v_lshlrev_b32 v20, 4, v39
    v_cvt_pk_bf16_f32 v105, v106, v107
    v_mfma_f32_16x16x32_bf16 v[136:139], v[48:51], a[160:163], v[136:139]
    v_cvt_pk_bf16_f32 v108, v108, v109
    v_cvt_pk_bf16_f32 v109, v110, v111
    v_mfma_f32_16x16x32_bf16 v[140:143], v[48:51], a[164:167], v[140:143]
    ds_write_b64 v21, v[100:101] offset:1024
    v_mfma_f32_16x16x32_bf16 v[144:147], v[48:51], a[168:171], v[144:147]
    v_cvt_pk_bf16_f32 v112, v112, v113
    buffer_load_dwordx4 v5, s[36:39], s22 offen offset:3264 nt lds
    v_mfma_f32_16x16x32_bf16 v[148:151], v[48:51], a[172:175], v[148:151]
    ds_write_b64 v21, v[104:105] offset:2048
    v_mfma_f32_16x16x32_bf16 v[152:155], v[48:51], a[176:179], v[152:155]
    v_cvt_pk_bf16_f32 v113, v114, v115
    v_cvt_pk_bf16_f32 v116, v116, v117
    v_mfma_f32_16x16x32_bf16 v[156:159], v[52:55], a[160:163], v[156:159]
    ds_write_b64 v21, v[108:109] offset:3072
    v_mfma_f32_16x16x32_bf16 v[160:163], v[52:55], a[164:167], v[160:163]
    v_cvt_pk_bf16_f32 v117, v118, v119
    v_cvt_pk_bf16_f32 v120, v120, v121
    v_mfma_f32_16x16x32_bf16 v[164:167], v[52:55], a[168:171], v[164:167]
    ds_write_b64 v21, v[112:113] offset:4096
    v_mfma_f32_16x16x32_bf16 v[168:171], v[52:55], a[172:175], v[168:171]
    v_cvt_pk_bf16_f32 v121, v122, v123
    v_cvt_pk_bf16_f32 v124, v124, v125
    v_mfma_f32_16x16x32_bf16 v[172:175], v[52:55], a[176:179], v[172:175]
    ds_write_b64 v21, v[116:117] offset:512
    v_mfma_f32_16x16x32_bf16 v[136:139], v[88:91], a[180:183], v[136:139]
    v_cvt_pk_bf16_f32 v125, v126, v127
    v_cvt_pk_bf16_f32 v128, v128, v129
    v_mfma_f32_16x16x32_bf16 v[140:143], v[88:91], a[184:187], v[140:143]
    ds_write_b64 v21, v[120:121] offset:1536
    v_mfma_f32_16x16x32_bf16 v[144:147], v[88:91], a[188:191], v[144:147]
    v_cvt_pk_bf16_f32 v129, v130, v131
    v_cvt_pk_bf16_f32 v132, v132, v133
    v_mfma_f32_16x16x32_bf16 v[148:151], v[88:91], a[192:195], v[148:151]
    s_add_u32 m0, s21, 17408
    s_mov_b32 s22, 65536
    buffer_load_dwordx4 v2, s[32:35], s22 offen nt lds
    v_mfma_f32_16x16x32_bf16 v[152:155], v[88:91], a[196:199], v[152:155]
    ds_write_b64 v21, v[124:125] offset:2560
    v_mfma_f32_16x16x32_bf16 v[156:159], v[92:95], a[180:183], v[156:159]
    v_cvt_pk_bf16_f32 v133, v134, v135
    v_mfma_f32_16x16x32_bf16 v[160:163], v[92:95], a[184:187], v[160:163]
    ds_write_b64 v21, v[128:129] offset:3584
    v_mfma_f32_16x16x32_bf16 v[164:167], v[92:95], a[188:191], v[164:167]
    ds_write_b64 v21, v[132:133] offset:4608
    v_mfma_f32_16x16x32_bf16 v[168:171], v[92:95], a[192:195], v[168:171]
    v_mfma_f32_16x16x32_bf16 v[172:175], v[92:95], a[196:199], v[172:175]
    v_mfma_f32_16x16x32_bf16 v[136:139], a[72:75], a[120:123], v[136:139]
    v_mfma_f32_16x16x32_bf16 v[140:143], a[72:75], a[124:127], v[140:143]
    v_mfma_f32_16x16x32_bf16 v[144:147], a[72:75], a[128:131], v[144:147]
    v_mfma_f32_16x16x32_bf16 v[148:151], a[72:75], a[132:135], v[148:151]
    v_mfma_f32_16x16x32_bf16 v[152:155], a[72:75], a[136:139], v[152:155]
    buffer_load_dwordx4 v3, s[32:35], s22 offen offset:1088 nt lds
    v_mfma_f32_16x16x32_bf16 v[156:159], a[76:79], a[120:123], v[156:159]
    v_mfma_f32_16x16x32_bf16 v[160:163], a[76:79], a[124:127], v[160:163]
    v_mfma_f32_16x16x32_bf16 v[164:167], a[76:79], a[128:131], v[164:167]
    v_mfma_f32_16x16x32_bf16 v[168:171], a[76:79], a[132:135], v[168:171]
    v_mfma_f32_16x16x32_bf16 v[172:175], a[76:79], a[136:139], v[172:175]
    s_waitcnt vmcnt(14) lgkmcnt(0)
    s_barrier
    v_mfma_f32_16x16x32_bf16 v[136:139], a[112:115], a[140:143], v[136:139]
    ds_read_b128 v[96:99], v24 offset:34816
    ds_read_b128 v[100:103], v25 offset:34816
    v_mfma_f32_16x16x32_bf16 v[140:143], a[112:115], a[144:147], v[140:143]
    ds_read_b128 v[104:107], v24 offset:34944
    ds_read_b128 v[108:111], v25 offset:34944
    v_mfma_f32_16x16x32_bf16 v[144:147], a[112:115], a[148:151], v[144:147]
    ds_read_b128 v[112:115], v24 offset:35072
    ds_read_b128 v[116:119], v25 offset:35072
    v_mfma_f32_16x16x32_bf16 v[148:151], a[112:115], a[152:155], v[148:151]
    v_cvt_pk_bf16_f32 v136, v136, v137
    v_cvt_pk_bf16_f32 v137, v138, v139
    v_mfma_f32_16x16x32_bf16 v[152:155], a[112:115], a[156:159], v[152:155]
    v_cvt_pk_bf16_f32 v140, v140, v141
    v_cvt_pk_bf16_f32 v141, v142, v143
    v_mfma_f32_16x16x32_bf16 v[156:159], a[116:119], a[140:143], v[156:159]
    buffer_load_dwordx4 v4, s[32:35], s22 offen offset:2176 nt lds
    v_cvt_pk_bf16_f32 v144, v144, v145
    v_mfma_f32_16x16x32_bf16 v[160:163], a[116:119], a[144:147], v[160:163]
    v_add_u32 v21, 0xffffac00, v21
    ds_write_b64 v21, v[136:137]
    v_mfma_f32_16x16x32_bf16 v[164:167], a[116:119], a[148:151], v[164:167]
    v_cvt_pk_bf16_f32 v145, v146, v147
    v_cvt_pk_bf16_f32 v148, v148, v149
    v_mfma_f32_16x16x32_bf16 v[168:171], a[116:119], a[152:155], v[168:171]
    ds_write_b64 v21, v[140:141] offset:1024
    v_mfma_f32_16x16x32_bf16 v[172:175], a[116:119], a[156:159], v[172:175]
    v_cvt_pk_bf16_f32 v149, v150, v151
    v_cvt_pk_bf16_f32 v152, v152, v153
    v_mfma_f32_16x16x32_bf16 v[176:179], a[40:43], a[160:163], v[176:179]
    ds_write_b64 v21, v[144:145] offset:2048
    v_mfma_f32_16x16x32_bf16 v[180:183], a[40:43], a[164:167], v[180:183]
    v_cvt_pk_bf16_f32 v153, v154, v155
    v_cvt_pk_bf16_f32 v156, v156, v157
    v_mfma_f32_16x16x32_bf16 v[184:187], a[40:43], a[168:171], v[184:187]
    ds_write_b64 v21, v[148:149] offset:3072
    v_mfma_f32_16x16x32_bf16 v[188:191], a[40:43], a[172:175], v[188:191]
    v_cvt_pk_bf16_f32 v157, v158, v159
    v_cvt_pk_bf16_f32 v160, v160, v161
    v_mfma_f32_16x16x32_bf16 v[192:195], a[40:43], a[176:179], v[192:195]
    ds_write_b64 v21, v[152:153] offset:4096
    v_mfma_f32_16x16x32_bf16 v[196:199], a[44:47], a[160:163], v[196:199]
    v_cvt_pk_bf16_f32 v161, v162, v163
    v_cvt_pk_bf16_f32 v164, v164, v165
    v_mfma_f32_16x16x32_bf16 v[200:203], a[44:47], a[164:167], v[200:203]
    buffer_load_dwordx4 v5, s[32:35], s22 offen offset:3264 nt lds
    v_cvt_pk_bf16_f32 v165, v166, v167
    v_mfma_f32_16x16x32_bf16 v[204:207], a[44:47], a[168:171], v[204:207]
    ds_write_b64 v21, v[156:157] offset:512
    v_mfma_f32_16x16x32_bf16 v[208:211], a[44:47], a[172:175], v[208:211]
    ds_write_b64 v21, v[160:161] offset:1536
    v_mfma_f32_16x16x32_bf16 v[212:215], a[44:47], a[176:179], v[212:215]
    v_cvt_pk_bf16_f32 v168, v168, v169
    ds_read_b128 v[120:123], v24 offset:35200
    v_mfma_f32_16x16x32_bf16 v[176:179], a[48:51], a[180:183], v[176:179]
    v_cvt_pk_bf16_f32 v169, v170, v171
    v_cvt_pk_bf16_f32 v172, v172, v173
    v_mfma_f32_16x16x32_bf16 v[180:183], a[48:51], a[184:187], v[180:183]
    ds_write_b64 v21, v[164:165] offset:2560
    v_mfma_f32_16x16x32_bf16 v[184:187], a[48:51], a[188:191], v[184:187]
    ds_read_b128 v[124:127], v25 offset:35200
    v_add_u32 v22, 0x23000, v22
    ds_read_b128 a[0:3], v22
    v_mfma_f32_16x16x32_bf16 v[188:191], a[48:51], a[192:195], v[188:191]
    ds_read_b128 a[4:7], v22 offset:1024
    ds_read_b128 a[8:11], v22 offset:2048
    v_mfma_f32_16x16x32_bf16 v[192:195], a[48:51], a[196:199], v[192:195]
    ds_read_b128 a[12:15], v22 offset:3072
    ds_read_b128 a[16:19], v22 offset:4096
    v_mfma_f32_16x16x32_bf16 v[196:199], a[52:55], a[180:183], v[196:199]
    v_add_u32 v23, 0x23000, v23
    ds_read_b128 a[20:23], v23
    v_mfma_f32_16x16x32_bf16 v[200:203], a[52:55], a[184:187], v[200:203]
    ds_read_b128 a[24:27], v23 offset:1024
    ds_read_b128 a[28:31], v23 offset:2048
    v_mfma_f32_16x16x32_bf16 v[204:207], a[52:55], a[188:191], v[204:207]
    s_add_u32 m0, s21, 52224
    s_mov_b32 s22, 32768
    buffer_load_dwordx4 v2, s[36:39], s22 offen nt lds
    v_mfma_f32_16x16x32_bf16 v[208:211], a[52:55], a[192:195], v[208:211]
    ds_read_b128 a[32:35], v23 offset:3072
    ds_read_b128 a[36:39], v23 offset:4096
    v_mfma_f32_16x16x32_bf16 v[212:215], a[52:55], a[196:199], v[212:215]
    v_cvt_pk_bf16_f32 v173, v174, v175
    v_mfma_f32_16x16x32_bf16 v[176:179], a[56:59], a[120:123], v[176:179]
    ds_write_b64 v21, v[168:169] offset:3584
    v_mfma_f32_16x16x32_bf16 v[180:183], a[56:59], a[124:127], v[180:183]
    ds_write_b64 v21, v[172:173] offset:4608
    v_mfma_f32_16x16x32_bf16 v[184:187], a[56:59], a[128:131], v[184:187]
    v_mfma_f32_16x16x32_bf16 v[188:191], a[56:59], a[132:135], v[188:191]
    v_mfma_f32_16x16x32_bf16 v[192:195], a[56:59], a[136:139], v[192:195]
    v_mfma_f32_16x16x32_bf16 v[196:199], a[60:63], a[120:123], v[196:199]
    v_mfma_f32_16x16x32_bf16 v[200:203], a[60:63], a[124:127], v[200:203]
    v_mfma_f32_16x16x32_bf16 v[204:207], a[60:63], a[128:131], v[204:207]
    v_mfma_f32_16x16x32_bf16 v[208:211], a[60:63], a[132:135], v[208:211]
    buffer_load_dwordx4 v3, s[36:39], s22 offen offset:1088 nt lds
    v_mfma_f32_16x16x32_bf16 v[212:215], a[60:63], a[136:139], v[212:215]
    s_waitcnt vmcnt(14) lgkmcnt(0)
    s_barrier
    v_mfma_f32_16x16x32_bf16 v[176:179], a[64:67], a[140:143], v[176:179]
    v_add_u32 v24, 0x11000, v24
    ds_read_b128 v[136:139], v24
    v_mfma_f32_16x16x32_bf16 v[180:183], a[64:67], a[144:147], v[180:183]
    v_add_u32 v25, 0x11000, v25
    ds_read_b128 v[140:143], v25
    v_mfma_f32_16x16x32_bf16 v[184:187], a[64:67], a[148:151], v[184:187]
    ds_read_b128 v[144:147], v24 offset:128
    ds_read_b128 v[148:151], v25 offset:128
    v_mfma_f32_16x16x32_bf16 v[188:191], a[64:67], a[152:155], v[188:191]
    v_cvt_pk_bf16_f32 v176, v176, v177
    v_cvt_pk_bf16_f32 v177, v178, v179
    v_mfma_f32_16x16x32_bf16 v[192:195], a[64:67], a[156:159], v[192:195]
    v_cvt_pk_bf16_f32 v180, v180, v181
    v_cvt_pk_bf16_f32 v181, v182, v183
    v_mfma_f32_16x16x32_bf16 v[196:199], a[68:71], a[140:143], v[196:199]
    v_cvt_pk_bf16_f32 v184, v184, v185
    v_cvt_pk_bf16_f32 v185, v186, v187
    v_mfma_f32_16x16x32_bf16 v[200:203], a[68:71], a[144:147], v[200:203]
    ds_write_b64 v21, v[176:177] offset:21504
    v_mfma_f32_16x16x32_bf16 v[204:207], a[68:71], a[148:151], v[204:207]
    v_cvt_pk_bf16_f32 v188, v188, v189
    v_cvt_pk_bf16_f32 v189, v190, v191
    v_mfma_f32_16x16x32_bf16 v[208:211], a[68:71], a[152:155], v[208:211]
    ds_write_b64 v21, v[180:181] offset:22528
    v_mfma_f32_16x16x32_bf16 v[212:215], a[68:71], a[156:159], v[212:215]
    buffer_load_dwordx4 v4, s[36:39], s22 offen offset:2176 nt lds
    v_cvt_pk_bf16_f32 v192, v192, v193
    v_mfma_f32_16x16x32_bf16 v[216:219], a[80:83], a[160:163], v[216:219]
    ds_write_b64 v21, v[184:185] offset:23552
    v_mfma_f32_16x16x32_bf16 v[220:223], a[80:83], a[164:167], v[220:223]
    v_cvt_pk_bf16_f32 v193, v194, v195
    v_cvt_pk_bf16_f32 v196, v196, v197
    v_mfma_f32_16x16x32_bf16 v[224:227], a[80:83], a[168:171], v[224:227]
    ds_write_b64 v21, v[188:189] offset:24576
    v_mfma_f32_16x16x32_bf16 v[228:231], a[80:83], a[172:175], v[228:231]
    v_cvt_pk_bf16_f32 v197, v198, v199
    ds_read_b128 v[152:155], v24 offset:256
    v_mfma_f32_16x16x32_bf16 v[232:235], a[80:83], a[176:179], v[232:235]
    ds_write_b64 v21, v[192:193] offset:25600
    v_mfma_f32_16x16x32_bf16 v[236:239], a[84:87], a[160:163], v[236:239]
    v_cvt_pk_bf16_f32 v200, v200, v201
    v_cvt_pk_bf16_f32 v201, v202, v203
    v_mfma_f32_16x16x32_bf16 v[240:243], a[84:87], a[164:167], v[240:243]
    ds_write_b64 v21, v[196:197] offset:22016
    v_mfma_f32_16x16x32_bf16 v[244:247], a[84:87], a[168:171], v[244:247]
    v_cvt_pk_bf16_f32 v204, v204, v205
    ds_read_b128 v[156:159], v25 offset:256
    v_mfma_f32_16x16x32_bf16 v[248:251], a[84:87], a[172:175], v[248:251]
    v_cvt_pk_bf16_f32 v205, v206, v207
    v_cvt_pk_bf16_f32 v208, v208, v209
    v_mfma_f32_16x16x32_bf16 v[252:255], a[84:87], a[176:179], v[252:255]
    ds_write_b64 v21, v[200:201] offset:23040
    v_mfma_f32_16x16x32_bf16 v[216:219], a[88:91], a[180:183], v[216:219]
    buffer_load_dwordx4 v5, s[36:39], s22 offen offset:3264 nt lds
    v_cvt_pk_bf16_f32 v209, v210, v211
    v_mfma_f32_16x16x32_bf16 v[220:223], a[88:91], a[184:187], v[220:223]
    ds_read_b128 v[160:163], v24 offset:384
    v_cvt_pk_bf16_f32 v212, v212, v213
    v_mfma_f32_16x16x32_bf16 v[224:227], a[88:91], a[188:191], v[224:227]
    ds_write_b64 v21, v[204:205] offset:24064
    v_mfma_f32_16x16x32_bf16 v[228:231], a[88:91], a[192:195], v[228:231]
    v_add_u32 v22, 0xffffac00, v22
    ds_read_b128 a[40:43], v22
    v_mfma_f32_16x16x32_bf16 v[232:235], a[88:91], a[196:199], v[232:235]
    ds_read_b128 a[44:47], v22 offset:1024
    ds_read_b128 a[48:51], v22 offset:2048
    v_mfma_f32_16x16x32_bf16 v[236:239], a[92:95], a[180:183], v[236:239]
    ds_read_b128 a[52:55], v22 offset:3072
    ds_read_b128 a[56:59], v22 offset:4096
    v_mfma_f32_16x16x32_bf16 v[240:243], a[92:95], a[184:187], v[240:243]
    v_add_u32 v23, 0xffffac00, v23
    ds_read_b128 a[60:63], v23
    v_mfma_f32_16x16x32_bf16 v[244:247], a[92:95], a[188:191], v[244:247]
    ds_read_b128 a[64:67], v23 offset:1024
    ds_read_b128 a[68:71], v23 offset:2048
    v_mfma_f32_16x16x32_bf16 v[248:251], a[92:95], a[192:195], v[248:251]
    ds_read_b128 a[72:75], v23 offset:3072
    ds_read_b128 a[76:79], v23 offset:4096
    v_mfma_f32_16x16x32_bf16 v[252:255], a[92:95], a[196:199], v[252:255]
    v_cvt_pk_bf16_f32 v213, v214, v215
    ds_read_b128 v[164:167], v25 offset:384
    v_mfma_f32_16x16x32_bf16 v[216:219], a[96:99], a[120:123], v[216:219]
    ds_write_b64 v21, v[208:209] offset:25088
    v_mfma_f32_16x16x32_bf16 v[220:223], a[96:99], a[124:127], v[220:223]
    s_add_u32 m0, s21, 104448
    s_mov_b32 s22, 81920
    buffer_load_dwordx4 v2, s[32:35], s22 offen nt lds
    v_mfma_f32_16x16x32_bf16 v[224:227], a[96:99], a[128:131], v[224:227]
    ds_write_b64 v21, v[212:213] offset:26112
    v_mfma_f32_16x16x32_bf16 v[228:231], a[96:99], a[132:135], v[228:231]
    v_mfma_f32_16x16x32_bf16 v[232:235], a[96:99], a[136:139], v[232:235]
    v_mfma_f32_16x16x32_bf16 v[236:239], a[100:103], a[120:123], v[236:239]
    v_mfma_f32_16x16x32_bf16 v[240:243], a[100:103], a[124:127], v[240:243]
    v_mfma_f32_16x16x32_bf16 v[244:247], a[100:103], a[128:131], v[244:247]
    v_mfma_f32_16x16x32_bf16 v[248:251], a[100:103], a[132:135], v[248:251]
    v_mfma_f32_16x16x32_bf16 v[252:255], a[100:103], a[136:139], v[252:255]
    s_waitcnt vmcnt(13) lgkmcnt(0)
    s_barrier
    v_mfma_f32_16x16x32_bf16 v[216:219], a[104:107], a[140:143], v[216:219]
    ds_read_b128 a[216:219], v24 offset:17408
    ds_read_b128 a[220:223], v25 offset:17408
    v_mfma_f32_16x16x32_bf16 v[220:223], a[104:107], a[144:147], v[220:223]
    ds_read_b128 a[200:203], v24 offset:17536
    ds_read_b128 a[80:83], v22 offset:21504
    v_mfma_f32_16x16x32_bf16 v[224:227], a[104:107], a[148:151], v[224:227]
    buffer_load_dwordx4 v3, s[32:35], s22 offen offset:1088 nt lds
    ds_read_b128 a[84:87], v22 offset:22528
    v_mfma_f32_16x16x32_bf16 v[228:231], a[104:107], a[152:155], v[228:231]
    v_cvt_pk_bf16_f32 v216, v216, v217
    v_cvt_pk_bf16_f32 v217, v218, v219
    v_mfma_f32_16x16x32_bf16 v[232:235], a[104:107], a[156:159], v[232:235]
    v_cvt_pk_bf16_f32 v220, v220, v221
    v_cvt_pk_bf16_f32 v221, v222, v223
    v_mfma_f32_16x16x32_bf16 v[236:239], a[108:111], a[140:143], v[236:239]
    ds_write_b64 v21, v[216:217]
    v_mfma_f32_16x16x32_bf16 v[240:243], a[108:111], a[144:147], v[240:243]
    v_cvt_pk_bf16_f32 v224, v224, v225
    v_cvt_pk_bf16_f32 v225, v226, v227
    v_mfma_f32_16x16x32_bf16 v[244:247], a[108:111], a[148:151], v[244:247]
    ds_write_b64 v21, v[220:221] offset:1024
    v_mfma_f32_16x16x32_bf16 v[248:251], a[108:111], a[152:155], v[248:251]
    v_cvt_pk_bf16_f32 v228, v228, v229
    v_cvt_pk_bf16_f32 v229, v230, v231
    v_mfma_f32_16x16x32_bf16 v[252:255], a[108:111], a[156:159], v[252:255]
    v_xor_b32 v17, 4096, v15
    v_xor_b32 v18, 4096, v16
    v_mfma_f32_16x16x32_bf16 v[36:39], v[56:59], a[0:3], 0
    ds_write_b64 v21, v[224:225] offset:2048
    v_mfma_f32_16x16x32_bf16 v[40:43], v[56:59], a[4:7], 0
    v_cvt_pk_bf16_f32 v232, v232, v233
    ds_read_b128 a[88:91], v22 offset:23552
    v_mfma_f32_16x16x32_bf16 v[44:47], v[56:59], a[8:11], 0
    ds_write_b64 v21, v[228:229] offset:3072
    v_mfma_f32_16x16x32_bf16 v[48:51], v[56:59], a[12:15], 0
    buffer_load_dwordx4 v4, s[32:35], s22 offen offset:2176 nt lds
    ds_read_b128 a[92:95], v22 offset:24576
    v_mfma_f32_16x16x32_bf16 v[52:55], v[56:59], a[16:19], 0
    v_cvt_pk_bf16_f32 v233, v234, v235
    ds_read_b128 a[96:99], v22 offset:25600
    v_mfma_f32_16x16x32_bf16 v[36:39], v[60:63], a[20:23], v[36:39]
    ds_read_b128 a[204:207], v25 offset:17536
    ds_read_b128 a[100:103], v23 offset:21504
    v_mfma_f32_16x16x32_bf16 v[40:43], v[60:63], a[24:27], v[40:43]
    v_cvt_pk_bf16_f32 v236, v236, v237
    ds_read_b128 a[104:107], v23 offset:22528
    v_mfma_f32_16x16x32_bf16 v[44:47], v[60:63], a[28:31], v[44:47]
    ds_read_b128 a[108:111], v23 offset:23552
    ds_read_b128 a[112:115], v23 offset:24576
    v_mfma_f32_16x16x32_bf16 v[48:51], v[60:63], a[32:35], v[48:51]
    ds_write_b64 v21, v[232:233] offset:4096
    v_mfma_f32_16x16x32_bf16 v[52:55], v[60:63], a[36:39], v[52:55]
    v_cvt_pk_bf16_f32 v237, v238, v239
    ds_read_b128 a[116:119], v23 offset:25600
    v_mfma_f32_16x16x32_bf16 v[36:39], v[64:67], a[40:43], v[36:39]
    ds_read_b128 a[208:211], v24 offset:17664
    v_cvt_pk_bf16_f32 v240, v240, v241
    v_mfma_f32_16x16x32_bf16 v[40:43], v[64:67], a[44:47], v[40:43]
    v_cvt_pk_bf16_f32 v241, v242, v243
    v_cvt_pk_bf16_f32 v244, v244, v245
    v_mfma_f32_16x16x32_bf16 v[44:47], v[64:67], a[48:51], v[44:47]
    ds_write_b64 v21, v[236:237] offset:512
    v_mfma_f32_16x16x32_bf16 v[48:51], v[64:67], a[52:55], v[48:51]
    ds_read_b128 a[212:215], v25 offset:17664
    v_cvt_pk_bf16_f32 v245, v246, v247
    v_mfma_f32_16x16x32_bf16 v[52:55], v[64:67], a[56:59], v[52:55]
    buffer_load_dwordx4 v5, s[32:35], s22 offen offset:3264 nt lds
    v_cvt_pk_bf16_f32 v248, v248, v249
    v_mfma_f32_16x16x32_bf16 v[36:39], v[68:71], a[60:63], v[36:39]
    ds_write_b64 v21, v[240:241] offset:1536
    v_mfma_f32_16x16x32_bf16 v[40:43], v[68:71], a[64:67], v[40:43]
    ds_write_b64 v21, v[244:245] offset:2560
    v_mfma_f32_16x16x32_bf16 v[44:47], v[68:71], a[68:71], v[44:47]
    ds_read_b128 a[160:163], v24 offset:17792
    v_cvt_pk_bf16_f32 v249, v250, v251
    v_mfma_f32_16x16x32_bf16 v[48:51], v[68:71], a[72:75], v[48:51]
    v_cvt_pk_bf16_f32 v252, v252, v253
    v_cvt_pk_bf16_f32 v253, v254, v255
    v_mfma_f32_16x16x32_bf16 v[52:55], v[68:71], a[76:79], v[52:55]
    ds_write_b64 v21, v[248:249] offset:3584
    s_waitcnt lgkmcnt(15)
    v_mfma_f32_16x16x32_bf16 v[36:39], v[72:75], a[80:83], v[36:39]
    ds_read_b128 a[164:167], v25 offset:17792
    v_mfma_f32_16x16x32_bf16 v[40:43], v[72:75], a[84:87], v[40:43]
    ds_write_b64 v21, v[252:253] offset:4608
    v_mfma_f32_16x16x32_bf16 v[44:47], v[72:75], a[88:91], v[44:47]
    v_mfma_f32_16x16x32_bf16 v[48:51], v[72:75], a[92:95], v[48:51]
    s_waitcnt lgkmcnt(15)
    v_mfma_f32_16x16x32_bf16 v[52:55], v[72:75], a[96:99], v[52:55]
    s_waitcnt lgkmcnt(14)
    v_mfma_f32_16x16x32_bf16 v[36:39], v[76:79], a[100:103], v[36:39]
    s_add_u32 m0, s21, 34816
    s_mov_b32 s22, 49152
    buffer_load_dwordx4 v2, s[36:39], s22 offen nt lds
    s_waitcnt lgkmcnt(13)
    v_mfma_f32_16x16x32_bf16 v[40:43], v[76:79], a[104:107], v[40:43]
    s_waitcnt lgkmcnt(12)
    v_mfma_f32_16x16x32_bf16 v[44:47], v[76:79], a[108:111], v[44:47]
    s_waitcnt lgkmcnt(11)
    v_mfma_f32_16x16x32_bf16 v[48:51], v[76:79], a[112:115], v[48:51]
    s_waitcnt lgkmcnt(9)
    v_mfma_f32_16x16x32_bf16 v[52:55], v[76:79], a[116:119], v[52:55]
    v_mfma_f32_16x16x32_bf16 v[56:59], v[96:99], a[0:3], 0
    v_mfma_f32_16x16x32_bf16 v[60:63], v[96:99], a[4:7], 0
    v_mfma_f32_16x16x32_bf16 v[64:67], v[96:99], a[8:11], 0
    v_mfma_f32_16x16x32_bf16 v[68:71], v[96:99], a[12:15], 0
    v_mfma_f32_16x16x32_bf16 v[72:75], v[96:99], a[16:19], 0
    v_mfma_f32_16x16x32_bf16 v[56:59], v[100:103], a[20:23], v[56:59]
    v_mfma_f32_16x16x32_bf16 v[60:63], v[100:103], a[24:27], v[60:63]
    buffer_load_dwordx4 v3, s[36:39], s22 offen offset:1088 nt lds
    v_mfma_f32_16x16x32_bf16 v[64:67], v[100:103], a[28:31], v[64:67]
    v_mfma_f32_16x16x32_bf16 v[68:71], v[100:103], a[32:35], v[68:71]
    v_mfma_f32_16x16x32_bf16 v[72:75], v[100:103], a[36:39], v[72:75]
    v_mfma_f32_16x16x32_bf16 v[56:59], v[104:107], a[40:43], v[56:59]
    v_mfma_f32_16x16x32_bf16 v[60:63], v[104:107], a[44:47], v[60:63]
    v_mfma_f32_16x16x32_bf16 v[64:67], v[104:107], a[48:51], v[64:67]
    v_mfma_f32_16x16x32_bf16 v[68:71], v[104:107], a[52:55], v[68:71]
    v_mfma_f32_16x16x32_bf16 v[72:75], v[104:107], a[56:59], v[72:75]
    v_mfma_f32_16x16x32_bf16 v[56:59], v[108:111], a[60:63], v[56:59]
    s_waitcnt vmcnt(14) lgkmcnt(0)
    s_barrier
    v_mfma_f32_16x16x32_bf16 v[60:63], v[108:111], a[64:67], v[60:63]
    ds_read_b128 a[120:123], v22
    ds_read_b64_tr_b16 a[168:169], v10
    v_mfma_f32_16x16x32_bf16 v[64:67], v[108:111], a[68:71], v[64:67]
    buffer_load_dwordx4 v4, s[36:39], s22 offen offset:2176 nt lds
    ds_read_b128 a[124:127], v22 offset:1024
    v_mfma_f32_16x16x32_bf16 v[68:71], v[108:111], a[72:75], v[68:71]
    ds_read_b128 a[128:131], v22 offset:2048
    ds_read_b128 a[132:135], v22 offset:3072
    v_mfma_f32_16x16x32_bf16 v[72:75], v[108:111], a[76:79], v[72:75]
    ds_read_b64_tr_b16 a[170:171], v12
    ds_read_b128 a[136:139], v22 offset:4096
    v_mfma_f32_16x16x32_bf16 v[56:59], v[112:115], a[80:83], v[56:59]
    ds_read_b128 a[140:143], v23
    ds_read_b128 a[144:147], v23 offset:1024
    v_mfma_f32_16x16x32_bf16 v[60:63], v[112:115], a[84:87], v[60:63]
    ds_read_b128 a[148:151], v23 offset:2048
    ds_read_b64_tr_b16 a[172:173], v11
    v_mfma_f32_16x16x32_bf16 v[64:67], v[112:115], a[88:91], v[64:67]
    ds_read_b128 a[152:155], v23 offset:3072
    ds_read_b128 a[156:159], v23 offset:4096
    v_mfma_f32_16x16x32_bf16 v[68:71], v[112:115], a[92:95], v[68:71]
    ds_read_b64_tr_b16 a[174:175], v13
    ds_read_b64_tr_b16 a[176:177], v10 offset:128
    v_mfma_f32_16x16x32_bf16 v[72:75], v[112:115], a[96:99], v[72:75]
    ds_read_b64_tr_b16 a[178:179], v12 offset:128
    ds_read_b64_tr_b16 a[180:181], v11 offset:128
    v_mfma_f32_16x16x32_bf16 v[56:59], v[116:119], a[100:103], v[56:59]
    ds_read_b64_tr_b16 a[182:183], v13 offset:128
    ds_read_b64_tr_b16 a[184:185], v10 offset:256
    v_mfma_f32_16x16x32_bf16 v[60:63], v[116:119], a[104:107], v[60:63]
    ds_read_b64_tr_b16 a[186:187], v12 offset:256
    ds_read_b64_tr_b16 a[188:189], v11 offset:256
    v_mfma_f32_16x16x32_bf16 v[64:67], v[116:119], a[108:111], v[64:67]
    ds_read_b64_tr_b16 a[190:191], v13 offset:256
    ds_read_b64_tr_b16 a[192:193], v10 offset:384
    v_mfma_f32_16x16x32_bf16 v[68:71], v[116:119], a[112:115], v[68:71]
    buffer_load_dwordx4 v5, s[36:39], s22 offen offset:3264 nt lds
    ds_read_b64_tr_b16 a[194:195], v12 offset:384
    v_mfma_f32_16x16x32_bf16 v[72:75], v[116:119], a[116:119], v[72:75]
    ds_read_b64_tr_b16 a[196:197], v11 offset:384
    s_waitcnt lgkmcnt(15)
    v_mfma_f32_16x16x32_bf16 v[36:39], v[80:83], a[120:123], v[36:39]
    ds_read_b64_tr_b16 a[198:199], v13 offset:384
    v_mfma_f32_16x16x32_bf16 v[40:43], v[80:83], a[124:127], v[40:43]
    v_mfma_f32_16x16x32_bf16 v[44:47], v[80:83], a[128:131], v[44:47]
    v_mfma_f32_16x16x32_bf16 v[48:51], v[80:83], a[132:135], v[48:51]
    v_mfma_f32_16x16x32_bf16 v[52:55], v[80:83], a[136:139], v[52:55]
    v_mfma_f32_16x16x32_bf16 v[36:39], v[84:87], a[140:143], v[36:39]
    v_mfma_f32_16x16x32_bf16 v[40:43], v[84:87], a[144:147], v[40:43]
    v_mfma_f32_16x16x32_bf16 v[44:47], v[84:87], a[148:151], v[44:47]
    s_nop 5
    v_mul_f32 v36, s23, v36
    v_mul_f32 v37, s23, v37
    s_waitcnt lgkmcnt(14)
    v_mfma_f32_16x16x32_bf16 v[48:51], v[84:87], a[152:155], v[48:51]
    v_mul_f32 v38, s23, v38
    v_mul_f32 v39, s23, v39
    s_waitcnt lgkmcnt(13)
    v_mfma_f32_16x16x32_bf16 v[52:55], v[84:87], a[156:159], v[52:55]
    v_exp_f32 v36, v36
    v_exp_f32 v37, v37
    v_mfma_f32_16x16x32_bf16 v[56:59], v[120:123], a[120:123], v[56:59]
    v_exp_f32 v38, v38
    v_exp_f32 v39, v39
    v_add_f32 v26, v36, v37
    v_mfma_f32_16x16x32_bf16 v[60:63], v[120:123], a[124:127], v[60:63]
    v_add_f32 v26, v26, v38
    v_add_f32 v26, v26, v39
    v_mfma_f32_16x16x32_bf16 v[64:67], v[120:123], a[128:131], v[64:67]
    v_cvt_pk_bf16_f32 v36, v36, v37
    v_cvt_pk_bf16_f32 v37, v38, v39
    s_add_u32 m0, s21, 69632
    s_mov_b32 s22, 98304
    buffer_load_dwordx4 v2, s[32:35], s22 offen nt lds
    v_mfma_f32_16x16x32_bf16 v[68:71], v[120:123], a[132:135], v[68:71]
    v_add_u32 v14, 0x23000, v14
    ds_write_b64 v14, v[36:37]
    v_mfma_f32_16x16x32_bf16 v[72:75], v[120:123], a[136:139], v[72:75]
    v_mul_f32 v40, s23, v40
    v_mul_f32 v41, s23, v41
    v_mfma_f32_16x16x32_bf16 v[56:59], v[124:127], a[140:143], v[56:59]
    v_mul_f32 v42, s23, v42
    v_mul_f32 v43, s23, v43
    v_mfma_f32_16x16x32_bf16 v[60:63], v[124:127], a[144:147], v[60:63]
    v_exp_f32 v40, v40
    v_mfma_f32_16x16x32_bf16 v[64:67], v[124:127], a[148:151], v[64:67]
    v_exp_f32 v41, v41
    v_exp_f32 v42, v42
    v_exp_f32 v43, v43
    v_mul_f32 v44, s23, v44
    v_mul_f32 v45, s23, v45
    v_mul_f32 v46, s23, v46
    v_mul_f32 v47, s23, v47
    v_exp_f32 v44, v44
    v_exp_f32 v45, v45
    v_exp_f32 v46, v46
    v_exp_f32 v47, v47
    v_mul_f32 v48, s23, v48
    v_mul_f32 v49, s23, v49
    v_mul_f32 v50, s23, v50
    v_mul_f32 v51, s23, v51
    v_exp_f32 v48, v48
    v_exp_f32 v49, v49
    v_exp_f32 v50, v50
    v_exp_f32 v51, v51
    v_mul_f32 v52, s23, v52
    v_mul_f32 v53, s23, v53
    v_mul_f32 v54, s23, v54
    v_mul_f32 v55, s23, v55
    v_exp_f32 v52, v52
    v_exp_f32 v53, v53
    v_exp_f32 v54, v54
    v_exp_f32 v55, v55
    v_mul_f32 v56, s23, v56
    v_mfma_f32_16x16x32_bf16 v[68:71], v[124:127], a[152:155], v[68:71]
    v_add_f32 v27, v40, v41
    v_mul_f32 v57, s23, v57
    v_mfma_f32_16x16x32_bf16 v[72:75], v[124:127], a[156:159], v[72:75]
    v_add_f32 v27, v27, v42
    v_mul_f32 v58, s23, v58
    v_mfma_f32_16x16x32_bf16 v[76:79], v[136:139], a[0:3], 0
    v_add_f32 v27, v27, v43
    v_cvt_pk_bf16_f32 v40, v40, v41
    v_mul_f32 v59, s23, v59
    v_mfma_f32_16x16x32_bf16 v[80:83], v[136:139], a[4:7], 0
    v_cvt_pk_bf16_f32 v41, v42, v43
    v_exp_f32 v56, v56
    v_exp_f32 v57, v57
    v_mfma_f32_16x16x32_bf16 v[84:87], v[136:139], a[8:11], 0
    ds_write_b64 v14, v[40:41] offset:512
    v_exp_f32 v58, v58
    v_mfma_f32_16x16x32_bf16 v[88:91], v[136:139], a[12:15], 0
    v_exp_f32 v59, v59
    v_add_f32 v26, v26, v56
    buffer_load_dwordx4 v3, s[32:35], s22 offen offset:1088 nt lds
    v_mfma_f32_16x16x32_bf16 v[92:95], v[136:139], a[16:19], 0
    v_add_f32 v26, v26, v57
    v_add_f32 v28, v44, v45
    v_mfma_f32_16x16x32_bf16 v[76:79], v[140:143], a[20:23], v[76:79]
    v_add_f32 v26, v26, v58
    v_add_f32 v28, v28, v46
    v_mfma_f32_16x16x32_bf16 v[80:83], v[140:143], a[24:27], v[80:83]
    v_add_f32 v28, v28, v47
    v_add_f32 v26, v26, v59
    v_mfma_f32_16x16x32_bf16 v[84:87], v[140:143], a[28:31], v[84:87]
    v_cvt_pk_bf16_f32 v44, v44, v45
    v_cvt_pk_bf16_f32 v45, v46, v47
    v_cvt_pk_bf16_f32 v56, v56, v57
    v_mfma_f32_16x16x32_bf16 v[88:91], v[140:143], a[32:35], v[88:91]
    v_cvt_pk_bf16_f32 v57, v58, v59
    v_mul_f32 v60, s23, v60
    v_mfma_f32_16x16x32_bf16 v[92:95], v[140:143], a[36:39], v[92:95]
    ds_write_b64 v14, v[44:45] offset:1024
    v_mfma_f32_16x16x32_bf16 v[76:79], v[144:147], a[40:43], v[76:79]
    v_mul_f32 v61, s23, v61
    v_mul_f32 v62, s23, v62
    v_mfma_f32_16x16x32_bf16 v[80:83], v[144:147], a[44:47], v[80:83]
    v_add_f32 v29, v48, v49
    v_mul_f32 v63, s23, v63
    v_mfma_f32_16x16x32_bf16 v[84:87], v[144:147], a[48:51], v[84:87]
    v_add_f32 v29, v29, v50
    buffer_load_dwordx4 v4, s[32:35], s22 offen offset:2176 nt lds
    v_mfma_f32_16x16x32_bf16 v[88:91], v[144:147], a[52:55], v[88:91]
    v_exp_f32 v60, v60
    v_mfma_f32_16x16x32_bf16 v[92:95], v[144:147], a[56:59], v[92:95]
    v_add_f32 v29, v29, v51
    v_cvt_pk_bf16_f32 v48, v48, v49
    v_mfma_f32_16x16x32_bf16 v[76:79], v[148:151], a[60:63], v[76:79]
    v_exp_f32 v61, v61
    v_mfma_f32_16x16x32_bf16 v[80:83], v[148:151], a[64:67], v[80:83]
    v_cvt_pk_bf16_f32 v49, v50, v51
    v_exp_f32 v62, v62
    v_mfma_f32_16x16x32_bf16 v[84:87], v[148:151], a[68:71], v[84:87]
    ds_write_b64 v14, v[48:49] offset:1536
    v_exp_f32 v63, v63
    v_mfma_f32_16x16x32_bf16 v[88:91], v[148:151], a[72:75], v[88:91]
    v_add_f32 v27, v27, v60
    v_add_f32 v27, v27, v61
    v_mfma_f32_16x16x32_bf16 v[92:95], v[148:151], a[76:79], v[92:95]
    v_add_f32 v27, v27, v62
    v_add_f32 v30, v52, v53
    v_mfma_f32_16x16x32_bf16 v[76:79], v[152:155], a[80:83], v[76:79]
    v_add_f32 v27, v27, v63
    v_add_f32 v30, v30, v54
    v_mfma_f32_16x16x32_bf16 v[80:83], v[152:155], a[84:87], v[80:83]
    v_cvt_pk_bf16_f32 v60, v60, v61
    v_add_f32 v30, v30, v55
    v_mfma_f32_16x16x32_bf16 v[84:87], v[152:155], a[88:91], v[84:87]
    v_cvt_pk_bf16_f32 v52, v52, v53
    v_cvt_pk_bf16_f32 v61, v62, v63
    v_mfma_f32_16x16x32_bf16 v[88:91], v[152:155], a[92:95], v[88:91]
    v_cvt_pk_bf16_f32 v53, v54, v55
    v_mul_f32 v64, s23, v64
    v_mfma_f32_16x16x32_bf16 v[92:95], v[152:155], a[96:99], v[92:95]
    ds_write_b64 v14, v[52:53] offset:2048
    v_mfma_f32_16x16x32_bf16 v[76:79], v[156:159], a[100:103], v[76:79]
    v_mul_f32 v65, s23, v65
    buffer_load_dwordx4 v5, s[32:35], s22 offen offset:3264 nt lds
    v_mfma_f32_16x16x32_bf16 v[80:83], v[156:159], a[104:107], v[80:83]
    v_mul_f32 v66, s23, v66
    v_mul_f32 v67, s23, v67
    v_mfma_f32_16x16x32_bf16 v[84:87], v[156:159], a[108:111], v[84:87]
    v_exp_f32 v64, v64
    v_mfma_f32_16x16x32_bf16 v[88:91], v[156:159], a[112:115], v[88:91]
    v_exp_f32 v65, v65
    v_mfma_f32_16x16x32_bf16 v[92:95], v[156:159], a[116:119], v[92:95]
    s_waitcnt lgkmcnt(0)
    s_barrier
    ds_write_b64 v14, v[56:57] offset:10240
    ds_write_b64 v14, v[60:61] offset:10752
    v_exp_f32 v66, v66
    v_mfma_f32_16x16x32_bf16 v[76:79], v[160:163], a[120:123], v[76:79]
    v_exp_f32 v67, v67
    v_add_f32 v28, v28, v64
    v_mfma_f32_16x16x32_bf16 v[80:83], v[160:163], a[124:127], v[80:83]
    v_add_f32 v28, v28, v65
    v_add_u32 v19, 0x23000, v19
    ds_read_b64 v[38:39], v19
    v_mfma_f32_16x16x32_bf16 v[84:87], v[160:163], a[128:131], v[84:87]
    v_add_f32 v28, v28, v66
    ds_read_b64 v[42:43], v19 offset:512
    v_mfma_f32_16x16x32_bf16 v[88:91], v[160:163], a[132:135], v[88:91]
    v_add_f32 v28, v28, v67
    ds_read_b64 v[46:47], v19 offset:1024
    v_mfma_f32_16x16x32_bf16 v[92:95], v[160:163], a[136:139], v[92:95]
    v_cvt_pk_bf16_f32 v64, v64, v65
    ds_read_b64 v[50:51], v19 offset:1536
    v_mfma_f32_16x16x32_bf16 v[76:79], v[164:167], a[140:143], v[76:79]
    v_cvt_pk_bf16_f32 v65, v66, v67
    ds_read_b64 v[54:55], v19 offset:2048
    v_mfma_f32_16x16x32_bf16 v[80:83], v[164:167], a[144:147], v[80:83]
    s_add_u32 m0, s21, 87040
    s_mov_b32 s22, 65536
    buffer_load_dwordx4 v2, s[36:39], s22 offen nt lds
    v_mfma_f32_16x16x32_bf16 v[84:87], v[164:167], a[148:151], v[84:87]
    ds_write_b64 v14, v[64:65] offset:11264
    v_mul_f32 v68, s23, v68
    v_mfma_f32_16x16x32_bf16 v[88:91], v[164:167], a[152:155], v[88:91]
    v_mul_f32 v69, s23, v69
    v_mul_f32 v70, s23, v70
    v_mfma_f32_16x16x32_bf16 v[92:95], v[164:167], a[156:159], v[92:95]
    v_mul_f32 v71, s23, v71
    s_waitcnt lgkmcnt(5)
    v_mfma_f32_16x16x32_bf16 v[96:99], a[224:227], v[36:39], 0
    v_exp_f32 v68, v68
    s_waitcnt lgkmcnt(4)
    v_mfma_f32_16x16x32_bf16 v[100:103], a[224:227], v[40:43], 0
    v_exp_f32 v69, v69
    s_waitcnt lgkmcnt(3)
    v_mfma_f32_16x16x32_bf16 v[104:107], a[224:227], v[44:47], 0
    v_exp_f32 v70, v70
    s_waitcnt lgkmcnt(2)
    v_mfma_f32_16x16x32_bf16 v[108:111], a[224:227], v[48:51], 0
    v_exp_f32 v71, v71
    s_waitcnt lgkmcnt(1)
    v_mfma_f32_16x16x32_bf16 v[112:115], a[224:227], v[52:55], 0
    v_add_f32 v29, v29, v68
    v_add_f32 v29, v29, v69
    v_mfma_f32_16x16x32_bf16 v[116:119], a[228:231], v[36:39], 0
    v_add_f32 v29, v29, v70
    buffer_load_dwordx4 v3, s[36:39], s22 offen offset:1088 nt lds
    v_mfma_f32_16x16x32_bf16 v[120:123], a[228:231], v[40:43], 0
    v_add_f32 v29, v29, v71
    v_cvt_pk_bf16_f32 v68, v68, v69
    v_mfma_f32_16x16x32_bf16 v[124:127], a[228:231], v[44:47], 0
    v_cvt_pk_bf16_f32 v69, v70, v71
    v_mul_f32 v72, s23, v72
    v_mfma_f32_16x16x32_bf16 v[128:131], a[228:231], v[48:51], 0
    ds_write_b64 v14, v[68:69] offset:11776
    v_mfma_f32_16x16x32_bf16 v[132:135], a[228:231], v[52:55], 0
    v_mul_f32 v73, s23, v73
    v_mul_f32 v74, s23, v74
    v_mfma_f32_16x16x32_bf16 v[136:139], a[232:235], v[36:39], 0
    v_mul_f32 v75, s23, v75
    v_mfma_f32_16x16x32_bf16 v[140:143], a[232:235], v[40:43], 0
    v_exp_f32 v72, v72
    v_mfma_f32_16x16x32_bf16 v[144:147], a[232:235], v[44:47], 0
    v_exp_f32 v73, v73
    v_mfma_f32_16x16x32_bf16 v[148:151], a[232:235], v[48:51], 0
    v_exp_f32 v74, v74
    v_mfma_f32_16x16x32_bf16 v[152:155], a[232:235], v[52:55], 0
    v_exp_f32 v75, v75
    v_mfma_f32_16x16x32_bf16 v[156:159], a[236:239], v[36:39], 0
    buffer_load_dwordx4 v4, s[36:39], s22 offen offset:2176 nt lds
    v_add_f32 v30, v30, v72
    v_mfma_f32_16x16x32_bf16 v[160:163], a[236:239], v[40:43], 0
    v_add_f32 v30, v30, v73
    v_add_f32 v30, v30, v74
    v_mfma_f32_16x16x32_bf16 v[164:167], a[236:239], v[44:47], 0
    v_add_f32 v30, v30, v75
    v_cvt_pk_bf16_f32 v72, v72, v73
    v_mfma_f32_16x16x32_bf16 v[168:171], a[236:239], v[48:51], 0
    v_cvt_pk_bf16_f32 v73, v74, v75
    v_mul_f32 v76, s23, v76
    v_mfma_f32_16x16x32_bf16 v[172:175], a[236:239], v[52:55], 0
    ds_write_b64 v14, v[72:73] offset:12288
    v_mfma_f32_16x16x32_bf16 v[176:179], a[240:243], v[36:39], 0
    v_mul_f32 v77, s23, v77
    v_mul_f32 v78, s23, v78
    v_mfma_f32_16x16x32_bf16 v[180:183], a[240:243], v[40:43], 0
    v_mul_f32 v79, s23, v79
    v_mfma_f32_16x16x32_bf16 v[184:187], a[240:243], v[44:47], 0
    v_exp_f32 v76, v76
    v_mfma_f32_16x16x32_bf16 v[188:191], a[240:243], v[48:51], 0
    v_exp_f32 v77, v77
    v_mfma_f32_16x16x32_bf16 v[192:195], a[240:243], v[52:55], 0
    v_exp_f32 v78, v78
    v_mfma_f32_16x16x32_bf16 v[196:199], a[244:247], v[36:39], 0
    v_exp_f32 v79, v79
    v_mfma_f32_16x16x32_bf16 v[200:203], a[244:247], v[40:43], 0
    buffer_load_dwordx4 v5, s[36:39], s22 offen offset:3264 nt lds
    v_add_f32 v26, v26, v76
    v_mfma_f32_16x16x32_bf16 v[204:207], a[244:247], v[44:47], 0
    v_add_f32 v26, v26, v77
    v_add_f32 v26, v26, v78
    v_mfma_f32_16x16x32_bf16 v[208:211], a[244:247], v[48:51], 0
    v_add_f32 v26, v26, v79
    v_cvt_pk_bf16_f32 v76, v76, v77
    v_mfma_f32_16x16x32_bf16 v[212:215], a[244:247], v[52:55], 0
    s_waitcnt vmcnt(16) lgkmcnt(0)
    s_barrier
    v_mfma_f32_16x16x32_bf16 v[216:219], a[248:251], v[36:39], 0
    v_add_u32 v24, 0xffff3400, v24
    ds_read_b128 a[224:227], v24
    v_mfma_f32_16x16x32_bf16 v[220:223], a[248:251], v[40:43], 0
    v_add_u32 v25, 0xffff3400, v25
    ds_read_b128 a[228:231], v25
    v_mfma_f32_16x16x32_bf16 v[224:227], a[248:251], v[44:47], 0
    v_cvt_pk_bf16_f32 v77, v78, v79
    ds_read_b128 a[232:235], v24 offset:128
    v_mfma_f32_16x16x32_bf16 v[228:231], a[248:251], v[48:51], 0
    ds_read_b64 v[58:59], v19 offset:10240
    ds_read_b64 v[62:63], v19 offset:10752
    v_mfma_f32_16x16x32_bf16 v[232:235], a[248:251], v[52:55], 0
    ds_write_b64 v14, v[76:77]
    v_mfma_f32_16x16x32_bf16 v[236:239], a[252:255], v[36:39], 0
    v_mul_f32 v80, s23, v80
    ds_read_b64 v[66:67], v19 offset:11264
    v_mfma_f32_16x16x32_bf16 v[240:243], a[252:255], v[40:43], 0
    v_mul_f32 v81, s23, v81
    ds_read_b128 a[236:239], v25 offset:128
    v_mfma_f32_16x16x32_bf16 v[244:247], a[252:255], v[44:47], 0
    s_add_u32 m0, s21, 121856
    s_mov_b32 s22, 114688
    buffer_load_dwordx4 v2, s[32:35], s22 offen nt lds
    v_mfma_f32_16x16x32_bf16 v[248:251], a[252:255], v[48:51], 0
    ds_read_b64 v[70:71], v19 offset:11776
    v_mul_f32 v82, s23, v82
    v_mfma_f32_16x16x32_bf16 v[252:255], a[252:255], v[52:55], 0
    ds_read_b64 v[74:75], v19 offset:12288
    v_mul_f32 v83, s23, v83
    v_mfma_f32_16x16x32_bf16 v[36:39], a[216:219], a[0:3], 0
    v_exp_f32 v80, v80
    v_mfma_f32_16x16x32_bf16 v[40:43], a[216:219], a[4:7], 0
    ds_read_b128 a[240:243], v24 offset:256
    ds_read_b128 a[244:247], v25 offset:256
    v_mfma_f32_16x16x32_bf16 v[44:47], a[216:219], a[8:11], 0
    v_exp_f32 v81, v81
    v_mfma_f32_16x16x32_bf16 v[48:51], a[216:219], a[12:15], 0
    v_exp_f32 v82, v82
    v_mfma_f32_16x16x32_bf16 v[52:55], a[216:219], a[16:19], 0
    v_exp_f32 v83, v83
    v_mfma_f32_16x16x32_bf16 v[36:39], a[220:223], a[20:23], v[36:39]
    v_add_f32 v27, v27, v80
    v_add_f32 v27, v27, v81
    v_mfma_f32_16x16x32_bf16 v[40:43], a[220:223], a[24:27], v[40:43]
    v_add_f32 v27, v27, v82
    ds_read_b128 a[248:251], v24 offset:384
    v_mfma_f32_16x16x32_bf16 v[44:47], a[220:223], a[28:31], v[44:47]
    v_add_f32 v27, v27, v83
    v_cvt_pk_bf16_f32 v80, v80, v81
    v_mfma_f32_16x16x32_bf16 v[48:51], a[220:223], a[32:35], v[48:51]
    buffer_load_dwordx4 v3, s[32:35], s22 offen offset:1088 nt lds
    v_cvt_pk_bf16_f32 v81, v82, v83
    v_mfma_f32_16x16x32_bf16 v[52:55], a[220:223], a[36:39], v[52:55]
    ds_read_b128 a[252:255], v25 offset:384
    v_mul_f32 v84, s23, v84
    v_mfma_f32_16x16x32_bf16 v[36:39], a[200:203], a[40:43], v[36:39]
    ds_write_b64 v14, v[80:81] offset:512
    v_mfma_f32_16x16x32_bf16 v[40:43], a[200:203], a[44:47], v[40:43]
    ds_read_b64_tr_b16 a[216:217], v10 offset:52224
    v_mul_f32 v85, s23, v85
    v_mfma_f32_16x16x32_bf16 v[44:47], a[200:203], a[48:51], v[44:47]
    v_mul_f32 v86, s23, v86
    v_mul_f32 v87, s23, v87
    v_mfma_f32_16x16x32_bf16 v[48:51], a[200:203], a[52:55], v[48:51]
    ds_read_b64_tr_b16 a[218:219], v12 offset:52224
    ds_read_b64_tr_b16 a[220:221], v11 offset:52224
    v_mfma_f32_16x16x32_bf16 v[52:55], a[200:203], a[56:59], v[52:55]
    v_exp_f32 v84, v84
    v_mfma_f32_16x16x32_bf16 v[36:39], a[204:207], a[60:63], v[36:39]
    v_exp_f32 v85, v85
    v_mfma_f32_16x16x32_bf16 v[40:43], a[204:207], a[64:67], v[40:43]
    v_exp_f32 v86, v86
    v_mfma_f32_16x16x32_bf16 v[44:47], a[204:207], a[68:71], v[44:47]
    v_exp_f32 v87, v87
    v_mfma_f32_16x16x32_bf16 v[48:51], a[204:207], a[72:75], v[48:51]
    v_add_f32 v28, v28, v84
    v_add_f32 v28, v28, v85
    v_mfma_f32_16x16x32_bf16 v[52:55], a[204:207], a[76:79], v[52:55]
    buffer_load_dwordx4 v4, s[32:35], s22 offen offset:2176 nt lds
    ds_read_b64_tr_b16 a[222:223], v13 offset:52224
    v_mfma_f32_16x16x32_bf16 v[36:39], a[208:211], a[80:83], v[36:39]
    v_add_f32 v28, v28, v86
    v_add_f32 v28, v28, v87
    v_mfma_f32_16x16x32_bf16 v[40:43], a[208:211], a[84:87], v[40:43]
    ds_read_b64_tr_b16 a[200:201], v10 offset:52352
    v_cvt_pk_bf16_f32 v84, v84, v85
    v_mfma_f32_16x16x32_bf16 v[44:47], a[208:211], a[88:91], v[44:47]
    v_cvt_pk_bf16_f32 v85, v86, v87
    ds_read_b64_tr_b16 a[202:203], v12 offset:52352
    v_mfma_f32_16x16x32_bf16 v[48:51], a[208:211], a[92:95], v[48:51]
    ds_write_b64 v14, v[84:85] offset:1024
    v_mfma_f32_16x16x32_bf16 v[52:55], a[208:211], a[96:99], v[52:55]
    v_mul_f32 v88, s23, v88
    v_mul_f32 v89, s23, v89
    v_mfma_f32_16x16x32_bf16 v[36:39], a[212:215], a[100:103], v[36:39]
    ds_read_b64_tr_b16 a[204:205], v11 offset:52352
    v_mul_f32 v90, s23, v90
    v_mfma_f32_16x16x32_bf16 v[40:43], a[212:215], a[104:107], v[40:43]
    v_mul_f32 v91, s23, v91
    ds_read_b64_tr_b16 a[206:207], v13 offset:52352
    v_mfma_f32_16x16x32_bf16 v[44:47], a[212:215], a[108:111], v[44:47]
    v_exp_f32 v88, v88
    v_mfma_f32_16x16x32_bf16 v[48:51], a[212:215], a[112:115], v[48:51]
    v_exp_f32 v89, v89
    v_mfma_f32_16x16x32_bf16 v[52:55], a[212:215], a[116:119], v[52:55]
    v_exp_f32 v90, v90
    v_mfma_f32_16x16x32_bf16 v[36:39], a[160:163], a[120:123], v[36:39]
    buffer_load_dwordx4 v5, s[32:35], s22 offen offset:3264 nt lds
    ds_read_b64_tr_b16 a[208:209], v10 offset:52480
    v_mfma_f32_16x16x32_bf16 v[40:43], a[160:163], a[124:127], v[40:43]
    v_exp_f32 v91, v91
    v_mfma_f32_16x16x32_bf16 v[44:47], a[160:163], a[128:131], v[44:47]
    v_add_f32 v29, v29, v88
    v_add_f32 v29, v29, v89
    v_mfma_f32_16x16x32_bf16 v[48:51], a[160:163], a[132:135], v[48:51]
    v_add_f32 v29, v29, v90
    ds_read_b64_tr_b16 a[210:211], v12 offset:52480
    v_mfma_f32_16x16x32_bf16 v[52:55], a[160:163], a[136:139], v[52:55]
    v_add_f32 v29, v29, v91
    v_cvt_pk_bf16_f32 v88, v88, v89
    v_mfma_f32_16x16x32_bf16 v[36:39], a[164:167], a[140:143], v[36:39]
    v_cvt_pk_bf16_f32 v89, v90, v91
    ds_read_b64_tr_b16 a[212:213], v11 offset:52480
    v_mfma_f32_16x16x32_bf16 v[40:43], a[164:167], a[144:147], v[40:43]
    ds_write_b64 v14, v[88:89] offset:1536
    v_mfma_f32_16x16x32_bf16 v[44:47], a[164:167], a[148:151], v[44:47]
    v_mul_f32 v92, s23, v92
    ds_read_b64_tr_b16 a[214:215], v13 offset:52480
    v_mfma_f32_16x16x32_bf16 v[48:51], a[164:167], a[152:155], v[48:51]
    v_mul_f32 v93, s23, v93
    v_mul_f32 v94, s23, v94
    v_mfma_f32_16x16x32_bf16 v[52:55], a[164:167], a[156:159], v[52:55]
    v_mul_f32 v95, s23, v95
    s_waitcnt lgkmcnt(15)
    v_mfma_f32_16x16x32_bf16 v[96:99], a[168:171], v[56:59], v[96:99]
    ds_read_b64_tr_b16 a[160:161], v10 offset:52608
    ds_read_b64_tr_b16 a[162:163], v12 offset:52608
    v_mfma_f32_16x16x32_bf16 v[100:103], a[168:171], v[60:63], v[100:103]
    s_add_u32 m0, s21, 0
    s_mov_b32 s22, 81920
    buffer_load_dwordx4 v2, s[36:39], s22 offen nt lds
    v_mfma_f32_16x16x32_bf16 v[104:107], a[168:171], v[64:67], v[104:107]
    v_exp_f32 v92, v92
    v_mfma_f32_16x16x32_bf16 v[108:111], a[168:171], v[68:71], v[108:111]
    v_exp_f32 v93, v93
    v_mfma_f32_16x16x32_bf16 v[112:115], a[168:171], v[72:75], v[112:115]
    v_exp_f32 v94, v94
    v_mfma_f32_16x16x32_bf16 v[116:119], a[172:175], v[56:59], v[116:119]
    v_exp_f32 v95, v95
    v_mfma_f32_16x16x32_bf16 v[120:123], a[172:175], v[60:63], v[120:123]
    v_add_f32 v30, v30, v92
    v_add_f32 v30, v30, v93
    v_mfma_f32_16x16x32_bf16 v[124:127], a[172:175], v[64:67], v[124:127]
    ds_read_b64_tr_b16 a[164:165], v11 offset:52608
    v_add_f32 v30, v30, v94
    v_mfma_f32_16x16x32_bf16 v[128:131], a[172:175], v[68:71], v[128:131]
    v_add_f32 v30, v30, v95
    v_cvt_pk_bf16_f32 v92, v92, v93
    v_mfma_f32_16x16x32_bf16 v[132:135], a[172:175], v[72:75], v[132:135]
    ds_read_b64_tr_b16 a[166:167], v13 offset:52608
    v_cvt_pk_bf16_f32 v93, v94, v95
    v_mfma_f32_16x16x32_bf16 v[136:139], a[176:179], v[56:59], v[136:139]
    ds_write_b64 v14, v[92:93] offset:2048
    v_mfma_f32_16x16x32_bf16 v[140:143], a[176:179], v[60:63], v[140:143]
    v_mul_f32 v36, s23, v36
    v_mul_f32 v37, s23, v37
    v_mfma_f32_16x16x32_bf16 v[144:147], a[176:179], v[64:67], v[144:147]
    buffer_load_dwordx4 v3, s[36:39], s22 offen offset:1088 nt lds
    v_mul_f32 v38, s23, v38
    v_mfma_f32_16x16x32_bf16 v[148:151], a[176:179], v[68:71], v[148:151]
    v_mul_f32 v39, s23, v39
    v_mfma_f32_16x16x32_bf16 v[152:155], a[176:179], v[72:75], v[152:155]
    v_exp_f32 v36, v36
    v_mfma_f32_16x16x32_bf16 v[156:159], a[180:183], v[56:59], v[156:159]
    v_exp_f32 v37, v37
    v_mfma_f32_16x16x32_bf16 v[160:163], a[180:183], v[60:63], v[160:163]
    v_exp_f32 v38, v38
    v_mfma_f32_16x16x32_bf16 v[164:167], a[180:183], v[64:67], v[164:167]
    v_exp_f32 v39, v39
    v_mfma_f32_16x16x32_bf16 v[168:171], a[180:183], v[68:71], v[168:171]
    v_add_f32 v26, v26, v36
    v_add_f32 v26, v26, v37
    v_mfma_f32_16x16x32_bf16 v[172:175], a[180:183], v[72:75], v[172:175]
    v_add_f32 v26, v26, v38
    v_add_f32 v26, v26, v39
    v_mfma_f32_16x16x32_bf16 v[176:179], a[184:187], v[56:59], v[176:179]
    v_cvt_pk_bf16_f32 v36, v36, v37
    v_cvt_pk_bf16_f32 v37, v38, v39
    v_mfma_f32_16x16x32_bf16 v[180:183], a[184:187], v[60:63], v[180:183]
    v_mul_f32 v40, s23, v40
    v_mul_f32 v41, s23, v41
    v_mfma_f32_16x16x32_bf16 v[184:187], a[184:187], v[64:67], v[184:187]
    v_mul_f32 v42, s23, v42
    v_mul_f32 v43, s23, v43
    v_mfma_f32_16x16x32_bf16 v[188:191], a[184:187], v[68:71], v[188:191]
    buffer_load_dwordx4 v4, s[36:39], s22 offen offset:2176 nt lds
    v_mfma_f32_16x16x32_bf16 v[192:195], a[184:187], v[72:75], v[192:195]
    v_exp_f32 v40, v40
    v_mfma_f32_16x16x32_bf16 v[196:199], a[188:191], v[56:59], v[196:199]
    v_exp_f32 v41, v41
    v_mfma_f32_16x16x32_bf16 v[200:203], a[188:191], v[60:63], v[200:203]
    v_exp_f32 v42, v42
    v_mfma_f32_16x16x32_bf16 v[204:207], a[188:191], v[64:67], v[204:207]
    v_exp_f32 v43, v43
    v_mfma_f32_16x16x32_bf16 v[208:211], a[188:191], v[68:71], v[208:211]
    v_add_f32 v27, v27, v40
    v_add_f32 v27, v27, v41
    v_mfma_f32_16x16x32_bf16 v[212:215], a[188:191], v[72:75], v[212:215]
    s_waitcnt vmcnt(15) lgkmcnt(0)
    s_barrier
    v_mfma_f32_16x16x32_bf16 v[216:219], a[192:195], v[56:59], v[216:219]
    v_add_u32 v24, 0x15400, v24
    ds_read_b128 a[168:171], v24
    v_mfma_f32_16x16x32_bf16 v[220:223], a[192:195], v[60:63], v[220:223]
    v_add_u32 v25, 0x15400, v25
    ds_read_b128 a[172:175], v25
    v_mfma_f32_16x16x32_bf16 v[224:227], a[192:195], v[64:67], v[224:227]
    ds_read_b128 a[176:179], v24 offset:128
    ds_read_b64 v[78:79], v19
    v_mfma_f32_16x16x32_bf16 v[228:231], a[192:195], v[68:71], v[228:231]
    ds_write_b64 v14, v[36:37] offset:10240
    v_mfma_f32_16x16x32_bf16 v[232:235], a[192:195], v[72:75], v[232:235]
    buffer_load_dwordx4 v5, s[36:39], s22 offen offset:3264 nt lds
    ds_read_b64 v[82:83], v19 offset:512
    v_mfma_f32_16x16x32_bf16 v[236:239], a[196:199], v[56:59], v[236:239]
    ds_read_b64 v[86:87], v19 offset:1024
    ds_read_b128 a[180:183], v25 offset:128
    v_mfma_f32_16x16x32_bf16 v[240:243], a[196:199], v[60:63], v[240:243]
    ds_read_b64 v[90:91], v19 offset:1536
    ds_read_b64 v[94:95], v19 offset:2048
    v_mfma_f32_16x16x32_bf16 v[244:247], a[196:199], v[64:67], v[244:247]
    ds_read_b128 a[184:187], v24 offset:256
    ds_read_b128 a[188:191], v25 offset:256
    v_mfma_f32_16x16x32_bf16 v[248:251], a[196:199], v[68:71], v[248:251]
    v_add_f32 v27, v27, v42
    ds_read_b128 a[192:195], v24 offset:384
    v_mfma_f32_16x16x32_bf16 v[252:255], a[196:199], v[72:75], v[252:255]
    v_add_f32 v27, v27, v43
    v_cvt_pk_bf16_f32 v40, v40, v41
    v_mfma_f32_16x16x32_bf16 v[56:59], a[224:227], a[0:3], 0
    v_cvt_pk_bf16_f32 v41, v42, v43
    ds_read_b128 a[196:199], v25 offset:384
    v_mfma_f32_16x16x32_bf16 v[60:63], a[224:227], a[4:7], 0
    ds_write_b64 v14, v[40:41] offset:10752
    v_mfma_f32_16x16x32_bf16 v[64:67], a[224:227], a[8:11], 0
    v_mul_f32 v44, s23, v44
    v_mul_f32 v45, s23, v45
    v_mfma_f32_16x16x32_bf16 v[68:71], a[224:227], a[12:15], 0
    v_mul_f32 v46, s23, v46
    v_mul_f32 v47, s23, v47
    v_mfma_f32_16x16x32_bf16 v[72:75], a[224:227], a[16:19], 0
    ds_read_b64_tr_b16 a[224:225], v10 offset:34816
    ds_read_b64_tr_b16 a[226:227], v12 offset:34816
    v_mfma_f32_16x16x32_bf16 v[56:59], a[228:231], a[20:23], v[56:59]
    s_add_u32 m0, s21, 17408
    s_mov_b32 s22, 131072
    buffer_load_dwordx4 v2, s[32:35], s22 offen nt lds
    v_mfma_f32_16x16x32_bf16 v[60:63], a[228:231], a[24:27], v[60:63]
    v_exp_f32 v44, v44
    v_mfma_f32_16x16x32_bf16 v[64:67], a[228:231], a[28:31], v[64:67]
    v_exp_f32 v45, v45
    v_mfma_f32_16x16x32_bf16 v[68:71], a[228:231], a[32:35], v[68:71]
    v_exp_f32 v46, v46
    v_mfma_f32_16x16x32_bf16 v[72:75], a[228:231], a[36:39], v[72:75]
    ds_read_b64_tr_b16 a[228:229], v11 offset:34816
    ds_read_b64_tr_b16 a[230:231], v13 offset:34816
    v_mfma_f32_16x16x32_bf16 v[56:59], a[232:235], a[40:43], v[56:59]
    v_exp_f32 v47, v47
    v_mfma_f32_16x16x32_bf16 v[60:63], a[232:235], a[44:47], v[60:63]
    v_add_f32 v28, v28, v44
    v_add_f32 v28, v28, v45
    v_mfma_f32_16x16x32_bf16 v[64:67], a[232:235], a[48:51], v[64:67]
    v_add_f32 v28, v28, v46
    v_add_f32 v28, v28, v47
    v_mfma_f32_16x16x32_bf16 v[68:71], a[232:235], a[52:55], v[68:71]
    v_cvt_pk_bf16_f32 v44, v44, v45
    v_cvt_pk_bf16_f32 v45, v46, v47
    v_mfma_f32_16x16x32_bf16 v[72:75], a[232:235], a[56:59], v[72:75]
    ds_read_b64_tr_b16 a[232:233], v10 offset:34944
    ds_read_b64_tr_b16 a[234:235], v12 offset:34944
    v_mfma_f32_16x16x32_bf16 v[56:59], a[236:239], a[60:63], v[56:59]
    ds_write_b64 v14, v[44:45] offset:11264
    v_mfma_f32_16x16x32_bf16 v[60:63], a[236:239], a[64:67], v[60:63]
    buffer_load_dwordx4 v3, s[32:35], s22 offen offset:1088 nt lds
    v_mul_f32 v48, s23, v48
    v_mfma_f32_16x16x32_bf16 v[64:67], a[236:239], a[68:71], v[64:67]
    v_mul_f32 v49, s23, v49
    v_mul_f32 v50, s23, v50
    v_mfma_f32_16x16x32_bf16 v[68:71], a[236:239], a[72:75], v[68:71]
    v_mul_f32 v51, s23, v51
    v_mfma_f32_16x16x32_bf16 v[72:75], a[236:239], a[76:79], v[72:75]
    ds_read_b64_tr_b16 a[236:237], v11 offset:34944
    ds_read_b64_tr_b16 a[238:239], v13 offset:34944
    v_mfma_f32_16x16x32_bf16 v[56:59], a[240:243], a[80:83], v[56:59]
    v_exp_f32 v48, v48
    v_mfma_f32_16x16x32_bf16 v[60:63], a[240:243], a[84:87], v[60:63]
    v_exp_f32 v49, v49
    v_mfma_f32_16x16x32_bf16 v[64:67], a[240:243], a[88:91], v[64:67]
    v_exp_f32 v50, v50
    v_mfma_f32_16x16x32_bf16 v[68:71], a[240:243], a[92:95], v[68:71]
    v_exp_f32 v51, v51
    v_mfma_f32_16x16x32_bf16 v[72:75], a[240:243], a[96:99], v[72:75]
    ds_read_b64_tr_b16 a[240:241], v10 offset:35072
    v_add_f32 v29, v29, v48
    v_mfma_f32_16x16x32_bf16 v[56:59], a[244:247], a[100:103], v[56:59]
    v_add_f32 v29, v29, v49
    v_add_f32 v29, v29, v50
    v_mfma_f32_16x16x32_bf16 v[60:63], a[244:247], a[104:107], v[60:63]
    ds_read_b64_tr_b16 a[242:243], v12 offset:35072
    v_add_f32 v29, v29, v51
    v_mfma_f32_16x16x32_bf16 v[64:67], a[244:247], a[108:111], v[64:67]
    buffer_load_dwordx4 v4, s[32:35], s22 offen offset:2176 nt lds
    v_cvt_pk_bf16_f32 v48, v48, v49
    v_mfma_f32_16x16x32_bf16 v[68:71], a[244:247], a[112:115], v[68:71]
    v_cvt_pk_bf16_f32 v49, v50, v51
    v_mul_f32 v52, s23, v52
    v_mfma_f32_16x16x32_bf16 v[72:75], a[244:247], a[116:119], v[72:75]
    ds_read_b64_tr_b16 a[244:245], v11 offset:35072
    ds_read_b64_tr_b16 a[246:247], v13 offset:35072
    v_mfma_f32_16x16x32_bf16 v[56:59], a[248:251], a[120:123], v[56:59]
    ds_write_b64 v14, v[48:49] offset:11776
    v_mfma_f32_16x16x32_bf16 v[60:63], a[248:251], a[124:127], v[60:63]
    v_mul_f32 v53, s23, v53
    v_mul_f32 v54, s23, v54
    v_mfma_f32_16x16x32_bf16 v[64:67], a[248:251], a[128:131], v[64:67]
    v_mul_f32 v55, s23, v55
    v_mfma_f32_16x16x32_bf16 v[68:71], a[248:251], a[132:135], v[68:71]
    v_exp_f32 v52, v52
    v_mfma_f32_16x16x32_bf16 v[72:75], a[248:251], a[136:139], v[72:75]
    ds_read_b64_tr_b16 a[248:249], v10 offset:35200
    ds_read_b64_tr_b16 a[250:251], v12 offset:35200
    v_mfma_f32_16x16x32_bf16 v[56:59], a[252:255], a[140:143], v[56:59]
    v_exp_f32 v53, v53
    v_mfma_f32_16x16x32_bf16 v[60:63], a[252:255], a[144:147], v[60:63]
    v_exp_f32 v54, v54
    v_mfma_f32_16x16x32_bf16 v[64:67], a[252:255], a[148:151], v[64:67]
    v_exp_f32 v55, v55
    v_mfma_f32_16x16x32_bf16 v[68:71], a[252:255], a[152:155], v[68:71]
    buffer_load_dwordx4 v5, s[32:35], s22 offen offset:3264 nt lds
    v_add_f32 v30, v30, v52
    v_mfma_f32_16x16x32_bf16 v[72:75], a[252:255], a[156:159], v[72:75]
    v_add_f32 v30, v30, v53
    s_waitcnt lgkmcnt(15)
    v_mfma_f32_16x16x32_bf16 v[96:99], a[216:219], v[76:79], v[96:99]
    ds_read_b64_tr_b16 a[252:253], v11 offset:35200
    v_add_f32 v30, v30, v54
    v_mfma_f32_16x16x32_bf16 v[100:103], a[216:219], v[80:83], v[100:103]
    v_add_f32 v30, v30, v55
    v_cvt_pk_bf16_f32 v52, v52, v53
    v_mfma_f32_16x16x32_bf16 v[104:107], a[216:219], v[84:87], v[104:107]
    ds_read_b64_tr_b16 a[254:255], v13 offset:35200
    v_cvt_pk_bf16_f32 v53, v54, v55
    v_mfma_f32_16x16x32_bf16 v[108:111], a[216:219], v[88:91], v[108:111]
    ds_write_b64 v14, v[52:53] offset:12288
    v_mfma_f32_16x16x32_bf16 v[112:115], a[216:219], v[92:95], v[112:115]
    v_mul_f32 v56, s23, v56
    v_mul_f32 v57, s23, v57
    v_mfma_f32_16x16x32_bf16 v[116:119], a[220:223], v[76:79], v[116:119]
    v_mul_f32 v58, s23, v58
    v_mul_f32 v59, s23, v59
    v_mfma_f32_16x16x32_bf16 v[120:123], a[220:223], v[80:83], v[120:123]
    v_exp_f32 v56, v56
    v_mfma_f32_16x16x32_bf16 v[124:127], a[220:223], v[84:87], v[124:127]
    v_exp_f32 v57, v57
    v_mfma_f32_16x16x32_bf16 v[128:131], a[220:223], v[88:91], v[128:131]
    v_exp_f32 v58, v58
    v_mfma_f32_16x16x32_bf16 v[132:135], a[220:223], v[92:95], v[132:135]
    s_add_u32 m0, s21, 52224
    s_mov_b32 s22, 98304
    buffer_load_dwordx4 v2, s[36:39], s22 offen nt lds
    v_mfma_f32_16x16x32_bf16 v[136:139], a[200:203], v[76:79], v[136:139]
    v_exp_f32 v59, v59
    v_mfma_f32_16x16x32_bf16 v[140:143], a[200:203], v[80:83], v[140:143]
    v_add_f32 v26, v26, v56
    v_add_f32 v26, v26, v57
    v_mfma_f32_16x16x32_bf16 v[144:147], a[200:203], v[84:87], v[144:147]
    v_add_f32 v26, v26, v58
    v_add_f32 v26, v26, v59
    v_mfma_f32_16x16x32_bf16 v[148:151], a[200:203], v[88:91], v[148:151]
    v_cvt_pk_bf16_f32 v56, v56, v57
    v_cvt_pk_bf16_f32 v57, v58, v59
    v_mfma_f32_16x16x32_bf16 v[152:155], a[200:203], v[92:95], v[152:155]
    v_mul_f32 v60, s23, v60
    v_mul_f32 v61, s23, v61
    v_mfma_f32_16x16x32_bf16 v[156:159], a[204:207], v[76:79], v[156:159]
    v_mul_f32 v62, s23, v62
    v_mul_f32 v63, s23, v63
    v_mfma_f32_16x16x32_bf16 v[160:163], a[204:207], v[80:83], v[160:163]
    v_exp_f32 v60, v60
    v_mfma_f32_16x16x32_bf16 v[164:167], a[204:207], v[84:87], v[164:167]
    v_exp_f32 v61, v61
    v_mfma_f32_16x16x32_bf16 v[168:171], a[204:207], v[88:91], v[168:171]
    v_exp_f32 v62, v62
    v_mfma_f32_16x16x32_bf16 v[172:175], a[204:207], v[92:95], v[172:175]
    v_exp_f32 v63, v63
    v_mfma_f32_16x16x32_bf16 v[176:179], a[208:211], v[76:79], v[176:179]
    buffer_load_dwordx4 v3, s[36:39], s22 offen offset:1088 nt lds
    v_add_f32 v27, v27, v60
    v_mfma_f32_16x16x32_bf16 v[180:183], a[208:211], v[80:83], v[180:183]
    v_add_f32 v27, v27, v61
    v_add_f32 v27, v27, v62
    v_mfma_f32_16x16x32_bf16 v[184:187], a[208:211], v[84:87], v[184:187]
    v_add_f32 v27, v27, v63
    v_cvt_pk_bf16_f32 v60, v60, v61
    v_mfma_f32_16x16x32_bf16 v[188:191], a[208:211], v[88:91], v[188:191]
    v_cvt_pk_bf16_f32 v61, v62, v63
    v_mul_f32 v64, s23, v64
    v_mfma_f32_16x16x32_bf16 v[192:195], a[208:211], v[92:95], v[192:195]
    v_mul_f32 v65, s23, v65
    v_mul_f32 v66, s23, v66
    v_mfma_f32_16x16x32_bf16 v[196:199], a[212:215], v[76:79], v[196:199]
    v_mul_f32 v67, s23, v67
    v_mfma_f32_16x16x32_bf16 v[200:203], a[212:215], v[80:83], v[200:203]
    v_exp_f32 v64, v64
    v_mfma_f32_16x16x32_bf16 v[204:207], a[212:215], v[84:87], v[204:207]
    v_exp_f32 v65, v65
    v_mfma_f32_16x16x32_bf16 v[208:211], a[212:215], v[88:91], v[208:211]
    v_exp_f32 v66, v66
    v_mfma_f32_16x16x32_bf16 v[212:215], a[212:215], v[92:95], v[212:215]
    s_waitcnt vmcnt(14) lgkmcnt(0)
    s_barrier
    v_mfma_f32_16x16x32_bf16 v[216:219], a[160:163], v[76:79], v[216:219]
    v_add_u32 v24, 0xffff7800, v24
    ds_read_b128 a[216:219], v24
    v_mfma_f32_16x16x32_bf16 v[220:223], a[160:163], v[80:83], v[220:223]
    buffer_load_dwordx4 v4, s[36:39], s22 offen offset:2176 nt lds
    v_add_u32 v25, 0xffff7800, v25
    ds_read_b128 a[220:223], v25
    v_mfma_f32_16x16x32_bf16 v[224:227], a[160:163], v[84:87], v[224:227]
    ds_read_b128 a[200:203], v24 offset:128
    ds_read_b64 v[38:39], v19 offset:10240
    v_mfma_f32_16x16x32_bf16 v[228:231], a[160:163], v[88:91], v[228:231]
    ds_write_b64 v14, v[56:57]
    v_mfma_f32_16x16x32_bf16 v[232:235], a[160:163], v[92:95], v[232:235]
    ds_read_b64 v[42:43], v19 offset:10752
    ds_read_b64 v[46:47], v19 offset:11264
    v_mfma_f32_16x16x32_bf16 v[236:239], a[164:167], v[76:79], v[236:239]
    ds_read_b128 a[204:207], v25 offset:128
    ds_read_b64 v[50:51], v19 offset:11776
    v_mfma_f32_16x16x32_bf16 v[240:243], a[164:167], v[80:83], v[240:243]
    ds_read_b64 v[54:55], v19 offset:12288
    ds_read_b128 a[208:211], v24 offset:256
    v_mfma_f32_16x16x32_bf16 v[244:247], a[164:167], v[84:87], v[244:247]
    ds_read_b128 a[212:215], v25 offset:256
    ds_read_b128 a[160:163], v24 offset:384
    v_mfma_f32_16x16x32_bf16 v[248:251], a[164:167], v[88:91], v[248:251]
    ds_write_b64 v14, v[60:61] offset:512
    v_mfma_f32_16x16x32_bf16 v[252:255], a[164:167], v[92:95], v[252:255]
    ds_read_b128 a[164:167], v25 offset:384
    v_mfma_f32_16x16x32_bf16 v[76:79], a[168:171], a[0:3], 0
    v_exp_f32 v67, v67
    v_mfma_f32_16x16x32_bf16 v[80:83], a[168:171], a[4:7], 0
    v_add_f32 v28, v28, v64
    v_add_f32 v28, v28, v65
    v_mfma_f32_16x16x32_bf16 v[84:87], a[168:171], a[8:11], 0
    buffer_load_dwordx4 v5, s[36:39], s22 offen offset:3264 nt lds
    v_add_f32 v28, v28, v66
    v_mfma_f32_16x16x32_bf16 v[88:91], a[168:171], a[12:15], 0
    v_add_f32 v28, v28, v67
    v_cvt_pk_bf16_f32 v64, v64, v65
    v_mfma_f32_16x16x32_bf16 v[92:95], a[168:171], a[16:19], 0
    v_add_u32 v10, 0x15400, v10
    ds_read_b64_tr_b16 a[168:169], v10
    v_mfma_f32_16x16x32_bf16 v[76:79], a[172:175], a[20:23], v[76:79]
    v_add_u32 v12, 0x15400, v12
    ds_read_b64_tr_b16 a[170:171], v12
    v_mfma_f32_16x16x32_bf16 v[80:83], a[172:175], a[24:27], v[80:83]
    v_cvt_pk_bf16_f32 v65, v66, v67
    v_mul_f32 v68, s23, v68
    v_mfma_f32_16x16x32_bf16 v[84:87], a[172:175], a[28:31], v[84:87]
    ds_write_b64 v14, v[64:65] offset:1024
    v_mfma_f32_16x16x32_bf16 v[88:91], a[172:175], a[32:35], v[88:91]
    v_mul_f32 v69, s23, v69
    v_mul_f32 v70, s23, v70
    v_mfma_f32_16x16x32_bf16 v[92:95], a[172:175], a[36:39], v[92:95]
    v_add_u32 v11, 0x15400, v11
    ds_read_b64_tr_b16 a[172:173], v11
    v_mfma_f32_16x16x32_bf16 v[76:79], a[176:179], a[40:43], v[76:79]
    v_add_u32 v13, 0x15400, v13
    ds_read_b64_tr_b16 a[174:175], v13
    v_mfma_f32_16x16x32_bf16 v[80:83], a[176:179], a[44:47], v[80:83]
    v_mul_f32 v71, s23, v71
    v_mfma_f32_16x16x32_bf16 v[84:87], a[176:179], a[48:51], v[84:87]
    v_exp_f32 v68, v68
    v_mfma_f32_16x16x32_bf16 v[88:91], a[176:179], a[52:55], v[88:91]
    s_add_u32 m0, s21, 104448
    s_mov_b32 s22, 147456
    buffer_load_dwordx4 v2, s[32:35], s22 offen nt lds
    v_mfma_f32_16x16x32_bf16 v[92:95], a[176:179], a[56:59], v[92:95]
    ds_read_b64_tr_b16 a[176:177], v10 offset:128
    ds_read_b64_tr_b16 a[178:179], v12 offset:128
    v_mfma_f32_16x16x32_bf16 v[76:79], a[180:183], a[60:63], v[76:79]
    v_exp_f32 v69, v69
    v_mfma_f32_16x16x32_bf16 v[80:83], a[180:183], a[64:67], v[80:83]
    v_exp_f32 v70, v70
    v_mfma_f32_16x16x32_bf16 v[84:87], a[180:183], a[68:71], v[84:87]
    v_exp_f32 v71, v71
    v_mfma_f32_16x16x32_bf16 v[88:91], a[180:183], a[72:75], v[88:91]
    v_add_f32 v29, v29, v68
    v_add_f32 v29, v29, v69
    v_mfma_f32_16x16x32_bf16 v[92:95], a[180:183], a[76:79], v[92:95]
    ds_read_b64_tr_b16 a[180:181], v11 offset:128
    ds_read_b64_tr_b16 a[182:183], v13 offset:128
    v_mfma_f32_16x16x32_bf16 v[76:79], a[184:187], a[80:83], v[76:79]
    v_add_f32 v29, v29, v70
    v_add_f32 v29, v29, v71
    v_mfma_f32_16x16x32_bf16 v[80:83], a[184:187], a[84:87], v[80:83]
    v_cvt_pk_bf16_f32 v68, v68, v69
    v_cvt_pk_bf16_f32 v69, v70, v71
    v_mfma_f32_16x16x32_bf16 v[84:87], a[184:187], a[88:91], v[84:87]
    ds_write_b64 v14, v[68:69] offset:1536
    v_mfma_f32_16x16x32_bf16 v[88:91], a[184:187], a[92:95], v[88:91]
    v_mul_f32 v72, s23, v72
    v_mul_f32 v73, s23, v73
    v_mfma_f32_16x16x32_bf16 v[92:95], a[184:187], a[96:99], v[92:95]
    buffer_load_dwordx4 v3, s[32:35], s22 offen offset:1088 nt lds
    ds_read_b64_tr_b16 a[184:185], v10 offset:256
    v_mfma_f32_16x16x32_bf16 v[76:79], a[188:191], a[100:103], v[76:79]
    ds_read_b64_tr_b16 a[186:187], v12 offset:256
    v_mul_f32 v74, s23, v74
    v_mfma_f32_16x16x32_bf16 v[80:83], a[188:191], a[104:107], v[80:83]
    v_mul_f32 v75, s23, v75
    v_mfma_f32_16x16x32_bf16 v[84:87], a[188:191], a[108:111], v[84:87]
    v_exp_f32 v72, v72
    v_mfma_f32_16x16x32_bf16 v[88:91], a[188:191], a[112:115], v[88:91]
    v_exp_f32 v73, v73
    v_mfma_f32_16x16x32_bf16 v[92:95], a[188:191], a[116:119], v[92:95]
    ds_read_b64_tr_b16 a[188:189], v11 offset:256
    ds_read_b64_tr_b16 a[190:191], v13 offset:256
    v_mfma_f32_16x16x32_bf16 v[76:79], a[192:195], a[120:123], v[76:79]
    v_exp_f32 v74, v74
    v_mfma_f32_16x16x32_bf16 v[80:83], a[192:195], a[124:127], v[80:83]
    v_exp_f32 v75, v75
    v_mfma_f32_16x16x32_bf16 v[84:87], a[192:195], a[128:131], v[84:87]
    v_add_f32 v30, v30, v72
    v_add_f32 v30, v30, v73
    v_mfma_f32_16x16x32_bf16 v[88:91], a[192:195], a[132:135], v[88:91]
    v_add_f32 v30, v30, v74
    v_add_f32 v30, v30, v75
    v_mfma_f32_16x16x32_bf16 v[92:95], a[192:195], a[136:139], v[92:95]
    ds_read_b64_tr_b16 a[192:193], v10 offset:384
    ds_read_b64_tr_b16 a[194:195], v12 offset:384
    v_mfma_f32_16x16x32_bf16 v[76:79], a[196:199], a[140:143], v[76:79]
    buffer_load_dwordx4 v4, s[32:35], s22 offen offset:2176 nt lds
    v_cvt_pk_bf16_f32 v72, v72, v73
    v_mfma_f32_16x16x32_bf16 v[80:83], a[196:199], a[144:147], v[80:83]
    v_cvt_pk_bf16_f32 v73, v74, v75
    v_mfma_f32_16x16x32_bf16 v[84:87], a[196:199], a[148:151], v[84:87]
    ds_write_b64 v14, v[72:73] offset:2048
    v_mfma_f32_16x16x32_bf16 v[88:91], a[196:199], a[152:155], v[88:91]
    v_mfma_f32_16x16x32_bf16 v[92:95], a[196:199], a[156:159], v[92:95]
    ds_read_b64_tr_b16 a[196:197], v11 offset:384
    s_waitcnt lgkmcnt(15)
    v_mfma_f32_16x16x32_bf16 v[96:99], a[224:227], v[36:39], v[96:99]
    ds_read_b64_tr_b16 a[198:199], v13 offset:384
    v_mul_f32 v76, s23, v76
    v_mfma_f32_16x16x32_bf16 v[100:103], a[224:227], v[40:43], v[100:103]
    v_mul_f32 v77, s23, v77
    v_mul_f32 v78, s23, v78
    v_mfma_f32_16x16x32_bf16 v[104:107], a[224:227], v[44:47], v[104:107]
    v_mul_f32 v79, s23, v79
    v_mfma_f32_16x16x32_bf16 v[108:111], a[224:227], v[48:51], v[108:111]
    v_exp_f32 v76, v76
    v_mfma_f32_16x16x32_bf16 v[112:115], a[224:227], v[52:55], v[112:115]
    v_exp_f32 v77, v77
    v_mfma_f32_16x16x32_bf16 v[116:119], a[228:231], v[36:39], v[116:119]
    v_exp_f32 v78, v78
    v_mfma_f32_16x16x32_bf16 v[120:123], a[228:231], v[40:43], v[120:123]
    buffer_load_dwordx4 v5, s[32:35], s22 offen offset:3264 nt lds
    v_mfma_f32_16x16x32_bf16 v[124:127], a[228:231], v[44:47], v[124:127]
    v_exp_f32 v79, v79
    v_mfma_f32_16x16x32_bf16 v[128:131], a[228:231], v[48:51], v[128:131]
    v_add_f32 v26, v26, v76
    v_add_f32 v26, v26, v77
    v_mfma_f32_16x16x32_bf16 v[132:135], a[228:231], v[52:55], v[132:135]
    v_add_f32 v26, v26, v78
    v_add_f32 v26, v26, v79
    v_mfma_f32_16x16x32_bf16 v[136:139], a[232:235], v[36:39], v[136:139]
    v_cvt_pk_bf16_f32 v76, v76, v77
    v_cvt_pk_bf16_f32 v77, v78, v79
    v_mfma_f32_16x16x32_bf16 v[140:143], a[232:235], v[40:43], v[140:143]
    v_mul_f32 v80, s23, v80
    v_mul_f32 v81, s23, v81
    v_mfma_f32_16x16x32_bf16 v[144:147], a[232:235], v[44:47], v[144:147]
    v_mul_f32 v82, s23, v82
    v_mul_f32 v83, s23, v83
    v_mfma_f32_16x16x32_bf16 v[148:151], a[232:235], v[48:51], v[148:151]
    v_exp_f32 v80, v80
    v_mfma_f32_16x16x32_bf16 v[152:155], a[232:235], v[52:55], v[152:155]
    v_exp_f32 v81, v81
    v_mfma_f32_16x16x32_bf16 v[156:159], a[236:239], v[36:39], v[156:159]
    v_exp_f32 v82, v82
    v_mfma_f32_16x16x32_bf16 v[160:163], a[236:239], v[40:43], v[160:163]
    v_exp_f32 v83, v83
    v_mfma_f32_16x16x32_bf16 v[164:167], a[236:239], v[44:47], v[164:167]
    s_add_u32 m0, s21, 34816
    s_mov_b32 s22, 114688
    buffer_load_dwordx4 v2, s[36:39], s22 offen nt lds
    v_mfma_f32_16x16x32_bf16 v[168:171], a[236:239], v[48:51], v[168:171]
    v_add_f32 v27, v27, v80
    v_add_f32 v27, v27, v81
    v_mfma_f32_16x16x32_bf16 v[172:175], a[236:239], v[52:55], v[172:175]
    v_add_f32 v27, v27, v82
    v_add_f32 v27, v27, v83
    v_mfma_f32_16x16x32_bf16 v[176:179], a[240:243], v[36:39], v[176:179]
    v_cvt_pk_bf16_f32 v80, v80, v81
    v_cvt_pk_bf16_f32 v81, v82, v83
    v_mfma_f32_16x16x32_bf16 v[180:183], a[240:243], v[40:43], v[180:183]
    v_mul_f32 v84, s23, v84
    v_mul_f32 v85, s23, v85
    v_mfma_f32_16x16x32_bf16 v[184:187], a[240:243], v[44:47], v[184:187]
    v_mul_f32 v86, s23, v86
    v_mul_f32 v87, s23, v87
    v_mfma_f32_16x16x32_bf16 v[188:191], a[240:243], v[48:51], v[188:191]
    v_exp_f32 v84, v84
    v_mfma_f32_16x16x32_bf16 v[192:195], a[240:243], v[52:55], v[192:195]
    v_exp_f32 v85, v85
    v_mfma_f32_16x16x32_bf16 v[196:199], a[244:247], v[36:39], v[196:199]
    v_exp_f32 v86, v86
    v_mfma_f32_16x16x32_bf16 v[200:203], a[244:247], v[40:43], v[200:203]
    v_exp_f32 v87, v87
    v_mfma_f32_16x16x32_bf16 v[204:207], a[244:247], v[44:47], v[204:207]
    v_add_f32 v28, v28, v84
    v_add_f32 v28, v28, v85
    v_mfma_f32_16x16x32_bf16 v[208:211], a[244:247], v[48:51], v[208:211]
    buffer_load_dwordx4 v3, s[36:39], s22 offen offset:1088 nt lds
    v_add_f32 v28, v28, v86
    v_mfma_f32_16x16x32_bf16 v[212:215], a[244:247], v[52:55], v[212:215]
    s_waitcnt vmcnt(18) lgkmcnt(0)
    s_barrier
    v_mfma_f32_16x16x32_bf16 v[216:219], a[248:251], v[36:39], v[216:219]
    ds_read_b128 a[224:227], v24 offset:52224
    ds_read_b64 v[58:59], v19
    v_mfma_f32_16x16x32_bf16 v[220:223], a[248:251], v[40:43], v[220:223]
    ds_write_b64 v14, v[76:77] offset:10240
    v_mfma_f32_16x16x32_bf16 v[224:227], a[248:251], v[44:47], v[224:227]
    ds_read_b64 v[62:63], v19 offset:512
    ds_read_b64 v[66:67], v19 offset:1024
    v_mfma_f32_16x16x32_bf16 v[228:231], a[248:251], v[48:51], v[228:231]
    ds_read_b64 v[70:71], v19 offset:1536
    ds_read_b64 v[74:75], v19 offset:2048
    v_mfma_f32_16x16x32_bf16 v[232:235], a[248:251], v[52:55], v[232:235]
    ds_read_b128 a[228:231], v25 offset:52224
    ds_read_b128 a[232:235], v24 offset:52352
    v_mfma_f32_16x16x32_bf16 v[236:239], a[252:255], v[36:39], v[236:239]
    ds_write_b64 v14, v[80:81] offset:10752
    v_mfma_f32_16x16x32_bf16 v[240:243], a[252:255], v[40:43], v[240:243]
    ds_read_b128 a[236:239], v25 offset:52352
    v_add_f32 v28, v28, v87
    v_mfma_f32_16x16x32_bf16 v[244:247], a[252:255], v[44:47], v[244:247]
    v_cvt_pk_bf16_f32 v84, v84, v85
    v_cvt_pk_bf16_f32 v85, v86, v87
    v_mfma_f32_16x16x32_bf16 v[248:251], a[252:255], v[48:51], v[248:251]
    ds_write_b64 v14, v[84:85] offset:11264
    v_mfma_f32_16x16x32_bf16 v[252:255], a[252:255], v[52:55], v[252:255]
    buffer_load_dwordx4 v4, s[36:39], s22 offen offset:2176 nt lds
    v_mul_f32 v88, s23, v88
    v_mfma_f32_16x16x32_bf16 v[36:39], a[216:219], a[0:3], 0
    v_mul_f32 v89, s23, v89
    ds_read_b128 a[240:243], v24 offset:52480
    v_mfma_f32_16x16x32_bf16 v[40:43], a[216:219], a[4:7], 0
    v_mul_f32 v90, s23, v90
    v_mul_f32 v91, s23, v91
    v_mfma_f32_16x16x32_bf16 v[44:47], a[216:219], a[8:11], 0
    v_exp_f32 v88, v88
    v_mfma_f32_16x16x32_bf16 v[48:51], a[216:219], a[12:15], 0
    v_exp_f32 v89, v89
    v_mfma_f32_16x16x32_bf16 v[52:55], a[216:219], a[16:19], 0
    v_exp_f32 v90, v90
    v_mfma_f32_16x16x32_bf16 v[36:39], a[220:223], a[20:23], v[36:39]
    v_exp_f32 v91, v91
    v_mfma_f32_16x16x32_bf16 v[40:43], a[220:223], a[24:27], v[40:43]
    v_add_f32 v29, v29, v88
    v_add_f32 v29, v29, v89
    v_mfma_f32_16x16x32_bf16 v[44:47], a[220:223], a[28:31], v[44:47]
    v_add_f32 v29, v29, v90
    ds_read_b128 a[244:247], v25 offset:52480
    v_mfma_f32_16x16x32_bf16 v[48:51], a[220:223], a[32:35], v[48:51]
    v_add_f32 v29, v29, v91
    v_cvt_pk_bf16_f32 v88, v88, v89
    v_mfma_f32_16x16x32_bf16 v[52:55], a[220:223], a[36:39], v[52:55]
    v_cvt_pk_bf16_f32 v89, v90, v91
    v_mul_f32 v92, s23, v92
    v_mfma_f32_16x16x32_bf16 v[36:39], a[200:203], a[40:43], v[36:39]
    buffer_load_dwordx4 v5, s[36:39], s22 offen offset:3264 nt lds
    v_mul_f32 v93, s23, v93
    v_mfma_f32_16x16x32_bf16 v[40:43], a[200:203], a[44:47], v[40:43]
    ds_write_b64 v14, v[88:89] offset:11776
    v_mfma_f32_16x16x32_bf16 v[44:47], a[200:203], a[48:51], v[44:47]
    v_mul_f32 v94, s23, v94
    v_mul_f32 v95, s23, v95
    v_mfma_f32_16x16x32_bf16 v[48:51], a[200:203], a[52:55], v[48:51]
    ds_read_b128 a[248:251], v24 offset:52608
    ds_read_b128 a[252:255], v25 offset:52608
    v_mfma_f32_16x16x32_bf16 v[52:55], a[200:203], a[56:59], v[52:55]
    v_exp_f32 v92, v92
    v_mfma_f32_16x16x32_bf16 v[36:39], a[204:207], a[60:63], v[36:39]
    v_exp_f32 v93, v93
    v_mfma_f32_16x16x32_bf16 v[40:43], a[204:207], a[64:67], v[40:43]
    v_exp_f32 v94, v94
    v_mfma_f32_16x16x32_bf16 v[44:47], a[204:207], a[68:71], v[44:47]
    v_exp_f32 v95, v95
    v_mfma_f32_16x16x32_bf16 v[48:51], a[204:207], a[72:75], v[48:51]
    v_add_f32 v30, v30, v92
    v_add_f32 v30, v30, v93
    v_mfma_f32_16x16x32_bf16 v[52:55], a[204:207], a[76:79], v[52:55]
    v_add_f32 v30, v30, v94
    v_add_f32 v30, v30, v95
    v_mfma_f32_16x16x32_bf16 v[36:39], a[208:211], a[80:83], v[36:39]
    v_cvt_pk_bf16_f32 v92, v92, v93
    v_cvt_pk_bf16_f32 v93, v94, v95
    v_mfma_f32_16x16x32_bf16 v[40:43], a[208:211], a[84:87], v[40:43]
    s_add_u32 m0, s21, 69632
    s_mov_b32 s22, 163840
    buffer_load_dwordx4 v2, s[32:35], s22 offen nt lds
    v_mfma_f32_16x16x32_bf16 v[44:47], a[208:211], a[88:91], v[44:47]
    ds_write_b64 v14, v[92:93] offset:12288
    v_mfma_f32_16x16x32_bf16 v[48:51], a[208:211], a[92:95], v[48:51]
    v_mfma_f32_16x16x32_bf16 v[52:55], a[208:211], a[96:99], v[52:55]
    v_mfma_f32_16x16x32_bf16 v[36:39], a[212:215], a[100:103], v[36:39]
    v_mfma_f32_16x16x32_bf16 v[40:43], a[212:215], a[104:107], v[40:43]
    v_mfma_f32_16x16x32_bf16 v[44:47], a[212:215], a[108:111], v[44:47]
    v_mfma_f32_16x16x32_bf16 v[48:51], a[212:215], a[112:115], v[48:51]
    v_mfma_f32_16x16x32_bf16 v[52:55], a[212:215], a[116:119], v[52:55]
    v_mfma_f32_16x16x32_bf16 v[36:39], a[160:163], a[120:123], v[36:39]
    v_mfma_f32_16x16x32_bf16 v[40:43], a[160:163], a[124:127], v[40:43]
    v_mfma_f32_16x16x32_bf16 v[44:47], a[160:163], a[128:131], v[44:47]
    buffer_load_dwordx4 v3, s[32:35], s22 offen offset:1088 nt lds
    v_mfma_f32_16x16x32_bf16 v[48:51], a[160:163], a[132:135], v[48:51]
    v_mfma_f32_16x16x32_bf16 v[52:55], a[160:163], a[136:139], v[52:55]
    v_mfma_f32_16x16x32_bf16 v[36:39], a[164:167], a[140:143], v[36:39]
    v_mfma_f32_16x16x32_bf16 v[40:43], a[164:167], a[144:147], v[40:43]
    v_mfma_f32_16x16x32_bf16 v[44:47], a[164:167], a[148:151], v[44:47]
    v_mfma_f32_16x16x32_bf16 v[48:51], a[164:167], a[152:155], v[48:51]
    v_mfma_f32_16x16x32_bf16 v[52:55], a[164:167], a[156:159], v[52:55]
    s_waitcnt lgkmcnt(15)
    v_mfma_f32_16x16x32_bf16 v[96:99], a[168:171], v[56:59], v[96:99]
    s_waitcnt lgkmcnt(14)
    v_mfma_f32_16x16x32_bf16 v[100:103], a[168:171], v[60:63], v[100:103]
    v_mul_f32 v36, s23, v36
    s_waitcnt lgkmcnt(13)
    v_mfma_f32_16x16x32_bf16 v[104:107], a[168:171], v[64:67], v[104:107]
    v_mul_f32 v37, s23, v37
    s_waitcnt lgkmcnt(12)
    v_mfma_f32_16x16x32_bf16 v[108:111], a[168:171], v[68:71], v[108:111]
    buffer_load_dwordx4 v4, s[32:35], s22 offen offset:2176 nt lds
    s_waitcnt lgkmcnt(11)
    v_mfma_f32_16x16x32_bf16 v[112:115], a[168:171], v[72:75], v[112:115]
    v_mul_f32 v38, s23, v38
    v_mul_f32 v39, s23, v39
    v_mfma_f32_16x16x32_bf16 v[116:119], a[172:175], v[56:59], v[116:119]
    v_exp_f32 v36, v36
    v_mfma_f32_16x16x32_bf16 v[120:123], a[172:175], v[60:63], v[120:123]
    v_exp_f32 v37, v37
    v_mfma_f32_16x16x32_bf16 v[124:127], a[172:175], v[64:67], v[124:127]
    v_exp_f32 v38, v38
    v_mfma_f32_16x16x32_bf16 v[128:131], a[172:175], v[68:71], v[128:131]
    v_exp_f32 v39, v39
    v_mfma_f32_16x16x32_bf16 v[132:135], a[172:175], v[72:75], v[132:135]
    v_add_f32 v26, v26, v36
    v_add_f32 v26, v26, v37
    v_mfma_f32_16x16x32_bf16 v[136:139], a[176:179], v[56:59], v[136:139]
    v_add_f32 v26, v26, v38
    v_add_f32 v26, v26, v39
    v_mfma_f32_16x16x32_bf16 v[140:143], a[176:179], v[60:63], v[140:143]
    v_cvt_pk_bf16_f32 v36, v36, v37
    v_cvt_pk_bf16_f32 v37, v38, v39
    v_mfma_f32_16x16x32_bf16 v[144:147], a[176:179], v[64:67], v[144:147]
    v_mul_f32 v40, s23, v40
    v_mul_f32 v41, s23, v41
    v_mfma_f32_16x16x32_bf16 v[148:151], a[176:179], v[68:71], v[148:151]
    v_mul_f32 v42, s23, v42
    v_mul_f32 v43, s23, v43
    v_mfma_f32_16x16x32_bf16 v[152:155], a[176:179], v[72:75], v[152:155]
    buffer_load_dwordx4 v5, s[32:35], s22 offen offset:3264 nt lds
    v_mfma_f32_16x16x32_bf16 v[156:159], a[180:183], v[56:59], v[156:159]
    v_exp_f32 v40, v40
    v_mfma_f32_16x16x32_bf16 v[160:163], a[180:183], v[60:63], v[160:163]
    v_exp_f32 v41, v41
    v_mfma_f32_16x16x32_bf16 v[164:167], a[180:183], v[64:67], v[164:167]
    v_exp_f32 v42, v42
    v_mfma_f32_16x16x32_bf16 v[168:171], a[180:183], v[68:71], v[168:171]
    v_exp_f32 v43, v43
    v_mfma_f32_16x16x32_bf16 v[172:175], a[180:183], v[72:75], v[172:175]
    v_add_f32 v27, v27, v40
    v_add_f32 v27, v27, v41
    v_mfma_f32_16x16x32_bf16 v[176:179], a[184:187], v[56:59], v[176:179]
    v_add_f32 v27, v27, v42
    v_add_f32 v27, v27, v43
    v_mfma_f32_16x16x32_bf16 v[180:183], a[184:187], v[60:63], v[180:183]
    v_cvt_pk_bf16_f32 v40, v40, v41
    v_cvt_pk_bf16_f32 v41, v42, v43
    v_mfma_f32_16x16x32_bf16 v[184:187], a[184:187], v[64:67], v[184:187]
    v_mul_f32 v44, s23, v44
    v_mul_f32 v45, s23, v45
    v_mfma_f32_16x16x32_bf16 v[188:191], a[184:187], v[68:71], v[188:191]
    v_mul_f32 v46, s23, v46
    v_mul_f32 v47, s23, v47
    v_mfma_f32_16x16x32_bf16 v[192:195], a[184:187], v[72:75], v[192:195]
    v_exp_f32 v44, v44
    v_mfma_f32_16x16x32_bf16 v[196:199], a[188:191], v[56:59], v[196:199]
    s_add_u32 m0, s21, 87040
    s_mov_b32 s22, 131072
    buffer_load_dwordx4 v2, s[36:39], s22 offen nt lds
    v_mfma_f32_16x16x32_bf16 v[200:203], a[188:191], v[60:63], v[200:203]
    v_exp_f32 v45, v45
    v_mfma_f32_16x16x32_bf16 v[204:207], a[188:191], v[64:67], v[204:207]
    v_exp_f32 v46, v46
    v_mfma_f32_16x16x32_bf16 v[208:211], a[188:191], v[68:71], v[208:211]
    v_exp_f32 v47, v47
    v_mfma_f32_16x16x32_bf16 v[212:215], a[188:191], v[72:75], v[212:215]
    s_waitcnt vmcnt(17) lgkmcnt(0)
    s_barrier
    v_mfma_f32_16x16x32_bf16 v[216:219], a[192:195], v[56:59], v[216:219]
    v_add_u32 v24, 0xffff3400, v24
    ds_read_b128 a[168:171], v24
    v_mfma_f32_16x16x32_bf16 v[220:223], a[192:195], v[60:63], v[220:223]
    ds_read_b64 v[78:79], v19 offset:10240
    ds_read_b64 v[82:83], v19 offset:10752
    v_mfma_f32_16x16x32_bf16 v[224:227], a[192:195], v[64:67], v[224:227]
    ds_write_b64 v14, v[36:37]
    v_mfma_f32_16x16x32_bf16 v[228:231], a[192:195], v[68:71], v[228:231]
    ds_read_b64 v[86:87], v19 offset:11264
    ds_read_b64 v[90:91], v19 offset:11776
    v_mfma_f32_16x16x32_bf16 v[232:235], a[192:195], v[72:75], v[232:235]
    ds_read_b64 v[94:95], v19 offset:12288
    v_add_u32 v25, 0xffff3400, v25
    ds_read_b128 a[172:175], v25
    v_mfma_f32_16x16x32_bf16 v[236:239], a[196:199], v[56:59], v[236:239]
    ds_write_b64 v14, v[40:41] offset:512
    v_mfma_f32_16x16x32_bf16 v[240:243], a[196:199], v[60:63], v[240:243]
    ds_read_b128 a[176:179], v24 offset:128
    v_add_f32 v28, v28, v44
    v_mfma_f32_16x16x32_bf16 v[244:247], a[196:199], v[64:67], v[244:247]
    v_add_f32 v28, v28, v45
    ds_read_b128 a[180:183], v25 offset:128
    v_mfma_f32_16x16x32_bf16 v[248:251], a[196:199], v[68:71], v[248:251]
    buffer_load_dwordx4 v3, s[36:39], s22 offen offset:1088 nt lds
    v_add_f32 v28, v28, v46
    v_mfma_f32_16x16x32_bf16 v[252:255], a[196:199], v[72:75], v[252:255]
    v_add_f32 v28, v28, v47
    v_cvt_pk_bf16_f32 v44, v44, v45
    v_mfma_f32_16x16x32_bf16 v[56:59], a[224:227], a[0:3], 0
    v_cvt_pk_bf16_f32 v45, v46, v47
    v_mul_f32 v48, s23, v48
    v_mfma_f32_16x16x32_bf16 v[60:63], a[224:227], a[4:7], 0
    ds_write_b64 v14, v[44:45] offset:1024
    v_mfma_f32_16x16x32_bf16 v[64:67], a[224:227], a[8:11], 0
    v_mul_f32 v49, s23, v49
    ds_read_b128 a[184:187], v24 offset:256
    v_mfma_f32_16x16x32_bf16 v[68:71], a[224:227], a[12:15], 0
    v_mul_f32 v50, s23, v50
    v_mul_f32 v51, s23, v51
    v_mfma_f32_16x16x32_bf16 v[72:75], a[224:227], a[16:19], 0
    v_exp_f32 v48, v48
    v_mfma_f32_16x16x32_bf16 v[56:59], a[228:231], a[20:23], v[56:59]
    v_exp_f32 v49, v49
    v_mfma_f32_16x16x32_bf16 v[60:63], a[228:231], a[24:27], v[60:63]
    v_exp_f32 v50, v50
    v_mfma_f32_16x16x32_bf16 v[64:67], a[228:231], a[28:31], v[64:67]
    v_exp_f32 v51, v51
    v_mfma_f32_16x16x32_bf16 v[68:71], a[228:231], a[32:35], v[68:71]
    v_add_f32 v29, v29, v48
    v_add_f32 v29, v29, v49
    v_mfma_f32_16x16x32_bf16 v[72:75], a[228:231], a[36:39], v[72:75]
    v_add_f32 v29, v29, v50
    ds_read_b128 a[188:191], v25 offset:256
    v_mfma_f32_16x16x32_bf16 v[56:59], a[232:235], a[40:43], v[56:59]
    v_add_f32 v29, v29, v51
    v_cvt_pk_bf16_f32 v48, v48, v49
    v_mfma_f32_16x16x32_bf16 v[60:63], a[232:235], a[44:47], v[60:63]
    v_cvt_pk_bf16_f32 v49, v50, v51
    v_mul_f32 v52, s23, v52
    v_mfma_f32_16x16x32_bf16 v[64:67], a[232:235], a[48:51], v[64:67]
    buffer_load_dwordx4 v4, s[36:39], s22 offen offset:2176 nt lds
    v_mul_f32 v53, s23, v53
    v_mfma_f32_16x16x32_bf16 v[68:71], a[232:235], a[52:55], v[68:71]
    ds_write_b64 v14, v[48:49] offset:1536
    v_mfma_f32_16x16x32_bf16 v[72:75], a[232:235], a[56:59], v[72:75]
    v_mul_f32 v54, s23, v54
    v_mul_f32 v55, s23, v55
    v_mfma_f32_16x16x32_bf16 v[56:59], a[236:239], a[60:63], v[56:59]
    ds_read_b128 a[192:195], v24 offset:384
    ds_read_b128 a[196:199], v25 offset:384
    v_mfma_f32_16x16x32_bf16 v[60:63], a[236:239], a[64:67], v[60:63]
    v_exp_f32 v52, v52
    v_mfma_f32_16x16x32_bf16 v[64:67], a[236:239], a[68:71], v[64:67]
    v_add_u32 v10, 0xfffeac00, v10
    ds_read_b64_tr_b16 a[216:217], v10
    v_mfma_f32_16x16x32_bf16 v[68:71], a[236:239], a[72:75], v[68:71]
    v_add_u32 v12, 0xfffeac00, v12
    ds_read_b64_tr_b16 a[218:219], v12
    v_mfma_f32_16x16x32_bf16 v[72:75], a[236:239], a[76:79], v[72:75]
    v_exp_f32 v53, v53
    v_mfma_f32_16x16x32_bf16 v[56:59], a[240:243], a[80:83], v[56:59]
    v_exp_f32 v54, v54
    v_mfma_f32_16x16x32_bf16 v[60:63], a[240:243], a[84:87], v[60:63]
    v_exp_f32 v55, v55
    v_mfma_f32_16x16x32_bf16 v[64:67], a[240:243], a[88:91], v[64:67]
    v_add_u32 v11, 0xfffeac00, v11
    ds_read_b64_tr_b16 a[220:221], v11
    v_mfma_f32_16x16x32_bf16 v[68:71], a[240:243], a[92:95], v[68:71]
    v_add_u32 v13, 0xfffeac00, v13
    ds_read_b64_tr_b16 a[222:223], v13
    v_mfma_f32_16x16x32_bf16 v[72:75], a[240:243], a[96:99], v[72:75]
    v_add_f32 v30, v30, v52
    v_add_f32 v30, v30, v53
    v_mfma_f32_16x16x32_bf16 v[56:59], a[244:247], a[100:103], v[56:59]
    buffer_load_dwordx4 v5, s[36:39], s22 offen offset:3264 nt lds
    v_add_f32 v30, v30, v54
    v_mfma_f32_16x16x32_bf16 v[60:63], a[244:247], a[104:107], v[60:63]
    v_add_f32 v30, v30, v55
    v_cvt_pk_bf16_f32 v52, v52, v53
    v_mfma_f32_16x16x32_bf16 v[64:67], a[244:247], a[108:111], v[64:67]
    ds_read_b64_tr_b16 a[200:201], v10 offset:128
    ds_read_b64_tr_b16 a[202:203], v12 offset:128
    v_mfma_f32_16x16x32_bf16 v[68:71], a[244:247], a[112:115], v[68:71]
    v_cvt_pk_bf16_f32 v53, v54, v55
    v_mfma_f32_16x16x32_bf16 v[72:75], a[244:247], a[116:119], v[72:75]
    ds_write_b64 v14, v[52:53] offset:2048
    v_mfma_f32_16x16x32_bf16 v[56:59], a[248:251], a[120:123], v[56:59]
    v_mfma_f32_16x16x32_bf16 v[60:63], a[248:251], a[124:127], v[60:63]
    v_mfma_f32_16x16x32_bf16 v[64:67], a[248:251], a[128:131], v[64:67]
    ds_read_b64_tr_b16 a[204:205], v11 offset:128
    ds_read_b64_tr_b16 a[206:207], v13 offset:128
    v_mfma_f32_16x16x32_bf16 v[68:71], a[248:251], a[132:135], v[68:71]
    v_mfma_f32_16x16x32_bf16 v[72:75], a[248:251], a[136:139], v[72:75]
    v_mfma_f32_16x16x32_bf16 v[56:59], a[252:255], a[140:143], v[56:59]
    v_mfma_f32_16x16x32_bf16 v[60:63], a[252:255], a[144:147], v[60:63]
    v_mfma_f32_16x16x32_bf16 v[64:67], a[252:255], a[148:151], v[64:67]
    ds_read_b64_tr_b16 a[208:209], v10 offset:256
    ds_read_b64_tr_b16 a[210:211], v12 offset:256
    v_mfma_f32_16x16x32_bf16 v[68:71], a[252:255], a[152:155], v[68:71]
    v_mfma_f32_16x16x32_bf16 v[72:75], a[252:255], a[156:159], v[72:75]
    s_add_u32 m0, s21, 121856
    s_mov_b32 s22, 180224
    buffer_load_dwordx4 v2, s[32:35], s22 offen nt lds
    s_waitcnt lgkmcnt(9)
    v_mfma_f32_16x16x32_bf16 v[96:99], a[216:219], v[76:79], v[96:99]
    v_mul_f32 v56, s23, v56
    v_mul_f32 v57, s23, v57
    v_mfma_f32_16x16x32_bf16 v[100:103], a[216:219], v[80:83], v[100:103]
    v_mul_f32 v58, s23, v58
    v_mul_f32 v59, s23, v59
    v_mfma_f32_16x16x32_bf16 v[104:107], a[216:219], v[84:87], v[104:107]
    ds_read_b64_tr_b16 a[212:213], v11 offset:256
    ds_read_b64_tr_b16 a[214:215], v13 offset:256
    v_mfma_f32_16x16x32_bf16 v[108:111], a[216:219], v[88:91], v[108:111]
    v_exp_f32 v56, v56
    v_mfma_f32_16x16x32_bf16 v[112:115], a[216:219], v[92:95], v[112:115]
    v_exp_f32 v57, v57
    s_waitcnt lgkmcnt(9)
    v_mfma_f32_16x16x32_bf16 v[116:119], a[220:223], v[76:79], v[116:119]
    v_exp_f32 v58, v58
    v_mfma_f32_16x16x32_bf16 v[120:123], a[220:223], v[80:83], v[120:123]
    v_exp_f32 v59, v59
    v_mfma_f32_16x16x32_bf16 v[124:127], a[220:223], v[84:87], v[124:127]
    ds_read_b64_tr_b16 a[160:161], v10 offset:384
    ds_read_b64_tr_b16 a[162:163], v12 offset:384
    v_mfma_f32_16x16x32_bf16 v[128:131], a[220:223], v[88:91], v[128:131]
    v_add_f32 v26, v26, v56
    v_add_f32 v26, v26, v57
    v_mfma_f32_16x16x32_bf16 v[132:135], a[220:223], v[92:95], v[132:135]
    v_add_f32 v26, v26, v58
    s_waitcnt lgkmcnt(9)
    v_mfma_f32_16x16x32_bf16 v[136:139], a[200:203], v[76:79], v[136:139]
    v_add_f32 v26, v26, v59
    v_cvt_pk_bf16_f32 v56, v56, v57
    v_mfma_f32_16x16x32_bf16 v[140:143], a[200:203], v[80:83], v[140:143]
    v_cvt_pk_bf16_f32 v57, v58, v59
    v_mul_f32 v60, s23, v60
    v_mfma_f32_16x16x32_bf16 v[144:147], a[200:203], v[84:87], v[144:147]
    buffer_load_dwordx4 v3, s[32:35], s22 offen offset:1088 nt lds
    ds_read_b64_tr_b16 a[164:165], v11 offset:384
    v_mfma_f32_16x16x32_bf16 v[148:151], a[200:203], v[88:91], v[148:151]
    ds_read_b64_tr_b16 a[166:167], v13 offset:384
    v_mul_f32 v61, s23, v61
    v_mfma_f32_16x16x32_bf16 v[152:155], a[200:203], v[92:95], v[152:155]
    v_mul_f32 v62, s23, v62
    s_waitcnt lgkmcnt(8)
    v_mfma_f32_16x16x32_bf16 v[156:159], a[204:207], v[76:79], v[156:159]
    v_mul_f32 v63, s23, v63
    v_mfma_f32_16x16x32_bf16 v[160:163], a[204:207], v[80:83], v[160:163]
    v_exp_f32 v60, v60
    v_mfma_f32_16x16x32_bf16 v[164:167], a[204:207], v[84:87], v[164:167]
    v_exp_f32 v61, v61
    v_mfma_f32_16x16x32_bf16 v[168:171], a[204:207], v[88:91], v[168:171]
    v_exp_f32 v62, v62
    v_mfma_f32_16x16x32_bf16 v[172:175], a[204:207], v[92:95], v[172:175]
    v_exp_f32 v63, v63
    s_waitcnt lgkmcnt(6)
    v_mfma_f32_16x16x32_bf16 v[176:179], a[208:211], v[76:79], v[176:179]
    v_add_f32 v27, v27, v60
    v_add_f32 v27, v27, v61
    v_mfma_f32_16x16x32_bf16 v[180:183], a[208:211], v[80:83], v[180:183]
    v_add_f32 v27, v27, v62
    v_add_f32 v27, v27, v63
    v_mfma_f32_16x16x32_bf16 v[184:187], a[208:211], v[84:87], v[184:187]
    v_cvt_pk_bf16_f32 v60, v60, v61
    v_cvt_pk_bf16_f32 v61, v62, v63
    v_mfma_f32_16x16x32_bf16 v[188:191], a[208:211], v[88:91], v[188:191]
    v_mul_f32 v64, s23, v64
    v_mul_f32 v65, s23, v65
    v_mfma_f32_16x16x32_bf16 v[192:195], a[208:211], v[92:95], v[192:195]
    v_mul_f32 v66, s23, v66
    s_waitcnt lgkmcnt(4)
    v_mfma_f32_16x16x32_bf16 v[196:199], a[212:215], v[76:79], v[196:199]
    v_mul_f32 v67, s23, v67
    v_mfma_f32_16x16x32_bf16 v[200:203], a[212:215], v[80:83], v[200:203]
    buffer_load_dwordx4 v4, s[32:35], s22 offen offset:2176 nt lds
    v_mfma_f32_16x16x32_bf16 v[204:207], a[212:215], v[84:87], v[204:207]
    v_exp_f32 v64, v64
    v_mfma_f32_16x16x32_bf16 v[208:211], a[212:215], v[88:91], v[208:211]
    v_exp_f32 v65, v65
    v_mfma_f32_16x16x32_bf16 v[212:215], a[212:215], v[92:95], v[212:215]
    s_waitcnt vmcnt(19) lgkmcnt(0)
    s_barrier
    v_mfma_f32_16x16x32_bf16 v[216:219], a[160:163], v[76:79], v[216:219]
    ds_read_b64 v[38:39], v19
    ds_read_b64 v[42:43], v19 offset:512
    v_mfma_f32_16x16x32_bf16 v[220:223], a[160:163], v[80:83], v[220:223]
    ds_write_b64 v14, v[56:57] offset:10240
    v_mfma_f32_16x16x32_bf16 v[224:227], a[160:163], v[84:87], v[224:227]
    ds_read_b64 v[46:47], v19 offset:1024
    ds_read_b64 v[50:51], v19 offset:1536
    v_mfma_f32_16x16x32_bf16 v[228:231], a[160:163], v[88:91], v[228:231]
    ds_read_b64 v[54:55], v19 offset:2048
    v_mfma_f32_16x16x32_bf16 v[232:235], a[160:163], v[92:95], v[232:235]
    ds_write_b64 v14, v[60:61] offset:10752
    v_mfma_f32_16x16x32_bf16 v[236:239], a[164:167], v[76:79], v[236:239]
    v_exp_f32 v66, v66
    v_mfma_f32_16x16x32_bf16 v[240:243], a[164:167], v[80:83], v[240:243]
    v_exp_f32 v67, v67
    v_mfma_f32_16x16x32_bf16 v[244:247], a[164:167], v[84:87], v[244:247]
    v_add_f32 v28, v28, v64
    v_add_f32 v28, v28, v65
    v_mfma_f32_16x16x32_bf16 v[248:251], a[164:167], v[88:91], v[248:251]
    v_add_f32 v28, v28, v66
    v_add_f32 v28, v28, v67
    v_mfma_f32_16x16x32_bf16 v[252:255], a[164:167], v[92:95], v[252:255]
    buffer_load_dwordx4 v5, s[32:35], s22 offen offset:3264 nt lds
    v_cvt_pk_bf16_f32 v64, v64, v65
    v_mfma_f32_16x16x32_bf16 v[76:79], a[168:171], a[0:3], 0
    v_cvt_pk_bf16_f32 v65, v66, v67
    v_mul_f32 v68, s23, v68
    v_mfma_f32_16x16x32_bf16 v[80:83], a[168:171], a[4:7], 0
    ds_write_b64 v14, v[64:65] offset:11264
    v_mfma_f32_16x16x32_bf16 v[84:87], a[168:171], a[8:11], 0
    v_mul_f32 v69, s23, v69
    v_mul_f32 v70, s23, v70
    v_mfma_f32_16x16x32_bf16 v[88:91], a[168:171], a[12:15], 0
    v_mul_f32 v71, s23, v71
    v_mfma_f32_16x16x32_bf16 v[92:95], a[168:171], a[16:19], 0
    v_exp_f32 v68, v68
    v_mfma_f32_16x16x32_bf16 v[76:79], a[172:175], a[20:23], v[76:79]
    v_exp_f32 v69, v69
    v_mfma_f32_16x16x32_bf16 v[80:83], a[172:175], a[24:27], v[80:83]
    v_exp_f32 v70, v70
    v_mfma_f32_16x16x32_bf16 v[84:87], a[172:175], a[28:31], v[84:87]
    v_exp_f32 v71, v71
    v_mfma_f32_16x16x32_bf16 v[88:91], a[172:175], a[32:35], v[88:91]
    v_add_f32 v29, v29, v68
    v_add_f32 v29, v29, v69
    v_mfma_f32_16x16x32_bf16 v[92:95], a[172:175], a[36:39], v[92:95]
    v_add_f32 v29, v29, v70
    v_add_f32 v29, v29, v71
    v_mfma_f32_16x16x32_bf16 v[76:79], a[176:179], a[40:43], v[76:79]
    v_cvt_pk_bf16_f32 v68, v68, v69
    v_cvt_pk_bf16_f32 v69, v70, v71
    v_mfma_f32_16x16x32_bf16 v[80:83], a[176:179], a[44:47], v[80:83]
    ds_write_b64 v14, v[68:69] offset:11776
    v_mfma_f32_16x16x32_bf16 v[84:87], a[176:179], a[48:51], v[84:87]
    v_mul_f32 v72, s23, v72
    v_mul_f32 v73, s23, v73
    v_mfma_f32_16x16x32_bf16 v[88:91], a[176:179], a[52:55], v[88:91]
    s_add_u32 m0, s21, 0
    s_mov_b32 s22, 147456
    buffer_load_dwordx4 v2, s[36:39], s22 offen nt lds
    v_mfma_f32_16x16x32_bf16 v[92:95], a[176:179], a[56:59], v[92:95]
    v_mul_f32 v74, s23, v74
    v_mul_f32 v75, s23, v75
    v_mfma_f32_16x16x32_bf16 v[76:79], a[180:183], a[60:63], v[76:79]
    v_exp_f32 v72, v72
    v_mfma_f32_16x16x32_bf16 v[80:83], a[180:183], a[64:67], v[80:83]
    v_exp_f32 v73, v73
    v_mfma_f32_16x16x32_bf16 v[84:87], a[180:183], a[68:71], v[84:87]
    ds_read_b64_tr_b16 a[224:225], v10 offset:52224
    ds_read_b64_tr_b16 a[226:227], v12 offset:52224
    v_mfma_f32_16x16x32_bf16 v[88:91], a[180:183], a[72:75], v[88:91]
    v_exp_f32 v74, v74
    v_mfma_f32_16x16x32_bf16 v[92:95], a[180:183], a[76:79], v[92:95]
    buffer_load_dword v33, off, s[56:59], 0 sc1
    v_mfma_f32_16x16x32_bf16 v[76:79], a[184:187], a[80:83], v[76:79]
    v_exp_f32 v75, v75
    v_mfma_f32_16x16x32_bf16 v[80:83], a[184:187], a[84:87], v[80:83]
    v_add_f32 v30, v30, v72
    v_add_f32 v30, v30, v73
    v_mfma_f32_16x16x32_bf16 v[84:87], a[184:187], a[88:91], v[84:87]
    ds_read_b64_tr_b16 a[228:229], v11 offset:52224
    ds_read_b64_tr_b16 a[230:231], v13 offset:52224
    v_mfma_f32_16x16x32_bf16 v[88:91], a[184:187], a[92:95], v[88:91]
    v_add_f32 v30, v30, v74
    v_add_f32 v30, v30, v75
    v_mfma_f32_16x16x32_bf16 v[92:95], a[184:187], a[96:99], v[92:95]
    v_cvt_pk_bf16_f32 v72, v72, v73
    v_cvt_pk_bf16_f32 v73, v74, v75
    v_mfma_f32_16x16x32_bf16 v[76:79], a[188:191], a[100:103], v[76:79]
    ds_write_b64 v14, v[72:73] offset:12288
    v_mfma_f32_16x16x32_bf16 v[80:83], a[188:191], a[104:107], v[80:83]
    buffer_load_dwordx4 v3, s[36:39], s22 offen offset:1088 nt lds
    v_mfma_f32_16x16x32_bf16 v[84:87], a[188:191], a[108:111], v[84:87]
    ds_read_b64_tr_b16 a[232:233], v10 offset:52352
    ds_read_b64_tr_b16 a[234:235], v12 offset:52352
    v_mfma_f32_16x16x32_bf16 v[88:91], a[188:191], a[112:115], v[88:91]
    v_mfma_f32_16x16x32_bf16 v[92:95], a[188:191], a[116:119], v[92:95]
    v_mfma_f32_16x16x32_bf16 v[76:79], a[192:195], a[120:123], v[76:79]
    v_mfma_f32_16x16x32_bf16 v[80:83], a[192:195], a[124:127], v[80:83]
    v_mfma_f32_16x16x32_bf16 v[84:87], a[192:195], a[128:131], v[84:87]
    ds_read_b64_tr_b16 a[236:237], v11 offset:52352
    ds_read_b64_tr_b16 a[238:239], v13 offset:52352
    v_mfma_f32_16x16x32_bf16 v[88:91], a[192:195], a[132:135], v[88:91]
    v_mfma_f32_16x16x32_bf16 v[92:95], a[192:195], a[136:139], v[92:95]
    v_mfma_f32_16x16x32_bf16 v[76:79], a[196:199], a[140:143], v[76:79]
    v_mfma_f32_16x16x32_bf16 v[80:83], a[196:199], a[144:147], v[80:83]
    v_mfma_f32_16x16x32_bf16 v[84:87], a[196:199], a[148:151], v[84:87]
    ds_read_b64_tr_b16 a[240:241], v10 offset:52480
    ds_read_b64_tr_b16 a[242:243], v12 offset:52480
    v_mfma_f32_16x16x32_bf16 v[88:91], a[196:199], a[152:155], v[88:91]
    v_mfma_f32_16x16x32_bf16 v[92:95], a[196:199], a[156:159], v[92:95]
    s_waitcnt lgkmcnt(9)
    v_mfma_f32_16x16x32_bf16 v[96:99], a[224:227], v[36:39], v[96:99]
    buffer_load_dwordx4 v4, s[36:39], s22 offen offset:2176 nt lds
    v_mul_f32 v76, s23, v76
    v_mfma_f32_16x16x32_bf16 v[100:103], a[224:227], v[40:43], v[100:103]
    v_mul_f32 v77, s23, v77
    v_mul_f32 v78, s23, v78
    v_mfma_f32_16x16x32_bf16 v[104:107], a[224:227], v[44:47], v[104:107]
    ds_read_b64_tr_b16 a[244:245], v11 offset:52480
    ds_read_b64_tr_b16 a[246:247], v13 offset:52480
    v_mfma_f32_16x16x32_bf16 v[108:111], a[224:227], v[48:51], v[108:111]
    v_mul_f32 v79, s23, v79
    v_mfma_f32_16x16x32_bf16 v[112:115], a[224:227], v[52:55], v[112:115]
    v_exp_f32 v76, v76
    s_waitcnt lgkmcnt(9)
    v_mfma_f32_16x16x32_bf16 v[116:119], a[228:231], v[36:39], v[116:119]
    v_exp_f32 v77, v77
    v_mfma_f32_16x16x32_bf16 v[120:123], a[228:231], v[40:43], v[120:123]
    v_exp_f32 v78, v78
    v_mfma_f32_16x16x32_bf16 v[124:127], a[228:231], v[44:47], v[124:127]
    ds_read_b64_tr_b16 a[248:249], v10 offset:52608
    ds_read_b64_tr_b16 a[250:251], v12 offset:52608
    v_mfma_f32_16x16x32_bf16 v[128:131], a[228:231], v[48:51], v[128:131]
    v_exp_f32 v79, v79
    v_mfma_f32_16x16x32_bf16 v[132:135], a[228:231], v[52:55], v[132:135]
    v_add_f32 v26, v26, v76
    s_waitcnt lgkmcnt(8)
    v_mfma_f32_16x16x32_bf16 v[136:139], a[232:235], v[36:39], v[136:139]
    v_add_f32 v26, v26, v77
    v_add_f32 v26, v26, v78
    v_mfma_f32_16x16x32_bf16 v[140:143], a[232:235], v[40:43], v[140:143]
    v_add_f32 v26, v26, v79
    v_cvt_pk_bf16_f32 v76, v76, v77
    v_mfma_f32_16x16x32_bf16 v[144:147], a[232:235], v[44:47], v[144:147]
    ds_read_b64_tr_b16 a[252:253], v11 offset:52608
    ds_read_b64_tr_b16 a[254:255], v13 offset:52608
    v_mfma_f32_16x16x32_bf16 v[148:151], a[232:235], v[48:51], v[148:151]
    buffer_load_dwordx4 v5, s[36:39], s22 offen offset:3264 nt lds
    v_cvt_pk_bf16_f32 v77, v78, v79
    v_mfma_f32_16x16x32_bf16 v[152:155], a[232:235], v[52:55], v[152:155]
    v_mul_f32 v80, s23, v80
    s_waitcnt lgkmcnt(8)
    v_mfma_f32_16x16x32_bf16 v[156:159], a[236:239], v[36:39], v[156:159]
    v_mul_f32 v81, s23, v81
    v_mul_f32 v82, s23, v82
    v_mfma_f32_16x16x32_bf16 v[160:163], a[236:239], v[40:43], v[160:163]
    v_mul_f32 v83, s23, v83
    v_mfma_f32_16x16x32_bf16 v[164:167], a[236:239], v[44:47], v[164:167]
    v_exp_f32 v80, v80
    v_mfma_f32_16x16x32_bf16 v[168:171], a[236:239], v[48:51], v[168:171]
    v_exp_f32 v81, v81
    v_mfma_f32_16x16x32_bf16 v[172:175], a[236:239], v[52:55], v[172:175]
    v_exp_f32 v82, v82
    s_waitcnt lgkmcnt(6)
    v_mfma_f32_16x16x32_bf16 v[176:179], a[240:243], v[36:39], v[176:179]
    v_exp_f32 v83, v83
    v_mfma_f32_16x16x32_bf16 v[180:183], a[240:243], v[40:43], v[180:183]
    v_add_f32 v27, v27, v80
    v_add_f32 v27, v27, v81
    v_mfma_f32_16x16x32_bf16 v[184:187], a[240:243], v[44:47], v[184:187]
    v_add_f32 v27, v27, v82
    v_add_f32 v27, v27, v83
    v_mfma_f32_16x16x32_bf16 v[188:191], a[240:243], v[48:51], v[188:191]
    v_cvt_pk_bf16_f32 v80, v80, v81
    v_cvt_pk_bf16_f32 v81, v82, v83
    v_mfma_f32_16x16x32_bf16 v[192:195], a[240:243], v[52:55], v[192:195]
    v_mul_f32 v84, s23, v84
    s_waitcnt lgkmcnt(4)
    v_mfma_f32_16x16x32_bf16 v[196:199], a[244:247], v[36:39], v[196:199]
    v_mul_f32 v85, s23, v85
    v_mul_f32 v86, s23, v86
    v_mfma_f32_16x16x32_bf16 v[200:203], a[244:247], v[40:43], v[200:203]
    v_mul_f32 v87, s23, v87
    v_mfma_f32_16x16x32_bf16 v[204:207], a[244:247], v[44:47], v[204:207]
    s_add_u32 m0, s21, 17408
    s_mov_b32 s22, 196608
    buffer_load_dwordx4 v2, s[32:35], s22 offen nt lds
    v_mfma_f32_16x16x32_bf16 v[208:211], a[244:247], v[48:51], v[208:211]
    v_exp_f32 v84, v84
    v_mfma_f32_16x16x32_bf16 v[212:215], a[244:247], v[52:55], v[212:215]
    s_waitcnt vmcnt(18) lgkmcnt(0)
    s_barrier
    v_mfma_f32_16x16x32_bf16 v[216:219], a[248:251], v[36:39], v[216:219]
    v_add_u32 v24, 0x15400, v24
    ds_read_b128 a[216:219], v24
    v_mfma_f32_16x16x32_bf16 v[220:223], a[248:251], v[40:43], v[220:223]
    v_add_u32 v25, 0x15400, v25
    ds_read_b128 a[220:223], v25
    v_mfma_f32_16x16x32_bf16 v[224:227], a[248:251], v[44:47], v[224:227]
    ds_read_b64 v[58:59], v19 offset:10240
    ds_read_b128 a[200:203], v24 offset:128
    v_mfma_f32_16x16x32_bf16 v[228:231], a[248:251], v[48:51], v[228:231]
    ds_write_b64 v14, v[76:77]
    v_mfma_f32_16x16x32_bf16 v[232:235], a[248:251], v[52:55], v[232:235]
    ds_read_b64 v[62:63], v19 offset:10752
    ds_read_b64 v[66:67], v19 offset:11264
    v_mfma_f32_16x16x32_bf16 v[236:239], a[252:255], v[36:39], v[236:239]
    ds_read_b64 v[70:71], v19 offset:11776
    ds_read_b64 v[74:75], v19 offset:12288
    v_mfma_f32_16x16x32_bf16 v[240:243], a[252:255], v[40:43], v[240:243]
    ds_read_b128 a[204:207], v25 offset:128
    v_mfma_f32_16x16x32_bf16 v[244:247], a[252:255], v[44:47], v[244:247]
    ds_read_b128 a[208:211], v24 offset:256
    v_mfma_f32_16x16x32_bf16 v[248:251], a[252:255], v[48:51], v[248:251]
    ds_write_b64 v14, v[80:81] offset:512
    v_mfma_f32_16x16x32_bf16 v[252:255], a[252:255], v[52:55], v[252:255]
    v_exp_f32 v85, v85
    s_waitcnt lgkmcnt(11)
    v_mfma_f32_16x16x32_bf16 v[36:39], a[216:219], a[0:3], 0
    buffer_load_dwordx4 v3, s[32:35], s22 offen offset:1088 nt lds
    v_mfma_f32_16x16x32_bf16 v[40:43], a[216:219], a[4:7], 0
    v_exp_f32 v86, v86
    v_mfma_f32_16x16x32_bf16 v[44:47], a[216:219], a[8:11], 0
    ds_read_b128 a[212:215], v25 offset:256
    v_mfma_f32_16x16x32_bf16 v[48:51], a[216:219], a[12:15], 0
    v_exp_f32 v87, v87
    v_mfma_f32_16x16x32_bf16 v[52:55], a[216:219], a[16:19], 0
    v_add_f32 v28, v28, v84
    s_waitcnt lgkmcnt(11)
    v_mfma_f32_16x16x32_bf16 v[36:39], a[220:223], a[20:23], v[36:39]
    v_add_f32 v28, v28, v85
    v_add_f32 v28, v28, v86
    v_mfma_f32_16x16x32_bf16 v[40:43], a[220:223], a[24:27], v[40:43]
    v_add_f32 v28, v28, v87
    v_cvt_pk_bf16_f32 v84, v84, v85
    v_mfma_f32_16x16x32_bf16 v[44:47], a[220:223], a[28:31], v[44:47]
    ds_read_b128 a[160:163], v24 offset:384
    v_cvt_pk_bf16_f32 v85, v86, v87
    v_mfma_f32_16x16x32_bf16 v[48:51], a[220:223], a[32:35], v[48:51]
    ds_write_b64 v14, v[84:85] offset:1024
    v_mfma_f32_16x16x32_bf16 v[52:55], a[220:223], a[36:39], v[52:55]
    v_mul_f32 v88, s23, v88
    s_waitcnt lgkmcnt(11)
    v_mfma_f32_16x16x32_bf16 v[36:39], a[200:203], a[40:43], v[36:39]
    v_mul_f32 v89, s23, v89
    v_mul_f32 v90, s23, v90
    v_mfma_f32_16x16x32_bf16 v[40:43], a[200:203], a[44:47], v[40:43]
    v_mul_f32 v91, s23, v91
    v_mfma_f32_16x16x32_bf16 v[44:47], a[200:203], a[48:51], v[44:47]
    ds_read_b128 a[164:167], v25 offset:384
    v_mfma_f32_16x16x32_bf16 v[48:51], a[200:203], a[52:55], v[48:51]
    v_exp_f32 v88, v88
    v_mfma_f32_16x16x32_bf16 v[52:55], a[200:203], a[56:59], v[52:55]
    buffer_load_dwordx4 v4, s[32:35], s22 offen offset:2176 nt lds
    s_waitcnt lgkmcnt(6)
    v_mfma_f32_16x16x32_bf16 v[36:39], a[204:207], a[60:63], v[36:39]
    v_exp_f32 v89, v89
    v_mfma_f32_16x16x32_bf16 v[40:43], a[204:207], a[64:67], v[40:43]
    v_exp_f32 v90, v90
    v_mfma_f32_16x16x32_bf16 v[44:47], a[204:207], a[68:71], v[44:47]
    ds_read_b64_tr_b16 a[168:169], v10 offset:34816
    ds_read_b64_tr_b16 a[170:171], v12 offset:34816
    v_mfma_f32_16x16x32_bf16 v[48:51], a[204:207], a[72:75], v[48:51]
    v_exp_f32 v91, v91
    v_mfma_f32_16x16x32_bf16 v[52:55], a[204:207], a[76:79], v[52:55]
    v_add_f32 v29, v29, v88
    s_waitcnt lgkmcnt(7)
    v_mfma_f32_16x16x32_bf16 v[36:39], a[208:211], a[80:83], v[36:39]
    v_add_f32 v29, v29, v89
    v_add_f32 v29, v29, v90
    v_mfma_f32_16x16x32_bf16 v[40:43], a[208:211], a[84:87], v[40:43]
    v_add_f32 v29, v29, v91
    v_cvt_pk_bf16_f32 v88, v88, v89
    v_mfma_f32_16x16x32_bf16 v[44:47], a[208:211], a[88:91], v[44:47]
    ds_read_b64_tr_b16 a[172:173], v11 offset:34816
    ds_read_b64_tr_b16 a[174:175], v13 offset:34816
    v_mfma_f32_16x16x32_bf16 v[48:51], a[208:211], a[92:95], v[48:51]
    v_cvt_pk_bf16_f32 v89, v90, v91
    v_mul_f32 v92, s23, v92
    v_mfma_f32_16x16x32_bf16 v[52:55], a[208:211], a[96:99], v[52:55]
    ds_write_b64 v14, v[88:89] offset:1536
    s_waitcnt lgkmcnt(8)
    v_mfma_f32_16x16x32_bf16 v[36:39], a[212:215], a[100:103], v[36:39]
    v_mul_f32 v93, s23, v93
    v_mul_f32 v94, s23, v94
    v_mfma_f32_16x16x32_bf16 v[40:43], a[212:215], a[104:107], v[40:43]
    v_mul_f32 v95, s23, v95
    v_mfma_f32_16x16x32_bf16 v[44:47], a[212:215], a[108:111], v[44:47]
    buffer_load_dwordx4 v5, s[32:35], s22 offen offset:3264 nt lds
    ds_read_b64_tr_b16 a[176:177], v10 offset:34944
    v_mfma_f32_16x16x32_bf16 v[48:51], a[212:215], a[112:115], v[48:51]
    ds_read_b64_tr_b16 a[178:179], v12 offset:34944
    v_mfma_f32_16x16x32_bf16 v[52:55], a[212:215], a[116:119], v[52:55]
    v_exp_f32 v92, v92
    s_waitcnt lgkmcnt(9)
    v_mfma_f32_16x16x32_bf16 v[36:39], a[160:163], a[120:123], v[36:39]
    v_exp_f32 v93, v93
    v_mfma_f32_16x16x32_bf16 v[40:43], a[160:163], a[124:127], v[40:43]
    v_exp_f32 v94, v94
    v_mfma_f32_16x16x32_bf16 v[44:47], a[160:163], a[128:131], v[44:47]
    ds_read_b64_tr_b16 a[180:181], v11 offset:34944
    ds_read_b64_tr_b16 a[182:183], v13 offset:34944
    v_mfma_f32_16x16x32_bf16 v[48:51], a[160:163], a[132:135], v[48:51]
    v_exp_f32 v95, v95
    v_mfma_f32_16x16x32_bf16 v[52:55], a[160:163], a[136:139], v[52:55]
    v_add_f32 v30, v30, v92
    s_waitcnt lgkmcnt(9)
    v_mfma_f32_16x16x32_bf16 v[36:39], a[164:167], a[140:143], v[36:39]
    v_add_f32 v30, v30, v93
    v_add_f32 v30, v30, v94
    v_mfma_f32_16x16x32_bf16 v[40:43], a[164:167], a[144:147], v[40:43]
    v_add_f32 v30, v30, v95
    v_cvt_pk_bf16_f32 v92, v92, v93
    v_mfma_f32_16x16x32_bf16 v[44:47], a[164:167], a[148:151], v[44:47]
    ds_read_b64_tr_b16 a[184:185], v10 offset:35072
    ds_read_b64_tr_b16 a[186:187], v12 offset:35072
    v_mfma_f32_16x16x32_bf16 v[48:51], a[164:167], a[152:155], v[48:51]
    v_cvt_pk_bf16_f32 v93, v94, v95
    v_mul_f32 v36, s23, v36
    v_mfma_f32_16x16x32_bf16 v[52:55], a[164:167], a[156:159], v[52:55]
    ds_write_b64 v14, v[92:93] offset:2048
    s_waitcnt lgkmcnt(10)
    v_mfma_f32_16x16x32_bf16 v[96:99], a[168:171], v[56:59], v[96:99]
    v_mul_f32 v37, s23, v37
    v_mul_f32 v38, s23, v38
    v_mfma_f32_16x16x32_bf16 v[100:103], a[168:171], v[60:63], v[100:103]
    s_add_u32 m0, s21, 52224
    s_mov_b32 s22, 163840
    buffer_load_dwordx4 v2, s[36:39], s22 offen nt lds
    v_mfma_f32_16x16x32_bf16 v[104:107], a[168:171], v[64:67], v[104:107]
    ds_read_b64_tr_b16 a[188:189], v11 offset:35072
    ds_read_b64_tr_b16 a[190:191], v13 offset:35072
    v_mfma_f32_16x16x32_bf16 v[108:111], a[168:171], v[68:71], v[108:111]
    v_mul_f32 v39, s23, v39
    v_mfma_f32_16x16x32_bf16 v[112:115], a[168:171], v[72:75], v[112:115]
    v_exp_f32 v36, v36
    s_waitcnt lgkmcnt(10)
    v_mfma_f32_16x16x32_bf16 v[116:119], a[172:175], v[56:59], v[116:119]
    v_exp_f32 v37, v37
    v_mfma_f32_16x16x32_bf16 v[120:123], a[172:175], v[60:63], v[120:123]
    v_exp_f32 v38, v38
    v_mfma_f32_16x16x32_bf16 v[124:127], a[172:175], v[64:67], v[124:127]
    ds_read_b64_tr_b16 a[192:193], v10 offset:35200
    ds_read_b64_tr_b16 a[194:195], v12 offset:35200
    v_mfma_f32_16x16x32_bf16 v[128:131], a[172:175], v[68:71], v[128:131]
    v_exp_f32 v39, v39
    v_mfma_f32_16x16x32_bf16 v[132:135], a[172:175], v[72:75], v[132:135]
    v_add_f32 v26, v26, v36
    s_waitcnt lgkmcnt(9)
    v_mfma_f32_16x16x32_bf16 v[136:139], a[176:179], v[56:59], v[136:139]
    v_add_f32 v26, v26, v37
    v_add_f32 v26, v26, v38
    v_mfma_f32_16x16x32_bf16 v[140:143], a[176:179], v[60:63], v[140:143]
    v_add_f32 v26, v26, v39
    v_cvt_pk_bf16_f32 v36, v36, v37
    v_mfma_f32_16x16x32_bf16 v[144:147], a[176:179], v[64:67], v[144:147]
    ds_read_b64_tr_b16 a[196:197], v11 offset:35200
    ds_read_b64_tr_b16 a[198:199], v13 offset:35200
    v_mfma_f32_16x16x32_bf16 v[148:151], a[176:179], v[68:71], v[148:151]
    v_cvt_pk_bf16_f32 v37, v38, v39
    v_mul_f32 v40, s23, v40
    v_mfma_f32_16x16x32_bf16 v[152:155], a[176:179], v[72:75], v[152:155]
    buffer_load_dwordx4 v3, s[36:39], s22 offen offset:1088 nt lds
    s_waitcnt lgkmcnt(9)
    v_mfma_f32_16x16x32_bf16 v[156:159], a[180:183], v[56:59], v[156:159]
    v_mul_f32 v41, s23, v41
    v_mul_f32 v42, s23, v42
    v_mfma_f32_16x16x32_bf16 v[160:163], a[180:183], v[60:63], v[160:163]
    v_mul_f32 v43, s23, v43
    v_mfma_f32_16x16x32_bf16 v[164:167], a[180:183], v[64:67], v[164:167]
    v_exp_f32 v40, v40
    v_mfma_f32_16x16x32_bf16 v[168:171], a[180:183], v[68:71], v[168:171]
    v_exp_f32 v41, v41
    v_mfma_f32_16x16x32_bf16 v[172:175], a[180:183], v[72:75], v[172:175]
    v_exp_f32 v42, v42
    s_waitcnt lgkmcnt(7)
    v_mfma_f32_16x16x32_bf16 v[176:179], a[184:187], v[56:59], v[176:179]
    v_exp_f32 v43, v43
    v_mfma_f32_16x16x32_bf16 v[180:183], a[184:187], v[60:63], v[180:183]
    v_add_f32 v27, v27, v40
    v_add_f32 v27, v27, v41
    v_mfma_f32_16x16x32_bf16 v[184:187], a[184:187], v[64:67], v[184:187]
    v_add_f32 v27, v27, v42
    v_add_f32 v27, v27, v43
    v_mfma_f32_16x16x32_bf16 v[188:191], a[184:187], v[68:71], v[188:191]
    v_cvt_pk_bf16_f32 v40, v40, v41
    v_cvt_pk_bf16_f32 v41, v42, v43
    v_mfma_f32_16x16x32_bf16 v[192:195], a[184:187], v[72:75], v[192:195]
    v_mul_f32 v44, s23, v44
    s_waitcnt lgkmcnt(4)
    v_mfma_f32_16x16x32_bf16 v[196:199], a[188:191], v[56:59], v[196:199]
    v_mul_f32 v45, s23, v45
    v_mul_f32 v46, s23, v46
    v_mfma_f32_16x16x32_bf16 v[200:203], a[188:191], v[60:63], v[200:203]
    v_mul_f32 v47, s23, v47
    v_mfma_f32_16x16x32_bf16 v[204:207], a[188:191], v[64:67], v[204:207]
    v_exp_f32 v44, v44
    v_mfma_f32_16x16x32_bf16 v[208:211], a[188:191], v[68:71], v[208:211]
    buffer_load_dwordx4 v4, s[36:39], s22 offen offset:2176 nt lds
    v_mfma_f32_16x16x32_bf16 v[212:215], a[188:191], v[72:75], v[212:215]
    s_waitcnt vmcnt(16) lgkmcnt(0)
    s_barrier
    v_mfma_f32_16x16x32_bf16 v[216:219], a[192:195], v[56:59], v[216:219]
    v_add_u32 v24, 0xffff7800, v24
    ds_read_b128 a[224:227], v24
    v_mfma_f32_16x16x32_bf16 v[220:223], a[192:195], v[60:63], v[220:223]
    v_add_u32 v25, 0xffff7800, v25
    ds_read_b128 a[228:231], v25
    v_mfma_f32_16x16x32_bf16 v[224:227], a[192:195], v[64:67], v[224:227]
    ds_read_b64 v[78:79], v19
    ds_read_b128 a[232:235], v24 offset:128
    v_mfma_f32_16x16x32_bf16 v[228:231], a[192:195], v[68:71], v[228:231]
    ds_write_b64 v14, v[36:37] offset:10240
    v_mfma_f32_16x16x32_bf16 v[232:235], a[192:195], v[72:75], v[232:235]
    ds_read_b64 v[82:83], v19 offset:512
    ds_read_b64 v[86:87], v19 offset:1024
    v_mfma_f32_16x16x32_bf16 v[236:239], a[196:199], v[56:59], v[236:239]
    ds_read_b64 v[90:91], v19 offset:1536
    ds_read_b64 v[94:95], v19 offset:2048
    v_mfma_f32_16x16x32_bf16 v[240:243], a[196:199], v[60:63], v[240:243]
    ds_read_b128 a[236:239], v25 offset:128
    v_mfma_f32_16x16x32_bf16 v[244:247], a[196:199], v[64:67], v[244:247]
    ds_read_b128 a[240:243], v24 offset:256
    v_mfma_f32_16x16x32_bf16 v[248:251], a[196:199], v[68:71], v[248:251]
    ds_write_b64 v14, v[40:41] offset:10752
    v_mfma_f32_16x16x32_bf16 v[252:255], a[196:199], v[72:75], v[252:255]
    v_exp_f32 v45, v45
    s_waitcnt lgkmcnt(11)
    v_mfma_f32_16x16x32_bf16 v[56:59], a[224:227], a[0:3], 0
    v_exp_f32 v46, v46
    v_mfma_f32_16x16x32_bf16 v[60:63], a[224:227], a[4:7], 0
    buffer_load_dwordx4 v5, s[36:39], s22 offen offset:3264 nt lds
    v_mfma_f32_16x16x32_bf16 v[64:67], a[224:227], a[8:11], 0
    ds_read_b128 a[244:247], v25 offset:256
    v_mfma_f32_16x16x32_bf16 v[68:71], a[224:227], a[12:15], 0
    v_exp_f32 v47, v47
    v_mfma_f32_16x16x32_bf16 v[72:75], a[224:227], a[16:19], 0
    v_add_f32 v28, v28, v44
    s_waitcnt lgkmcnt(11)
    v_mfma_f32_16x16x32_bf16 v[56:59], a[228:231], a[20:23], v[56:59]
    v_add_f32 v28, v28, v45
    v_add_f32 v28, v28, v46
    v_mfma_f32_16x16x32_bf16 v[60:63], a[228:231], a[24:27], v[60:63]
    v_add_f32 v28, v28, v47
    v_cvt_pk_bf16_f32 v44, v44, v45
    v_mfma_f32_16x16x32_bf16 v[64:67], a[228:231], a[28:31], v[64:67]
    ds_read_b128 a[248:251], v24 offset:384
    v_cvt_pk_bf16_f32 v45, v46, v47
    v_mfma_f32_16x16x32_bf16 v[68:71], a[228:231], a[32:35], v[68:71]
    ds_write_b64 v14, v[44:45] offset:11264
    v_mfma_f32_16x16x32_bf16 v[72:75], a[228:231], a[36:39], v[72:75]
    v_mul_f32 v48, s23, v48
    s_waitcnt lgkmcnt(11)
    v_mfma_f32_16x16x32_bf16 v[56:59], a[232:235], a[40:43], v[56:59]
    v_mul_f32 v49, s23, v49
    v_mul_f32 v50, s23, v50
    v_mfma_f32_16x16x32_bf16 v[60:63], a[232:235], a[44:47], v[60:63]
    v_mul_f32 v51, s23, v51
    v_mfma_f32_16x16x32_bf16 v[64:67], a[232:235], a[48:51], v[64:67]
    ds_read_b128 a[252:255], v25 offset:384
    v_mfma_f32_16x16x32_bf16 v[68:71], a[232:235], a[52:55], v[68:71]
    v_exp_f32 v48, v48
    v_mfma_f32_16x16x32_bf16 v[72:75], a[232:235], a[56:59], v[72:75]
    v_exp_f32 v49, v49
    s_waitcnt lgkmcnt(6)
    v_mfma_f32_16x16x32_bf16 v[56:59], a[236:239], a[60:63], v[56:59]
    s_add_u32 m0, s21, 104448
    s_mov_b32 s22, 212992
    buffer_load_dwordx4 v2, s[32:35], s22 offen nt lds
    v_mfma_f32_16x16x32_bf16 v[60:63], a[236:239], a[64:67], v[60:63]
    v_exp_f32 v50, v50
    v_mfma_f32_16x16x32_bf16 v[64:67], a[236:239], a[68:71], v[64:67]
    v_add_u32 v10, 0x15400, v10
    ds_read_b64_tr_b16 a[216:217], v10
    v_mfma_f32_16x16x32_bf16 v[68:71], a[236:239], a[72:75], v[68:71]
    v_add_u32 v12, 0x15400, v12
    ds_read_b64_tr_b16 a[218:219], v12
    v_mfma_f32_16x16x32_bf16 v[72:75], a[236:239], a[76:79], v[72:75]
    v_exp_f32 v51, v51
    s_waitcnt lgkmcnt(7)
    v_mfma_f32_16x16x32_bf16 v[56:59], a[240:243], a[80:83], v[56:59]
    v_add_f32 v29, v29, v48
    v_add_f32 v29, v29, v49
    v_mfma_f32_16x16x32_bf16 v[60:63], a[240:243], a[84:87], v[60:63]
    v_add_f32 v29, v29, v50
    v_add_f32 v29, v29, v51
    v_mfma_f32_16x16x32_bf16 v[64:67], a[240:243], a[88:91], v[64:67]
    v_add_u32 v11, 0x15400, v11
    ds_read_b64_tr_b16 a[220:221], v11
    v_mfma_f32_16x16x32_bf16 v[68:71], a[240:243], a[92:95], v[68:71]
    v_add_u32 v13, 0x15400, v13
    ds_read_b64_tr_b16 a[222:223], v13
    v_mfma_f32_16x16x32_bf16 v[72:75], a[240:243], a[96:99], v[72:75]
    v_cvt_pk_bf16_f32 v48, v48, v49
    s_waitcnt lgkmcnt(7)
    v_mfma_f32_16x16x32_bf16 v[56:59], a[244:247], a[100:103], v[56:59]
    v_cvt_pk_bf16_f32 v49, v50, v51
    v_mul_f32 v52, s23, v52
    v_mfma_f32_16x16x32_bf16 v[60:63], a[244:247], a[104:107], v[60:63]
    ds_write_b64 v14, v[48:49] offset:11776
    v_mfma_f32_16x16x32_bf16 v[64:67], a[244:247], a[108:111], v[64:67]
    ds_read_b64_tr_b16 a[200:201], v10 offset:128
    ds_read_b64_tr_b16 a[202:203], v12 offset:128
    v_mfma_f32_16x16x32_bf16 v[68:71], a[244:247], a[112:115], v[68:71]
    buffer_load_dwordx4 v3, s[32:35], s22 offen offset:1088 nt lds
    v_mul_f32 v53, s23, v53
    v_mfma_f32_16x16x32_bf16 v[72:75], a[244:247], a[116:119], v[72:75]
    v_mul_f32 v54, s23, v54
    s_waitcnt lgkmcnt(9)
    v_mfma_f32_16x16x32_bf16 v[56:59], a[248:251], a[120:123], v[56:59]
    v_mul_f32 v55, s23, v55
    v_mfma_f32_16x16x32_bf16 v[60:63], a[248:251], a[124:127], v[60:63]
    v_exp_f32 v52, v52
    v_mfma_f32_16x16x32_bf16 v[64:67], a[248:251], a[128:131], v[64:67]
    ds_read_b64_tr_b16 a[204:205], v11 offset:128
    ds_read_b64_tr_b16 a[206:207], v13 offset:128
    v_mfma_f32_16x16x32_bf16 v[68:71], a[248:251], a[132:135], v[68:71]
    v_exp_f32 v53, v53
    v_mfma_f32_16x16x32_bf16 v[72:75], a[248:251], a[136:139], v[72:75]
    v_exp_f32 v54, v54
    s_waitcnt lgkmcnt(9)
    v_mfma_f32_16x16x32_bf16 v[56:59], a[252:255], a[140:143], v[56:59]
    v_exp_f32 v55, v55
    v_mfma_f32_16x16x32_bf16 v[60:63], a[252:255], a[144:147], v[60:63]
    v_add_f32 v30, v30, v52
    v_add_f32 v30, v30, v53
    v_mfma_f32_16x16x32_bf16 v[64:67], a[252:255], a[148:151], v[64:67]
    ds_read_b64_tr_b16 a[208:209], v10 offset:256
    ds_read_b64_tr_b16 a[210:211], v12 offset:256
    v_mfma_f32_16x16x32_bf16 v[68:71], a[252:255], a[152:155], v[68:71]
    v_add_f32 v30, v30, v54
    v_add_f32 v30, v30, v55
    v_mfma_f32_16x16x32_bf16 v[72:75], a[252:255], a[156:159], v[72:75]
    v_cvt_pk_bf16_f32 v52, v52, v53
    s_waitcnt lgkmcnt(9)
    v_mfma_f32_16x16x32_bf16 v[96:99], a[216:219], v[76:79], v[96:99]
    v_cvt_pk_bf16_f32 v53, v54, v55
    v_mul_f32 v56, s23, v56
    v_mfma_f32_16x16x32_bf16 v[100:103], a[216:219], v[80:83], v[100:103]
    ds_write_b64 v14, v[52:53] offset:12288
    v_mfma_f32_16x16x32_bf16 v[104:107], a[216:219], v[84:87], v[104:107]
    buffer_load_dwordx4 v4, s[32:35], s22 offen offset:2176 nt lds
    ds_read_b64_tr_b16 a[212:213], v11 offset:256
    v_mfma_f32_16x16x32_bf16 v[108:111], a[216:219], v[88:91], v[108:111]
    ds_read_b64_tr_b16 a[214:215], v13 offset:256
    v_mul_f32 v57, s23, v57
    v_mfma_f32_16x16x32_bf16 v[112:115], a[216:219], v[92:95], v[112:115]
    v_mul_f32 v58, s23, v58
    s_waitcnt lgkmcnt(10)
    v_mfma_f32_16x16x32_bf16 v[116:119], a[220:223], v[76:79], v[116:119]
    v_mul_f32 v59, s23, v59
    v_mfma_f32_16x16x32_bf16 v[120:123], a[220:223], v[80:83], v[120:123]
    v_exp_f32 v56, v56
    v_mfma_f32_16x16x32_bf16 v[124:127], a[220:223], v[84:87], v[124:127]
    ds_read_b64_tr_b16 a[160:161], v10 offset:384
    ds_read_b64_tr_b16 a[162:163], v12 offset:384
    v_mfma_f32_16x16x32_bf16 v[128:131], a[220:223], v[88:91], v[128:131]
    v_exp_f32 v57, v57
    v_mfma_f32_16x16x32_bf16 v[132:135], a[220:223], v[92:95], v[132:135]
    v_exp_f32 v58, v58
    s_waitcnt lgkmcnt(9)
    v_mfma_f32_16x16x32_bf16 v[136:139], a[200:203], v[76:79], v[136:139]
    v_exp_f32 v59, v59
    v_mfma_f32_16x16x32_bf16 v[140:143], a[200:203], v[80:83], v[140:143]
    v_add_f32 v26, v26, v56
    v_add_f32 v26, v26, v57
    v_mfma_f32_16x16x32_bf16 v[144:147], a[200:203], v[84:87], v[144:147]
    ds_read_b64_tr_b16 a[164:165], v11 offset:384
    ds_read_b64_tr_b16 a[166:167], v13 offset:384
    v_mfma_f32_16x16x32_bf16 v[148:151], a[200:203], v[88:91], v[148:151]
    v_add_f32 v26, v26, v58
    v_add_f32 v26, v26, v59
    v_mfma_f32_16x16x32_bf16 v[152:155], a[200:203], v[92:95], v[152:155]
    v_cvt_pk_bf16_f32 v56, v56, v57
    s_waitcnt lgkmcnt(9)
    v_mfma_f32_16x16x32_bf16 v[156:159], a[204:207], v[76:79], v[156:159]
    buffer_load_dwordx4 v5, s[32:35], s22 offen offset:3264 nt lds
    v_cvt_pk_bf16_f32 v57, v58, v59
    v_mfma_f32_16x16x32_bf16 v[160:163], a[204:207], v[80:83], v[160:163]
    v_mul_f32 v60, s23, v60
    v_mul_f32 v61, s23, v61
    v_mfma_f32_16x16x32_bf16 v[164:167], a[204:207], v[84:87], v[164:167]
    v_mul_f32 v62, s23, v62
    v_mul_f32 v63, s23, v63
    v_mfma_f32_16x16x32_bf16 v[168:171], a[204:207], v[88:91], v[168:171]
    v_exp_f32 v60, v60
    v_mfma_f32_16x16x32_bf16 v[172:175], a[204:207], v[92:95], v[172:175]
    v_exp_f32 v61, v61
    s_waitcnt lgkmcnt(7)
    v_mfma_f32_16x16x32_bf16 v[176:179], a[208:211], v[76:79], v[176:179]
    v_exp_f32 v62, v62
    v_mfma_f32_16x16x32_bf16 v[180:183], a[208:211], v[80:83], v[180:183]
    v_exp_f32 v63, v63
    v_mfma_f32_16x16x32_bf16 v[184:187], a[208:211], v[84:87], v[184:187]
    v_add_f32 v27, v27, v60
    v_add_f32 v27, v27, v61
    v_mfma_f32_16x16x32_bf16 v[188:191], a[208:211], v[88:91], v[188:191]
    v_add_f32 v27, v27, v62
    v_add_f32 v27, v27, v63
    v_mfma_f32_16x16x32_bf16 v[192:195], a[208:211], v[92:95], v[192:195]
    v_cvt_pk_bf16_f32 v60, v60, v61
    s_waitcnt lgkmcnt(4)
    v_mfma_f32_16x16x32_bf16 v[196:199], a[212:215], v[76:79], v[196:199]
    v_cvt_pk_bf16_f32 v61, v62, v63
    v_mul_f32 v64, s23, v64
    v_mfma_f32_16x16x32_bf16 v[200:203], a[212:215], v[80:83], v[200:203]
    v_mul_f32 v65, s23, v65
    v_mul_f32 v66, s23, v66
    v_mfma_f32_16x16x32_bf16 v[204:207], a[212:215], v[84:87], v[204:207]
    v_mul_f32 v67, s23, v67
    v_mfma_f32_16x16x32_bf16 v[208:211], a[212:215], v[88:91], v[208:211]
    v_exp_f32 v64, v64
    v_mfma_f32_16x16x32_bf16 v[212:215], a[212:215], v[92:95], v[212:215]
    s_waitcnt vmcnt(12) lgkmcnt(0)
    s_barrier
    v_mfma_f32_16x16x32_bf16 v[216:219], a[160:163], v[76:79], v[216:219]
    ds_read_b128 a[168:171], v24 offset:52224
    s_add_u32 m0, s21, 34816
    s_mov_b32 s22, 180224
    buffer_load_dwordx4 v2, s[36:39], s22 offen nt lds
    v_mfma_f32_16x16x32_bf16 v[220:223], a[160:163], v[80:83], v[220:223]
    ds_read_b128 a[172:175], v25 offset:52224
    ds_read_b64 v[38:39], v19 offset:10240
    v_mfma_f32_16x16x32_bf16 v[224:227], a[160:163], v[84:87], v[224:227]
    ds_write_b64 v14, v[56:57]
    v_mfma_f32_16x16x32_bf16 v[228:231], a[160:163], v[88:91], v[228:231]
    ds_read_b128 a[176:179], v24 offset:52352
    ds_read_b64 v[42:43], v19 offset:10752
    v_mfma_f32_16x16x32_bf16 v[232:235], a[160:163], v[92:95], v[232:235]
    ds_read_b64 v[46:47], v19 offset:11264
    ds_read_b64 v[50:51], v19 offset:11776
    v_mfma_f32_16x16x32_bf16 v[236:239], a[164:167], v[76:79], v[236:239]
    ds_read_b64 v[54:55], v19 offset:12288
    ds_read_b128 a[180:183], v25 offset:52352
    v_mfma_f32_16x16x32_bf16 v[240:243], a[164:167], v[80:83], v[240:243]
    ds_write_b64 v14, v[60:61] offset:512
    v_mfma_f32_16x16x32_bf16 v[244:247], a[164:167], v[84:87], v[244:247]
    ds_read_b128 a[184:187], v24 offset:52480
    v_mfma_f32_16x16x32_bf16 v[248:251], a[164:167], v[88:91], v[248:251]
    v_exp_f32 v65, v65
    v_mfma_f32_16x16x32_bf16 v[252:255], a[164:167], v[92:95], v[252:255]
    v_exp_f32 v66, v66
    s_waitcnt lgkmcnt(11)
    v_mfma_f32_16x16x32_bf16 v[76:79], a[168:171], a[0:3], 0
    v_exp_f32 v67, v67
    v_mfma_f32_16x16x32_bf16 v[80:83], a[168:171], a[4:7], 0
    v_add_f32 v28, v28, v64
    v_add_f32 v28, v28, v65
    v_mfma_f32_16x16x32_bf16 v[84:87], a[168:171], a[8:11], 0
    buffer_load_dwordx4 v3, s[36:39], s22 offen offset:1088 nt lds
    ds_read_b128 a[188:191], v25 offset:52480
    v_mfma_f32_16x16x32_bf16 v[88:91], a[168:171], a[12:15], 0
    v_add_f32 v28, v28, v66
    v_add_f32 v28, v28, v67
    v_mfma_f32_16x16x32_bf16 v[92:95], a[168:171], a[16:19], 0
    v_cvt_pk_bf16_f32 v64, v64, v65
    s_waitcnt lgkmcnt(11)
    v_mfma_f32_16x16x32_bf16 v[76:79], a[172:175], a[20:23], v[76:79]
    v_cvt_pk_bf16_f32 v65, v66, v67
    v_mul_f32 v68, s23, v68
    v_mfma_f32_16x16x32_bf16 v[80:83], a[172:175], a[24:27], v[80:83]
    ds_write_b64 v14, v[64:65] offset:1024
    v_mfma_f32_16x16x32_bf16 v[84:87], a[172:175], a[28:31], v[84:87]
    ds_read_b128 a[192:195], v24 offset:52608
    v_mul_f32 v69, s23, v69
    v_mfma_f32_16x16x32_bf16 v[88:91], a[172:175], a[32:35], v[88:91]
    v_mul_f32 v70, s23, v70
    v_mul_f32 v71, s23, v71
    v_mfma_f32_16x16x32_bf16 v[92:95], a[172:175], a[36:39], v[92:95]
    v_exp_f32 v68, v68
    s_waitcnt lgkmcnt(10)
    v_mfma_f32_16x16x32_bf16 v[76:79], a[176:179], a[40:43], v[76:79]
    v_exp_f32 v69, v69
    v_mfma_f32_16x16x32_bf16 v[80:83], a[176:179], a[44:47], v[80:83]
    v_exp_f32 v70, v70
    v_mfma_f32_16x16x32_bf16 v[84:87], a[176:179], a[48:51], v[84:87]
    ds_read_b128 a[196:199], v25 offset:52608
    v_mfma_f32_16x16x32_bf16 v[88:91], a[176:179], a[52:55], v[88:91]
    v_exp_f32 v71, v71
    v_mfma_f32_16x16x32_bf16 v[92:95], a[176:179], a[56:59], v[92:95]
    buffer_load_dwordx4 v4, s[36:39], s22 offen offset:2176 nt lds
    s_waitcnt lgkmcnt(6)
    v_mfma_f32_16x16x32_bf16 v[76:79], a[180:183], a[60:63], v[76:79]
    v_add_f32 v29, v29, v68
    v_add_f32 v29, v29, v69
    v_mfma_f32_16x16x32_bf16 v[80:83], a[180:183], a[64:67], v[80:83]
    v_add_f32 v29, v29, v70
    v_add_f32 v29, v29, v71
    v_mfma_f32_16x16x32_bf16 v[84:87], a[180:183], a[68:71], v[84:87]
    v_add_u32 v10, 0xfffeac00, v10
    ds_read_b64_tr_b16 a[224:225], v10
    v_mfma_f32_16x16x32_bf16 v[88:91], a[180:183], a[72:75], v[88:91]
    v_add_u32 v12, 0xfffeac00, v12
    ds_read_b64_tr_b16 a[226:227], v12
    v_mfma_f32_16x16x32_bf16 v[92:95], a[180:183], a[76:79], v[92:95]
    v_cvt_pk_bf16_f32 v68, v68, v69
    s_waitcnt lgkmcnt(6)
    v_mfma_f32_16x16x32_bf16 v[76:79], a[184:187], a[80:83], v[76:79]
    v_cvt_pk_bf16_f32 v69, v70, v71
    v_mul_f32 v72, s23, v72
    v_mfma_f32_16x16x32_bf16 v[80:83], a[184:187], a[84:87], v[80:83]
    ds_write_b64 v14, v[68:69] offset:1536
    v_mfma_f32_16x16x32_bf16 v[84:87], a[184:187], a[88:91], v[84:87]
    buffer_load_dwordx4 v5, s[36:39], s22 offen offset:3264 nt lds
    v_add_u32 v11, 0xfffeac00, v11
    ds_read_b64_tr_b16 a[228:229], v11
    v_mfma_f32_16x16x32_bf16 v[88:91], a[184:187], a[92:95], v[88:91]
    v_add_u32 v13, 0xfffeac00, v13
    ds_read_b64_tr_b16 a[230:231], v13
    v_mfma_f32_16x16x32_bf16 v[92:95], a[184:187], a[96:99], v[92:95]
    v_mul_f32 v73, s23, v73
    s_waitcnt lgkmcnt(8)
    v_mfma_f32_16x16x32_bf16 v[76:79], a[188:191], a[100:103], v[76:79]
    v_mul_f32 v74, s23, v74
    v_mul_f32 v75, s23, v75
    v_mfma_f32_16x16x32_bf16 v[80:83], a[188:191], a[104:107], v[80:83]
    v_exp_f32 v72, v72
    v_mfma_f32_16x16x32_bf16 v[84:87], a[188:191], a[108:111], v[84:87]
    ds_read_b64_tr_b16 a[232:233], v10 offset:128
    ds_read_b64_tr_b16 a[234:235], v12 offset:128
    v_mfma_f32_16x16x32_bf16 v[88:91], a[188:191], a[112:115], v[88:91]
    v_exp_f32 v73, v73
    v_mfma_f32_16x16x32_bf16 v[92:95], a[188:191], a[116:119], v[92:95]
    v_exp_f32 v74, v74
    s_waitcnt lgkmcnt(8)
    v_mfma_f32_16x16x32_bf16 v[76:79], a[192:195], a[120:123], v[76:79]
    v_exp_f32 v75, v75
    v_mfma_f32_16x16x32_bf16 v[80:83], a[192:195], a[124:127], v[80:83]
    v_add_f32 v30, v30, v72
    v_add_f32 v30, v30, v73
    v_mfma_f32_16x16x32_bf16 v[84:87], a[192:195], a[128:131], v[84:87]
    ds_read_b64_tr_b16 a[236:237], v11 offset:128
    ds_read_b64_tr_b16 a[238:239], v13 offset:128
    v_mfma_f32_16x16x32_bf16 v[88:91], a[192:195], a[132:135], v[88:91]
    v_add_f32 v30, v30, v74
    v_add_f32 v30, v30, v75
    v_mfma_f32_16x16x32_bf16 v[92:95], a[192:195], a[136:139], v[92:95]
    v_cvt_pk_bf16_f32 v72, v72, v73
    s_waitcnt lgkmcnt(9)
    v_mfma_f32_16x16x32_bf16 v[76:79], a[196:199], a[140:143], v[76:79]
    v_cvt_pk_bf16_f32 v73, v74, v75
    v_mfma_f32_16x16x32_bf16 v[80:83], a[196:199], a[144:147], v[80:83]
    ds_write_b64 v14, v[72:73] offset:2048
    v_mfma_f32_16x16x32_bf16 v[84:87], a[196:199], a[148:151], v[84:87]
    ds_read_b64_tr_b16 a[240:241], v10 offset:256
    ds_read_b64_tr_b16 a[242:243], v12 offset:256
    v_mfma_f32_16x16x32_bf16 v[88:91], a[196:199], a[152:155], v[88:91]
    v_mfma_f32_16x16x32_bf16 v[92:95], a[196:199], a[156:159], v[92:95]
    v_mul_f32 v76, s23, v76
    s_waitcnt lgkmcnt(10)
    v_mfma_f32_16x16x32_bf16 v[96:99], a[224:227], v[36:39], v[96:99]
    v_mul_f32 v77, s23, v77
    v_mul_f32 v78, s23, v78
    v_mfma_f32_16x16x32_bf16 v[100:103], a[224:227], v[40:43], v[100:103]
    v_mul_f32 v79, s23, v79
    v_mfma_f32_16x16x32_bf16 v[104:107], a[224:227], v[44:47], v[104:107]
    ds_read_b64_tr_b16 a[244:245], v11 offset:256
    ds_read_b64_tr_b16 a[246:247], v13 offset:256
    v_mfma_f32_16x16x32_bf16 v[108:111], a[224:227], v[48:51], v[108:111]
    s_add_u32 m0, s21, 69632
    s_mov_b32 s22, 229376
    buffer_load_dwordx4 v2, s[32:35], s22 offen nt lds
    v_mfma_f32_16x16x32_bf16 v[112:115], a[224:227], v[52:55], v[112:115]
    v_exp_f32 v76, v76
    s_waitcnt lgkmcnt(9)
    v_mfma_f32_16x16x32_bf16 v[116:119], a[228:231], v[36:39], v[116:119]
    v_exp_f32 v77, v77
    v_mfma_f32_16x16x32_bf16 v[120:123], a[228:231], v[40:43], v[120:123]
    v_exp_f32 v78, v78
    v_mfma_f32_16x16x32_bf16 v[124:127], a[228:231], v[44:47], v[124:127]
    ds_read_b64_tr_b16 a[248:249], v10 offset:384
    ds_read_b64_tr_b16 a[250:251], v12 offset:384
    v_mfma_f32_16x16x32_bf16 v[128:131], a[228:231], v[48:51], v[128:131]
    v_exp_f32 v79, v79
    v_mfma_f32_16x16x32_bf16 v[132:135], a[228:231], v[52:55], v[132:135]
    v_add_f32 v26, v26, v76
    s_waitcnt lgkmcnt(9)
    v_mfma_f32_16x16x32_bf16 v[136:139], a[232:235], v[36:39], v[136:139]
    v_add_f32 v26, v26, v77
    v_add_f32 v26, v26, v78
    v_mfma_f32_16x16x32_bf16 v[140:143], a[232:235], v[40:43], v[140:143]
    v_add_f32 v26, v26, v79
    v_cvt_pk_bf16_f32 v76, v76, v77
    v_mfma_f32_16x16x32_bf16 v[144:147], a[232:235], v[44:47], v[144:147]
    ds_read_b64_tr_b16 a[252:253], v11 offset:384
    ds_read_b64_tr_b16 a[254:255], v13 offset:384
    v_mfma_f32_16x16x32_bf16 v[148:151], a[232:235], v[48:51], v[148:151]
    v_cvt_pk_bf16_f32 v77, v78, v79
    v_mul_f32 v80, s23, v80
    v_mfma_f32_16x16x32_bf16 v[152:155], a[232:235], v[52:55], v[152:155]
    v_mul_f32 v81, s23, v81
    s_waitcnt lgkmcnt(9)
    v_mfma_f32_16x16x32_bf16 v[156:159], a[236:239], v[36:39], v[156:159]
    v_mul_f32 v82, s23, v82
    v_mul_f32 v83, s23, v83
    v_mfma_f32_16x16x32_bf16 v[160:163], a[236:239], v[40:43], v[160:163]
    buffer_load_dwordx4 v3, s[32:35], s22 offen offset:1088 nt lds
    v_mfma_f32_16x16x32_bf16 v[164:167], a[236:239], v[44:47], v[164:167]
    v_exp_f32 v80, v80
    v_mfma_f32_16x16x32_bf16 v[168:171], a[236:239], v[48:51], v[168:171]
    v_exp_f32 v81, v81
    v_mfma_f32_16x16x32_bf16 v[172:175], a[236:239], v[52:55], v[172:175]
    v_exp_f32 v82, v82
    s_waitcnt lgkmcnt(6)
    v_mfma_f32_16x16x32_bf16 v[176:179], a[240:243], v[36:39], v[176:179]
    v_exp_f32 v83, v83
    v_mfma_f32_16x16x32_bf16 v[180:183], a[240:243], v[40:43], v[180:183]
    v_add_f32 v27, v27, v80
    v_add_f32 v27, v27, v81
    v_mfma_f32_16x16x32_bf16 v[184:187], a[240:243], v[44:47], v[184:187]
    v_add_f32 v27, v27, v82
    v_add_f32 v27, v27, v83
    v_mfma_f32_16x16x32_bf16 v[188:191], a[240:243], v[48:51], v[188:191]
    v_cvt_pk_bf16_f32 v80, v80, v81
    v_cvt_pk_bf16_f32 v81, v82, v83
    v_mfma_f32_16x16x32_bf16 v[192:195], a[240:243], v[52:55], v[192:195]
    v_mul_f32 v84, s23, v84
    s_waitcnt lgkmcnt(4)
    v_mfma_f32_16x16x32_bf16 v[196:199], a[244:247], v[36:39], v[196:199]
    v_mul_f32 v85, s23, v85
    v_mul_f32 v86, s23, v86
    v_mfma_f32_16x16x32_bf16 v[200:203], a[244:247], v[40:43], v[200:203]
    v_mul_f32 v87, s23, v87
    v_mfma_f32_16x16x32_bf16 v[204:207], a[244:247], v[44:47], v[204:207]
    v_exp_f32 v84, v84
    v_mfma_f32_16x16x32_bf16 v[208:211], a[244:247], v[48:51], v[208:211]
    v_exp_f32 v85, v85
    v_mfma_f32_16x16x32_bf16 v[212:215], a[244:247], v[52:55], v[212:215]
    s_waitcnt vmcnt(10) lgkmcnt(0)
    s_barrier
    v_mfma_f32_16x16x32_bf16 v[216:219], a[248:251], v[36:39], v[216:219]
    v_add_u32 v24, 0xffff3400, v24
    ds_read_b128 a[216:219], v24
    v_mfma_f32_16x16x32_bf16 v[220:223], a[248:251], v[40:43], v[220:223]
    buffer_load_dwordx4 v4, s[32:35], s22 offen offset:2176 nt lds
    v_add_u32 v25, 0xffff3400, v25
    ds_read_b128 a[220:223], v25
    v_mfma_f32_16x16x32_bf16 v[224:227], a[248:251], v[44:47], v[224:227]
    ds_read_b64 v[58:59], v19
    ds_read_b128 a[200:203], v24 offset:128
    v_mfma_f32_16x16x32_bf16 v[228:231], a[248:251], v[48:51], v[228:231]
    ds_write_b64 v14, v[76:77] offset:10240
    v_mfma_f32_16x16x32_bf16 v[232:235], a[248:251], v[52:55], v[232:235]
    ds_read_b64 v[62:63], v19 offset:512
    ds_read_b64 v[66:67], v19 offset:1024
    v_mfma_f32_16x16x32_bf16 v[236:239], a[252:255], v[36:39], v[236:239]
    ds_read_b64 v[70:71], v19 offset:1536
    ds_read_b64 v[74:75], v19 offset:2048
    v_mfma_f32_16x16x32_bf16 v[240:243], a[252:255], v[40:43], v[240:243]
    ds_read_b128 a[204:207], v25 offset:128
    v_mfma_f32_16x16x32_bf16 v[244:247], a[252:255], v[44:47], v[244:247]
    ds_read_b128 a[208:211], v24 offset:256
    v_mfma_f32_16x16x32_bf16 v[248:251], a[252:255], v[48:51], v[248:251]
    ds_write_b64 v14, v[80:81] offset:10752
    v_mfma_f32_16x16x32_bf16 v[252:255], a[252:255], v[52:55], v[252:255]
    v_exp_f32 v86, v86
    s_waitcnt lgkmcnt(11)
    v_mfma_f32_16x16x32_bf16 v[36:39], a[216:219], a[0:3], 0
    v_exp_f32 v87, v87
    v_mfma_f32_16x16x32_bf16 v[40:43], a[216:219], a[4:7], 0
    v_add_f32 v28, v28, v84
    v_add_f32 v28, v28, v85
    v_mfma_f32_16x16x32_bf16 v[44:47], a[216:219], a[8:11], 0
    ds_read_b128 a[212:215], v25 offset:256
    v_add_f32 v28, v28, v86
    v_mfma_f32_16x16x32_bf16 v[48:51], a[216:219], a[12:15], 0
    buffer_load_dwordx4 v5, s[32:35], s22 offen offset:3264 nt lds
    v_add_f32 v28, v28, v87
    v_mfma_f32_16x16x32_bf16 v[52:55], a[216:219], a[16:19], 0
    v_cvt_pk_bf16_f32 v84, v84, v85
    s_waitcnt lgkmcnt(11)
    v_mfma_f32_16x16x32_bf16 v[36:39], a[220:223], a[20:23], v[36:39]
    v_cvt_pk_bf16_f32 v85, v86, v87
    v_mul_f32 v88, s23, v88
    v_mfma_f32_16x16x32_bf16 v[40:43], a[220:223], a[24:27], v[40:43]
    ds_write_b64 v14, v[84:85] offset:11264
    v_mfma_f32_16x16x32_bf16 v[44:47], a[220:223], a[28:31], v[44:47]
    ds_read_b128 a[160:163], v24 offset:384
    v_mul_f32 v89, s23, v89
    v_mfma_f32_16x16x32_bf16 v[48:51], a[220:223], a[32:35], v[48:51]
    v_mul_f32 v90, s23, v90
    v_mul_f32 v91, s23, v91
    v_mfma_f32_16x16x32_bf16 v[52:55], a[220:223], a[36:39], v[52:55]
    v_exp_f32 v88, v88
    s_waitcnt lgkmcnt(11)
    v_mfma_f32_16x16x32_bf16 v[36:39], a[200:203], a[40:43], v[36:39]
    v_exp_f32 v89, v89
    v_mfma_f32_16x16x32_bf16 v[40:43], a[200:203], a[44:47], v[40:43]
    v_exp_f32 v90, v90
    v_mfma_f32_16x16x32_bf16 v[44:47], a[200:203], a[48:51], v[44:47]
    ds_read_b128 a[164:167], v25 offset:384
    v_mfma_f32_16x16x32_bf16 v[48:51], a[200:203], a[52:55], v[48:51]
    v_exp_f32 v91, v91
    v_mfma_f32_16x16x32_bf16 v[52:55], a[200:203], a[56:59], v[52:55]
    s_add_u32 m0, s21, 87040
    s_mov_b32 s22, 196608
    buffer_load_dwordx4 v2, s[36:39], s22 offen nt lds
    s_waitcnt lgkmcnt(6)
    v_mfma_f32_16x16x32_bf16 v[36:39], a[204:207], a[60:63], v[36:39]
    v_add_f32 v29, v29, v88
    v_add_f32 v29, v29, v89
    v_mfma_f32_16x16x32_bf16 v[40:43], a[204:207], a[64:67], v[40:43]
    v_add_f32 v29, v29, v90
    v_add_f32 v29, v29, v91
    v_mfma_f32_16x16x32_bf16 v[44:47], a[204:207], a[68:71], v[44:47]
    ds_read_b64_tr_b16 a[168:169], v10 offset:52224
    ds_read_b64_tr_b16 a[170:171], v12 offset:52224
    v_mfma_f32_16x16x32_bf16 v[48:51], a[204:207], a[72:75], v[48:51]
    v_cvt_pk_bf16_f32 v88, v88, v89
    v_cvt_pk_bf16_f32 v89, v90, v91
    v_mfma_f32_16x16x32_bf16 v[52:55], a[204:207], a[76:79], v[52:55]
    ds_write_b64 v14, v[88:89] offset:11776
    s_waitcnt lgkmcnt(8)
    v_mfma_f32_16x16x32_bf16 v[36:39], a[208:211], a[80:83], v[36:39]
    v_mul_f32 v92, s23, v92
    v_mul_f32 v93, s23, v93
    v_mfma_f32_16x16x32_bf16 v[40:43], a[208:211], a[84:87], v[40:43]
    v_mul_f32 v94, s23, v94
    v_mul_f32 v95, s23, v95
    v_mfma_f32_16x16x32_bf16 v[44:47], a[208:211], a[88:91], v[44:47]
    buffer_load_dwordx4 v3, s[36:39], s22 offen offset:1088 nt lds
    ds_read_b64_tr_b16 a[172:173], v11 offset:52224
    v_mfma_f32_16x16x32_bf16 v[48:51], a[208:211], a[92:95], v[48:51]
    ds_read_b64_tr_b16 a[174:175], v13 offset:52224
    v_mfma_f32_16x16x32_bf16 v[52:55], a[208:211], a[96:99], v[52:55]
    v_exp_f32 v92, v92
    s_waitcnt lgkmcnt(8)
    v_mfma_f32_16x16x32_bf16 v[36:39], a[212:215], a[100:103], v[36:39]
    v_exp_f32 v93, v93
    v_mfma_f32_16x16x32_bf16 v[40:43], a[212:215], a[104:107], v[40:43]
    v_exp_f32 v94, v94
    v_mfma_f32_16x16x32_bf16 v[44:47], a[212:215], a[108:111], v[44:47]
    ds_read_b64_tr_b16 a[176:177], v10 offset:52352
    ds_read_b64_tr_b16 a[178:179], v12 offset:52352
    v_mfma_f32_16x16x32_bf16 v[48:51], a[212:215], a[112:115], v[48:51]
    v_exp_f32 v95, v95
    v_mfma_f32_16x16x32_bf16 v[52:55], a[212:215], a[116:119], v[52:55]
    v_add_f32 v30, v30, v92
    s_waitcnt lgkmcnt(8)
    v_mfma_f32_16x16x32_bf16 v[36:39], a[160:163], a[120:123], v[36:39]
    buffer_load_dwordx4 v4, s[36:39], s22 offen offset:2176 nt lds
    v_add_f32 v30, v30, v93
    v_mfma_f32_16x16x32_bf16 v[40:43], a[160:163], a[124:127], v[40:43]
    v_add_f32 v30, v30, v94
    v_add_f32 v30, v30, v95
    v_mfma_f32_16x16x32_bf16 v[44:47], a[160:163], a[128:131], v[44:47]
    ds_read_b64_tr_b16 a[180:181], v11 offset:52352
    ds_read_b64_tr_b16 a[182:183], v13 offset:52352
    v_mfma_f32_16x16x32_bf16 v[48:51], a[160:163], a[132:135], v[48:51]
    v_cvt_pk_bf16_f32 v92, v92, v93
    v_cvt_pk_bf16_f32 v93, v94, v95
    v_mfma_f32_16x16x32_bf16 v[52:55], a[160:163], a[136:139], v[52:55]
    ds_write_b64 v14, v[92:93] offset:12288
    s_waitcnt lgkmcnt(10)
    v_mfma_f32_16x16x32_bf16 v[36:39], a[164:167], a[140:143], v[36:39]
    v_mfma_f32_16x16x32_bf16 v[40:43], a[164:167], a[144:147], v[40:43]
    v_mfma_f32_16x16x32_bf16 v[44:47], a[164:167], a[148:151], v[44:47]
    ds_read_b64_tr_b16 a[184:185], v10 offset:52480
    ds_read_b64_tr_b16 a[186:187], v12 offset:52480
    v_mfma_f32_16x16x32_bf16 v[48:51], a[164:167], a[152:155], v[48:51]
    buffer_load_dwordx4 v5, s[36:39], s22 offen offset:3264 nt lds
    v_mfma_f32_16x16x32_bf16 v[52:55], a[164:167], a[156:159], v[52:55]
    s_waitcnt lgkmcnt(10)
    v_mfma_f32_16x16x32_bf16 v[96:99], a[168:171], v[56:59], v[96:99]
    v_mul_f32 v36, s23, v36
    v_mul_f32 v37, s23, v37
    v_mfma_f32_16x16x32_bf16 v[100:103], a[168:171], v[60:63], v[100:103]
    v_mul_f32 v38, s23, v38
    v_mul_f32 v39, s23, v39
    v_mfma_f32_16x16x32_bf16 v[104:107], a[168:171], v[64:67], v[104:107]
    ds_read_b64_tr_b16 a[188:189], v11 offset:52480
    ds_read_b64_tr_b16 a[190:191], v13 offset:52480
    v_mfma_f32_16x16x32_bf16 v[108:111], a[168:171], v[68:71], v[108:111]
    v_exp_f32 v36, v36
    v_mfma_f32_16x16x32_bf16 v[112:115], a[168:171], v[72:75], v[112:115]
    v_exp_f32 v37, v37
    s_waitcnt lgkmcnt(9)
    v_mfma_f32_16x16x32_bf16 v[116:119], a[172:175], v[56:59], v[116:119]
    v_exp_f32 v38, v38
    v_mfma_f32_16x16x32_bf16 v[120:123], a[172:175], v[60:63], v[120:123]
    v_exp_f32 v39, v39
    v_mfma_f32_16x16x32_bf16 v[124:127], a[172:175], v[64:67], v[124:127]
    ds_read_b64_tr_b16 a[192:193], v10 offset:52608
    ds_read_b64_tr_b16 a[194:195], v12 offset:52608
    v_mfma_f32_16x16x32_bf16 v[128:131], a[172:175], v[68:71], v[128:131]
    v_add_f32 v26, v26, v36
    v_add_f32 v26, v26, v37
    v_mfma_f32_16x16x32_bf16 v[132:135], a[172:175], v[72:75], v[132:135]
    v_add_f32 v26, v26, v38
    s_waitcnt lgkmcnt(9)
    v_mfma_f32_16x16x32_bf16 v[136:139], a[176:179], v[56:59], v[136:139]
    v_add_f32 v26, v26, v39
    v_cvt_pk_bf16_f32 v36, v36, v37
    v_mfma_f32_16x16x32_bf16 v[140:143], a[176:179], v[60:63], v[140:143]
    v_cvt_pk_bf16_f32 v37, v38, v39
    v_mul_f32 v40, s23, v40
    v_mfma_f32_16x16x32_bf16 v[144:147], a[176:179], v[64:67], v[144:147]
    ds_read_b64_tr_b16 a[196:197], v11 offset:52608
    ds_read_b64_tr_b16 a[198:199], v13 offset:52608
    v_mfma_f32_16x16x32_bf16 v[148:151], a[176:179], v[68:71], v[148:151]
    v_mul_f32 v41, s23, v41
    v_mul_f32 v42, s23, v42
    v_mfma_f32_16x16x32_bf16 v[152:155], a[176:179], v[72:75], v[152:155]
    v_mul_f32 v43, s23, v43
    s_waitcnt lgkmcnt(9)
    v_mfma_f32_16x16x32_bf16 v[156:159], a[180:183], v[56:59], v[156:159]
    v_exp_f32 v40, v40
    v_mfma_f32_16x16x32_bf16 v[160:163], a[180:183], v[60:63], v[160:163]
    v_exp_f32 v41, v41
    v_mfma_f32_16x16x32_bf16 v[164:167], a[180:183], v[64:67], v[164:167]
    v_exp_f32 v42, v42
    v_mfma_f32_16x16x32_bf16 v[168:171], a[180:183], v[68:71], v[168:171]
    v_exp_f32 v43, v43
    v_mfma_f32_16x16x32_bf16 v[172:175], a[180:183], v[72:75], v[172:175]
    v_add_f32 v27, v27, v40
    s_waitcnt lgkmcnt(6)
    v_mfma_f32_16x16x32_bf16 v[176:179], a[184:187], v[56:59], v[176:179]
    v_add_f32 v27, v27, v41
    v_add_f32 v27, v27, v42
    v_mfma_f32_16x16x32_bf16 v[180:183], a[184:187], v[60:63], v[180:183]
    v_add_f32 v27, v27, v43
    v_cvt_pk_bf16_f32 v40, v40, v41
    v_mfma_f32_16x16x32_bf16 v[184:187], a[184:187], v[64:67], v[184:187]
    v_cvt_pk_bf16_f32 v41, v42, v43
    v_mul_f32 v44, s23, v44
    v_mfma_f32_16x16x32_bf16 v[188:191], a[184:187], v[68:71], v[188:191]
    v_mul_f32 v45, s23, v45
    v_mul_f32 v46, s23, v46
    v_mfma_f32_16x16x32_bf16 v[192:195], a[184:187], v[72:75], v[192:195]
    v_mul_f32 v47, s23, v47
    s_waitcnt lgkmcnt(4)
    v_mfma_f32_16x16x32_bf16 v[196:199], a[188:191], v[56:59], v[196:199]
    v_exp_f32 v44, v44
    v_mfma_f32_16x16x32_bf16 v[200:203], a[188:191], v[60:63], v[200:203]
    v_exp_f32 v45, v45
    v_mfma_f32_16x16x32_bf16 v[204:207], a[188:191], v[64:67], v[204:207]
    v_exp_f32 v46, v46
    v_mfma_f32_16x16x32_bf16 v[208:211], a[188:191], v[68:71], v[208:211]
    v_exp_f32 v47, v47
    v_mfma_f32_16x16x32_bf16 v[212:215], a[188:191], v[72:75], v[212:215]
    s_waitcnt vmcnt(8) lgkmcnt(0)
    s_barrier
    v_mfma_f32_16x16x32_bf16 v[216:219], a[192:195], v[56:59], v[216:219]
    v_add_u32 v24, 0x15400, v24
    ds_read_b128 a[224:227], v24
    v_mfma_f32_16x16x32_bf16 v[220:223], a[192:195], v[60:63], v[220:223]
    s_add_u32 m0, s21, 121856
    s_mov_b32 s22, 245760
    buffer_load_dwordx4 v2, s[32:35], s22 offen nt lds
    v_mfma_f32_16x16x32_bf16 v[224:227], a[192:195], v[64:67], v[224:227]
    v_add_u32 v25, 0x15400, v25
    ds_read_b128 a[228:231], v25
    v_mfma_f32_16x16x32_bf16 v[228:231], a[192:195], v[68:71], v[228:231]
    ds_read_b64 v[78:79], v19 offset:10240
    ds_read_b128 a[232:235], v24 offset:128
    v_mfma_f32_16x16x32_bf16 v[232:235], a[192:195], v[72:75], v[232:235]
    ds_write_b64 v14, v[36:37]
    v_mfma_f32_16x16x32_bf16 v[236:239], a[196:199], v[56:59], v[236:239]
    ds_read_b64 v[82:83], v19 offset:10752
    ds_read_b64 v[86:87], v19 offset:11264
    v_mfma_f32_16x16x32_bf16 v[240:243], a[196:199], v[60:63], v[240:243]
    ds_read_b64 v[90:91], v19 offset:11776
    ds_read_b64 v[94:95], v19 offset:12288
    v_mfma_f32_16x16x32_bf16 v[244:247], a[196:199], v[64:67], v[244:247]
    ds_read_b128 a[236:239], v25 offset:128
    v_cmp_eq_u32 vcc, 0, v33
    s_cbranch_vccnz L_hs
L_hsr:
    v_mfma_f32_16x16x32_bf16 v[248:251], a[196:199], v[68:71], v[248:251]
    ds_read_b128 a[240:243], v24 offset:256
    v_add_f32 v28, v28, v44
    v_mfma_f32_16x16x32_bf16 v[252:255], a[196:199], v[72:75], v[252:255]
    ds_write_b64 v14, v[40:41] offset:512
    s_waitcnt lgkmcnt(11)
    v_mfma_f32_16x16x32_bf16 v[56:59], a[224:227], a[0:3], 0
    v_add_f32 v28, v28, v45
    v_add_f32 v28, v28, v46
    v_mfma_f32_16x16x32_bf16 v[60:63], a[224:227], a[4:7], 0
    v_add_f32 v28, v28, v47
    v_cvt_pk_bf16_f32 v44, v44, v45
    v_mfma_f32_16x16x32_bf16 v[64:67], a[224:227], a[8:11], 0
    ds_read_b128 a[244:247], v25 offset:256
    v_cvt_pk_bf16_f32 v45, v46, v47
    v_mfma_f32_16x16x32_bf16 v[68:71], a[224:227], a[12:15], 0
    ds_write_b64 v14, v[44:45] offset:1024
    v_mfma_f32_16x16x32_bf16 v[72:75], a[224:227], a[16:19], 0
    buffer_load_dwordx4 v3, s[32:35], s22 offen offset:1088 nt lds
    s_waitcnt lgkmcnt(12)
    v_mfma_f32_16x16x32_bf16 v[56:59], a[228:231], a[20:23], v[56:59]
    v_mul_f32 v48, s23, v48
    v_mul_f32 v49, s23, v49
    v_mfma_f32_16x16x32_bf16 v[60:63], a[228:231], a[24:27], v[60:63]
    v_mul_f32 v50, s23, v50
    v_mul_f32 v51, s23, v51
    v_mfma_f32_16x16x32_bf16 v[64:67], a[228:231], a[28:31], v[64:67]
    ds_read_b128 a[248:251], v24 offset:384
    v_mfma_f32_16x16x32_bf16 v[68:71], a[228:231], a[32:35], v[68:71]
    v_exp_f32 v48, v48
    v_mfma_f32_16x16x32_bf16 v[72:75], a[228:231], a[36:39], v[72:75]
    v_exp_f32 v49, v49
    s_waitcnt lgkmcnt(11)
    v_mfma_f32_16x16x32_bf16 v[56:59], a[232:235], a[40:43], v[56:59]
    v_exp_f32 v50, v50
    v_mfma_f32_16x16x32_bf16 v[60:63], a[232:235], a[44:47], v[60:63]
    v_exp_f32 v51, v51
    v_mfma_f32_16x16x32_bf16 v[64:67], a[232:235], a[48:51], v[64:67]
    ds_read_b128 a[252:255], v25 offset:384
    v_add_f32 v29, v29, v48
    v_mfma_f32_16x16x32_bf16 v[68:71], a[232:235], a[52:55], v[68:71]
    v_add_f32 v29, v29, v49
    v_add_f32 v29, v29, v50
    v_mfma_f32_16x16x32_bf16 v[72:75], a[232:235], a[56:59], v[72:75]
    buffer_load_dwordx4 v4, s[32:35], s22 offen offset:2176 nt lds
    s_waitcnt lgkmcnt(6)
    v_mfma_f32_16x16x32_bf16 v[56:59], a[236:239], a[60:63], v[56:59]
    v_add_f32 v29, v29, v51
    v_cvt_pk_bf16_f32 v48, v48, v49
    v_mfma_f32_16x16x32_bf16 v[60:63], a[236:239], a[64:67], v[60:63]
    v_cvt_pk_bf16_f32 v49, v50, v51
    v_mul_f32 v52, s23, v52
    v_mfma_f32_16x16x32_bf16 v[64:67], a[236:239], a[68:71], v[64:67]
    ds_read_b64_tr_b16 a[216:217], v10 offset:34816
    ds_read_b64_tr_b16 a[218:219], v12 offset:34816
    v_mfma_f32_16x16x32_bf16 v[68:71], a[236:239], a[72:75], v[68:71]
    ds_write_b64 v14, v[48:49] offset:1536
    v_mfma_f32_16x16x32_bf16 v[72:75], a[236:239], a[76:79], v[72:75]
    v_mul_f32 v53, s23, v53
    s_waitcnt lgkmcnt(8)
    v_mfma_f32_16x16x32_bf16 v[56:59], a[240:243], a[80:83], v[56:59]
    v_mul_f32 v54, s23, v54
    v_mul_f32 v55, s23, v55
    v_mfma_f32_16x16x32_bf16 v[60:63], a[240:243], a[84:87], v[60:63]
    v_exp_f32 v52, v52
    v_mfma_f32_16x16x32_bf16 v[64:67], a[240:243], a[88:91], v[64:67]
    buffer_load_dwordx4 v5, s[32:35], s22 offen offset:3264 nt lds
    ds_read_b64_tr_b16 a[220:221], v11 offset:34816
    v_mfma_f32_16x16x32_bf16 v[68:71], a[240:243], a[92:95], v[68:71]
    ds_read_b64_tr_b16 a[222:223], v13 offset:34816
    v_mfma_f32_16x16x32_bf16 v[72:75], a[240:243], a[96:99], v[72:75]
    v_exp_f32 v53, v53
    s_waitcnt lgkmcnt(8)
    v_mfma_f32_16x16x32_bf16 v[56:59], a[244:247], a[100:103], v[56:59]
    v_exp_f32 v54, v54
    v_mfma_f32_16x16x32_bf16 v[60:63], a[244:247], a[104:107], v[60:63]
    v_exp_f32 v55, v55
    v_mfma_f32_16x16x32_bf16 v[64:67], a[244:247], a[108:111], v[64:67]
    ds_read_b64_tr_b16 a[200:201], v10 offset:34944
    ds_read_b64_tr_b16 a[202:203], v12 offset:34944
    v_mfma_f32_16x16x32_bf16 v[68:71], a[244:247], a[112:115], v[68:71]
    v_add_f32 v30, v30, v52
    v_add_f32 v30, v30, v53
    v_mfma_f32_16x16x32_bf16 v[72:75], a[244:247], a[116:119], v[72:75]
    v_add_f32 v30, v30, v54
    s_waitcnt lgkmcnt(8)
    v_mfma_f32_16x16x32_bf16 v[56:59], a[248:251], a[120:123], v[56:59]
    s_add_u32 m0, s21, 0
    s_mov_b32 s22, 212992
    buffer_load_dwordx4 v2, s[36:39], s22 offen nt lds
    v_mfma_f32_16x16x32_bf16 v[60:63], a[248:251], a[124:127], v[60:63]
    v_add_f32 v30, v30, v55
    v_cvt_pk_bf16_f32 v52, v52, v53
    v_mfma_f32_16x16x32_bf16 v[64:67], a[248:251], a[128:131], v[64:67]
    ds_read_b64_tr_b16 a[204:205], v11 offset:34944
    ds_read_b64_tr_b16 a[206:207], v13 offset:34944
    v_mfma_f32_16x16x32_bf16 v[68:71], a[248:251], a[132:135], v[68:71]
    v_cvt_pk_bf16_f32 v53, v54, v55
    v_mfma_f32_16x16x32_bf16 v[72:75], a[248:251], a[136:139], v[72:75]
    ds_write_b64 v14, v[52:53] offset:2048
    s_waitcnt lgkmcnt(10)
    v_mfma_f32_16x16x32_bf16 v[56:59], a[252:255], a[140:143], v[56:59]
    v_mfma_f32_16x16x32_bf16 v[60:63], a[252:255], a[144:147], v[60:63]
    v_mfma_f32_16x16x32_bf16 v[64:67], a[252:255], a[148:151], v[64:67]
    ds_read_b64_tr_b16 a[208:209], v10 offset:35072
    ds_read_b64_tr_b16 a[210:211], v12 offset:35072
    v_mfma_f32_16x16x32_bf16 v[68:71], a[252:255], a[152:155], v[68:71]
    buffer_load_dwordx4 v3, s[36:39], s22 offen offset:1088 nt lds
    v_mfma_f32_16x16x32_bf16 v[72:75], a[252:255], a[156:159], v[72:75]
    s_waitcnt lgkmcnt(10)
    v_mfma_f32_16x16x32_bf16 v[96:99], a[216:219], v[76:79], v[96:99]
    v_mul_f32 v56, s23, v56
    v_mul_f32 v57, s23, v57
    v_mfma_f32_16x16x32_bf16 v[100:103], a[216:219], v[80:83], v[100:103]
    v_mul_f32 v58, s23, v58
    v_mul_f32 v59, s23, v59
    v_mfma_f32_16x16x32_bf16 v[104:107], a[216:219], v[84:87], v[104:107]
    ds_read_b64_tr_b16 a[212:213], v11 offset:35072
    ds_read_b64_tr_b16 a[214:215], v13 offset:35072
    v_mfma_f32_16x16x32_bf16 v[108:111], a[216:219], v[88:91], v[108:111]
    v_exp_f32 v56, v56
    v_mfma_f32_16x16x32_bf16 v[112:115], a[216:219], v[92:95], v[112:115]
    v_exp_f32 v57, v57
    s_waitcnt lgkmcnt(9)
    v_mfma_f32_16x16x32_bf16 v[116:119], a[220:223], v[76:79], v[116:119]
    v_exp_f32 v58, v58
    v_mfma_f32_16x16x32_bf16 v[120:123], a[220:223], v[80:83], v[120:123]
    buffer_load_dwordx4 v4, s[36:39], s22 offen offset:2176 nt lds
    v_mfma_f32_16x16x32_bf16 v[124:127], a[220:223], v[84:87], v[124:127]
    ds_read_b64_tr_b16 a[160:161], v10 offset:35200
    ds_read_b64_tr_b16 a[162:163], v12 offset:35200
    v_mfma_f32_16x16x32_bf16 v[128:131], a[220:223], v[88:91], v[128:131]
    v_exp_f32 v59, v59
    v_mfma_f32_16x16x32_bf16 v[132:135], a[220:223], v[92:95], v[132:135]
    v_add_f32 v26, v26, v56
    s_waitcnt lgkmcnt(9)
    v_mfma_f32_16x16x32_bf16 v[136:139], a[200:203], v[76:79], v[136:139]
    v_add_f32 v26, v26, v57
    v_add_f32 v26, v26, v58
    v_mfma_f32_16x16x32_bf16 v[140:143], a[200:203], v[80:83], v[140:143]
    v_add_f32 v26, v26, v59
    v_cvt_pk_bf16_f32 v56, v56, v57
    v_mfma_f32_16x16x32_bf16 v[144:147], a[200:203], v[84:87], v[144:147]
    ds_read_b64_tr_b16 a[164:165], v11 offset:35200
    ds_read_b64_tr_b16 a[166:167], v13 offset:35200
    v_mfma_f32_16x16x32_bf16 v[148:151], a[200:203], v[88:91], v[148:151]
    v_cvt_pk_bf16_f32 v57, v58, v59
    v_mul_f32 v60, s23, v60
    v_mfma_f32_16x16x32_bf16 v[152:155], a[200:203], v[92:95], v[152:155]
    buffer_load_dwordx4 v5, s[36:39], s22 offen offset:3264 nt lds
    s_waitcnt lgkmcnt(9)
    v_mfma_f32_16x16x32_bf16 v[156:159], a[204:207], v[76:79], v[156:159]
    v_mul_f32 v61, s23, v61
    v_mul_f32 v62, s23, v62
    v_mfma_f32_16x16x32_bf16 v[160:163], a[204:207], v[80:83], v[160:163]
    v_mul_f32 v63, s23, v63
    v_mfma_f32_16x16x32_bf16 v[164:167], a[204:207], v[84:87], v[164:167]
    v_exp_f32 v60, v60
    v_mfma_f32_16x16x32_bf16 v[168:171], a[204:207], v[88:91], v[168:171]
    v_exp_f32 v61, v61
    v_mfma_f32_16x16x32_bf16 v[172:175], a[204:207], v[92:95], v[172:175]
    v_exp_f32 v62, v62
    s_waitcnt lgkmcnt(6)
    v_mfma_f32_16x16x32_bf16 v[176:179], a[208:211], v[76:79], v[176:179]
    v_exp_f32 v63, v63
    v_mfma_f32_16x16x32_bf16 v[180:183], a[208:211], v[80:83], v[180:183]
    v_add_f32 v27, v27, v60
    v_add_f32 v27, v27, v61
    v_mfma_f32_16x16x32_bf16 v[184:187], a[208:211], v[84:87], v[184:187]
    v_add_f32 v27, v27, v62
    v_add_f32 v27, v27, v63
    v_mfma_f32_16x16x32_bf16 v[188:191], a[208:211], v[88:91], v[188:191]
    v_cvt_pk_bf16_f32 v60, v60, v61
    v_cvt_pk_bf16_f32 v61, v62, v63
    v_mfma_f32_16x16x32_bf16 v[192:195], a[208:211], v[92:95], v[192:195]
    v_mul_f32 v64, s23, v64
    s_waitcnt lgkmcnt(4)
    v_mfma_f32_16x16x32_bf16 v[196:199], a[212:215], v[76:79], v[196:199]
    v_mul_f32 v65, s23, v65
    v_mul_f32 v66, s23, v66
    v_mfma_f32_16x16x32_bf16 v[200:203], a[212:215], v[80:83], v[200:203]
    v_mul_f32 v67, s23, v67
    v_mfma_f32_16x16x32_bf16 v[204:207], a[212:215], v[84:87], v[204:207]
    v_exp_f32 v64, v64
    v_mfma_f32_16x16x32_bf16 v[208:211], a[212:215], v[88:91], v[208:211]
    v_exp_f32 v65, v65
    v_mfma_f32_16x16x32_bf16 v[212:215], a[212:215], v[92:95], v[212:215]
    s_waitcnt vmcnt(8) lgkmcnt(0)
    s_barrier
    v_mfma_f32_16x16x32_bf16 v[216:219], a[160:163], v[76:79], v[216:219]
    v_add_u32 v24, 0xffff7800, v24
    ds_read_b128 a[168:171], v24
    v_mfma_f32_16x16x32_bf16 v[220:223], a[160:163], v[80:83], v[220:223]
    v_add_u32 v25, 0xffff7800, v25
    ds_read_b128 a[172:175], v25
    v_mfma_f32_16x16x32_bf16 v[224:227], a[160:163], v[84:87], v[224:227]
    ds_read_b64 v[38:39], v19
    ds_read_b128 a[176:179], v24 offset:128
    v_mfma_f32_16x16x32_bf16 v[228:231], a[160:163], v[88:91], v[228:231]
    ds_write_b64 v14, v[56:57] offset:10240
    v_mfma_f32_16x16x32_bf16 v[232:235], a[160:163], v[92:95], v[232:235]
    ds_read_b64 v[42:43], v19 offset:512
    ds_read_b64 v[46:47], v19 offset:1024
    v_mfma_f32_16x16x32_bf16 v[236:239], a[164:167], v[76:79], v[236:239]
    ds_read_b64 v[50:51], v19 offset:1536
    ds_read_b64 v[54:55], v19 offset:2048
    v_mfma_f32_16x16x32_bf16 v[240:243], a[164:167], v[80:83], v[240:243]
    ds_read_b128 a[180:183], v25 offset:128
    v_mfma_f32_16x16x32_bf16 v[244:247], a[164:167], v[84:87], v[244:247]
    ds_read_b128 a[184:187], v24 offset:256
    v_mfma_f32_16x16x32_bf16 v[248:251], a[164:167], v[88:91], v[248:251]
    ds_write_b64 v14, v[60:61] offset:10752
    v_mfma_f32_16x16x32_bf16 v[252:255], a[164:167], v[92:95], v[252:255]
    v_exp_f32 v66, v66
    s_waitcnt lgkmcnt(11)
    v_mfma_f32_16x16x32_bf16 v[76:79], a[168:171], a[0:3], 0
    v_exp_f32 v67, v67
    v_mfma_f32_16x16x32_bf16 v[80:83], a[168:171], a[4:7], 0
    v_add_f32 v28, v28, v64
    v_add_f32 v28, v28, v65
    v_mfma_f32_16x16x32_bf16 v[84:87], a[168:171], a[8:11], 0
    ds_read_b128 a[188:191], v25 offset:256
    v_add_f32 v28, v28, v66
    v_mfma_f32_16x16x32_bf16 v[88:91], a[168:171], a[12:15], 0
    v_add_f32 v28, v28, v67
    v_cvt_pk_bf16_f32 v64, v64, v65
    v_mfma_f32_16x16x32_bf16 v[92:95], a[168:171], a[16:19], 0
    v_cvt_pk_bf16_f32 v65, v66, v67
    s_waitcnt lgkmcnt(11)
    v_mfma_f32_16x16x32_bf16 v[76:79], a[172:175], a[20:23], v[76:79]
    ds_write_b64 v14, v[64:65] offset:11264
    v_mfma_f32_16x16x32_bf16 v[80:83], a[172:175], a[24:27], v[80:83]
    v_mul_f32 v68, s23, v68
    v_mul_f32 v69, s23, v69
    v_mfma_f32_16x16x32_bf16 v[84:87], a[172:175], a[28:31], v[84:87]
    ds_read_b128 a[192:195], v24 offset:384
    v_mul_f32 v70, s23, v70
    v_mfma_f32_16x16x32_bf16 v[88:91], a[172:175], a[32:35], v[88:91]
    v_mul_f32 v71, s23, v71
    v_mfma_f32_16x16x32_bf16 v[92:95], a[172:175], a[36:39], v[92:95]
    v_exp_f32 v68, v68
    s_waitcnt lgkmcnt(11)
    v_mfma_f32_16x16x32_bf16 v[76:79], a[176:179], a[40:43], v[76:79]
    v_exp_f32 v69, v69
    v_mfma_f32_16x16x32_bf16 v[80:83], a[176:179], a[44:47], v[80:83]
    v_exp_f32 v70, v70
    v_mfma_f32_16x16x32_bf16 v[84:87], a[176:179], a[48:51], v[84:87]
    ds_read_b128 a[196:199], v25 offset:384
    v_mfma_f32_16x16x32_bf16 v[88:91], a[176:179], a[52:55], v[88:91]
    v_exp_f32 v71, v71
    v_mfma_f32_16x16x32_bf16 v[92:95], a[176:179], a[56:59], v[92:95]
    s_add_u32 m0, s21, 17408
    s_mov_b32 s22, 229376
    buffer_load_dwordx4 v2, s[36:39], s22 offen nt lds
    s_waitcnt lgkmcnt(6)
    v_mfma_f32_16x16x32_bf16 v[76:79], a[180:183], a[60:63], v[76:79]
    v_add_f32 v29, v29, v68
    v_add_f32 v29, v29, v69
    v_mfma_f32_16x16x32_bf16 v[80:83], a[180:183], a[64:67], v[80:83]
    v_add_f32 v29, v29, v70
    v_add_f32 v29, v29, v71
    v_mfma_f32_16x16x32_bf16 v[84:87], a[180:183], a[68:71], v[84:87]
    v_add_u32 v10, 0x15400, v10
    ds_read_b64_tr_b16 a[224:225], v10
    v_mfma_f32_16x16x32_bf16 v[88:91], a[180:183], a[72:75], v[88:91]
    v_add_u32 v12, 0x15400, v12
    ds_read_b64_tr_b16 a[226:227], v12
    v_mfma_f32_16x16x32_bf16 v[92:95], a[180:183], a[76:79], v[92:95]
    v_cvt_pk_bf16_f32 v68, v68, v69
    s_waitcnt lgkmcnt(7)
    v_mfma_f32_16x16x32_bf16 v[76:79], a[184:187], a[80:83], v[76:79]
    v_cvt_pk_bf16_f32 v69, v70, v71
    v_mul_f32 v72, s23, v72
    v_mfma_f32_16x16x32_bf16 v[80:83], a[184:187], a[84:87], v[80:83]
    ds_write_b64 v14, v[68:69] offset:11776
    v_mfma_f32_16x16x32_bf16 v[84:87], a[184:187], a[88:91], v[84:87]
    buffer_load_dwordx4 v3, s[36:39], s22 offen offset:1088 nt lds
    v_add_u32 v11, 0x15400, v11
    ds_read_b64_tr_b16 a[228:229], v11
    v_mfma_f32_16x16x32_bf16 v[88:91], a[184:187], a[92:95], v[88:91]
    v_add_u32 v13, 0x15400, v13
    ds_read_b64_tr_b16 a[230:231], v13
    v_mfma_f32_16x16x32_bf16 v[92:95], a[184:187], a[96:99], v[92:95]
    v_mul_f32 v73, s23, v73
    s_waitcnt lgkmcnt(8)
    v_mfma_f32_16x16x32_bf16 v[76:79], a[188:191], a[100:103], v[76:79]
    v_mul_f32 v74, s23, v74
    v_mul_f32 v75, s23, v75
    v_mfma_f32_16x16x32_bf16 v[80:83], a[188:191], a[104:107], v[80:83]
    v_exp_f32 v72, v72
    v_mfma_f32_16x16x32_bf16 v[84:87], a[188:191], a[108:111], v[84:87]
    ds_read_b64_tr_b16 a[232:233], v10 offset:128
    ds_read_b64_tr_b16 a[234:235], v12 offset:128
    v_mfma_f32_16x16x32_bf16 v[88:91], a[188:191], a[112:115], v[88:91]
    v_exp_f32 v73, v73
    v_mfma_f32_16x16x32_bf16 v[92:95], a[188:191], a[116:119], v[92:95]
    v_exp_f32 v74, v74
    s_waitcnt lgkmcnt(8)
    v_mfma_f32_16x16x32_bf16 v[76:79], a[192:195], a[120:123], v[76:79]
    buffer_load_dwordx4 v4, s[36:39], s22 offen offset:2176 nt lds
    v_mfma_f32_16x16x32_bf16 v[80:83], a[192:195], a[124:127], v[80:83]
    v_exp_f32 v75, v75
    v_mfma_f32_16x16x32_bf16 v[84:87], a[192:195], a[128:131], v[84:87]
    ds_read_b64_tr_b16 a[236:237], v11 offset:128
    ds_read_b64_tr_b16 a[238:239], v13 offset:128
    v_mfma_f32_16x16x32_bf16 v[88:91], a[192:195], a[132:135], v[88:91]
    v_add_f32 v30, v30, v72
    v_add_f32 v30, v30, v73
    v_mfma_f32_16x16x32_bf16 v[92:95], a[192:195], a[136:139], v[92:95]
    v_add_f32 v30, v30, v74
    s_waitcnt lgkmcnt(9)
    v_mfma_f32_16x16x32_bf16 v[76:79], a[196:199], a[140:143], v[76:79]
    v_add_f32 v30, v30, v75
    v_cvt_pk_bf16_f32 v72, v72, v73
    v_mfma_f32_16x16x32_bf16 v[80:83], a[196:199], a[144:147], v[80:83]
    v_cvt_pk_bf16_f32 v73, v74, v75
    v_mfma_f32_16x16x32_bf16 v[84:87], a[196:199], a[148:151], v[84:87]
    ds_read_b64_tr_b16 a[240:241], v10 offset:256
    ds_read_b64_tr_b16 a[242:243], v12 offset:256
    v_mfma_f32_16x16x32_bf16 v[88:91], a[196:199], a[152:155], v[88:91]
    buffer_load_dwordx4 v5, s[36:39], s22 offen offset:3264 nt lds
    v_mul_f32 v76, s23, v76
    v_mfma_f32_16x16x32_bf16 v[92:95], a[196:199], a[156:159], v[92:95]
    ds_write_b64 v14, v[72:73] offset:12288
    s_waitcnt lgkmcnt(10)
    v_mfma_f32_16x16x32_bf16 v[96:99], a[224:227], v[36:39], v[96:99]
    v_mul_f32 v77, s23, v77
    v_mul_f32 v78, s23, v78
    v_mfma_f32_16x16x32_bf16 v[100:103], a[224:227], v[40:43], v[100:103]
    v_mul_f32 v79, s23, v79
    v_mfma_f32_16x16x32_bf16 v[104:107], a[224:227], v[44:47], v[104:107]
    ds_read_b64_tr_b16 a[244:245], v11 offset:256
    ds_read_b64_tr_b16 a[246:247], v13 offset:256
    v_mfma_f32_16x16x32_bf16 v[108:111], a[224:227], v[48:51], v[108:111]
    v_exp_f32 v76, v76
    v_mfma_f32_16x16x32_bf16 v[112:115], a[224:227], v[52:55], v[112:115]
    v_exp_f32 v77, v77
    s_waitcnt lgkmcnt(9)
    v_mfma_f32_16x16x32_bf16 v[116:119], a[228:231], v[36:39], v[116:119]
    v_exp_f32 v78, v78
    v_mfma_f32_16x16x32_bf16 v[120:123], a[228:231], v[40:43], v[120:123]
    v_exp_f32 v79, v79
    v_mfma_f32_16x16x32_bf16 v[124:127], a[228:231], v[44:47], v[124:127]
    ds_read_b64_tr_b16 a[248:249], v10 offset:384
    ds_read_b64_tr_b16 a[250:251], v12 offset:384
    v_mfma_f32_16x16x32_bf16 v[128:131], a[228:231], v[48:51], v[128:131]
    v_add_f32 v26, v26, v76
    v_add_f32 v26, v26, v77
    v_mfma_f32_16x16x32_bf16 v[132:135], a[228:231], v[52:55], v[132:135]
    v_add_f32 v26, v26, v78
    s_waitcnt lgkmcnt(9)
    v_mfma_f32_16x16x32_bf16 v[136:139], a[232:235], v[36:39], v[136:139]
    v_add_f32 v26, v26, v79
    v_cvt_pk_bf16_f32 v76, v76, v77
    v_mfma_f32_16x16x32_bf16 v[140:143], a[232:235], v[40:43], v[140:143]
    v_cvt_pk_bf16_f32 v77, v78, v79
    v_mul_f32 v80, s23, v80
    v_mfma_f32_16x16x32_bf16 v[144:147], a[232:235], v[44:47], v[144:147]
    ds_read_b64_tr_b16 a[252:253], v11 offset:384
    ds_read_b64_tr_b16 a[254:255], v13 offset:384
    v_mfma_f32_16x16x32_bf16 v[148:151], a[232:235], v[48:51], v[148:151]
    v_mul_f32 v81, s23, v81
    v_mul_f32 v82, s23, v82
    v_mfma_f32_16x16x32_bf16 v[152:155], a[232:235], v[52:55], v[152:155]
    s_add_u32 m0, s21, 52224
    s_mov_b32 s22, 245760
    buffer_load_dwordx4 v2, s[36:39], s22 offen nt lds
    s_waitcnt lgkmcnt(9)
    v_mfma_f32_16x16x32_bf16 v[156:159], a[236:239], v[36:39], v[156:159]
    v_mul_f32 v83, s23, v83
    v_mfma_f32_16x16x32_bf16 v[160:163], a[236:239], v[40:43], v[160:163]
    v_exp_f32 v80, v80
    v_mfma_f32_16x16x32_bf16 v[164:167], a[236:239], v[44:47], v[164:167]
    v_exp_f32 v81, v81
    v_mfma_f32_16x16x32_bf16 v[168:171], a[236:239], v[48:51], v[168:171]
    v_exp_f32 v82, v82
    v_mfma_f32_16x16x32_bf16 v[172:175], a[236:239], v[52:55], v[172:175]
    v_exp_f32 v83, v83
    s_waitcnt lgkmcnt(7)
    v_mfma_f32_16x16x32_bf16 v[176:179], a[240:243], v[36:39], v[176:179]
    v_add_f32 v27, v27, v80
    v_add_f32 v27, v27, v81
    v_mfma_f32_16x16x32_bf16 v[180:183], a[240:243], v[40:43], v[180:183]
    v_add_f32 v27, v27, v82
    v_add_f32 v27, v27, v83
    v_mfma_f32_16x16x32_bf16 v[184:187], a[240:243], v[44:47], v[184:187]
    buffer_load_dwordx4 v3, s[36:39], s22 offen offset:1088 nt lds
    v_cvt_pk_bf16_f32 v80, v80, v81
    v_mfma_f32_16x16x32_bf16 v[188:191], a[240:243], v[48:51], v[188:191]
    v_cvt_pk_bf16_f32 v81, v82, v83
    v_mul_f32 v84, s23, v84
    v_mfma_f32_16x16x32_bf16 v[192:195], a[240:243], v[52:55], v[192:195]
    v_mul_f32 v85, s23, v85
    s_waitcnt lgkmcnt(4)
    v_mfma_f32_16x16x32_bf16 v[196:199], a[244:247], v[36:39], v[196:199]
    v_mul_f32 v86, s23, v86
    v_mul_f32 v87, s23, v87
    v_mfma_f32_16x16x32_bf16 v[200:203], a[244:247], v[40:43], v[200:203]
    v_exp_f32 v84, v84
    v_mfma_f32_16x16x32_bf16 v[204:207], a[244:247], v[44:47], v[204:207]
    v_exp_f32 v85, v85
    v_mfma_f32_16x16x32_bf16 v[208:211], a[244:247], v[48:51], v[208:211]
    v_exp_f32 v86, v86
    v_mfma_f32_16x16x32_bf16 v[212:215], a[244:247], v[52:55], v[212:215]
    s_waitcnt vmcnt(6) lgkmcnt(0)
    s_barrier
    v_mfma_f32_16x16x32_bf16 v[216:219], a[248:251], v[36:39], v[216:219]
    ds_read_b128 a[216:219], v24 offset:52224
    buffer_load_dwordx4 v4, s[36:39], s22 offen offset:2176 nt lds
    v_mfma_f32_16x16x32_bf16 v[220:223], a[248:251], v[40:43], v[220:223]
    ds_read_b128 a[220:223], v25 offset:52224
    ds_read_b64 v[58:59], v19 offset:10240
    v_mfma_f32_16x16x32_bf16 v[224:227], a[248:251], v[44:47], v[224:227]
    ds_write_b64 v14, v[76:77]
    v_mfma_f32_16x16x32_bf16 v[228:231], a[248:251], v[48:51], v[228:231]
    ds_read_b128 a[200:203], v24 offset:52352
    ds_read_b64 v[62:63], v19 offset:10752
    v_mfma_f32_16x16x32_bf16 v[232:235], a[248:251], v[52:55], v[232:235]
    ds_read_b64 v[66:67], v19 offset:11264
    ds_read_b64 v[70:71], v19 offset:11776
    v_mfma_f32_16x16x32_bf16 v[236:239], a[252:255], v[36:39], v[236:239]
    ds_read_b64 v[74:75], v19 offset:12288
    ds_read_b128 a[204:207], v25 offset:52352
    v_mfma_f32_16x16x32_bf16 v[240:243], a[252:255], v[40:43], v[240:243]
    ds_write_b64 v14, v[80:81] offset:512
    v_mfma_f32_16x16x32_bf16 v[244:247], a[252:255], v[44:47], v[244:247]
    ds_read_b128 a[208:211], v24 offset:52480
    v_mfma_f32_16x16x32_bf16 v[248:251], a[252:255], v[48:51], v[248:251]
    buffer_load_dwordx4 v5, s[36:39], s22 offen offset:3264 nt lds
    v_mfma_f32_16x16x32_bf16 v[252:255], a[252:255], v[52:55], v[252:255]
    v_exp_f32 v87, v87
    s_waitcnt lgkmcnt(11)
    v_mfma_f32_16x16x32_bf16 v[36:39], a[216:219], a[0:3], 0
    v_add_f32 v28, v28, v84
    v_add_f32 v28, v28, v85
    v_mfma_f32_16x16x32_bf16 v[40:43], a[216:219], a[4:7], 0
    v_add_f32 v28, v28, v86
    v_add_f32 v28, v28, v87
    v_mfma_f32_16x16x32_bf16 v[44:47], a[216:219], a[8:11], 0
    s_add_u32 m0, s60, 69632
    s_add_u32 s22, s89, 0
    buffer_load_dwordx4 v6, s[40:43], s22 offen lds
    v_mfma_f32_16x16x32_bf16 v[48:51], a[216:219], a[12:15], 0
    ds_read_b128 a[212:215], v25 offset:52480
    v_cvt_pk_bf16_f32 v84, v84, v85
    v_mfma_f32_16x16x32_bf16 v[52:55], a[216:219], a[16:19], 0
    v_cvt_pk_bf16_f32 v85, v86, v87
    s_waitcnt lgkmcnt(11)
    v_mfma_f32_16x16x32_bf16 v[36:39], a[220:223], a[20:23], v[36:39]
    ds_write_b64 v14, v[84:85] offset:1024
    v_mfma_f32_16x16x32_bf16 v[40:43], a[220:223], a[24:27], v[40:43]
    buffer_load_dwordx4 v7, s[40:43], s22 offen offset:1024 lds
    v_mul_f32 v88, s23, v88
    v_mfma_f32_16x16x32_bf16 v[44:47], a[220:223], a[28:31], v[44:47]
    ds_read_b128 a[160:163], v24 offset:52608
    v_mul_f32 v89, s23, v89
    v_mfma_f32_16x16x32_bf16 v[48:51], a[220:223], a[32:35], v[48:51]
    v_mul_f32 v90, s23, v90
    v_mul_f32 v91, s23, v91
    v_mfma_f32_16x16x32_bf16 v[52:55], a[220:223], a[36:39], v[52:55]
    v_exp_f32 v88, v88
    s_waitcnt lgkmcnt(10)
    v_mfma_f32_16x16x32_bf16 v[36:39], a[200:203], a[40:43], v[36:39]
    buffer_load_dwordx4 v8, s[40:43], s22 offen offset:2048 lds
    v_mfma_f32_16x16x32_bf16 v[40:43], a[200:203], a[44:47], v[40:43]
    v_exp_f32 v89, v89
    v_mfma_f32_16x16x32_bf16 v[44:47], a[200:203], a[48:51], v[44:47]
    ds_read_b128 a[164:167], v25 offset:52608
    v_mfma_f32_16x16x32_bf16 v[48:51], a[200:203], a[52:55], v[48:51]
    v_exp_f32 v90, v90
    v_mfma_f32_16x16x32_bf16 v[52:55], a[200:203], a[56:59], v[52:55]
    buffer_load_dwordx4 v9, s[40:43], s22 offen offset:3072 lds
    s_waitcnt lgkmcnt(6)
    v_mfma_f32_16x16x32_bf16 v[36:39], a[204:207], a[60:63], v[36:39]
    v_exp_f32 v91, v91
    v_mfma_f32_16x16x32_bf16 v[40:43], a[204:207], a[64:67], v[40:43]
    v_add_f32 v29, v29, v88
    v_add_f32 v29, v29, v89
    v_mfma_f32_16x16x32_bf16 v[44:47], a[204:207], a[68:71], v[44:47]
    v_add_u32 v10, 0xfffeac00, v10
    ds_read_b64_tr_b16 a[168:169], v10
    v_mfma_f32_16x16x32_bf16 v[48:51], a[204:207], a[72:75], v[48:51]
    v_add_u32 v12, 0xfffeac00, v12
    ds_read_b64_tr_b16 a[170:171], v12
    v_mfma_f32_16x16x32_bf16 v[52:55], a[204:207], a[76:79], v[52:55]
    v_add_f32 v29, v29, v90
    s_waitcnt lgkmcnt(6)
    v_mfma_f32_16x16x32_bf16 v[36:39], a[208:211], a[80:83], v[36:39]
    v_add_f32 v29, v29, v91
    v_cvt_pk_bf16_f32 v88, v88, v89
    v_mfma_f32_16x16x32_bf16 v[40:43], a[208:211], a[84:87], v[40:43]
    v_cvt_pk_bf16_f32 v89, v90, v91
    v_mul_f32 v92, s23, v92
    v_mfma_f32_16x16x32_bf16 v[44:47], a[208:211], a[88:91], v[44:47]
    v_add_u32 v11, 0xfffeac00, v11
    ds_read_b64_tr_b16 a[172:173], v11
    v_mfma_f32_16x16x32_bf16 v[48:51], a[208:211], a[92:95], v[48:51]
    v_add_u32 v13, 0xfffeac00, v13
    ds_read_b64_tr_b16 a[174:175], v13
    v_mfma_f32_16x16x32_bf16 v[52:55], a[208:211], a[96:99], v[52:55]
    ds_write_b64 v14, v[88:89] offset:1536
    s_waitcnt lgkmcnt(8)
    v_mfma_f32_16x16x32_bf16 v[36:39], a[212:215], a[100:103], v[36:39]
    v_mul_f32 v93, s23, v93
    v_mul_f32 v94, s23, v94
    v_mfma_f32_16x16x32_bf16 v[40:43], a[212:215], a[104:107], v[40:43]
    v_mul_f32 v95, s23, v95
    v_mfma_f32_16x16x32_bf16 v[44:47], a[212:215], a[108:111], v[44:47]
    ds_read_b64_tr_b16 a[176:177], v10 offset:128
    ds_read_b64_tr_b16 a[178:179], v12 offset:128
    v_mfma_f32_16x16x32_bf16 v[48:51], a[212:215], a[112:115], v[48:51]
    v_exp_f32 v92, v92
    v_mfma_f32_16x16x32_bf16 v[52:55], a[212:215], a[116:119], v[52:55]
    v_exp_f32 v93, v93
    s_waitcnt lgkmcnt(8)
    v_mfma_f32_16x16x32_bf16 v[36:39], a[160:163], a[120:123], v[36:39]
    v_exp_f32 v94, v94
    v_mfma_f32_16x16x32_bf16 v[40:43], a[160:163], a[124:127], v[40:43]
    v_exp_f32 v95, v95
    v_mfma_f32_16x16x32_bf16 v[44:47], a[160:163], a[128:131], v[44:47]
    ds_read_b64_tr_b16 a[180:181], v11 offset:128
    ds_read_b64_tr_b16 a[182:183], v13 offset:128
    v_mfma_f32_16x16x32_bf16 v[48:51], a[160:163], a[132:135], v[48:51]
    v_add_f32 v30, v30, v92
    v_add_f32 v30, v30, v93
    v_mfma_f32_16x16x32_bf16 v[52:55], a[160:163], a[136:139], v[52:55]
    v_add_f32 v30, v30, v94
    s_waitcnt lgkmcnt(9)
    v_mfma_f32_16x16x32_bf16 v[36:39], a[164:167], a[140:143], v[36:39]
    v_add_f32 v30, v30, v95
    v_cvt_pk_bf16_f32 v92, v92, v93
    v_mfma_f32_16x16x32_bf16 v[40:43], a[164:167], a[144:147], v[40:43]
    v_cvt_pk_bf16_f32 v93, v94, v95
    v_mfma_f32_16x16x32_bf16 v[44:47], a[164:167], a[148:151], v[44:47]
    s_nop 2
    v_mul_f32 v36, s23, v36
    v_mfma_f32_16x16x32_bf16 v[48:51], a[164:167], a[152:155], v[48:51]
    v_mul_f32 v37, s23, v37
    v_mul_f32 v38, s23, v38
    v_mfma_f32_16x16x32_bf16 v[52:55], a[164:167], a[156:159], v[52:55]
    v_mul_f32 v39, s23, v39
    s_waitcnt lgkmcnt(7)
    v_mfma_f32_16x16x32_bf16 v[96:99], a[168:171], v[56:59], v[96:99]
    v_exp_f32 v36, v36
    v_mfma_f32_16x16x32_bf16 v[100:103], a[168:171], v[60:63], v[100:103]
    v_exp_f32 v37, v37
    v_mfma_f32_16x16x32_bf16 v[104:107], a[168:171], v[64:67], v[104:107]
    v_exp_f32 v38, v38
    v_mfma_f32_16x16x32_bf16 v[108:111], a[168:171], v[68:71], v[108:111]
    v_exp_f32 v39, v39
    v_add_f32 v26, v26, v36
    v_mfma_f32_16x16x32_bf16 v[112:115], a[168:171], v[72:75], v[112:115]
    v_add_f32 v26, v26, v37
    s_waitcnt lgkmcnt(5)
    v_mfma_f32_16x16x32_bf16 v[116:119], a[172:175], v[56:59], v[116:119]
    v_add_f32 v26, v26, v38
    v_add_f32 v26, v26, v39
    v_mfma_f32_16x16x32_bf16 v[120:123], a[172:175], v[60:63], v[120:123]
    v_cvt_pk_bf16_f32 v36, v36, v37
    v_cvt_pk_bf16_f32 v37, v38, v39
    v_mfma_f32_16x16x32_bf16 v[124:127], a[172:175], v[64:67], v[124:127]
    v_mul_f32 v40, s23, v40
    v_mul_f32 v41, s23, v41
    v_mfma_f32_16x16x32_bf16 v[128:131], a[172:175], v[68:71], v[128:131]
    ds_read_b64_tr_b16 a[184:185], v10 offset:256
    ds_read_b64_tr_b16 a[186:187], v12 offset:256
    v_mfma_f32_16x16x32_bf16 v[132:135], a[172:175], v[72:75], v[132:135]
    v_mul_f32 v42, s23, v42
    s_waitcnt lgkmcnt(4)
    v_mfma_f32_16x16x32_bf16 v[136:139], a[176:179], v[56:59], v[136:139]
    v_mul_f32 v43, s23, v43
    ds_read_b64_tr_b16 a[188:189], v11 offset:256
    v_mfma_f32_16x16x32_bf16 v[140:143], a[176:179], v[60:63], v[140:143]
    v_exp_f32 v40, v40
    v_mfma_f32_16x16x32_bf16 v[144:147], a[176:179], v[64:67], v[144:147]
    v_exp_f32 v41, v41
    v_mfma_f32_16x16x32_bf16 v[148:151], a[176:179], v[68:71], v[148:151]
    v_exp_f32 v42, v42
    v_mfma_f32_16x16x32_bf16 v[152:155], a[176:179], v[72:75], v[152:155]
    ds_read_b64_tr_b16 a[190:191], v13 offset:256
    s_waitcnt lgkmcnt(4)
    v_mfma_f32_16x16x32_bf16 v[156:159], a[180:183], v[56:59], v[156:159]
    v_exp_f32 v43, v43
    v_mfma_f32_16x16x32_bf16 v[160:163], a[180:183], v[60:63], v[160:163]
    v_add_f32 v27, v27, v40
    v_add_f32 v27, v27, v41
    v_mfma_f32_16x16x32_bf16 v[164:167], a[180:183], v[64:67], v[164:167]
    v_add_f32 v27, v27, v42
    v_add_f32 v27, v27, v43
    v_mfma_f32_16x16x32_bf16 v[168:171], a[180:183], v[68:71], v[168:171]
    ds_read_b64_tr_b16 a[192:193], v10 offset:384
    ds_read_b64_tr_b16 a[194:195], v12 offset:384
    v_mfma_f32_16x16x32_bf16 v[172:175], a[180:183], v[72:75], v[172:175]
    v_cvt_pk_bf16_f32 v40, v40, v41
    s_waitcnt lgkmcnt(4)
    v_mfma_f32_16x16x32_bf16 v[176:179], a[184:187], v[56:59], v[176:179]
    ds_read_b64_tr_b16 a[196:197], v11 offset:384
    ds_read_b64_tr_b16 a[198:199], v13 offset:384
    v_mfma_f32_16x16x32_bf16 v[180:183], a[184:187], v[60:63], v[180:183]
    v_cvt_pk_bf16_f32 v41, v42, v43
    v_mul_f32 v44, s23, v44
    v_mfma_f32_16x16x32_bf16 v[184:187], a[184:187], v[64:67], v[184:187]
    ds_write_b64 v14, v[92:93] offset:2048
    v_mfma_f32_16x16x32_bf16 v[188:191], a[184:187], v[68:71], v[188:191]
    v_mul_f32 v45, s23, v45
    v_mul_f32 v46, s23, v46
    v_mfma_f32_16x16x32_bf16 v[192:195], a[184:187], v[72:75], v[192:195]
    v_mul_f32 v47, s23, v47
    s_waitcnt lgkmcnt(5)
    v_mfma_f32_16x16x32_bf16 v[196:199], a[188:191], v[56:59], v[196:199]
    v_exp_f32 v44, v44
    v_mfma_f32_16x16x32_bf16 v[200:203], a[188:191], v[60:63], v[200:203]
    v_exp_f32 v45, v45
    v_mfma_f32_16x16x32_bf16 v[204:207], a[188:191], v[64:67], v[204:207]
    v_exp_f32 v46, v46
    v_mfma_f32_16x16x32_bf16 v[208:211], a[188:191], v[68:71], v[208:211]
    v_exp_f32 v47, v47
    v_mfma_f32_16x16x32_bf16 v[212:215], a[188:191], v[72:75], v[212:215]
    s_waitcnt vmcnt(8) lgkmcnt(0)
    s_barrier
    ds_write_b64 v14, v[36:37] offset:10240
    ds_write_b64 v14, v[40:41] offset:10752
    v_mfma_f32_16x16x32_bf16 v[216:219], a[192:195], v[56:59], v[216:219]
    v_add_f32 v28, v28, v44
    v_add_f32 v28, v28, v45
    v_mfma_f32_16x16x32_bf16 v[220:223], a[192:195], v[60:63], v[220:223]
    ds_read_b64_tr_b16 a[224:225], v10 offset:17408
    ds_read_b64_tr_b16 a[226:227], v12 offset:17408
    v_mfma_f32_16x16x32_bf16 v[224:227], a[192:195], v[64:67], v[224:227]
    ds_read_b64 v[78:79], v19
    v_add_f32 v28, v28, v46
    s_add_u32 m0, s60, 87040
    s_add_u32 s22, s89, 114688
    buffer_load_dwordx4 v6, s[40:43], s22 offen lds
    v_mfma_f32_16x16x32_bf16 v[228:231], a[192:195], v[68:71], v[228:231]
    ds_read_b64 v[82:83], v19 offset:512
    v_add_f32 v28, v28, v47
    v_mfma_f32_16x16x32_bf16 v[232:235], a[192:195], v[72:75], v[232:235]
    ds_read_b64 v[86:87], v19 offset:1024
    v_cvt_pk_bf16_f32 v44, v44, v45
    v_mfma_f32_16x16x32_bf16 v[236:239], a[196:199], v[56:59], v[236:239]
    ds_read_b64 v[90:91], v19 offset:1536
    v_cvt_pk_bf16_f32 v45, v46, v47
    v_mfma_f32_16x16x32_bf16 v[240:243], a[196:199], v[60:63], v[240:243]
    ds_read_b64 v[94:95], v19 offset:2048
    buffer_load_dwordx4 v7, s[40:43], s22 offen offset:1024 lds
    v_mfma_f32_16x16x32_bf16 v[244:247], a[196:199], v[64:67], v[244:247]
    ds_write_b64 v14, v[44:45] offset:11264
    ds_read_b64_tr_b16 a[228:229], v11 offset:17408
    ds_read_b64_tr_b16 a[230:231], v13 offset:17408
    v_mul_f32 v48, s23, v48
    v_mfma_f32_16x16x32_bf16 v[248:251], a[196:199], v[68:71], v[248:251]
    v_mul_f32 v49, s23, v49
    v_mul_f32 v50, s23, v50
    v_mfma_f32_16x16x32_bf16 v[252:255], a[196:199], v[72:75], v[252:255]
    v_mul_f32 v51, s23, v51
    s_waitcnt lgkmcnt(7)
    v_mfma_f32_16x16x32_bf16 v[96:99], a[224:227], v[76:79], v[96:99]
    buffer_load_dwordx4 v8, s[40:43], s22 offen offset:2048 lds
    s_waitcnt lgkmcnt(6)
    v_mfma_f32_16x16x32_bf16 v[100:103], a[224:227], v[80:83], v[100:103]
    v_exp_f32 v48, v48
    s_waitcnt lgkmcnt(5)
    v_mfma_f32_16x16x32_bf16 v[104:107], a[224:227], v[84:87], v[104:107]
    ds_read_b64_tr_b16 a[232:233], v10 offset:17536
    ds_read_b64_tr_b16 a[234:235], v12 offset:17536
    v_exp_f32 v49, v49
    s_waitcnt lgkmcnt(6)
    v_mfma_f32_16x16x32_bf16 v[108:111], a[224:227], v[88:91], v[108:111]
    v_exp_f32 v50, v50
    s_waitcnt lgkmcnt(5)
    v_mfma_f32_16x16x32_bf16 v[112:115], a[224:227], v[92:95], v[112:115]
    v_exp_f32 v51, v51
    buffer_load_dwordx4 v9, s[40:43], s22 offen offset:3072 lds
    s_waitcnt lgkmcnt(2)
    v_mfma_f32_16x16x32_bf16 v[116:119], a[228:231], v[76:79], v[116:119]
    v_add_f32 v29, v29, v48
    v_add_f32 v29, v29, v49
    v_mfma_f32_16x16x32_bf16 v[120:123], a[228:231], v[80:83], v[120:123]
    ds_read_b64_tr_b16 a[236:237], v11 offset:17536
    ds_read_b64_tr_b16 a[238:239], v13 offset:17536
    v_mfma_f32_16x16x32_bf16 v[124:127], a[228:231], v[84:87], v[124:127]
    v_add_f32 v29, v29, v50
    v_add_f32 v29, v29, v51
    v_mfma_f32_16x16x32_bf16 v[128:131], a[228:231], v[88:91], v[128:131]
    v_cvt_pk_bf16_f32 v48, v48, v49
    v_cvt_pk_bf16_f32 v49, v50, v51
    v_mfma_f32_16x16x32_bf16 v[132:135], a[228:231], v[92:95], v[132:135]
    v_lshrrev_b32 v24, 7, v0
    v_mul_u32_u24 v24, 80, v24
    v_and_b32 v25, 15, v0
    v_add_u32 v24, v24, v25
    v_bfe_u32 v25, v0, 6, 1
    v_lshlrev_b32 v25, 2, v25
    v_lshl_add_u32 v21, v24, 3, v25
    s_waitcnt lgkmcnt(2)
    v_mfma_f32_16x16x32_bf16 v[136:139], a[232:235], v[76:79], v[136:139]
    ds_write_b64 v14, v[48:49] offset:11776
    v_mfma_f32_16x16x32_bf16 v[140:143], a[232:235], v[80:83], v[140:143]
    v_mul_f32 v52, s23, v52
    ds_read_b64_tr_b16 a[240:241], v10 offset:17664
    v_mfma_f32_16x16x32_bf16 v[144:147], a[232:235], v[84:87], v[144:147]
    ds_read_b64_tr_b16 a[242:243], v12 offset:17664
    v_mul_f32 v53, s23, v53
    v_mfma_f32_16x16x32_bf16 v[148:151], a[232:235], v[88:91], v[148:151]
    v_mul_f32 v54, s23, v54
    v_mul_f32 v55, s23, v55
    v_mfma_f32_16x16x32_bf16 v[152:155], a[232:235], v[92:95], v[152:155]
    v_exp_f32 v52, v52
    s_waitcnt lgkmcnt(3)
    v_mfma_f32_16x16x32_bf16 v[156:159], a[236:239], v[76:79], v[156:159]
    v_exp_f32 v53, v53
    v_mfma_f32_16x16x32_bf16 v[160:163], a[236:239], v[80:83], v[160:163]
    ds_read_b64_tr_b16 a[244:245], v11 offset:17664
    ds_read_b64_tr_b16 a[246:247], v13 offset:17664
    v_mfma_f32_16x16x32_bf16 v[164:167], a[236:239], v[84:87], v[164:167]
    v_exp_f32 v54, v54
    v_mfma_f32_16x16x32_bf16 v[168:171], a[236:239], v[88:91], v[168:171]
    v_exp_f32 v55, v55
    v_mfma_f32_16x16x32_bf16 v[172:175], a[236:239], v[92:95], v[172:175]
    v_add_f32 v30, v30, v52
    v_and_b32 v24, 15, v0
    s_lshr_b32 s18, s17, 2
    s_mul_i32 s78, s18, 256
    v_lshl_add_u32 v2, v24, 2, s78
    v_bfe_u32 v25, v0, 4, 2
    v_lshl_add_u32 v2, v25, 24, v2
    s_mul_i32 s78, s20, 64
    s_add_u32 s78, s78, s17
    s_lshl_b32 s78, s78, 2
    v_bfe_u32 v25, v0, 0, 6
    v_lshl_add_u32 v3, v25, 24, s78
    v_bfe_u32 v25, v0, 4, 2
    v_mul_u32_u24 v25, 143360, v25
    v_lshl_add_u32 v25, v24, 4, v25
    s_and_b32 s19, s17, 3
    s_mul_i32 s68, s18, 5120
    s_lshl_b32 s78, s19, 10
    s_add_u32 s78, s78, s68
    s_lshl_b32 s79, s20, 8
    s_add_u32 s78, s78, s79
    v_add_u32 v4, s78, v25
    s_lshl_b32 s78, s19, 8
    s_add_u32 s78, s78, s68
    s_mul_i32 s79, s20, 20480
    s_add_u32 s78, s78, s79
    s_add_u32 s78, s78, 4096
    v_add_u32 v5, s78, v25
    s_waitcnt lgkmcnt(2)
    v_mfma_f32_16x16x32_bf16 v[176:179], a[240:243], v[76:79], v[176:179]
    v_add_f32 v30, v30, v53
    v_add_f32 v30, v30, v54
    v_mfma_f32_16x16x32_bf16 v[180:183], a[240:243], v[80:83], v[180:183]
    ds_read_b64_tr_b16 a[248:249], v10 offset:17792
    ds_read_b64_tr_b16 a[250:251], v12 offset:17792
    v_mfma_f32_16x16x32_bf16 v[184:187], a[240:243], v[84:87], v[184:187]
    v_add_f32 v30, v30, v55
    ds_read_b64_tr_b16 a[252:253], v11 offset:17792
    v_mfma_f32_16x16x32_bf16 v[188:191], a[240:243], v[88:91], v[188:191]
    ds_read_b64_tr_b16 a[254:255], v13 offset:17792
    v_cvt_pk_bf16_f32 v52, v52, v53
    v_mfma_f32_16x16x32_bf16 v[192:195], a[240:243], v[92:95], v[192:195]
    v_cvt_pk_bf16_f32 v53, v54, v55
    s_waitcnt lgkmcnt(4)
    v_mfma_f32_16x16x32_bf16 v[196:199], a[244:247], v[76:79], v[196:199]
    ds_write_b64 v14, v[52:53] offset:12288
    v_mfma_f32_16x16x32_bf16 v[200:203], a[244:247], v[80:83], v[200:203]
    v_mfma_f32_16x16x32_bf16 v[204:207], a[244:247], v[84:87], v[204:207]
    v_mfma_f32_16x16x32_bf16 v[208:211], a[244:247], v[88:91], v[208:211]
    v_mfma_f32_16x16x32_bf16 v[212:215], a[244:247], v[92:95], v[212:215]
    s_waitcnt vmcnt(8) lgkmcnt(0)
    s_barrier
    v_mfma_f32_16x16x32_bf16 v[216:219], a[248:251], v[76:79], v[216:219]
    ds_read_b64_tr_b16 a[216:217], v10 offset:52224
    ds_read_b64_tr_b16 a[218:219], v12 offset:52224
    v_mfma_f32_16x16x32_bf16 v[220:223], a[248:251], v[80:83], v[220:223]
    ds_read_b64 v[38:39], v19 offset:10240
    s_add_u32 m0, s60, 104448
    s_add_u32 s22, s90, 0
    buffer_load_dwordx4 v6, s[40:43], s22 offen lds
    v_mfma_f32_16x16x32_bf16 v[224:227], a[248:251], v[84:87], v[224:227]
    ds_read_b64 v[42:43], v19 offset:10752
    ds_read_b64 v[46:47], v19 offset:11264
    v_mfma_f32_16x16x32_bf16 v[228:231], a[248:251], v[88:91], v[228:231]
    ds_read_b64 v[50:51], v19 offset:11776
    ds_read_b64 v[54:55], v19 offset:12288
    v_mfma_f32_16x16x32_bf16 v[232:235], a[248:251], v[92:95], v[232:235]
    buffer_load_dwordx4 v7, s[40:43], s22 offen offset:1024 lds
    ds_read_b64_tr_b16 a[220:221], v11 offset:52224
    v_mfma_f32_16x16x32_bf16 v[236:239], a[252:255], v[76:79], v[236:239]
    ds_read_b64_tr_b16 a[222:223], v13 offset:52224
    ds_read_b64_tr_b16 a[200:201], v10 offset:52352
    v_mfma_f32_16x16x32_bf16 v[240:243], a[252:255], v[80:83], v[240:243]
    ds_read_b64_tr_b16 a[202:203], v12 offset:52352
    ds_read_b64_tr_b16 a[204:205], v11 offset:52352
    v_mfma_f32_16x16x32_bf16 v[244:247], a[252:255], v[84:87], v[244:247]
    buffer_load_dwordx4 v8, s[40:43], s22 offen offset:2048 lds
    ds_read_b64_tr_b16 a[206:207], v13 offset:52352
    v_mfma_f32_16x16x32_bf16 v[248:251], a[252:255], v[88:91], v[248:251]
    ds_read_b64_tr_b16 a[208:209], v10 offset:52480
    ds_read_b64_tr_b16 a[210:211], v12 offset:52480
    v_mfma_f32_16x16x32_bf16 v[252:255], a[252:255], v[92:95], v[252:255]
    v_mov_b32 v31, v26
    s_waitcnt lgkmcnt(12)
    v_mfma_f32_16x16x32_bf16 v[96:99], a[216:219], v[36:39], v[96:99]
    v_mov_b32 v32, v27
    s_waitcnt lgkmcnt(11)
    v_mfma_f32_16x16x32_bf16 v[100:103], a[216:219], v[40:43], v[100:103]
    buffer_load_dwordx4 v9, s[40:43], s22 offen offset:3072 lds
    s_waitcnt lgkmcnt(10)
    v_mfma_f32_16x16x32_bf16 v[104:107], a[216:219], v[44:47], v[104:107]
    ds_read_b64_tr_b16 a[212:213], v11 offset:52480
    s_waitcnt lgkmcnt(10)
    v_mfma_f32_16x16x32_bf16 v[108:111], a[216:219], v[48:51], v[108:111]
    ds_read_b64_tr_b16 a[214:215], v13 offset:52480
    s_waitcnt lgkmcnt(10)
    v_mfma_f32_16x16x32_bf16 v[112:115], a[216:219], v[52:55], v[112:115]
    v_cvt_pk_bf16_f32 v96, v96, v97
    s_waitcnt lgkmcnt(8)
    v_mfma_f32_16x16x32_bf16 v[116:119], a[220:223], v[36:39], v[116:119]
    s_add_u32 m0, s60, 0
    s_add_u32 s22, s90, 114688
    buffer_load_dwordx4 v6, s[40:43], s22 offen lds
    v_mfma_f32_16x16x32_bf16 v[120:123], a[220:223], v[40:43], v[120:123]
    v_cvt_pk_bf16_f32 v97, v98, v99
    v_mov_b32 v33, v28
    v_mfma_f32_16x16x32_bf16 v[124:127], a[220:223], v[44:47], v[124:127]
    ds_read_b64_tr_b16 a[160:161], v10 offset:52608
    ds_read_b64_tr_b16 a[162:163], v12 offset:52608
    v_mfma_f32_16x16x32_bf16 v[128:131], a[220:223], v[48:51], v[128:131]
    v_cvt_pk_bf16_f32 v98, v116, v117
    v_cvt_pk_bf16_f32 v99, v118, v119
    v_mfma_f32_16x16x32_bf16 v[132:135], a[220:223], v[52:55], v[132:135]
    buffer_load_dwordx4 v7, s[40:43], s22 offen offset:1024 lds
    s_waitcnt lgkmcnt(8)
    v_mfma_f32_16x16x32_bf16 v[136:139], a[200:203], v[36:39], v[136:139]
    v_cvt_pk_bf16_f32 v100, v100, v101
    v_cvt_pk_bf16_f32 v101, v102, v103
    v_mfma_f32_16x16x32_bf16 v[140:143], a[200:203], v[40:43], v[140:143]
    v_cvt_pk_bf16_f32 v102, v120, v121
    v_cvt_pk_bf16_f32 v103, v122, v123
    v_mfma_f32_16x16x32_bf16 v[144:147], a[200:203], v[44:47], v[144:147]
    ds_read_b64_tr_b16 a[164:165], v11 offset:52608
    ds_read_b64_tr_b16 a[166:167], v13 offset:52608
    v_mfma_f32_16x16x32_bf16 v[148:151], a[200:203], v[48:51], v[148:151]
    buffer_load_dwordx4 v8, s[40:43], s22 offen offset:2048 lds
    v_cvt_pk_bf16_f32 v104, v104, v105
    v_mfma_f32_16x16x32_bf16 v[152:155], a[200:203], v[52:55], v[152:155]
    v_cvt_pk_bf16_f32 v105, v106, v107
    s_waitcnt lgkmcnt(8)
    v_mfma_f32_16x16x32_bf16 v[156:159], a[204:207], v[36:39], v[156:159]
    v_cvt_pk_bf16_f32 v106, v124, v125
    v_cvt_pk_bf16_f32 v107, v126, v127
    v_mfma_f32_16x16x32_bf16 v[160:163], a[204:207], v[40:43], v[160:163]
    v_cvt_pk_bf16_f32 v108, v108, v109
    v_cvt_pk_bf16_f32 v109, v110, v111
    v_mfma_f32_16x16x32_bf16 v[164:167], a[204:207], v[44:47], v[164:167]
    buffer_load_dwordx4 v9, s[40:43], s22 offen offset:3072 lds
    v_cvt_pk_bf16_f32 v110, v128, v129
    v_mfma_f32_16x16x32_bf16 v[168:171], a[204:207], v[48:51], v[168:171]
    v_cvt_pk_bf16_f32 v111, v130, v131
    v_cvt_pk_bf16_f32 v112, v112, v113
    v_mfma_f32_16x16x32_bf16 v[172:175], a[204:207], v[52:55], v[172:175]
    v_cvt_pk_bf16_f32 v113, v114, v115
    s_waitcnt lgkmcnt(6)
    v_mfma_f32_16x16x32_bf16 v[176:179], a[208:211], v[36:39], v[176:179]
    v_cvt_pk_bf16_f32 v114, v132, v133
    v_cvt_pk_bf16_f32 v115, v134, v135
    v_mfma_f32_16x16x32_bf16 v[180:183], a[208:211], v[40:43], v[180:183]
    v_cvt_pk_bf16_f32 v136, v136, v137
    v_cvt_pk_bf16_f32 v137, v138, v139
    v_mfma_f32_16x16x32_bf16 v[184:187], a[208:211], v[44:47], v[184:187]
    v_cvt_pk_bf16_f32 v138, v156, v157
    v_cvt_pk_bf16_f32 v139, v158, v159
    v_mfma_f32_16x16x32_bf16 v[188:191], a[208:211], v[48:51], v[188:191]
    v_add_u32 v22, 0xfffffc00, v22
    ds_write_b128 v22, v[96:99]
    v_mfma_f32_16x16x32_bf16 v[192:195], a[208:211], v[52:55], v[192:195]
    v_cvt_pk_bf16_f32 v140, v140, v141
    s_waitcnt lgkmcnt(5)
    v_mfma_f32_16x16x32_bf16 v[196:199], a[212:215], v[36:39], v[196:199]
    v_cvt_pk_bf16_f32 v141, v142, v143
    v_cvt_pk_bf16_f32 v142, v160, v161
    v_mfma_f32_16x16x32_bf16 v[200:203], a[212:215], v[40:43], v[200:203]
    v_cvt_pk_bf16_f32 v143, v162, v163
    v_cvt_pk_bf16_f32 v144, v144, v145
    v_mfma_f32_16x16x32_bf16 v[204:207], a[212:215], v[44:47], v[204:207]
    ds_write_b128 v22, v[100:103] offset:1024
    v_cvt_pk_bf16_f32 v145, v146, v147
    v_mfma_f32_16x16x32_bf16 v[208:211], a[212:215], v[48:51], v[208:211]
    v_cvt_pk_bf16_f32 v146, v164, v165
    v_cvt_pk_bf16_f32 v147, v166, v167
    v_mfma_f32_16x16x32_bf16 v[212:215], a[212:215], v[52:55], v[212:215]
    s_waitcnt vmcnt(8) lgkmcnt(0)
    s_barrier
    v_mfma_f32_16x16x32_bf16 v[216:219], a[160:163], v[36:39], v[216:219]
    v_add_u32 v15, 0x11000, v15
    ds_read_b64_tr_b16 a[224:225], v15
    v_mfma_f32_16x16x32_bf16 v[220:223], a[160:163], v[40:43], v[220:223]
    ds_read_b64_tr_b16 a[226:227], v15 offset:2048
    s_add_u32 m0, s60, 17408
    s_add_u32 s22, s91, 0
    buffer_load_dwordx4 v6, s[40:43], s22 offen lds
    v_mfma_f32_16x16x32_bf16 v[224:227], a[160:163], v[44:47], v[224:227]
    v_add_u32 v16, 0x11000, v16
    ds_read_b64_tr_b16 a[228:229], v16
    v_mfma_f32_16x16x32_bf16 v[228:231], a[160:163], v[48:51], v[228:231]
    buffer_load_dwordx4 v7, s[40:43], s22 offen offset:1024 lds
    ds_read_b64_tr_b16 a[230:231], v16 offset:2048
    v_mfma_f32_16x16x32_bf16 v[232:235], a[160:163], v[52:55], v[232:235]
    ds_write_b128 v22, v[104:107] offset:2048
    v_cvt_pk_bf16_f32 v148, v148, v149
    v_mfma_f32_16x16x32_bf16 v[236:239], a[164:167], v[36:39], v[236:239]
    v_cvt_pk_bf16_f32 v149, v150, v151
    v_cvt_pk_bf16_f32 v150, v168, v169
    v_mfma_f32_16x16x32_bf16 v[240:243], a[164:167], v[40:43], v[240:243]
    v_cvt_pk_bf16_f32 v151, v170, v171
    v_cvt_pk_bf16_f32 v152, v152, v153
    v_mfma_f32_16x16x32_bf16 v[244:247], a[164:167], v[44:47], v[244:247]
    buffer_load_dwordx4 v8, s[40:43], s22 offen offset:2048 lds
    ds_read_b64_tr_b16 a[232:233], v15 offset:8192
    v_mfma_f32_16x16x32_bf16 v[248:251], a[164:167], v[48:51], v[248:251]
    ds_write_b128 v22, v[108:111] offset:3072
    v_cvt_pk_bf16_f32 v153, v154, v155
    v_mfma_f32_16x16x32_bf16 v[252:255], a[164:167], v[52:55], v[252:255]
    v_cvt_pk_bf16_f32 v154, v172, v173
    s_waitcnt lgkmcnt(5)
    v_mfma_f32_16x16x32_bf16 v[56:59], a[224:227], v[96:99], 0
    v_cvt_pk_bf16_f32 v155, v174, v175
    v_cvt_pk_bf16_f32 v176, v176, v177
    v_mfma_f32_16x16x32_bf16 v[60:63], a[224:227], v[100:103], 0
    ds_read_b64_tr_b16 a[234:235], v15 offset:10240
    buffer_load_dwordx4 v9, s[40:43], s22 offen offset:3072 lds
    v_mfma_f32_16x16x32_bf16 v[64:67], a[224:227], v[104:107], 0
    ds_write_b128 v22, v[112:115] offset:4096
    v_cvt_pk_bf16_f32 v177, v178, v179
    v_mfma_f32_16x16x32_bf16 v[68:71], a[224:227], v[108:111], 0
    v_cvt_pk_bf16_f32 v178, v196, v197
    v_cvt_pk_bf16_f32 v179, v198, v199
    v_mfma_f32_16x16x32_bf16 v[72:75], a[224:227], v[112:115], 0
    v_cvt_pk_bf16_f32 v180, v180, v181
    s_waitcnt lgkmcnt(5)
    v_mfma_f32_16x16x32_bf16 v[76:79], a[228:231], v[96:99], 0
    ds_read_b64_tr_b16 a[236:237], v16 offset:8192
    ds_read_b64_tr_b16 a[238:239], v16 offset:10240
    v_mfma_f32_16x16x32_bf16 v[80:83], a[228:231], v[100:103], 0
    s_add_u32 m0, s60, 34816
    s_add_u32 s22, s91, 114688
    buffer_load_dwordx4 v6, s[40:43], s22 offen lds
    v_mfma_f32_16x16x32_bf16 v[84:87], a[228:231], v[104:107], 0
    ds_write_b128 v22, v[136:139] offset:22528
    v_cvt_pk_bf16_f32 v181, v182, v183
    v_mfma_f32_16x16x32_bf16 v[88:91], a[228:231], v[108:111], 0
    v_cvt_pk_bf16_f32 v182, v200, v201
    v_cvt_pk_bf16_f32 v183, v202, v203
    v_mfma_f32_16x16x32_bf16 v[92:95], a[228:231], v[112:115], 0
    buffer_load_dwordx4 v7, s[40:43], s22 offen offset:1024 lds
    s_waitcnt lgkmcnt(4)
    v_mfma_f32_16x16x32_bf16 v[56:59], a[232:235], v[136:139], v[56:59]
    ds_read_b64_tr_b16 a[240:241], v15 offset:17408
    ds_read_b64_tr_b16 a[242:243], v15 offset:19456
    v_mfma_f32_16x16x32_bf16 v[60:63], a[232:235], v[140:143], v[60:63]
    ds_write_b128 v22, v[140:143] offset:23552
    v_cvt_pk_bf16_f32 v184, v184, v185
    v_mfma_f32_16x16x32_bf16 v[64:67], a[232:235], v[144:147], v[64:67]
    v_cvt_pk_bf16_f32 v185, v186, v187
    v_cvt_pk_bf16_f32 v186, v204, v205
    v_mfma_f32_16x16x32_bf16 v[68:71], a[232:235], v[148:151], v[68:71]
    buffer_load_dwordx4 v8, s[40:43], s22 offen offset:2048 lds
    v_cvt_pk_bf16_f32 v187, v206, v207
    v_mfma_f32_16x16x32_bf16 v[72:75], a[232:235], v[152:155], v[72:75]
    ds_read_b64_tr_b16 a[244:245], v16 offset:17408
    s_waitcnt lgkmcnt(5)
    v_mfma_f32_16x16x32_bf16 v[76:79], a[236:239], v[136:139], v[76:79]
    ds_read_b64_tr_b16 a[246:247], v16 offset:19456
    v_cvt_pk_bf16_f32 v188, v188, v189
    v_mfma_f32_16x16x32_bf16 v[80:83], a[236:239], v[140:143], v[80:83]
    ds_write_b128 v22, v[144:147] offset:24576
    v_cvt_pk_bf16_f32 v189, v190, v191
    v_mfma_f32_16x16x32_bf16 v[84:87], a[236:239], v[144:147], v[84:87]
    v_cvt_pk_bf16_f32 v190, v208, v209
    v_cvt_pk_bf16_f32 v191, v210, v211
    v_mfma_f32_16x16x32_bf16 v[88:91], a[236:239], v[148:151], v[88:91]
    buffer_load_dwordx4 v9, s[40:43], s22 offen offset:3072 lds
    v_cvt_pk_bf16_f32 v192, v192, v193
    v_mfma_f32_16x16x32_bf16 v[92:95], a[236:239], v[152:155], v[92:95]
    ds_write_b128 v22, v[148:151] offset:25600
    s_waitcnt lgkmcnt(5)
    v_mfma_f32_16x16x32_bf16 v[56:59], a[240:243], v[176:179], v[56:59]
    v_cvt_pk_bf16_f32 v193, v194, v195
    v_cvt_pk_bf16_f32 v194, v212, v213
    v_mfma_f32_16x16x32_bf16 v[60:63], a[240:243], v[180:183], v[60:63]
    v_cvt_pk_bf16_f32 v195, v214, v215
    s_add_u32 m0, s60, 52224
    s_add_u32 s22, s92, 0
    buffer_load_dwordx4 v6, s[40:43], s22 offen lds
    v_mfma_f32_16x16x32_bf16 v[64:67], a[240:243], v[184:187], v[64:67]
    ds_read_b64_tr_b16 a[248:249], v15 offset:25600
    ds_read_b64_tr_b16 a[250:251], v15 offset:27648
    v_mfma_f32_16x16x32_bf16 v[68:71], a[240:243], v[188:191], v[68:71]
    ds_write_b128 v22, v[152:155] offset:26624
    v_cvt_pk_bf16_f32 v216, v216, v217
    v_mfma_f32_16x16x32_bf16 v[72:75], a[240:243], v[192:195], v[72:75]
    v_cvt_pk_bf16_f32 v217, v218, v219
    s_waitcnt lgkmcnt(5)
    v_mfma_f32_16x16x32_bf16 v[76:79], a[244:247], v[176:179], v[76:79]
    v_cvt_pk_bf16_f32 v218, v236, v237
    v_cvt_pk_bf16_f32 v219, v238, v239
    v_mfma_f32_16x16x32_bf16 v[80:83], a[244:247], v[180:183], v[80:83]
    ds_read_b64_tr_b16 a[252:253], v16 offset:25600
    ds_read_b64_tr_b16 a[254:255], v16 offset:27648
    v_mfma_f32_16x16x32_bf16 v[84:87], a[244:247], v[184:187], v[84:87]
    v_cvt_pk_bf16_f32 v220, v220, v221
    v_cvt_pk_bf16_f32 v221, v222, v223
    v_mfma_f32_16x16x32_bf16 v[88:91], a[244:247], v[188:191], v[88:91]
    v_cvt_pk_bf16_f32 v222, v240, v241
    v_cvt_pk_bf16_f32 v223, v242, v243
    buffer_load_dwordx4 v7, s[40:43], s22 offen offset:1024 lds
    v_mfma_f32_16x16x32_bf16 v[92:95], a[244:247], v[192:195], v[92:95]
    s_waitcnt vmcnt(10) lgkmcnt(0)
    s_barrier
    v_cvt_pk_bf16_f32 v224, v224, v225
    v_cvt_pk_bf16_f32 v225, v226, v227
    v_cvt_pk_bf16_f32 v226, v244, v245
    v_cvt_pk_bf16_f32 v227, v246, v247
    v_mfma_f32_16x16x32_bf16 v[56:59], a[248:251], v[216:219], v[56:59]
    v_cvt_pk_bf16_f32 v228, v228, v229
    v_cvt_pk_bf16_f32 v229, v230, v231
    v_cvt_pk_bf16_f32 v230, v248, v249
    v_cvt_pk_bf16_f32 v231, v250, v251
    v_add_u32 v23, 0xfffffc00, v23
    ds_read_b128 a[160:163], v23
    v_mfma_f32_16x16x32_bf16 v[60:63], a[248:251], v[220:223], v[60:63]
    v_cvt_pk_bf16_f32 v232, v232, v233
    v_cvt_pk_bf16_f32 v233, v234, v235
    v_cvt_pk_bf16_f32 v234, v252, v253
    v_cvt_pk_bf16_f32 v235, v254, v255
    ds_read_b128 a[164:167], v23 offset:1024
    v_mfma_f32_16x16x32_bf16 v[64:67], a[248:251], v[224:227], v[64:67]
    ds_read_b64_tr_b16 a[216:217], v15 offset:34816
    ds_read_b64_tr_b16 a[218:219], v15 offset:36864
    ds_read_b128 a[168:171], v23 offset:2048
    buffer_load_dwordx4 v8, s[40:43], s22 offen offset:2048 lds
    v_mfma_f32_16x16x32_bf16 v[68:71], a[248:251], v[228:231], v[68:71]
    ds_read_b128 a[172:175], v23 offset:3072
    ds_read_b128 a[176:179], v23 offset:4096
    v_mfma_f32_16x16x32_bf16 v[72:75], a[248:251], v[232:235], v[72:75]
    ds_read_b128 a[180:183], v23 offset:22528
    ds_read_b128 a[184:187], v23 offset:23552
    v_mfma_f32_16x16x32_bf16 v[76:79], a[252:255], v[216:219], v[76:79]
    buffer_load_dwordx4 v9, s[40:43], s22 offen offset:3072 lds
    ds_read_b64_tr_b16 a[220:221], v16 offset:34816
    v_mfma_f32_16x16x32_bf16 v[80:83], a[252:255], v[220:223], v[80:83]
    ds_read_b64_tr_b16 a[222:223], v16 offset:36864
    ds_read_b128 a[188:191], v23 offset:24576
    v_mfma_f32_16x16x32_bf16 v[84:87], a[252:255], v[224:227], v[84:87]
    ds_read_b128 a[192:195], v23 offset:25600
    ds_read_b128 a[196:199], v23 offset:26624
    v_mfma_f32_16x16x32_bf16 v[88:91], a[252:255], v[228:231], v[88:91]
    ds_read_b64_tr_b16 a[200:201], v15 offset:43008
    ds_read_b64_tr_b16 a[202:203], v15 offset:45056
    v_mfma_f32_16x16x32_bf16 v[92:95], a[252:255], v[232:235], v[92:95]
    ds_read_b64_tr_b16 a[204:205], v16 offset:43008
    s_waitcnt lgkmcnt(13)
    v_mfma_f32_16x16x32_bf16 v[116:119], a[216:219], v[96:99], 0
    ds_read_b64_tr_b16 a[206:207], v16 offset:45056
    v_add_u32 v15, 0xfffef000, v15
    ds_read_b64_tr_b16 a[208:209], v15
    v_mfma_f32_16x16x32_bf16 v[120:123], a[216:219], v[100:103], 0
    ds_read_b64_tr_b16 a[210:211], v15 offset:2048
    v_mov_b32 v34, v29
    v_mfma_f32_16x16x32_bf16 v[124:127], a[216:219], v[104:107], 0
    v_mov_b32 v35, v30
    v_add_u32 v16, 0xfffef000, v16
    ds_read_b64_tr_b16 a[212:213], v16
    v_mfma_f32_16x16x32_bf16 v[128:131], a[216:219], v[108:111], 0
    ds_read_b64_tr_b16 a[214:215], v16 offset:2048
    v_permlane32_swap_b32 v26, v31
    v_mfma_f32_16x16x32_bf16 v[132:135], a[216:219], v[112:115], 0
    v_permlane32_swap_b32 v27, v32
    s_waitcnt lgkmcnt(11)
    v_mfma_f32_16x16x32_bf16 v[156:159], a[220:223], v[96:99], 0
    v_permlane32_swap_b32 v28, v33
    v_permlane32_swap_b32 v29, v34
    v_mfma_f32_16x16x32_bf16 v[160:163], a[220:223], v[100:103], 0
    v_permlane32_swap_b32 v30, v35
    v_add_f32 v26, v26, v31
    v_mfma_f32_16x16x32_bf16 v[164:167], a[220:223], v[104:107], 0
    s_waitcnt lgkmcnt(0)
    s_barrier
    v_mfma_f32_16x16x32_bf16 v[168:171], a[220:223], v[108:111], 0
    ds_write_b128 v22, v[176:179]
    v_add_f32 v27, v27, v32
    v_mfma_f32_16x16x32_bf16 v[172:175], a[220:223], v[112:115], 0
    v_add_f32 v28, v28, v33
    v_add_f32 v29, v29, v34
    v_mfma_f32_16x16x32_bf16 v[116:119], a[200:203], v[136:139], v[116:119]
    v_add_f32 v30, v30, v35
    v_mov_b32 v31, v26
    v_mfma_f32_16x16x32_bf16 v[120:123], a[200:203], v[140:143], v[120:123]
    ds_write_b128 v22, v[180:183] offset:1024
    v_mov_b32 v32, v27
    v_mfma_f32_16x16x32_bf16 v[124:127], a[200:203], v[144:147], v[124:127]
    v_mov_b32 v33, v28
    v_mov_b32 v34, v29
    v_mfma_f32_16x16x32_bf16 v[128:131], a[200:203], v[148:151], v[128:131]
    v_mov_b32 v35, v30
    v_permlane16_swap_b32 v26, v31
    v_mfma_f32_16x16x32_bf16 v[132:135], a[200:203], v[152:155], v[132:135]
    ds_write_b128 v22, v[184:187] offset:2048
    v_permlane16_swap_b32 v27, v32
    v_mfma_f32_16x16x32_bf16 v[156:159], a[204:207], v[136:139], v[156:159]
    v_permlane16_swap_b32 v28, v33
    v_permlane16_swap_b32 v29, v34
    v_mfma_f32_16x16x32_bf16 v[160:163], a[204:207], v[140:143], v[160:163]
    v_permlane16_swap_b32 v30, v35
    v_add_f32 v26, v26, v31
    v_mfma_f32_16x16x32_bf16 v[164:167], a[204:207], v[144:147], v[164:167]
    ds_read_b64_tr_b16 a[224:225], v15 offset:8192
    ds_read_b64_tr_b16 a[226:227], v15 offset:10240
    v_mfma_f32_16x16x32_bf16 v[168:171], a[204:207], v[148:151], v[168:171]
    ds_write_b128 v22, v[188:191] offset:3072
    v_add_f32 v27, v27, v32
    v_mfma_f32_16x16x32_bf16 v[172:175], a[204:207], v[152:155], v[172:175]
    v_add_f32 v28, v28, v33
    v_add_f32 v29, v29, v34
    v_mfma_f32_16x16x32_bf16 v[116:119], a[208:211], v[176:179], v[116:119]
    v_add_f32 v30, v30, v35
    v_mfma_f32_16x16x32_bf16 v[120:123], a[208:211], v[180:183], v[120:123]
    ds_read_b64_tr_b16 a[228:229], v16 offset:8192
    ds_read_b64_tr_b16 a[230:231], v16 offset:10240
    v_mfma_f32_16x16x32_bf16 v[124:127], a[208:211], v[184:187], v[124:127]
    ds_write_b128 v22, v[192:195] offset:4096
    v_mfma_f32_16x16x32_bf16 v[128:131], a[208:211], v[188:191], v[128:131]
    v_mfma_f32_16x16x32_bf16 v[132:135], a[208:211], v[192:195], v[132:135]
    v_mfma_f32_16x16x32_bf16 v[156:159], a[212:215], v[176:179], v[156:159]
    ds_write_b128 v22, v[216:219] offset:22528
    v_mfma_f32_16x16x32_bf16 v[160:163], a[212:215], v[180:183], v[160:163]
    v_mfma_f32_16x16x32_bf16 v[164:167], a[212:215], v[184:187], v[164:167]
    v_mfma_f32_16x16x32_bf16 v[168:171], a[212:215], v[188:191], v[168:171]
    v_add_u32 v17, 0x11000, v17
    ds_read_b64_tr_b16 a[232:233], v17
    v_mfma_f32_16x16x32_bf16 v[172:175], a[212:215], v[192:195], v[172:175]
    ds_read_b64_tr_b16 a[234:235], v17 offset:2048
    s_waitcnt lgkmcnt(7)
    v_mfma_f32_16x16x32_bf16 v[116:119], a[224:227], v[216:219], v[116:119]
    ds_write_b128 v22, v[220:223] offset:23552
    v_mfma_f32_16x16x32_bf16 v[120:123], a[224:227], v[220:223], v[120:123]
    v_mfma_f32_16x16x32_bf16 v[124:127], a[224:227], v[224:227], v[124:127]
    v_mfma_f32_16x16x32_bf16 v[128:131], a[224:227], v[228:231], v[128:131]
    v_add_u32 v18, 0x11000, v18
    ds_read_b64_tr_b16 a[236:237], v18
    v_mfma_f32_16x16x32_bf16 v[132:135], a[224:227], v[232:235], v[132:135]
    ds_read_b64_tr_b16 a[238:239], v18 offset:2048
    s_waitcnt lgkmcnt(7)
    v_mfma_f32_16x16x32_bf16 v[156:159], a[228:231], v[216:219], v[156:159]
    ds_write_b128 v22, v[224:227] offset:24576
    v_mfma_f32_16x16x32_bf16 v[160:163], a[228:231], v[220:223], v[160:163]
    v_mfma_f32_16x16x32_bf16 v[164:167], a[228:231], v[224:227], v[164:167]
    v_mfma_f32_16x16x32_bf16 v[168:171], a[228:231], v[228:231], v[168:171]
    ds_read_b64_tr_b16 a[240:241], v17 offset:8192
    ds_read_b64_tr_b16 a[242:243], v17 offset:10240
    v_mfma_f32_16x16x32_bf16 v[172:175], a[228:231], v[232:235], v[172:175]
    ds_write_b128 v22, v[228:231] offset:25600
    s_waitcnt lgkmcnt(7)
    v_mfma_f32_16x16x32_bf16 v[56:59], a[232:235], a[160:163], v[56:59]
    v_mfma_f32_16x16x32_bf16 v[60:63], a[232:235], a[164:167], v[60:63]
    v_mfma_f32_16x16x32_bf16 v[64:67], a[232:235], a[168:171], v[64:67]
    v_add_u32 v21, 0x22800, v21
    ds_write_b32 v21, v26
    v_mfma_f32_16x16x32_bf16 v[68:71], a[232:235], a[172:175], v[68:71]
    ds_read_b64_tr_b16 a[244:245], v18 offset:8192
    ds_read_b64_tr_b16 a[246:247], v18 offset:10240
    ds_write_b32 v21, v27 offset:128
    v_mfma_f32_16x16x32_bf16 v[72:75], a[232:235], a[176:179], v[72:75]
    ds_write_b32 v21, v28 offset:256
    s_waitcnt lgkmcnt(9)
    v_mfma_f32_16x16x32_bf16 v[76:79], a[236:239], a[160:163], v[76:79]
    ds_write_b32 v21, v29 offset:384
    v_mfma_f32_16x16x32_bf16 v[80:83], a[236:239], a[164:167], v[80:83]
    ds_write_b128 v22, v[232:235] offset:26624
    ds_write_b32 v21, v30 offset:512
    v_mfma_f32_16x16x32_bf16 v[84:87], a[236:239], a[168:171], v[84:87]
    v_mfma_f32_16x16x32_bf16 v[88:91], a[236:239], a[172:175], v[88:91]
    v_mfma_f32_16x16x32_bf16 v[92:95], a[236:239], a[176:179], v[92:95]
    s_waitcnt lgkmcnt(0)
    s_barrier
    v_mfma_f32_16x16x32_bf16 v[56:59], a[240:243], a[180:183], v[56:59]
    ds_read_b128 v[196:199], v23
    v_xor_b32 v21, 4, v21
    v_mfma_f32_16x16x32_bf16 v[60:63], a[240:243], a[184:187], v[60:63]
    ds_read_b128 v[200:203], v23 offset:1024
    ds_read_b32 v31, v21
    v_mfma_f32_16x16x32_bf16 v[64:67], a[240:243], a[188:191], v[64:67]
    ds_read_b64_tr_b16 a[248:249], v17 offset:17408
    ds_read_b64_tr_b16 a[250:251], v17 offset:19456
    ds_read_b128 v[204:207], v23 offset:2048
    s_add_u32 m0, s60, 69632
    s_add_u32 s22, s92, 114688
    buffer_load_dwordx4 v6, s[40:43], s22 offen lds
    v_mfma_f32_16x16x32_bf16 v[68:71], a[240:243], a[192:195], v[68:71]
    ds_read_b128 v[208:211], v23 offset:3072
    v_add_u32 v44, 141312, v20
    ds_read_b32 v32, v21 offset:128
    v_mfma_f32_16x16x32_bf16 v[72:75], a[240:243], a[196:199], v[72:75]
    ds_read_b128 v[212:215], v23 offset:4096
    ds_read_b32 v33, v21 offset:256
    v_mfma_f32_16x16x32_bf16 v[76:79], a[244:247], a[180:183], v[76:79]
    ds_read_b128 v[236:239], v23 offset:22528
    ds_read_b32 v34, v21 offset:384
    v_mfma_f32_16x16x32_bf16 v[80:83], a[244:247], a[184:187], v[80:83]
    ds_read_b128 v[240:243], v23 offset:23552
    ds_read_b64_tr_b16 a[252:253], v18 offset:17408
    v_mfma_f32_16x16x32_bf16 v[84:87], a[244:247], a[188:191], v[84:87]
    ds_read_b64_tr_b16 a[254:255], v18 offset:19456
    ds_read_b128 v[244:247], v23 offset:24576
    ds_read_b32 v35, v21 offset:512
    v_mfma_f32_16x16x32_bf16 v[88:91], a[244:247], a[192:195], v[88:91]
    ds_read_b128 v[248:251], v23 offset:25600
    ds_read_b128 v[36:39], v44
    v_mfma_f32_16x16x32_bf16 v[92:95], a[244:247], a[196:199], v[92:95]
    ds_read_b128 v[252:255], v23 offset:26624
    s_waitcnt lgkmcnt(15)
    v_mfma_f32_16x16x32_bf16 v[56:59], a[248:251], v[196:199], v[56:59]
    ds_read_b64_tr_b16 a[216:217], v17 offset:25600
    ds_read_b64_tr_b16 a[218:219], v17 offset:27648
    v_mfma_f32_16x16x32_bf16 v[60:63], a[248:251], v[200:203], v[60:63]
    buffer_load_dwordx4 v7, s[40:43], s22 offen offset:1024 lds
    s_waitcnt lgkmcnt(15)
    v_mfma_f32_16x16x32_bf16 v[64:67], a[248:251], v[204:207], v[64:67]
    ds_read_b64_tr_b16 a[220:221], v18 offset:25600
    ds_read_b64_tr_b16 a[222:223], v18 offset:27648
    v_mfma_f32_16x16x32_bf16 v[68:71], a[248:251], v[208:211], v[68:71]
    ds_read_b128 v[40:43], v44 offset:256
    v_add_f32 v26, v26, v31
    s_waitcnt lgkmcnt(15)
    v_mfma_f32_16x16x32_bf16 v[72:75], a[248:251], v[212:215], v[72:75]
    v_add_f32 v27, v27, v32
    s_waitcnt lgkmcnt(10)
    v_mfma_f32_16x16x32_bf16 v[76:79], a[252:255], v[196:199], v[76:79]
    v_add_f32 v28, v28, v33
    v_add_f32 v29, v29, v34
    v_mfma_f32_16x16x32_bf16 v[80:83], a[252:255], v[200:203], v[80:83]
    s_waitcnt lgkmcnt(8)
    v_add_f32 v30, v30, v35
    v_mfma_f32_16x16x32_bf16 v[84:87], a[252:255], v[204:207], v[84:87]
    v_rcp_f32 v26, v26
    v_mfma_f32_16x16x32_bf16 v[88:91], a[252:255], v[208:211], v[88:91]
    v_rcp_f32 v27, v27
    v_mfma_f32_16x16x32_bf16 v[92:95], a[252:255], v[212:215], v[92:95]
    s_waitcnt lgkmcnt(0)
    s_barrier
    v_mfma_f32_16x16x32_bf16 v[56:59], a[216:219], v[236:239], v[56:59]
    v_rcp_f32 v28, v28
    v_mfma_f32_16x16x32_bf16 v[60:63], a[216:219], v[240:243], v[60:63]
    v_rcp_f32 v29, v29
    v_mfma_f32_16x16x32_bf16 v[64:67], a[216:219], v[244:247], v[64:67]
    ds_read_b64_tr_b16 a[200:201], v17 offset:34816
    ds_read_b64_tr_b16 a[202:203], v17 offset:36864
    v_rcp_f32 v30, v30
    s_nop 0
    v_mul_f32 v56, v26, v56
    buffer_load_dwordx4 v8, s[40:43], s22 offen offset:2048 lds
    v_mfma_f32_16x16x32_bf16 v[68:71], a[216:219], v[248:251], v[68:71]
    v_mul_f32 v57, v26, v57
    v_mul_f32 v58, v26, v58
    v_mfma_f32_16x16x32_bf16 v[72:75], a[216:219], v[252:255], v[72:75]
    v_mul_f32 v59, v26, v59
    v_cvt_pk_bf16_f32 v56, v56, v57
    v_mfma_f32_16x16x32_bf16 v[76:79], a[220:223], v[236:239], v[76:79]
    v_cvt_pk_bf16_f32 v57, v58, v59
    ds_read_b64_tr_b16 a[204:205], v18 offset:34816
    v_mfma_f32_16x16x32_bf16 v[80:83], a[220:223], v[240:243], v[80:83]
    ds_read_b64_tr_b16 a[206:207], v18 offset:36864
    ds_read_b64_tr_b16 a[208:209], v17 offset:43008
    v_mfma_f32_16x16x32_bf16 v[84:87], a[220:223], v[244:247], v[84:87]
    s_nop 1
    v_mul_f32 v76, v26, v76
    v_mfma_f32_16x16x32_bf16 v[88:91], a[220:223], v[248:251], v[88:91]
    v_mul_f32 v77, v26, v77
    v_mul_f32 v78, v26, v78
    v_mfma_f32_16x16x32_bf16 v[92:95], a[220:223], v[252:255], v[92:95]
    v_mul_f32 v79, v26, v79
    s_waitcnt lgkmcnt(3)
    v_mfma_f32_16x16x32_bf16 v[116:119], a[200:203], a[160:163], v[116:119]
    v_cvt_pk_bf16_f32 v58, v76, v77
    v_cvt_pk_bf16_f32 v59, v78, v79
    v_mfma_f32_16x16x32_bf16 v[120:123], a[200:203], a[164:167], v[120:123]
    v_mul_f32 v60, v27, v60
    ds_read_b64_tr_b16 a[210:211], v17 offset:45056
    v_mfma_f32_16x16x32_bf16 v[124:127], a[200:203], a[168:171], v[124:127]
    v_mul_f32 v61, v27, v61
    buffer_load_dwordx4 v9, s[40:43], s22 offen offset:3072 lds
    v_mfma_f32_16x16x32_bf16 v[128:131], a[200:203], a[172:175], v[128:131]
    v_mul_f32 v62, v27, v62
    v_mul_f32 v63, v27, v63
    v_mfma_f32_16x16x32_bf16 v[132:135], a[200:203], a[176:179], v[132:135]
    v_cvt_pk_bf16_f32 v60, v60, v61
    s_waitcnt lgkmcnt(2)
    v_mfma_f32_16x16x32_bf16 v[156:159], a[204:207], a[160:163], v[156:159]
    v_cvt_pk_bf16_f32 v61, v62, v63
    v_mul_f32 v80, v27, v80
    v_mfma_f32_16x16x32_bf16 v[160:163], a[204:207], a[164:167], v[160:163]
    buffer_store_dwordx4 v[56:59], v20, s[44:47], s62 offen sc1
    ds_read_b64_tr_b16 a[212:213], v18 offset:43008
    v_mfma_f32_16x16x32_bf16 v[164:167], a[204:207], a[168:171], v[164:167]
    ds_read_b64_tr_b16 a[214:215], v18 offset:45056
    v_max3_u32 v44, v36, v37, v38
    v_mul_f32 v81, v27, v81
    v_mul_f32 v82, v27, v82
    v_mfma_f32_16x16x32_bf16 v[168:171], a[204:207], a[172:175], v[168:171]
    v_mul_f32 v83, v27, v83
    v_cvt_pk_bf16_f32 v62, v80, v81
    v_mfma_f32_16x16x32_bf16 v[172:175], a[204:207], a[176:179], v[172:175]
    v_cvt_pk_bf16_f32 v63, v82, v83
    s_waitcnt lgkmcnt(2)
    v_mfma_f32_16x16x32_bf16 v[116:119], a[208:211], a[180:183], v[116:119]
    v_mul_f32 v64, v28, v64
    v_mul_f32 v65, v28, v65
    v_mfma_f32_16x16x32_bf16 v[120:123], a[208:211], a[184:187], v[120:123]
    v_add_u32 v17, 0xfffef000, v17
    ds_read_b64_tr_b16 a[224:225], v17
    v_mfma_f32_16x16x32_bf16 v[124:127], a[208:211], a[188:191], v[124:127]
    ds_read_b64_tr_b16 a[226:227], v17 offset:2048
    v_mul_f32 v66, v28, v66
    s_add_u32 m0, s60, 87040
    s_add_u32 s22, s93, 0
    buffer_load_dwordx4 v6, s[40:43], s22 offen lds
    v_mfma_f32_16x16x32_bf16 v[128:131], a[208:211], a[192:195], v[128:131]
    v_mul_f32 v67, v28, v67
    v_cvt_pk_bf16_f32 v64, v64, v65
    v_mfma_f32_16x16x32_bf16 v[132:135], a[208:211], a[196:199], v[132:135]
    buffer_store_dwordx4 v[60:63], v20, s[44:47], s62 offen offset:1024 sc1
    v_max3_u32 v44, v44, v39, v40
    v_cvt_pk_bf16_f32 v65, v66, v67
    s_waitcnt lgkmcnt(2)
    v_mfma_f32_16x16x32_bf16 v[156:159], a[212:215], a[180:183], v[156:159]
    v_mul_f32 v84, v28, v84
    v_mul_f32 v85, v28, v85
    v_mfma_f32_16x16x32_bf16 v[160:163], a[212:215], a[184:187], v[160:163]
    v_mul_f32 v86, v28, v86
    v_add_u32 v18, 0xfffef000, v18
    ds_read_b64_tr_b16 a[228:229], v18
    v_mfma_f32_16x16x32_bf16 v[164:167], a[212:215], a[188:191], v[164:167]
    ds_read_b64_tr_b16 a[230:231], v18 offset:2048
    v_mul_f32 v87, v28, v87
    v_mfma_f32_16x16x32_bf16 v[168:171], a[212:215], a[192:195], v[168:171]
    v_cvt_pk_bf16_f32 v66, v84, v85
    v_cvt_pk_bf16_f32 v67, v86, v87
    v_mfma_f32_16x16x32_bf16 v[172:175], a[212:215], a[196:199], v[172:175]
    v_mul_f32 v68, v29, v68
    s_waitcnt lgkmcnt(2)
    v_mfma_f32_16x16x32_bf16 v[116:119], a[224:227], v[196:199], v[116:119]
    v_max3_u32 v44, v44, v41, v42
    v_mul_f32 v69, v29, v69
    v_mfma_f32_16x16x32_bf16 v[120:123], a[224:227], v[200:203], v[120:123]
    v_mul_f32 v70, v29, v70
    ds_read_b64_tr_b16 a[232:233], v17 offset:8192
    v_mfma_f32_16x16x32_bf16 v[124:127], a[224:227], v[204:207], v[124:127]
    ds_read_b64_tr_b16 a[234:235], v17 offset:10240
    v_mul_f32 v71, v29, v71
    v_cvt_pk_bf16_f32 v68, v68, v69
    buffer_load_dwordx4 v7, s[40:43], s22 offen offset:1024 lds
    v_mfma_f32_16x16x32_bf16 v[128:131], a[224:227], v[208:211], v[128:131]
    buffer_store_dwordx4 v[64:67], v20, s[44:47], s62 offen offset:2048 sc1
    ds_read_b64_tr_b16 a[236:237], v18 offset:8192
    ds_read_b64_tr_b16 a[238:239], v18 offset:10240
    v_cvt_pk_bf16_f32 v69, v70, v71
    v_mfma_f32_16x16x32_bf16 v[132:135], a[224:227], v[212:215], v[132:135]
    v_mul_f32 v88, v29, v88
    s_waitcnt lgkmcnt(4)
    v_mfma_f32_16x16x32_bf16 v[156:159], a[228:231], v[196:199], v[156:159]
    v_mul_f32 v89, v29, v89
    v_mul_f32 v90, v29, v90
    v_mfma_f32_16x16x32_bf16 v[160:163], a[228:231], v[200:203], v[160:163]
    v_mul_f32 v91, v29, v91
    v_max_u32 v44, v44, v43
    v_mfma_f32_16x16x32_bf16 v[164:167], a[228:231], v[204:207], v[164:167]
    v_cvt_pk_bf16_f32 v70, v88, v89
    v_cvt_pk_bf16_f32 v71, v90, v91
    v_mfma_f32_16x16x32_bf16 v[168:171], a[228:231], v[208:211], v[168:171]
    v_mul_f32 v72, v30, v72
    v_mul_f32 v73, v30, v73
    v_mfma_f32_16x16x32_bf16 v[172:175], a[228:231], v[212:215], v[172:175]
    s_waitcnt vmcnt(17) lgkmcnt(0)
    s_barrier
    v_mfma_f32_16x16x32_bf16 v[116:119], a[232:235], v[236:239], v[116:119]
    v_mul_f32 v74, v30, v74
    v_mul_f32 v75, v30, v75
    v_mfma_f32_16x16x32_bf16 v[120:123], a[232:235], v[240:243], v[120:123]
    v_cvt_pk_bf16_f32 v72, v72, v73
    ds_read_b64_tr_b16 a[240:241], v15 offset:17408
    v_mfma_f32_16x16x32_bf16 v[124:127], a[232:235], v[244:247], v[124:127]
    buffer_store_dwordx4 v[68:71], v20, s[44:47], s62 offen offset:3072 sc1
    s_add_u32 s62, s62, 20480
    ds_read_b64_tr_b16 a[242:243], v15 offset:19456
    v_cvt_pk_bf16_f32 v73, v74, v75
    buffer_load_dwordx4 v8, s[40:43], s22 offen offset:2048 lds
    v_mfma_f32_16x16x32_bf16 v[128:131], a[232:235], v[248:251], v[128:131]
    v_min3_u32 v45, v36, v37, v38
    v_mul_f32 v92, v30, v92
    v_mul_f32 v93, v30, v93
    v_mul_f32 v94, v30, v94
    v_mul_f32 v95, v30, v95
    v_cvt_pk_bf16_f32 v74, v92, v93
    v_cvt_pk_bf16_f32 v75, v94, v95
    v_mul_f32 v116, v26, v116
    v_mfma_f32_16x16x32_bf16 v[132:135], a[232:235], v[252:255], v[132:135]
    v_mul_f32 v117, v26, v117
    v_mul_f32 v118, v26, v118
    v_mfma_f32_16x16x32_bf16 v[156:159], a[236:239], v[236:239], v[156:159]
    v_mul_f32 v119, v26, v119
    ds_read_b64_tr_b16 a[244:245], v16 offset:17408
    v_mfma_f32_16x16x32_bf16 v[160:163], a[236:239], v[240:243], v[160:163]
    ds_read_b64_tr_b16 a[246:247], v16 offset:19456
    v_cvt_pk_bf16_f32 v116, v116, v117
    v_mfma_f32_16x16x32_bf16 v[164:167], a[236:239], v[244:247], v[164:167]
    v_cvt_pk_bf16_f32 v117, v118, v119
    v_min3_u32 v45, v45, v39, v40
    v_mfma_f32_16x16x32_bf16 v[168:171], a[236:239], v[248:251], v[168:171]
    v_mul_f32 v156, v26, v156
    v_mul_f32 v157, v26, v157
    v_mfma_f32_16x16x32_bf16 v[172:175], a[236:239], v[252:255], v[172:175]
    v_mul_f32 v158, v26, v158
    s_waitcnt lgkmcnt(2)
    v_mfma_f32_16x16x32_bf16 v[56:59], a[240:243], v[96:99], 0
    ds_read_b64_tr_b16 a[248:249], v17 offset:17408
    ds_read_b64_tr_b16 a[250:251], v17 offset:19456
    v_mfma_f32_16x16x32_bf16 v[60:63], a[240:243], v[100:103], 0
    buffer_store_dwordx4 v[72:75], v20, s[44:47], s63 offen sc1
    s_add_u32 s63, s63, 20480
    v_mfma_f32_16x16x32_bf16 v[64:67], a[240:243], v[104:107], 0
    v_mul_f32 v159, v26, v159
    buffer_load_dwordx4 v9, s[40:43], s22 offen offset:3072 lds
    v_mfma_f32_16x16x32_bf16 v[68:71], a[240:243], v[108:111], 0
    v_cvt_pk_bf16_f32 v118, v156, v157
    v_cvt_pk_bf16_f32 v119, v158, v159
    v_mfma_f32_16x16x32_bf16 v[72:75], a[240:243], v[112:115], 0
    v_mul_f32 v120, v27, v120
    s_waitcnt lgkmcnt(2)
    v_mfma_f32_16x16x32_bf16 v[76:79], a[244:247], v[96:99], 0
    v_min3_u32 v45, v45, v41, v42
    v_mul_f32 v121, v27, v121
    v_mfma_f32_16x16x32_bf16 v[80:83], a[244:247], v[100:103], 0
    ds_read_b64_tr_b16 a[252:253], v18 offset:17408
    ds_read_b64_tr_b16 a[254:255], v18 offset:19456
    v_mfma_f32_16x16x32_bf16 v[84:87], a[244:247], v[104:107], 0
    v_mul_f32 v122, v27, v122
    v_mul_f32 v123, v27, v123
    v_mfma_f32_16x16x32_bf16 v[88:91], a[244:247], v[108:111], 0
    buffer_store_dwordx4 v[116:119], v20, s[44:47], s62 offen sc1
    v_cvt_pk_bf16_f32 v120, v120, v121
    v_mfma_f32_16x16x32_bf16 v[92:95], a[244:247], v[112:115], 0
    v_cvt_pk_bf16_f32 v121, v122, v123
    s_waitcnt lgkmcnt(2)
    v_mfma_f32_16x16x32_bf16 v[56:59], a[248:251], a[160:163], v[56:59]
    v_mul_f32 v160, v27, v160
    ds_read_b64_tr_b16 a[216:217], v15 offset:25600
    v_mfma_f32_16x16x32_bf16 v[60:63], a[248:251], a[164:167], v[60:63]
    ds_read_b64_tr_b16 a[218:219], v15 offset:27648
    v_mul_f32 v161, v27, v161
    v_mfma_f32_16x16x32_bf16 v[64:67], a[248:251], a[168:171], v[64:67]
    s_add_u32 m0, s60, 121856
    s_add_u32 s22, s93, 114688
    buffer_load_dwordx4 v6, s[40:43], s22 offen lds
    v_mfma_f32_16x16x32_bf16 v[68:71], a[248:251], a[172:175], v[68:71]
    v_min_u32 v45, v45, v43
    v_mul_f32 v162, v27, v162
    v_mfma_f32_16x16x32_bf16 v[72:75], a[248:251], a[176:179], v[72:75]
    v_mul_f32 v163, v27, v163
    s_waitcnt lgkmcnt(2)
    v_mfma_f32_16x16x32_bf16 v[76:79], a[252:255], a[160:163], v[76:79]
    v_cvt_pk_bf16_f32 v122, v160, v161
    v_cvt_pk_bf16_f32 v123, v162, v163
    v_mfma_f32_16x16x32_bf16 v[80:83], a[252:255], a[164:167], v[80:83]
    ds_read_b64_tr_b16 a[220:221], v16 offset:25600
    ds_read_b64_tr_b16 a[222:223], v16 offset:27648
    v_mfma_f32_16x16x32_bf16 v[84:87], a[252:255], a[168:171], v[84:87]
    v_mul_f32 v124, v28, v124
    v_mul_f32 v125, v28, v125
    v_mfma_f32_16x16x32_bf16 v[88:91], a[252:255], a[172:175], v[88:91]
    v_subrev_u32 v44, 0x33800000, v44
    v_mul_f32 v126, v28, v126
    v_mfma_f32_16x16x32_bf16 v[92:95], a[252:255], a[176:179], v[92:95]
    v_mul_f32 v127, v28, v127
    s_waitcnt lgkmcnt(2)
    v_mfma_f32_16x16x32_bf16 v[56:59], a[216:219], v[136:139], v[56:59]
    v_cvt_pk_bf16_f32 v124, v124, v125
    ds_read_b64_tr_b16 a[200:201], v17 offset:25600
    v_mfma_f32_16x16x32_bf16 v[60:63], a[216:219], v[140:143], v[60:63]
    buffer_store_dwordx4 v[120:123], v20, s[44:47], s62 offen offset:1024 sc1
    ds_read_b64_tr_b16 a[202:203], v17 offset:27648
    v_mfma_f32_16x16x32_bf16 v[64:67], a[216:219], v[144:147], v[64:67]
    buffer_load_dwordx4 v7, s[40:43], s22 offen offset:1024 lds
    ds_read_b64_tr_b16 a[204:205], v18 offset:25600
    v_mfma_f32_16x16x32_bf16 v[68:71], a[216:219], v[148:151], v[68:71]
    ds_read_b64_tr_b16 a[206:207], v18 offset:27648
    v_cvt_pk_bf16_f32 v125, v126, v127
    v_mfma_f32_16x16x32_bf16 v[72:75], a[216:219], v[152:155], v[72:75]
    v_mul_f32 v164, v28, v164
    s_waitcnt lgkmcnt(4)
    v_mfma_f32_16x16x32_bf16 v[76:79], a[220:223], v[136:139], v[76:79]
    v_mul_f32 v165, v28, v165
    v_subrev_u32 v45, 0x33800000, v45
    v_mfma_f32_16x16x32_bf16 v[80:83], a[220:223], v[140:143], v[80:83]
    v_mul_f32 v166, v28, v166
    v_mul_f32 v167, v28, v167
    v_mfma_f32_16x16x32_bf16 v[84:87], a[220:223], v[144:147], v[84:87]
    v_cvt_pk_bf16_f32 v126, v164, v165
    v_cvt_pk_bf16_f32 v127, v166, v167
    v_mfma_f32_16x16x32_bf16 v[88:91], a[220:223], v[148:151], v[88:91]
    v_mul_f32 v128, v29, v128
    v_mul_f32 v129, v29, v129
    v_mfma_f32_16x16x32_bf16 v[92:95], a[220:223], v[152:155], v[92:95]
    s_waitcnt vmcnt(21) lgkmcnt(0)
    s_barrier
    v_mfma_f32_16x16x32_bf16 v[56:59], a[200:203], a[180:183], v[56:59]
    ds_read_b64_tr_b16 a[208:209], v15 offset:34816
    ds_read_b64_tr_b16 a[210:211], v15 offset:36864
    v_mfma_f32_16x16x32_bf16 v[60:63], a[200:203], a[184:187], v[60:63]
    v_max_u32 v44, v44, v45
    v_mul_f32 v130, v29, v130
    v_mfma_f32_16x16x32_bf16 v[64:67], a[200:203], a[188:191], v[64:67]
    buffer_load_dwordx4 v8, s[40:43], s22 offen offset:2048 lds
    v_mul_f32 v131, v29, v131
    v_mfma_f32_16x16x32_bf16 v[68:71], a[200:203], a[192:195], v[68:71]
    v_cvt_pk_bf16_f32 v128, v128, v129
    v_cvt_pk_bf16_f32 v129, v130, v131
    v_mfma_f32_16x16x32_bf16 v[72:75], a[200:203], a[196:199], v[72:75]
    v_mul_f32 v168, v29, v168
    ds_read_b64_tr_b16 a[212:213], v16 offset:34816
    v_mfma_f32_16x16x32_bf16 v[76:79], a[204:207], a[180:183], v[76:79]
    buffer_store_dwordx4 v[124:127], v20, s[44:47], s62 offen offset:2048 sc1
    ds_read_b64_tr_b16 a[214:215], v16 offset:36864
    v_mfma_f32_16x16x32_bf16 v[80:83], a[204:207], a[184:187], v[80:83]
    v_mul_f32 v169, v29, v169
    v_mul_f32 v170, v29, v170
    v_mfma_f32_16x16x32_bf16 v[84:87], a[204:207], a[188:191], v[84:87]
    v_cmp_lt_u32 vcc, 0x18000000, v44
    s_cbranch_vccnz L_fb
    v_mfma_f32_16x16x32_bf16 v[88:91], a[204:207], a[192:195], v[88:91]
    v_mul_f32 v171, v29, v171
    v_cvt_pk_bf16_f32 v130, v168, v169
    v_mfma_f32_16x16x32_bf16 v[92:95], a[204:207], a[196:199], v[92:95]
    v_cvt_pk_bf16_f32 v131, v170, v171
    s_waitcnt lgkmcnt(2)
    v_mfma_f32_16x16x32_bf16 v[56:59], a[208:211], v[176:179], v[56:59]
    ds_read_b64_tr_b16 a[224:225], v17 offset:34816
    ds_read_b64_tr_b16 a[226:227], v17 offset:36864
    v_mfma_f32_16x16x32_bf16 v[60:63], a[208:211], v[180:183], v[60:63]
    v_mul_f32 v132, v30, v132
    buffer_load_dwordx4 v9, s[40:43], s22 offen offset:3072 lds
    v_mfma_f32_16x16x32_bf16 v[64:67], a[208:211], v[184:187], v[64:67]
    v_mul_f32 v133, v30, v133
    v_mul_f32 v134, v30, v134
    v_mfma_f32_16x16x32_bf16 v[68:71], a[208:211], v[188:191], v[68:71]
    v_mul_f32 v135, v30, v135
    v_cvt_pk_bf16_f32 v132, v132, v133
    v_mfma_f32_16x16x32_bf16 v[72:75], a[208:211], v[192:195], v[72:75]
    ds_read_b64_tr_b16 a[228:229], v18 offset:34816
    s_waitcnt lgkmcnt(3)
    v_mfma_f32_16x16x32_bf16 v[76:79], a[212:215], v[176:179], v[76:79]
    ds_read_b64_tr_b16 a[230:231], v18 offset:36864
    v_cvt_pk_bf16_f32 v133, v134, v135
    v_mfma_f32_16x16x32_bf16 v[80:83], a[212:215], v[180:183], v[80:83]
    v_mul_f32 v172, v30, v172
    v_mul_f32 v173, v30, v173
    v_mfma_f32_16x16x32_bf16 v[84:87], a[212:215], v[184:187], v[84:87]
    v_mul_f32 v174, v30, v174
    v_mul_f32 v175, v30, v175
    v_mfma_f32_16x16x32_bf16 v[88:91], a[212:215], v[188:191], v[88:91]
    buffer_store_dwordx4 v[128:131], v20, s[44:47], s62 offen offset:3072 sc1
    s_add_u32 s62, s62, 20480
    v_mfma_f32_16x16x32_bf16 v[92:95], a[212:215], v[192:195], v[92:95]
    ds_read_b64_tr_b16 a[232:233], v15 offset:43008
    s_waitcnt lgkmcnt(3)
    v_mfma_f32_16x16x32_bf16 v[56:59], a[224:227], v[196:199], v[56:59]
    ds_read_b64_tr_b16 a[234:235], v15 offset:45056
    v_cvt_pk_bf16_f32 v134, v172, v173
    v_mfma_f32_16x16x32_bf16 v[60:63], a[224:227], v[200:203], v[60:63]
    v_cvt_pk_bf16_f32 v135, v174, v175
    ds_read_b64_tr_b16 a[236:237], v16 offset:43008
    v_mfma_f32_16x16x32_bf16 v[64:67], a[224:227], v[204:207], v[64:67]
    s_add_u32 m0, s60, 143360
    s_add_u32 s22, s94, 0
    buffer_load_dwordx4 v6, s[40:43], s22 offen lds
    v_mfma_f32_16x16x32_bf16 v[68:71], a[224:227], v[208:211], v[68:71]
    ds_read_b64_tr_b16 a[238:239], v16 offset:45056
    s_waitcnt vmcnt(10)
    v_mov_b32 v25, 1
    buffer_atomic_umax v25, v3, s[52:55], 0 offen sc1
    v_mfma_f32_16x16x32_bf16 v[72:75], a[224:227], v[212:215], v[72:75]
    ds_read_b64_tr_b16 a[240:241], v17 offset:43008
    s_waitcnt lgkmcnt(5)
    v_mfma_f32_16x16x32_bf16 v[76:79], a[228:231], v[196:199], v[76:79]
    ds_read_b64_tr_b16 a[242:243], v17 offset:45056
    ds_read_b64_tr_b16 a[244:245], v18 offset:43008
    v_mfma_f32_16x16x32_bf16 v[80:83], a[228:231], v[200:203], v[80:83]
    ds_read_b64_tr_b16 a[246:247], v18 offset:45056
    v_mfma_f32_16x16x32_bf16 v[84:87], a[228:231], v[204:207], v[84:87]
    v_mfma_f32_16x16x32_bf16 v[88:91], a[228:231], v[208:211], v[88:91]
    v_mfma_f32_16x16x32_bf16 v[92:95], a[228:231], v[212:215], v[92:95]
    buffer_load_dwordx4 v7, s[40:43], s22 offen offset:1024 lds
    s_waitcnt lgkmcnt(6)
    v_mfma_f32_16x16x32_bf16 v[56:59], a[232:235], v[216:219], v[56:59]
    v_mfma_f32_16x16x32_bf16 v[60:63], a[232:235], v[220:223], v[60:63]
    v_mfma_f32_16x16x32_bf16 v[64:67], a[232:235], v[224:227], v[64:67]
    buffer_store_dwordx4 v[132:135], v20, s[44:47], s63 offen sc1
    s_add_u32 s63, s63, 20480
    v_mfma_f32_16x16x32_bf16 v[68:71], a[232:235], v[228:231], v[68:71]
    v_mfma_f32_16x16x32_bf16 v[72:75], a[232:235], v[232:235], v[72:75]
    s_waitcnt lgkmcnt(4)
    v_mfma_f32_16x16x32_bf16 v[76:79], a[236:239], v[216:219], v[76:79]
    v_mfma_f32_16x16x32_bf16 v[80:83], a[236:239], v[220:223], v[80:83]
    v_mfma_f32_16x16x32_bf16 v[84:87], a[236:239], v[224:227], v[84:87]
    v_mfma_f32_16x16x32_bf16 v[88:91], a[236:239], v[228:231], v[88:91]
    v_mfma_f32_16x16x32_bf16 v[92:95], a[236:239], v[232:235], v[92:95]
    s_waitcnt lgkmcnt(0)
    s_barrier
    v_mfma_f32_16x16x32_bf16 v[56:59], a[240:243], v[236:239], v[56:59]
    ds_read_b64_tr_b16 a[248:249], v15 offset:52224
    ds_read_b64_tr_b16 a[250:251], v15 offset:54272
    v_mfma_f32_16x16x32_bf16 v[60:63], a[240:243], v[240:243], v[60:63]
    buffer_load_dwordx4 v8, s[40:43], s22 offen offset:2048 lds
    ds_read_b64_tr_b16 a[252:253], v16 offset:52224
    v_mfma_f32_16x16x32_bf16 v[64:67], a[240:243], v[244:247], v[64:67]
    ds_read_b64_tr_b16 a[254:255], v16 offset:54272
    ds_read_b64_tr_b16 a[216:217], v17 offset:52224
    v_mfma_f32_16x16x32_bf16 v[68:71], a[240:243], v[248:251], v[68:71]
    v_mul_f32 v56, v26, v56
    v_mul_f32 v57, v26, v57
    v_mfma_f32_16x16x32_bf16 v[72:75], a[240:243], v[252:255], v[72:75]
    v_mul_f32 v58, v26, v58
    v_mul_f32 v59, v26, v59
    v_mfma_f32_16x16x32_bf16 v[76:79], a[244:247], v[236:239], v[76:79]
    v_cvt_pk_bf16_f32 v56, v56, v57
    v_cvt_pk_bf16_f32 v57, v58, v59
    v_mfma_f32_16x16x32_bf16 v[80:83], a[244:247], v[240:243], v[80:83]
    ds_read_b64_tr_b16 a[218:219], v17 offset:54272
    ds_read_b64_tr_b16 a[220:221], v18 offset:52224
    v_mfma_f32_16x16x32_bf16 v[84:87], a[244:247], v[244:247], v[84:87]
    ds_read_b64_tr_b16 a[222:223], v18 offset:54272
    ds_read_b64_tr_b16 a[200:201], v15 offset:60416
    v_mfma_f32_16x16x32_bf16 v[88:91], a[244:247], v[248:251], v[88:91]
    v_mul_f32 v76, v26, v76
    v_mul_f32 v77, v26, v77
    v_mfma_f32_16x16x32_bf16 v[92:95], a[244:247], v[252:255], v[92:95]
    v_mul_f32 v78, v26, v78
    s_waitcnt lgkmcnt(7)
    v_mfma_f32_16x16x32_bf16 v[116:119], a[248:251], v[96:99], 0
    v_mul_f32 v79, v26, v79
    buffer_load_dwordx4 v9, s[40:43], s22 offen offset:3072 lds
    v_mfma_f32_16x16x32_bf16 v[120:123], a[248:251], v[100:103], 0
    v_cvt_pk_bf16_f32 v58, v76, v77
    v_cvt_pk_bf16_f32 v59, v78, v79
    v_mfma_f32_16x16x32_bf16 v[124:127], a[248:251], v[104:107], 0
    v_mul_f32 v60, v27, v60
    v_mul_f32 v61, v27, v61
    v_mfma_f32_16x16x32_bf16 v[128:131], a[248:251], v[108:111], 0
    v_mul_f32 v62, v27, v62
    v_mul_f32 v63, v27, v63
    v_mfma_f32_16x16x32_bf16 v[132:135], a[248:251], v[112:115], 0
    buffer_store_dwordx4 v[56:59], v20, s[44:47], s62 offen sc1
    s_waitcnt lgkmcnt(5)
    v_mfma_f32_16x16x32_bf16 v[156:159], a[252:255], v[96:99], 0
    v_cvt_pk_bf16_f32 v60, v60, v61
    v_cvt_pk_bf16_f32 v61, v62, v63
    v_mfma_f32_16x16x32_bf16 v[160:163], a[252:255], v[100:103], 0
    v_mul_f32 v80, v27, v80
    ds_read_b64_tr_b16 a[202:203], v15 offset:62464
    v_mfma_f32_16x16x32_bf16 v[164:167], a[252:255], v[104:107], 0
    v_mul_f32 v81, v27, v81
    v_mul_f32 v82, v27, v82
    v_mfma_f32_16x16x32_bf16 v[168:171], a[252:255], v[108:111], 0
    v_mul_f32 v83, v27, v83
    v_cvt_pk_bf16_f32 v62, v80, v81
    v_mfma_f32_16x16x32_bf16 v[172:175], a[252:255], v[112:115], 0
    s_add_u32 m0, s60, 0
    s_add_u32 s22, s94, 114688
    buffer_load_dwordx4 v6, s[40:43], s22 offen lds
    s_waitcnt lgkmcnt(4)
    v_mfma_f32_16x16x32_bf16 v[116:119], a[216:219], a[160:163], v[116:119]
    v_cvt_pk_bf16_f32 v63, v82, v83
    ds_read_b64_tr_b16 a[204:205], v16 offset:60416
    v_mfma_f32_16x16x32_bf16 v[120:123], a[216:219], a[164:167], v[120:123]
    ds_read_b64_tr_b16 a[206:207], v16 offset:62464
    v_mul_f32 v64, v28, v64
    v_mfma_f32_16x16x32_bf16 v[124:127], a[216:219], a[168:171], v[124:127]
    v_mul_f32 v65, v28, v65
    v_mul_f32 v66, v28, v66
    v_mfma_f32_16x16x32_bf16 v[128:131], a[216:219], a[172:175], v[128:131]
    v_mul_f32 v67, v28, v67
    v_cvt_pk_bf16_f32 v64, v64, v65
    v_mfma_f32_16x16x32_bf16 v[132:135], a[216:219], a[176:179], v[132:135]
    ds_read_b64_tr_b16 a[208:209], v17 offset:60416
    s_waitcnt lgkmcnt(5)
    v_mfma_f32_16x16x32_bf16 v[156:159], a[220:223], a[160:163], v[156:159]
    ds_read_b64_tr_b16 a[210:211], v17 offset:62464
    v_cvt_pk_bf16_f32 v65, v66, v67
    v_mfma_f32_16x16x32_bf16 v[160:163], a[220:223], a[164:167], v[160:163]
    v_mul_f32 v84, v28, v84
    v_mul_f32 v85, v28, v85
    v_mfma_f32_16x16x32_bf16 v[164:167], a[220:223], a[168:171], v[164:167]
    buffer_store_dwordx4 v[60:63], v20, s[44:47], s62 offen offset:1024 sc1
    v_mul_f32 v86, v28, v86
    v_mfma_f32_16x16x32_bf16 v[168:171], a[220:223], a[172:175], v[168:171]
    ds_read_b64_tr_b16 a[212:213], v18 offset:60416
    ds_read_b64_tr_b16 a[214:215], v18 offset:62464
    v_mfma_f32_16x16x32_bf16 v[172:175], a[220:223], a[176:179], v[172:175]
    v_mul_f32 v87, v28, v87
    s_waitcnt lgkmcnt(6)
    v_mfma_f32_16x16x32_bf16 v[116:119], a[200:203], v[136:139], v[116:119]
    v_cvt_pk_bf16_f32 v66, v84, v85
    v_cvt_pk_bf16_f32 v67, v86, v87
    v_mfma_f32_16x16x32_bf16 v[120:123], a[200:203], v[140:143], v[120:123]
    buffer_load_dwordx4 v7, s[40:43], s22 offen offset:1024 lds
    v_mul_f32 v68, v29, v68
    v_mfma_f32_16x16x32_bf16 v[124:127], a[200:203], v[144:147], v[124:127]
    v_mul_f32 v69, v29, v69
    v_add_u32 v15, 0x11000, v15
    ds_read_b64_tr_b16 a[224:225], v15
    v_mfma_f32_16x16x32_bf16 v[128:131], a[200:203], v[148:151], v[128:131]
    ds_read_b64_tr_b16 a[226:227], v15 offset:2048
    v_mul_f32 v70, v29, v70
    v_mfma_f32_16x16x32_bf16 v[132:135], a[200:203], v[152:155], v[132:135]
    v_mul_f32 v71, v29, v71
    s_waitcnt lgkmcnt(6)
    v_mfma_f32_16x16x32_bf16 v[156:159], a[204:207], v[136:139], v[156:159]
    v_cvt_pk_bf16_f32 v68, v68, v69
    v_cvt_pk_bf16_f32 v69, v70, v71
    v_mfma_f32_16x16x32_bf16 v[160:163], a[204:207], v[140:143], v[160:163]
    v_mul_f32 v88, v29, v88
    v_add_u32 v16, 0x11000, v16
    ds_read_b64_tr_b16 a[228:229], v16
    v_mfma_f32_16x16x32_bf16 v[164:167], a[204:207], v[144:147], v[164:167]
    ds_read_b64_tr_b16 a[230:231], v16 offset:2048
    v_mul_f32 v89, v29, v89
    v_mfma_f32_16x16x32_bf16 v[168:171], a[204:207], v[148:151], v[168:171]
    v_mul_f32 v90, v29, v90
    v_mul_f32 v91, v29, v91
    v_mfma_f32_16x16x32_bf16 v[172:175], a[204:207], v[152:155], v[172:175]
    buffer_load_dwordx4 v8, s[40:43], s22 offen offset:2048 lds
    s_waitcnt lgkmcnt(6)
    v_mfma_f32_16x16x32_bf16 v[116:119], a[208:211], a[180:183], v[116:119]
    v_cvt_pk_bf16_f32 v70, v88, v89
    v_cvt_pk_bf16_f32 v71, v90, v91
    v_mfma_f32_16x16x32_bf16 v[120:123], a[208:211], a[184:187], v[120:123]
    v_add_u32 v17, 0x11000, v17
    ds_read_b64_tr_b16 a[232:233], v17
    v_mfma_f32_16x16x32_bf16 v[124:127], a[208:211], a[188:191], v[124:127]
    buffer_store_dwordx4 v[64:67], v20, s[44:47], s62 offen offset:2048 sc1
    ds_read_b64_tr_b16 a[234:235], v17 offset:2048
    v_mfma_f32_16x16x32_bf16 v[128:131], a[208:211], a[192:195], v[128:131]
    v_mul_f32 v72, v30, v72
    v_mul_f32 v73, v30, v73
    v_mfma_f32_16x16x32_bf16 v[132:135], a[208:211], a[196:199], v[132:135]
    v_mul_f32 v74, v30, v74
    s_waitcnt lgkmcnt(6)
    v_mfma_f32_16x16x32_bf16 v[156:159], a[212:215], a[180:183], v[156:159]
    v_mul_f32 v75, v30, v75
    v_cvt_pk_bf16_f32 v72, v72, v73
    v_mfma_f32_16x16x32_bf16 v[160:163], a[212:215], a[184:187], v[160:163]
    v_add_u32 v18, 0x11000, v18
    ds_read_b64_tr_b16 a[236:237], v18
    v_mfma_f32_16x16x32_bf16 v[164:167], a[212:215], a[188:191], v[164:167]
    ds_read_b64_tr_b16 a[238:239], v18 offset:2048
    v_cvt_pk_bf16_f32 v73, v74, v75
    v_mfma_f32_16x16x32_bf16 v[168:171], a[212:215], a[192:195], v[168:171]
    v_mul_f32 v92, v30, v92
    v_mul_f32 v93, v30, v93
    v_mfma_f32_16x16x32_bf16 v[172:175], a[212:215], a[196:199], v[172:175]
    buffer_load_dwordx4 v9, s[40:43], s22 offen offset:3072 lds
    s_waitcnt lgkmcnt(6)
    v_mfma_f32_16x16x32_bf16 v[116:119], a[224:227], v[176:179], v[116:119]
    v_mul_f32 v94, v30, v94
    v_mul_f32 v95, v30, v95
    v_mfma_f32_16x16x32_bf16 v[120:123], a[224:227], v[180:183], v[120:123]
    ds_read_b64_tr_b16 a[240:241], v15 offset:8192
    ds_read_b64_tr_b16 a[242:243], v15 offset:10240
    v_mfma_f32_16x16x32_bf16 v[124:127], a[224:227], v[184:187], v[124:127]
    v_cvt_pk_bf16_f32 v74, v92, v93
    v_cvt_pk_bf16_f32 v75, v94, v95
    v_mfma_f32_16x16x32_bf16 v[128:131], a[224:227], v[188:191], v[128:131]
    ds_read_b64_tr_b16 a[244:245], v16 offset:8192
    ds_read_b64_tr_b16 a[246:247], v16 offset:10240
    v_mfma_f32_16x16x32_bf16 v[132:135], a[224:227], v[192:195], v[132:135]
    s_waitcnt lgkmcnt(8)
    v_mfma_f32_16x16x32_bf16 v[156:159], a[228:231], v[176:179], v[156:159]
    v_mfma_f32_16x16x32_bf16 v[160:163], a[228:231], v[180:183], v[160:163]
    v_mfma_f32_16x16x32_bf16 v[164:167], a[228:231], v[184:187], v[164:167]
    buffer_store_dwordx4 v[68:71], v20, s[44:47], s62 offen offset:3072 sc1
    s_add_u32 s62, s62, 20480
    v_mfma_f32_16x16x32_bf16 v[168:171], a[228:231], v[188:191], v[168:171]
    ds_read_b64_tr_b16 a[248:249], v17 offset:8192
    ds_read_b64_tr_b16 a[250:251], v17 offset:10240
    v_mfma_f32_16x16x32_bf16 v[172:175], a[228:231], v[192:195], v[172:175]
    s_waitcnt lgkmcnt(8)
    v_mfma_f32_16x16x32_bf16 v[116:119], a[232:235], v[196:199], v[116:119]
    v_mfma_f32_16x16x32_bf16 v[120:123], a[232:235], v[200:203], v[120:123]
    s_add_u32 m0, s60, 104448
    s_add_u32 s22, s95, 0
    buffer_load_dwordx4 v6, s[40:43], s22 offen lds
    v_mfma_f32_16x16x32_bf16 v[124:127], a[232:235], v[204:207], v[124:127]
    s_waitcnt vmcnt(11)
    v_mov_b32 v25, 2
    buffer_atomic_umax v25, v3, s[52:55], 0 offen sc1
    v_mfma_f32_16x16x32_bf16 v[128:131], a[232:235], v[208:211], v[128:131]
    v_mov_b32 v24, 0
    buffer_atomic_or v24, v2, s[52:55], 0 offen sc0 sc1
    v_mfma_f32_16x16x32_bf16 v[132:135], a[232:235], v[212:215], v[132:135]
    ds_read_b64_tr_b16 a[252:253], v18 offset:8192
    s_waitcnt lgkmcnt(7)
    v_mfma_f32_16x16x32_bf16 v[156:159], a[236:239], v[196:199], v[156:159]
    ds_read_b64_tr_b16 a[254:255], v18 offset:10240
    v_mfma_f32_16x16x32_bf16 v[160:163], a[236:239], v[200:203], v[160:163]
    v_mfma_f32_16x16x32_bf16 v[164:167], a[236:239], v[204:207], v[164:167]
    v_mfma_f32_16x16x32_bf16 v[168:171], a[236:239], v[208:211], v[168:171]
    v_mfma_f32_16x16x32_bf16 v[172:175], a[236:239], v[212:215], v[172:175]
    buffer_load_dwordx4 v7, s[40:43], s22 offen offset:1024 lds
    s_waitcnt lgkmcnt(6)
    v_mfma_f32_16x16x32_bf16 v[116:119], a[240:243], v[216:219], v[116:119]
    v_mfma_f32_16x16x32_bf16 v[120:123], a[240:243], v[220:223], v[120:123]
    v_mfma_f32_16x16x32_bf16 v[124:127], a[240:243], v[224:227], v[124:127]
    buffer_store_dwordx4 v[72:75], v20, s[44:47], s63 offen sc1
    s_add_u32 s63, s63, 20480
    v_mfma_f32_16x16x32_bf16 v[128:131], a[240:243], v[228:231], v[128:131]
    v_mfma_f32_16x16x32_bf16 v[132:135], a[240:243], v[232:235], v[132:135]
    s_waitcnt lgkmcnt(4)
    v_mfma_f32_16x16x32_bf16 v[156:159], a[244:247], v[216:219], v[156:159]
    v_mfma_f32_16x16x32_bf16 v[160:163], a[244:247], v[220:223], v[160:163]
    v_mfma_f32_16x16x32_bf16 v[164:167], a[244:247], v[224:227], v[164:167]
    v_mfma_f32_16x16x32_bf16 v[168:171], a[244:247], v[228:231], v[168:171]
    v_mfma_f32_16x16x32_bf16 v[172:175], a[244:247], v[232:235], v[172:175]
    s_waitcnt lgkmcnt(0)
    s_barrier
    v_mfma_f32_16x16x32_bf16 v[116:119], a[248:251], v[236:239], v[116:119]
    ds_read_b64_tr_b16 a[216:217], v15 offset:17408
    ds_read_b64_tr_b16 a[218:219], v15 offset:19456
    v_mfma_f32_16x16x32_bf16 v[120:123], a[248:251], v[240:243], v[120:123]
    buffer_load_dwordx4 v8, s[40:43], s22 offen offset:2048 lds
    ds_read_b64_tr_b16 a[220:221], v16 offset:17408
    v_mfma_f32_16x16x32_bf16 v[124:127], a[248:251], v[244:247], v[124:127]
    ds_read_b64_tr_b16 a[222:223], v16 offset:19456
    ds_read_b64_tr_b16 a[200:201], v17 offset:17408
    v_mfma_f32_16x16x32_bf16 v[128:131], a[248:251], v[248:251], v[128:131]
    v_mul_f32 v116, v26, v116
    v_mul_f32 v117, v26, v117
    v_mfma_f32_16x16x32_bf16 v[132:135], a[248:251], v[252:255], v[132:135]
    v_mul_f32 v118, v26, v118
    v_mul_f32 v119, v26, v119
    v_mfma_f32_16x16x32_bf16 v[156:159], a[252:255], v[236:239], v[156:159]
    v_cvt_pk_bf16_f32 v116, v116, v117
    v_cvt_pk_bf16_f32 v117, v118, v119
    v_mfma_f32_16x16x32_bf16 v[160:163], a[252:255], v[240:243], v[160:163]
    ds_read_b64_tr_b16 a[202:203], v17 offset:19456
    ds_read_b64_tr_b16 a[204:205], v18 offset:17408
    v_mfma_f32_16x16x32_bf16 v[164:167], a[252:255], v[244:247], v[164:167]
    ds_read_b64_tr_b16 a[206:207], v18 offset:19456
    ds_read_b64_tr_b16 a[208:209], v15 offset:25600
    v_mfma_f32_16x16x32_bf16 v[168:171], a[252:255], v[248:251], v[168:171]
    v_mul_f32 v156, v26, v156
    v_mul_f32 v157, v26, v157
    v_mfma_f32_16x16x32_bf16 v[172:175], a[252:255], v[252:255], v[172:175]
    v_mul_f32 v158, v26, v158
    s_waitcnt lgkmcnt(7)
    v_mfma_f32_16x16x32_bf16 v[56:59], a[216:219], v[96:99], 0
    v_mul_f32 v159, v26, v159
    buffer_load_dwordx4 v9, s[40:43], s22 offen offset:3072 lds
    v_mfma_f32_16x16x32_bf16 v[60:63], a[216:219], v[100:103], 0
    v_cvt_pk_bf16_f32 v118, v156, v157
    v_cvt_pk_bf16_f32 v119, v158, v159
    v_mfma_f32_16x16x32_bf16 v[64:67], a[216:219], v[104:107], 0
    v_mul_f32 v120, v27, v120
    v_mul_f32 v121, v27, v121
    v_mfma_f32_16x16x32_bf16 v[68:71], a[216:219], v[108:111], 0
    v_mul_f32 v122, v27, v122
    v_mul_f32 v123, v27, v123
    v_mfma_f32_16x16x32_bf16 v[72:75], a[216:219], v[112:115], 0
    buffer_store_dwordx4 v[116:119], v20, s[44:47], s62 offen sc1
    s_waitcnt lgkmcnt(5)
    v_mfma_f32_16x16x32_bf16 v[76:79], a[220:223], v[96:99], 0
    v_cvt_pk_bf16_f32 v120, v120, v121
    v_cvt_pk_bf16_f32 v121, v122, v123
    v_mfma_f32_16x16x32_bf16 v[80:83], a[220:223], v[100:103], 0
    v_mul_f32 v160, v27, v160
    ds_read_b64_tr_b16 a[210:211], v15 offset:27648
    v_mfma_f32_16x16x32_bf16 v[84:87], a[220:223], v[104:107], 0
    v_mul_f32 v161, v27, v161
    v_mul_f32 v162, v27, v162
    v_mfma_f32_16x16x32_bf16 v[88:91], a[220:223], v[108:111], 0
    v_mul_f32 v163, v27, v163
    v_cvt_pk_bf16_f32 v122, v160, v161
    v_mfma_f32_16x16x32_bf16 v[92:95], a[220:223], v[112:115], 0
    s_add_u32 m0, s60, 17408
    s_add_u32 s22, s95, 114688
    buffer_load_dwordx4 v6, s[40:43], s22 offen lds
    s_waitcnt lgkmcnt(4)
    v_mfma_f32_16x16x32_bf16 v[56:59], a[200:203], a[160:163], v[56:59]
    v_cvt_pk_bf16_f32 v123, v162, v163
    ds_read_b64_tr_b16 a[212:213], v16 offset:25600
    v_mfma_f32_16x16x32_bf16 v[60:63], a[200:203], a[164:167], v[60:63]
    ds_read_b64_tr_b16 a[214:215], v16 offset:27648
    v_mul_f32 v124, v28, v124
    v_mfma_f32_16x16x32_bf16 v[64:67], a[200:203], a[168:171], v[64:67]
    v_mul_f32 v125, v28, v125
    v_mul_f32 v126, v28, v126
    v_mfma_f32_16x16x32_bf16 v[68:71], a[200:203], a[172:175], v[68:71]
    v_mul_f32 v127, v28, v127
    v_cvt_pk_bf16_f32 v124, v124, v125
    v_mfma_f32_16x16x32_bf16 v[72:75], a[200:203], a[176:179], v[72:75]
    ds_read_b64_tr_b16 a[224:225], v17 offset:25600
    s_waitcnt lgkmcnt(5)
    v_mfma_f32_16x16x32_bf16 v[76:79], a[204:207], a[160:163], v[76:79]
    ds_read_b64_tr_b16 a[226:227], v17 offset:27648
    v_cvt_pk_bf16_f32 v125, v126, v127
    v_mfma_f32_16x16x32_bf16 v[80:83], a[204:207], a[164:167], v[80:83]
    v_mul_f32 v164, v28, v164
    v_mul_f32 v165, v28, v165
    v_mfma_f32_16x16x32_bf16 v[84:87], a[204:207], a[168:171], v[84:87]
    buffer_store_dwordx4 v[120:123], v20, s[44:47], s62 offen offset:1024 sc1
    v_mul_f32 v166, v28, v166
    v_mfma_f32_16x16x32_bf16 v[88:91], a[204:207], a[172:175], v[88:91]
    ds_read_b64_tr_b16 a[228:229], v18 offset:25600
    ds_read_b64_tr_b16 a[230:231], v18 offset:27648
    v_mfma_f32_16x16x32_bf16 v[92:95], a[204:207], a[176:179], v[92:95]
    v_mul_f32 v167, v28, v167
    s_waitcnt lgkmcnt(6)
    v_mfma_f32_16x16x32_bf16 v[56:59], a[208:211], v[136:139], v[56:59]
    v_cvt_pk_bf16_f32 v126, v164, v165
    v_cvt_pk_bf16_f32 v127, v166, v167
    v_mfma_f32_16x16x32_bf16 v[60:63], a[208:211], v[140:143], v[60:63]
    buffer_load_dwordx4 v7, s[40:43], s22 offen offset:1024 lds
    v_mul_f32 v128, v29, v128
    v_mfma_f32_16x16x32_bf16 v[64:67], a[208:211], v[144:147], v[64:67]
    v_mul_f32 v129, v29, v129
    ds_read_b64_tr_b16 a[232:233], v15 offset:52224
    v_mfma_f32_16x16x32_bf16 v[68:71], a[208:211], v[148:151], v[68:71]
    ds_read_b64_tr_b16 a[234:235], v15 offset:54272
    v_mul_f32 v130, v29, v130
    v_mfma_f32_16x16x32_bf16 v[72:75], a[208:211], v[152:155], v[72:75]
    v_mul_f32 v131, v29, v131
    s_waitcnt lgkmcnt(6)
    v_mfma_f32_16x16x32_bf16 v[76:79], a[212:215], v[136:139], v[76:79]
    v_cvt_pk_bf16_f32 v128, v128, v129
    v_cvt_pk_bf16_f32 v129, v130, v131
    v_mfma_f32_16x16x32_bf16 v[80:83], a[212:215], v[140:143], v[80:83]
    v_mul_f32 v168, v29, v168
    ds_read_b64_tr_b16 a[236:237], v16 offset:52224
    v_mfma_f32_16x16x32_bf16 v[84:87], a[212:215], v[144:147], v[84:87]
    ds_read_b64_tr_b16 a[238:239], v16 offset:54272
    v_mul_f32 v169, v29, v169
    v_mfma_f32_16x16x32_bf16 v[88:91], a[212:215], v[148:151], v[88:91]
    v_mul_f32 v170, v29, v170
    v_mul_f32 v171, v29, v171
    v_mfma_f32_16x16x32_bf16 v[92:95], a[212:215], v[152:155], v[92:95]
    buffer_load_dwordx4 v8, s[40:43], s22 offen offset:2048 lds
    s_waitcnt lgkmcnt(6)
    v_mfma_f32_16x16x32_bf16 v[56:59], a[224:227], a[180:183], v[56:59]
    v_cvt_pk_bf16_f32 v130, v168, v169
    v_cvt_pk_bf16_f32 v131, v170, v171
    v_mfma_f32_16x16x32_bf16 v[60:63], a[224:227], a[184:187], v[60:63]
    ds_read_b64_tr_b16 a[240:241], v17 offset:52224
    ds_read_b64_tr_b16 a[242:243], v17 offset:54272
    v_mfma_f32_16x16x32_bf16 v[64:67], a[224:227], a[188:191], v[64:67]
    buffer_store_dwordx4 v[124:127], v20, s[44:47], s62 offen offset:2048 sc1
    v_mul_f32 v132, v30, v132
    v_mfma_f32_16x16x32_bf16 v[68:71], a[224:227], a[192:195], v[68:71]
    v_mul_f32 v133, v30, v133
    v_mul_f32 v134, v30, v134
    v_mfma_f32_16x16x32_bf16 v[72:75], a[224:227], a[196:199], v[72:75]
    v_mul_f32 v135, v30, v135
    s_waitcnt lgkmcnt(6)
    v_mfma_f32_16x16x32_bf16 v[76:79], a[228:231], a[180:183], v[76:79]
    v_cvt_pk_bf16_f32 v132, v132, v133
    ds_read_b64_tr_b16 a[244:245], v18 offset:52224
    v_mfma_f32_16x16x32_bf16 v[80:83], a[228:231], a[184:187], v[80:83]
    ds_read_b64_tr_b16 a[246:247], v18 offset:54272
    v_cvt_pk_bf16_f32 v133, v134, v135
    v_mfma_f32_16x16x32_bf16 v[84:87], a[228:231], a[188:191], v[84:87]
    v_mul_f32 v172, v30, v172
    v_mul_f32 v173, v30, v173
    v_mfma_f32_16x16x32_bf16 v[88:91], a[228:231], a[192:195], v[88:91]
    v_mul_f32 v174, v30, v174
    v_mul_f32 v175, v30, v175
    v_mfma_f32_16x16x32_bf16 v[92:95], a[228:231], a[196:199], v[92:95]
    buffer_load_dwordx4 v9, s[40:43], s22 offen offset:3072 lds
    s_waitcnt lgkmcnt(6)
    v_mfma_f32_16x16x32_bf16 v[56:59], a[232:235], v[176:179], v[56:59]
    ds_read_b64_tr_b16 a[248:249], v15 offset:60416
    ds_read_b64_tr_b16 a[250:251], v15 offset:62464
    v_mfma_f32_16x16x32_bf16 v[60:63], a[232:235], v[180:183], v[60:63]
    v_cvt_pk_bf16_f32 v134, v172, v173
    v_cvt_pk_bf16_f32 v135, v174, v175
    v_mfma_f32_16x16x32_bf16 v[64:67], a[232:235], v[184:187], v[64:67]
    ds_read_b64_tr_b16 a[252:253], v16 offset:60416
    ds_read_b64_tr_b16 a[254:255], v16 offset:62464
    v_mfma_f32_16x16x32_bf16 v[68:71], a[232:235], v[188:191], v[68:71]
    v_mfma_f32_16x16x32_bf16 v[72:75], a[232:235], v[192:195], v[72:75]
    s_waitcnt lgkmcnt(8)
    v_mfma_f32_16x16x32_bf16 v[76:79], a[236:239], v[176:179], v[76:79]
    v_mfma_f32_16x16x32_bf16 v[80:83], a[236:239], v[180:183], v[80:83]
    v_mfma_f32_16x16x32_bf16 v[84:87], a[236:239], v[184:187], v[84:87]
    buffer_store_dwordx4 v[128:131], v20, s[44:47], s62 offen offset:3072 sc1
    s_add_u32 s62, s62, 20480
    v_mfma_f32_16x16x32_bf16 v[88:91], a[236:239], v[188:191], v[88:91]
    ds_read_b64_tr_b16 a[216:217], v17 offset:60416
    ds_read_b64_tr_b16 a[218:219], v17 offset:62464
    v_mfma_f32_16x16x32_bf16 v[92:95], a[236:239], v[192:195], v[92:95]
    s_waitcnt lgkmcnt(8)
    v_mfma_f32_16x16x32_bf16 v[56:59], a[240:243], v[196:199], v[56:59]
    v_mfma_f32_16x16x32_bf16 v[60:63], a[240:243], v[200:203], v[60:63]
    s_waitcnt vmcnt(10)
    v_mov_b32 v25, 3
    buffer_atomic_umax v25, v3, s[52:55], 0 offen sc1
    v_mfma_f32_16x16x32_bf16 v[64:67], a[240:243], v[204:207], v[64:67]
    v_cmp_gt_u32 vcc, 1, v24
    s_and_b32 s3, vcc_lo, 0xffff
    s_cselect_b32 s84, 0x1000000, 0
    v_mfma_f32_16x16x32_bf16 v[68:71], a[240:243], v[208:211], v[68:71]
    v_mov_b32 v24, 0
    buffer_atomic_or v24, v2, s[52:55], 0 offen sc0 sc1
    v_mfma_f32_16x16x32_bf16 v[72:75], a[240:243], v[212:215], v[72:75]
    s_add_u32 s88, s84, 0
    buffer_load_dwordx4 a[0:3], v4, s[48:51], s88 offen sc1
    s_waitcnt lgkmcnt(6)
    v_mfma_f32_16x16x32_bf16 v[76:79], a[244:247], v[196:199], v[76:79]
    s_add_u32 s88, s84, 573440
    buffer_load_dwordx4 a[4:7], v4, s[48:51], s88 offen sc1
    v_mfma_f32_16x16x32_bf16 v[80:83], a[244:247], v[200:203], v[80:83]
    ds_read_b64_tr_b16 a[220:221], v18 offset:60416
    ds_read_b64_tr_b16 a[222:223], v18 offset:62464
    v_mfma_f32_16x16x32_bf16 v[84:87], a[244:247], v[204:207], v[84:87]
    s_add_u32 s88, s84, 1146880
    buffer_load_dwordx4 a[8:11], v4, s[48:51], s88 offen sc1
    v_mfma_f32_16x16x32_bf16 v[88:91], a[244:247], v[208:211], v[88:91]
    s_add_u32 s88, s84, 1720320
    buffer_load_dwordx4 a[12:15], v4, s[48:51], s88 offen sc1
    v_mfma_f32_16x16x32_bf16 v[92:95], a[244:247], v[212:215], v[92:95]
    s_waitcnt lgkmcnt(6)
    v_mfma_f32_16x16x32_bf16 v[56:59], a[248:251], v[216:219], v[56:59]
    v_mfma_f32_16x16x32_bf16 v[60:63], a[248:251], v[220:223], v[60:63]
    v_mfma_f32_16x16x32_bf16 v[64:67], a[248:251], v[224:227], v[64:67]
    buffer_store_dwordx4 v[132:135], v20, s[44:47], s63 offen sc1
    s_add_u32 s63, s63, 20480
    v_mfma_f32_16x16x32_bf16 v[68:71], a[248:251], v[228:231], v[68:71]
    v_mfma_f32_16x16x32_bf16 v[72:75], a[248:251], v[232:235], v[72:75]
    s_waitcnt lgkmcnt(4)
    v_mfma_f32_16x16x32_bf16 v[76:79], a[252:255], v[216:219], v[76:79]
    v_mfma_f32_16x16x32_bf16 v[80:83], a[252:255], v[220:223], v[80:83]
    v_mfma_f32_16x16x32_bf16 v[84:87], a[252:255], v[224:227], v[84:87]
    v_mfma_f32_16x16x32_bf16 v[88:91], a[252:255], v[228:231], v[88:91]
    v_mfma_f32_16x16x32_bf16 v[92:95], a[252:255], v[232:235], v[92:95]
    s_waitcnt lgkmcnt(0)
    s_barrier
    v_mfma_f32_16x16x32_bf16 v[56:59], a[216:219], v[236:239], v[56:59]
    v_add_u32 v15, 0x12000, v15
    ds_read_b64_tr_b16 a[200:201], v15
    v_mfma_f32_16x16x32_bf16 v[60:63], a[216:219], v[240:243], v[60:63]
    ds_read_b64_tr_b16 a[202:203], v15 offset:2048
    v_add_u32 v16, 0x12000, v16
    ds_read_b64_tr_b16 a[204:205], v16
    v_mfma_f32_16x16x32_bf16 v[64:67], a[216:219], v[244:247], v[64:67]
    ds_read_b64_tr_b16 a[206:207], v16 offset:2048
    v_mul_f32 v56, v26, v56
    v_mfma_f32_16x16x32_bf16 v[68:71], a[216:219], v[248:251], v[68:71]
    v_mul_f32 v57, v26, v57
    v_mul_f32 v58, v26, v58
    v_mfma_f32_16x16x32_bf16 v[72:75], a[216:219], v[252:255], v[72:75]
    v_mul_f32 v59, v26, v59
    v_cvt_pk_bf16_f32 v56, v56, v57
    v_mfma_f32_16x16x32_bf16 v[76:79], a[220:223], v[236:239], v[76:79]
    v_cvt_pk_bf16_f32 v57, v58, v59
    v_add_u32 v17, 0x12000, v17
    ds_read_b64_tr_b16 a[208:209], v17
    v_mfma_f32_16x16x32_bf16 v[80:83], a[220:223], v[240:243], v[80:83]
    ds_read_b64_tr_b16 a[210:211], v17 offset:2048
    v_add_u32 v18, 0x12000, v18
    ds_read_b64_tr_b16 a[212:213], v18
    v_mfma_f32_16x16x32_bf16 v[84:87], a[220:223], v[244:247], v[84:87]
    v_mul_f32 v76, v26, v76
    v_mul_f32 v77, v26, v77
    v_mfma_f32_16x16x32_bf16 v[88:91], a[220:223], v[248:251], v[88:91]
    v_mul_f32 v78, v26, v78
    v_mul_f32 v79, v26, v79
    v_mfma_f32_16x16x32_bf16 v[92:95], a[220:223], v[252:255], v[92:95]
    v_cvt_pk_bf16_f32 v58, v76, v77
    s_waitcnt lgkmcnt(5)
    v_mfma_f32_16x16x32_bf16 v[116:119], a[200:203], v[96:99], 0
    v_cvt_pk_bf16_f32 v59, v78, v79
    v_mul_f32 v60, v27, v60
    v_mfma_f32_16x16x32_bf16 v[120:123], a[200:203], v[100:103], 0
    v_mul_f32 v61, v27, v61
    ds_read_b64_tr_b16 a[214:215], v18 offset:2048
    v_mfma_f32_16x16x32_bf16 v[124:127], a[200:203], v[104:107], 0
    v_mul_f32 v62, v27, v62
    v_mul_f32 v63, v27, v63
    v_mfma_f32_16x16x32_bf16 v[128:131], a[200:203], v[108:111], 0
    buffer_store_dwordx4 v[56:59], v20, s[44:47], s62 offen sc1
    v_cvt_pk_bf16_f32 v60, v60, v61
    v_mfma_f32_16x16x32_bf16 v[132:135], a[200:203], v[112:115], 0
    v_cvt_pk_bf16_f32 v61, v62, v63
    s_waitcnt lgkmcnt(4)
    v_mfma_f32_16x16x32_bf16 v[156:159], a[204:207], v[96:99], 0
    v_mul_f32 v80, v27, v80
    ds_read_b64_tr_b16 a[224:225], v15 offset:8192
    v_mfma_f32_16x16x32_bf16 v[160:163], a[204:207], v[100:103], 0
    ds_read_b64_tr_b16 a[226:227], v15 offset:10240
    v_mul_f32 v81, v27, v81
    v_mfma_f32_16x16x32_bf16 v[164:167], a[204:207], v[104:107], 0
    v_mul_f32 v82, v27, v82
    v_mul_f32 v83, v27, v83
    v_mfma_f32_16x16x32_bf16 v[168:171], a[204:207], v[108:111], 0
    v_cvt_pk_bf16_f32 v62, v80, v81
    v_cvt_pk_bf16_f32 v63, v82, v83
    v_mfma_f32_16x16x32_bf16 v[172:175], a[204:207], v[112:115], 0
    ds_read_b64_tr_b16 a[228:229], v16 offset:8192
    s_waitcnt lgkmcnt(5)
    v_mfma_f32_16x16x32_bf16 v[116:119], a[208:211], a[160:163], v[116:119]
    ds_read_b64_tr_b16 a[230:231], v16 offset:10240
    v_mul_f32 v64, v28, v64
    v_mfma_f32_16x16x32_bf16 v[120:123], a[208:211], a[164:167], v[120:123]
    v_mul_f32 v65, v28, v65
    v_mul_f32 v66, v28, v66
    v_mfma_f32_16x16x32_bf16 v[124:127], a[208:211], a[168:171], v[124:127]
    v_mul_f32 v67, v28, v67
    v_cvt_pk_bf16_f32 v64, v64, v65
    v_mfma_f32_16x16x32_bf16 v[128:131], a[208:211], a[172:175], v[128:131]
    ds_read_b64_tr_b16 a[232:233], v17 offset:8192
    ds_read_b64_tr_b16 a[234:235], v17 offset:10240
    v_mfma_f32_16x16x32_bf16 v[132:135], a[208:211], a[176:179], v[132:135]
    v_cvt_pk_bf16_f32 v65, v66, v67
    s_waitcnt lgkmcnt(6)
    v_mfma_f32_16x16x32_bf16 v[156:159], a[212:215], a[160:163], v[156:159]
    v_mul_f32 v84, v28, v84
    v_mul_f32 v85, v28, v85
    v_mfma_f32_16x16x32_bf16 v[160:163], a[212:215], a[164:167], v[160:163]
    v_mul_f32 v86, v28, v86
    ds_read_b64_tr_b16 a[236:237], v18 offset:8192
    v_mfma_f32_16x16x32_bf16 v[164:167], a[212:215], a[168:171], v[164:167]
    buffer_store_dwordx4 v[60:63], v20, s[44:47], s62 offen offset:1024 sc1
    ds_read_b64_tr_b16 a[238:239], v18 offset:10240
    v_mfma_f32_16x16x32_bf16 v[168:171], a[212:215], a[172:175], v[168:171]
    v_mul_f32 v87, v28, v87
    v_cvt_pk_bf16_f32 v66, v84, v85
    v_mfma_f32_16x16x32_bf16 v[172:175], a[212:215], a[176:179], v[172:175]
    v_cvt_pk_bf16_f32 v67, v86, v87
    s_waitcnt lgkmcnt(6)
    v_mfma_f32_16x16x32_bf16 v[116:119], a[224:227], v[136:139], v[116:119]
    v_mul_f32 v68, v29, v68
    v_mul_f32 v69, v29, v69
    v_mfma_f32_16x16x32_bf16 v[120:123], a[224:227], v[140:143], v[120:123]
    v_add_u32 v15, 0xfffdd000, v15
    ds_read_b64_tr_b16 a[240:241], v15
    v_mfma_f32_16x16x32_bf16 v[124:127], a[224:227], v[144:147], v[124:127]
    ds_read_b64_tr_b16 a[242:243], v15 offset:2048
    v_mul_f32 v70, v29, v70
    v_mfma_f32_16x16x32_bf16 v[128:131], a[224:227], v[148:151], v[128:131]
    v_mul_f32 v71, v29, v71
    v_cvt_pk_bf16_f32 v68, v68, v69
    v_mfma_f32_16x16x32_bf16 v[132:135], a[224:227], v[152:155], v[132:135]
    v_cvt_pk_bf16_f32 v69, v70, v71
    s_waitcnt lgkmcnt(6)
    v_mfma_f32_16x16x32_bf16 v[156:159], a[228:231], v[136:139], v[156:159]
    v_mul_f32 v88, v29, v88
    v_add_u32 v16, 0xfffdd000, v16
    ds_read_b64_tr_b16 a[244:245], v16
    v_mfma_f32_16x16x32_bf16 v[160:163], a[228:231], v[140:143], v[160:163]
    ds_read_b64_tr_b16 a[246:247], v16 offset:2048
    v_mul_f32 v89, v29, v89
    v_mfma_f32_16x16x32_bf16 v[164:167], a[228:231], v[144:147], v[164:167]
    v_mul_f32 v90, v29, v90
    v_mul_f32 v91, v29, v91
    v_mfma_f32_16x16x32_bf16 v[168:171], a[228:231], v[148:151], v[168:171]
    v_cvt_pk_bf16_f32 v70, v88, v89
    v_cvt_pk_bf16_f32 v71, v90, v91
    v_mfma_f32_16x16x32_bf16 v[172:175], a[228:231], v[152:155], v[172:175]
    v_add_u32 v17, 0xfffdd000, v17
    ds_read_b64_tr_b16 a[248:249], v17
    s_waitcnt lgkmcnt(7)
    v_mfma_f32_16x16x32_bf16 v[116:119], a[232:235], a[180:183], v[116:119]
    ds_read_b64_tr_b16 a[250:251], v17 offset:2048
    v_mul_f32 v72, v30, v72
    v_mfma_f32_16x16x32_bf16 v[120:123], a[232:235], a[184:187], v[120:123]
    v_mul_f32 v73, v30, v73
    v_mul_f32 v74, v30, v74
    v_mfma_f32_16x16x32_bf16 v[124:127], a[232:235], a[188:191], v[124:127]
    buffer_store_dwordx4 v[64:67], v20, s[44:47], s62 offen offset:2048 sc1
    v_mul_f32 v75, v30, v75
    v_mfma_f32_16x16x32_bf16 v[128:131], a[232:235], a[192:195], v[128:131]
    v_cvt_pk_bf16_f32 v72, v72, v73
    v_add_u32 v18, 0xfffdd000, v18
    ds_read_b64_tr_b16 a[252:253], v18
    v_mfma_f32_16x16x32_bf16 v[132:135], a[232:235], a[196:199], v[132:135]
    ds_read_b64_tr_b16 a[254:255], v18 offset:2048
    s_waitcnt lgkmcnt(8)
    v_mfma_f32_16x16x32_bf16 v[156:159], a[236:239], a[180:183], v[156:159]
    v_cvt_pk_bf16_f32 v73, v74, v75
    v_mul_f32 v92, v30, v92
    v_mfma_f32_16x16x32_bf16 v[160:163], a[236:239], a[184:187], v[160:163]
    v_mul_f32 v93, v30, v93
    v_mul_f32 v94, v30, v94
    v_mfma_f32_16x16x32_bf16 v[164:167], a[236:239], a[188:191], v[164:167]
    v_mul_f32 v95, v30, v95
    ds_read_b64_tr_b16 a[216:217], v15 offset:8192
    v_mfma_f32_16x16x32_bf16 v[168:171], a[236:239], a[192:195], v[168:171]
    ds_read_b64_tr_b16 a[218:219], v15 offset:10240
    v_cvt_pk_bf16_f32 v74, v92, v93
    v_mfma_f32_16x16x32_bf16 v[172:175], a[236:239], a[196:199], v[172:175]
    v_cvt_pk_bf16_f32 v75, v94, v95
    s_waitcnt lgkmcnt(8)
    v_mfma_f32_16x16x32_bf16 v[116:119], a[240:243], v[176:179], v[116:119]
    v_mfma_f32_16x16x32_bf16 v[120:123], a[240:243], v[180:183], v[120:123]
    v_mfma_f32_16x16x32_bf16 v[124:127], a[240:243], v[184:187], v[124:127]
    ds_read_b64_tr_b16 a[220:221], v16 offset:8192
    ds_read_b64_tr_b16 a[222:223], v16 offset:10240
    v_mfma_f32_16x16x32_bf16 v[128:131], a[240:243], v[188:191], v[128:131]
    v_mfma_f32_16x16x32_bf16 v[132:135], a[240:243], v[192:195], v[132:135]
    s_waitcnt lgkmcnt(8)
    v_mfma_f32_16x16x32_bf16 v[156:159], a[244:247], v[176:179], v[156:159]
    v_mfma_f32_16x16x32_bf16 v[160:163], a[244:247], v[180:183], v[160:163]
    v_mfma_f32_16x16x32_bf16 v[164:167], a[244:247], v[184:187], v[164:167]
    buffer_store_dwordx4 v[68:71], v20, s[44:47], s62 offen offset:3072 sc1
    s_add_u32 s62, s62, 20480
    v_mfma_f32_16x16x32_bf16 v[168:171], a[244:247], v[188:191], v[168:171]
    ds_read_b64_tr_b16 a[200:201], v17 offset:8192
    ds_read_b64_tr_b16 a[202:203], v17 offset:10240
    v_mfma_f32_16x16x32_bf16 v[172:175], a[244:247], v[192:195], v[172:175]
    s_waitcnt lgkmcnt(8)
    v_mfma_f32_16x16x32_bf16 v[116:119], a[248:251], v[196:199], v[116:119]
    v_mfma_f32_16x16x32_bf16 v[120:123], a[248:251], v[200:203], v[120:123]
    s_waitcnt vmcnt(4)
    v_mov_b32 v25, 4
    buffer_atomic_umax v25, v3, s[52:55], 0 offen sc1
    v_mfma_f32_16x16x32_bf16 v[124:127], a[248:251], v[204:207], v[124:127]
    v_cmp_gt_u32 vcc, 2, v24
    s_and_b32 s3, vcc_lo, 0xffff
    s_cselect_b32 s85, 0x1000000, 0
    v_mfma_f32_16x16x32_bf16 v[128:131], a[248:251], v[208:211], v[128:131]
    v_mov_b32 v24, 0
    buffer_atomic_or v24, v2, s[52:55], 0 offen sc0 sc1
    v_mfma_f32_16x16x32_bf16 v[132:135], a[248:251], v[212:215], v[132:135]
    s_add_u32 s88, s85, 20480
    buffer_load_dwordx4 a[16:19], v4, s[48:51], s88 offen sc1
    s_waitcnt lgkmcnt(6)
    v_mfma_f32_16x16x32_bf16 v[156:159], a[252:255], v[196:199], v[156:159]
    s_add_u32 s88, s85, 593920
    buffer_load_dwordx4 a[20:23], v4, s[48:51], s88 offen sc1
    v_mfma_f32_16x16x32_bf16 v[160:163], a[252:255], v[200:203], v[160:163]
    ds_read_b64_tr_b16 a[204:205], v18 offset:8192
    ds_read_b64_tr_b16 a[206:207], v18 offset:10240
    v_mfma_f32_16x16x32_bf16 v[164:167], a[252:255], v[204:207], v[164:167]
    s_add_u32 s88, s85, 1167360
    buffer_load_dwordx4 a[24:27], v4, s[48:51], s88 offen sc1
    v_mfma_f32_16x16x32_bf16 v[168:171], a[252:255], v[208:211], v[168:171]
    s_add_u32 s88, s85, 1740800
    buffer_load_dwordx4 a[28:31], v4, s[48:51], s88 offen sc1
    v_mfma_f32_16x16x32_bf16 v[172:175], a[252:255], v[212:215], v[172:175]
    s_waitcnt lgkmcnt(6)
    v_mfma_f32_16x16x32_bf16 v[116:119], a[216:219], v[216:219], v[116:119]
    v_mfma_f32_16x16x32_bf16 v[120:123], a[216:219], v[220:223], v[120:123]
    v_mfma_f32_16x16x32_bf16 v[124:127], a[216:219], v[224:227], v[124:127]
    buffer_store_dwordx4 v[72:75], v20, s[44:47], s63 offen sc1
    s_add_u32 s63, s63, 20480
    v_mfma_f32_16x16x32_bf16 v[128:131], a[216:219], v[228:231], v[128:131]
    v_mfma_f32_16x16x32_bf16 v[132:135], a[216:219], v[232:235], v[132:135]
    s_waitcnt lgkmcnt(4)
    v_mfma_f32_16x16x32_bf16 v[156:159], a[220:223], v[216:219], v[156:159]
    v_mfma_f32_16x16x32_bf16 v[160:163], a[220:223], v[220:223], v[160:163]
    v_mfma_f32_16x16x32_bf16 v[164:167], a[220:223], v[224:227], v[164:167]
    v_mfma_f32_16x16x32_bf16 v[168:171], a[220:223], v[228:231], v[168:171]
    v_mfma_f32_16x16x32_bf16 v[172:175], a[220:223], v[232:235], v[172:175]
    s_waitcnt lgkmcnt(0)
    s_barrier
    v_mfma_f32_16x16x32_bf16 v[116:119], a[200:203], v[236:239], v[116:119]
    v_add_u32 v15, 0x19800, v15
    ds_read_b64_tr_b16 a[208:209], v15
    v_mfma_f32_16x16x32_bf16 v[120:123], a[200:203], v[240:243], v[120:123]
    ds_read_b64_tr_b16 a[210:211], v15 offset:2048
    v_add_u32 v16, 0x19800, v16
    ds_read_b64_tr_b16 a[212:213], v16
    v_mfma_f32_16x16x32_bf16 v[124:127], a[200:203], v[244:247], v[124:127]
    ds_read_b64_tr_b16 a[214:215], v16 offset:2048
    v_mul_f32 v116, v26, v116
    v_mfma_f32_16x16x32_bf16 v[128:131], a[200:203], v[248:251], v[128:131]
    v_mul_f32 v117, v26, v117
    v_mul_f32 v118, v26, v118
    v_mfma_f32_16x16x32_bf16 v[132:135], a[200:203], v[252:255], v[132:135]
    v_mul_f32 v119, v26, v119
    v_cvt_pk_bf16_f32 v116, v116, v117
    v_mfma_f32_16x16x32_bf16 v[156:159], a[204:207], v[236:239], v[156:159]
    v_cvt_pk_bf16_f32 v117, v118, v119
    v_add_u32 v17, 0x19800, v17
    ds_read_b64_tr_b16 a[224:225], v17
    v_mfma_f32_16x16x32_bf16 v[160:163], a[204:207], v[240:243], v[160:163]
    ds_read_b64_tr_b16 a[226:227], v17 offset:2048
    v_add_u32 v18, 0x19800, v18
    ds_read_b64_tr_b16 a[228:229], v18
    v_mfma_f32_16x16x32_bf16 v[164:167], a[204:207], v[244:247], v[164:167]
    v_mul_f32 v156, v26, v156
    v_mul_f32 v157, v26, v157
    v_mfma_f32_16x16x32_bf16 v[168:171], a[204:207], v[248:251], v[168:171]
    v_mul_f32 v158, v26, v158
    v_mul_f32 v159, v26, v159
    v_mfma_f32_16x16x32_bf16 v[172:175], a[204:207], v[252:255], v[172:175]
    v_cvt_pk_bf16_f32 v118, v156, v157
    s_waitcnt lgkmcnt(5)
    v_mfma_f32_16x16x32_bf16 v[56:59], a[208:211], v[96:99], 0
    v_cvt_pk_bf16_f32 v119, v158, v159
    v_mul_f32 v120, v27, v120
    v_mfma_f32_16x16x32_bf16 v[60:63], a[208:211], v[100:103], 0
    v_mul_f32 v121, v27, v121
    ds_read_b64_tr_b16 a[230:231], v18 offset:2048
    v_mfma_f32_16x16x32_bf16 v[64:67], a[208:211], v[104:107], 0
    v_mul_f32 v122, v27, v122
    v_mul_f32 v123, v27, v123
    v_mfma_f32_16x16x32_bf16 v[68:71], a[208:211], v[108:111], 0
    buffer_store_dwordx4 v[116:119], v20, s[44:47], s62 offen sc1
    v_cvt_pk_bf16_f32 v120, v120, v121
    v_mfma_f32_16x16x32_bf16 v[72:75], a[208:211], v[112:115], 0
    v_cvt_pk_bf16_f32 v121, v122, v123
    s_waitcnt lgkmcnt(4)
    v_mfma_f32_16x16x32_bf16 v[76:79], a[212:215], v[96:99], 0
    v_mul_f32 v160, v27, v160
    ds_read_b64_tr_b16 a[232:233], v15 offset:8192
    v_mfma_f32_16x16x32_bf16 v[80:83], a[212:215], v[100:103], 0
    ds_read_b64_tr_b16 a[234:235], v15 offset:10240
    v_mul_f32 v161, v27, v161
    v_mfma_f32_16x16x32_bf16 v[84:87], a[212:215], v[104:107], 0
    v_mul_f32 v162, v27, v162
    v_mul_f32 v163, v27, v163
    v_mfma_f32_16x16x32_bf16 v[88:91], a[212:215], v[108:111], 0
    v_cvt_pk_bf16_f32 v122, v160, v161
    v_cvt_pk_bf16_f32 v123, v162, v163
    v_mfma_f32_16x16x32_bf16 v[92:95], a[212:215], v[112:115], 0
    ds_read_b64_tr_b16 a[236:237], v16 offset:8192
    s_waitcnt lgkmcnt(5)
    v_mfma_f32_16x16x32_bf16 v[56:59], a[224:227], a[160:163], v[56:59]
    ds_read_b64_tr_b16 a[238:239], v16 offset:10240
    v_mul_f32 v124, v28, v124
    v_mfma_f32_16x16x32_bf16 v[60:63], a[224:227], a[164:167], v[60:63]
    v_mul_f32 v125, v28, v125
    v_mul_f32 v126, v28, v126
    v_mfma_f32_16x16x32_bf16 v[64:67], a[224:227], a[168:171], v[64:67]
    v_mul_f32 v127, v28, v127
    v_cvt_pk_bf16_f32 v124, v124, v125
    v_mfma_f32_16x16x32_bf16 v[68:71], a[224:227], a[172:175], v[68:71]
    ds_read_b64_tr_b16 a[240:241], v17 offset:8192
    ds_read_b64_tr_b16 a[242:243], v17 offset:10240
    v_mfma_f32_16x16x32_bf16 v[72:75], a[224:227], a[176:179], v[72:75]
    v_cvt_pk_bf16_f32 v125, v126, v127
    s_waitcnt lgkmcnt(6)
    v_mfma_f32_16x16x32_bf16 v[76:79], a[228:231], a[160:163], v[76:79]
    v_mul_f32 v164, v28, v164
    v_mul_f32 v165, v28, v165
    v_mfma_f32_16x16x32_bf16 v[80:83], a[228:231], a[164:167], v[80:83]
    v_mul_f32 v166, v28, v166
    ds_read_b64_tr_b16 a[244:245], v18 offset:8192
    v_mfma_f32_16x16x32_bf16 v[84:87], a[228:231], a[168:171], v[84:87]
    buffer_store_dwordx4 v[120:123], v20, s[44:47], s62 offen offset:1024 sc1
    ds_read_b64_tr_b16 a[246:247], v18 offset:10240
    v_mfma_f32_16x16x32_bf16 v[88:91], a[228:231], a[172:175], v[88:91]
    v_mul_f32 v167, v28, v167
    v_cvt_pk_bf16_f32 v126, v164, v165
    v_mfma_f32_16x16x32_bf16 v[92:95], a[228:231], a[176:179], v[92:95]
    v_cvt_pk_bf16_f32 v127, v166, v167
    s_waitcnt lgkmcnt(6)
    v_mfma_f32_16x16x32_bf16 v[56:59], a[232:235], v[136:139], v[56:59]
    v_mul_f32 v128, v29, v128
    v_mul_f32 v129, v29, v129
    v_mfma_f32_16x16x32_bf16 v[60:63], a[232:235], v[140:143], v[60:63]
    v_add_u32 v15, 0xfffeac00, v15
    ds_read_b64_tr_b16 a[248:249], v15
    v_mfma_f32_16x16x32_bf16 v[64:67], a[232:235], v[144:147], v[64:67]
    ds_read_b64_tr_b16 a[250:251], v15 offset:2048
    v_mul_f32 v130, v29, v130
    v_mfma_f32_16x16x32_bf16 v[68:71], a[232:235], v[148:151], v[68:71]
    v_mul_f32 v131, v29, v131
    v_cvt_pk_bf16_f32 v128, v128, v129
    v_mfma_f32_16x16x32_bf16 v[72:75], a[232:235], v[152:155], v[72:75]
    v_cvt_pk_bf16_f32 v129, v130, v131
    s_waitcnt lgkmcnt(6)
    v_mfma_f32_16x16x32_bf16 v[76:79], a[236:239], v[136:139], v[76:79]
    v_mul_f32 v168, v29, v168
    v_add_u32 v17, 0xfffeac00, v17
    ds_read_b64_tr_b16 a[252:253], v17
    v_mfma_f32_16x16x32_bf16 v[80:83], a[236:239], v[140:143], v[80:83]
    ds_read_b64_tr_b16 a[254:255], v17 offset:2048
    v_mul_f32 v169, v29, v169
    v_mfma_f32_16x16x32_bf16 v[84:87], a[236:239], v[144:147], v[84:87]
    v_mul_f32 v170, v29, v170
    v_mul_f32 v171, v29, v171
    v_mfma_f32_16x16x32_bf16 v[88:91], a[236:239], v[148:151], v[88:91]
    v_cvt_pk_bf16_f32 v130, v168, v169
    v_cvt_pk_bf16_f32 v131, v170, v171
    v_mfma_f32_16x16x32_bf16 v[92:95], a[236:239], v[152:155], v[92:95]
    ds_read_b64_tr_b16 a[216:217], v15 offset:8192
    s_waitcnt lgkmcnt(7)
    v_mfma_f32_16x16x32_bf16 v[56:59], a[240:243], a[180:183], v[56:59]
    ds_read_b64_tr_b16 a[218:219], v15 offset:10240
    v_mul_f32 v132, v30, v132
    v_mfma_f32_16x16x32_bf16 v[60:63], a[240:243], a[184:187], v[60:63]
    v_mul_f32 v133, v30, v133
    v_mul_f32 v134, v30, v134
    v_mfma_f32_16x16x32_bf16 v[64:67], a[240:243], a[188:191], v[64:67]
    buffer_store_dwordx4 v[124:127], v20, s[44:47], s62 offen offset:2048 sc1
    v_mul_f32 v135, v30, v135
    v_mfma_f32_16x16x32_bf16 v[68:71], a[240:243], a[192:195], v[68:71]
    v_cvt_pk_bf16_f32 v132, v132, v133
    ds_read_b64_tr_b16 a[220:221], v17 offset:8192
    v_mfma_f32_16x16x32_bf16 v[72:75], a[240:243], a[196:199], v[72:75]
    ds_read_b64_tr_b16 a[222:223], v17 offset:10240
    s_waitcnt lgkmcnt(8)
    v_mfma_f32_16x16x32_bf16 v[76:79], a[244:247], a[180:183], v[76:79]
    v_cvt_pk_bf16_f32 v133, v134, v135
    v_mul_f32 v172, v30, v172
    v_mfma_f32_16x16x32_bf16 v[80:83], a[244:247], a[184:187], v[80:83]
    v_mul_f32 v173, v30, v173
    v_mul_f32 v174, v30, v174
    v_mfma_f32_16x16x32_bf16 v[84:87], a[244:247], a[188:191], v[84:87]
    v_mul_f32 v175, v30, v175
    v_add_u32 v16, 0xfffeac00, v16
    ds_read_b64_tr_b16 a[200:201], v16
    v_mfma_f32_16x16x32_bf16 v[88:91], a[244:247], a[192:195], v[88:91]
    ds_read_b64_tr_b16 a[202:203], v16 offset:2048
    v_cvt_pk_bf16_f32 v134, v172, v173
    v_mfma_f32_16x16x32_bf16 v[92:95], a[244:247], a[196:199], v[92:95]
    v_cvt_pk_bf16_f32 v135, v174, v175
    s_waitcnt lgkmcnt(8)
    v_mfma_f32_16x16x32_bf16 v[56:59], a[248:251], v[176:179], v[56:59]
    v_mfma_f32_16x16x32_bf16 v[60:63], a[248:251], v[180:183], v[60:63]
    v_mfma_f32_16x16x32_bf16 v[64:67], a[248:251], v[184:187], v[64:67]
    v_add_u32 v18, 0xfffeac00, v18
    ds_read_b64_tr_b16 a[204:205], v18
    v_mfma_f32_16x16x32_bf16 v[68:71], a[248:251], v[188:191], v[68:71]
    ds_read_b64_tr_b16 a[206:207], v18 offset:2048
    v_mfma_f32_16x16x32_bf16 v[72:75], a[248:251], v[192:195], v[72:75]
    s_waitcnt lgkmcnt(8)
    v_mfma_f32_16x16x32_bf16 v[56:59], a[252:255], v[196:199], v[56:59]
    v_mfma_f32_16x16x32_bf16 v[60:63], a[252:255], v[200:203], v[60:63]
    v_mfma_f32_16x16x32_bf16 v[64:67], a[252:255], v[204:207], v[64:67]
    buffer_store_dwordx4 v[128:131], v20, s[44:47], s62 offen offset:3072 sc1
    s_add_u32 s62, s62, 20480
    v_mfma_f32_16x16x32_bf16 v[68:71], a[252:255], v[208:211], v[68:71]
    ds_read_b64_tr_b16 a[208:209], v16 offset:8192
    ds_read_b64_tr_b16 a[210:211], v16 offset:10240
    v_mfma_f32_16x16x32_bf16 v[72:75], a[252:255], v[212:215], v[72:75]
    s_waitcnt lgkmcnt(8)
    v_mfma_f32_16x16x32_bf16 v[56:59], a[216:219], v[216:219], v[56:59]
    v_mfma_f32_16x16x32_bf16 v[60:63], a[216:219], v[220:223], v[60:63]
    s_waitcnt vmcnt(4)
    v_mov_b32 v25, 5
    buffer_atomic_umax v25, v3, s[52:55], 0 offen sc1
    v_mfma_f32_16x16x32_bf16 v[64:67], a[216:219], v[224:227], v[64:67]
    v_cmp_gt_u32 vcc, 3, v24
    s_and_b32 s3, vcc_lo, 0xffff
    s_cselect_b32 s86, 0x1000000, 0
    v_mfma_f32_16x16x32_bf16 v[68:71], a[216:219], v[228:231], v[68:71]
    v_mov_b32 v24, 0
    buffer_atomic_or v24, v2, s[52:55], 0 offen sc0 sc1
    v_mfma_f32_16x16x32_bf16 v[72:75], a[216:219], v[232:235], v[72:75]
    s_add_u32 s88, s86, 40960
    buffer_load_dwordx4 a[32:35], v4, s[48:51], s88 offen sc1
    s_waitcnt lgkmcnt(6)
    v_mfma_f32_16x16x32_bf16 v[56:59], a[220:223], v[236:239], v[56:59]
    s_add_u32 s88, s86, 614400
    buffer_load_dwordx4 a[36:39], v4, s[48:51], s88 offen sc1
    v_mfma_f32_16x16x32_bf16 v[60:63], a[220:223], v[240:243], v[60:63]
    ds_read_b64_tr_b16 a[212:213], v18 offset:8192
    ds_read_b64_tr_b16 a[214:215], v18 offset:10240
    v_mfma_f32_16x16x32_bf16 v[64:67], a[220:223], v[244:247], v[64:67]
    s_add_u32 s88, s86, 1187840
    buffer_load_dwordx4 a[40:43], v4, s[48:51], s88 offen sc1
    v_mfma_f32_16x16x32_bf16 v[68:71], a[220:223], v[248:251], v[68:71]
    s_add_u32 s88, s86, 1761280
    buffer_load_dwordx4 a[44:47], v4, s[48:51], s88 offen sc1
    v_mfma_f32_16x16x32_bf16 v[72:75], a[220:223], v[252:255], v[72:75]
    s_waitcnt lgkmcnt(6)
    v_mfma_f32_16x16x32_bf16 v[76:79], a[200:203], v[176:179], v[76:79]
    v_mul_f32 v56, v26, v56
    v_mul_f32 v57, v26, v57
    v_mfma_f32_16x16x32_bf16 v[80:83], a[200:203], v[180:183], v[80:83]
    v_mul_f32 v58, v26, v58
    v_mul_f32 v59, v26, v59
    v_mfma_f32_16x16x32_bf16 v[84:87], a[200:203], v[184:187], v[84:87]
    v_cvt_pk_bf16_f32 v56, v56, v57
    v_cvt_pk_bf16_f32 v57, v58, v59
    v_mfma_f32_16x16x32_bf16 v[88:91], a[200:203], v[188:191], v[88:91]
    v_mul_f32 v60, v27, v60
    v_mul_f32 v61, v27, v61
    v_mfma_f32_16x16x32_bf16 v[92:95], a[200:203], v[192:195], v[92:95]
    v_mul_f32 v62, v27, v62
    s_waitcnt lgkmcnt(4)
    v_mfma_f32_16x16x32_bf16 v[76:79], a[204:207], v[196:199], v[76:79]
    v_mul_f32 v63, v27, v63
    v_cvt_pk_bf16_f32 v60, v60, v61
    v_mfma_f32_16x16x32_bf16 v[80:83], a[204:207], v[200:203], v[80:83]
    buffer_store_dwordx4 v[132:135], v20, s[44:47], s63 offen sc1
    s_add_u32 s63, s63, 20480
    v_cvt_pk_bf16_f32 v61, v62, v63
    v_mfma_f32_16x16x32_bf16 v[84:87], a[204:207], v[204:207], v[84:87]
    v_mul_f32 v64, v28, v64
    v_mul_f32 v65, v28, v65
    v_mfma_f32_16x16x32_bf16 v[88:91], a[204:207], v[208:211], v[88:91]
    v_mul_f32 v66, v28, v66
    v_mul_f32 v67, v28, v67
    v_mfma_f32_16x16x32_bf16 v[92:95], a[204:207], v[212:215], v[92:95]
    v_cvt_pk_bf16_f32 v64, v64, v65
    s_waitcnt lgkmcnt(2)
    v_mfma_f32_16x16x32_bf16 v[76:79], a[208:211], v[216:219], v[76:79]
    v_cvt_pk_bf16_f32 v65, v66, v67
    v_mul_f32 v68, v29, v68
    v_mfma_f32_16x16x32_bf16 v[80:83], a[208:211], v[220:223], v[80:83]
    v_mul_f32 v69, v29, v69
    v_mul_f32 v70, v29, v70
    v_mfma_f32_16x16x32_bf16 v[84:87], a[208:211], v[224:227], v[84:87]
    v_mul_f32 v71, v29, v71
    v_cvt_pk_bf16_f32 v68, v68, v69
    v_mfma_f32_16x16x32_bf16 v[88:91], a[208:211], v[228:231], v[88:91]
    v_cvt_pk_bf16_f32 v69, v70, v71
    v_mul_f32 v72, v30, v72
    v_mfma_f32_16x16x32_bf16 v[92:95], a[208:211], v[232:235], v[92:95]
    v_mul_f32 v73, v30, v73
    s_waitcnt lgkmcnt(0)
    v_mfma_f32_16x16x32_bf16 v[76:79], a[212:215], v[236:239], v[76:79]
    v_mul_f32 v74, v30, v74
    v_mul_f32 v75, v30, v75
    v_mfma_f32_16x16x32_bf16 v[80:83], a[212:215], v[240:243], v[80:83]
    v_cvt_pk_bf16_f32 v72, v72, v73
    v_cvt_pk_bf16_f32 v73, v74, v75
    v_mfma_f32_16x16x32_bf16 v[84:87], a[212:215], v[244:247], v[84:87]
    v_mfma_f32_16x16x32_bf16 v[88:91], a[212:215], v[248:251], v[88:91]
    v_mfma_f32_16x16x32_bf16 v[92:95], a[212:215], v[252:255], v[92:95]
    v_mul_f32 v76, v26, v76
    v_mul_f32 v77, v26, v77
    v_mul_f32 v78, v26, v78
    v_mul_f32 v79, v26, v79
    v_cvt_pk_bf16_f32 v58, v76, v77
    v_cvt_pk_bf16_f32 v59, v78, v79
    buffer_store_dwordx4 v[56:59], v20, s[44:47], s62 offen sc1
    v_mul_f32 v80, v27, v80
    v_mul_f32 v81, v27, v81
    v_mul_f32 v82, v27, v82
    v_mul_f32 v83, v27, v83
    v_cvt_pk_bf16_f32 v62, v80, v81
    v_cvt_pk_bf16_f32 v63, v82, v83
    buffer_store_dwordx4 v[60:63], v20, s[44:47], s62 offen offset:1024 sc1
    v_mul_f32 v84, v28, v84
    v_mul_f32 v85, v28, v85
    v_mul_f32 v86, v28, v86
    v_mul_f32 v87, v28, v87
    v_cvt_pk_bf16_f32 v66, v84, v85
    v_cvt_pk_bf16_f32 v67, v86, v87
    buffer_store_dwordx4 v[64:67], v20, s[44:47], s62 offen offset:2048 sc1
    v_mul_f32 v88, v29, v88
    v_mul_f32 v89, v29, v89
    v_mul_f32 v90, v29, v90
    v_mul_f32 v91, v29, v91
    v_cvt_pk_bf16_f32 v70, v88, v89
    v_cvt_pk_bf16_f32 v71, v90, v91
    buffer_store_dwordx4 v[68:71], v20, s[44:47], s62 offen offset:3072 sc1
    v_mul_f32 v92, v30, v92
    v_mul_f32 v93, v30, v93
    v_mul_f32 v94, v30, v94
    v_mul_f32 v95, v30, v95
    v_cvt_pk_bf16_f32 v74, v92, v93
    v_cvt_pk_bf16_f32 v75, v94, v95
    buffer_store_dwordx4 v[72:75], v20, s[44:47], s63 offen sc1
    s_waitcnt vmcnt(5)
    v_mov_b32 v25, 6
    buffer_atomic_umax v25, v3, s[52:55], 0 offen sc1
    v_cmp_gt_u32 vcc, 4, v24
    s_and_b32 s3, vcc_lo, 0xffff
    s_cselect_b32 s87, 0x1000000, 0
    v_mov_b32 v24, 0
    buffer_atomic_or v24, v2, s[52:55], 0 offen sc0 sc1
    s_add_u32 s88, s87, 61440
    buffer_load_dwordx4 a[48:51], v4, s[48:51], s88 offen sc1
    s_add_u32 s88, s87, 634880
    buffer_load_dwordx4 a[52:55], v4, s[48:51], s88 offen sc1
    s_add_u32 s88, s87, 1208320
    buffer_load_dwordx4 a[56:59], v4, s[48:51], s88 offen sc1
    s_add_u32 s88, s87, 1781760
    buffer_load_dwordx4 a[60:63], v4, s[48:51], s88 offen sc1
    s_add_u32 s88, s87, 0
    buffer_load_dwordx4 a[112:115], v5, s[48:51], s88 offen sc1
    s_add_u32 s88, s87, 573440
    buffer_load_dwordx4 a[116:119], v5, s[48:51], s88 offen sc1
    s_add_u32 s88, s87, 1146880
    buffer_load_dwordx4 a[120:123], v5, s[48:51], s88 offen sc1
    s_add_u32 s88, s87, 1720320
    buffer_load_dwordx4 a[124:127], v5, s[48:51], s88 offen sc1
    v_and_b32 v36, 15, v0
    v_mov_b32 v37, 0x3f80
    v_mov_b32 v38, 0x3f800000
    v_cmp_eq_u32 vcc, 0, v36
    s_nop 1
    v_cndmask_b32 v44, 0, v37, vcc
    v_cmp_eq_u32 vcc, 1, v36
    s_nop 1
    v_cndmask_b32 v44, v44, v38, vcc
    v_cmp_eq_u32 vcc, 2, v36
    s_nop 1
    v_cndmask_b32 v45, 0, v37, vcc
    v_cmp_eq_u32 vcc, 3, v36
    s_nop 1
    v_cndmask_b32 v45, v45, v38, vcc
    v_cmp_eq_u32 vcc, 4, v36
    s_nop 1
    v_cndmask_b32 v46, 0, v37, vcc
    v_cmp_eq_u32 vcc, 5, v36
    s_nop 1
    v_cndmask_b32 v46, v46, v38, vcc
    v_cmp_eq_u32 vcc, 6, v36
    s_nop 1
    v_cndmask_b32 v47, 0, v37, vcc
    v_cmp_eq_u32 vcc, 7, v36
    s_nop 1
    v_cndmask_b32 v47, v47, v38, vcc
    v_bfe_u32 v37, v0, 4, 2
    s_lshr_b32 s18, s17, 2
    s_and_b32 s19, s17, 3
    v_lshrrev_b32 v38, 2, v36
    v_mul_u32_u24 v38, 896, v38
    v_and_b32 v36, 3, v36
    v_lshl_add_u32 v38, v36, 3, v38
    v_and_b32 v36, 1, v37
    v_lshl_add_u32 v38, v36, 5, v38
    v_lshrrev_b32 v36, 1, v37
    v_lshl_add_u32 v38, v36, 24, v38
    s_lshr_b32 s68, s18, 1
    s_mul_i32 s68, s68, 71680
    s_and_b32 s78, s18, 1
    s_lshl_b32 s78, s78, 6
    s_add_u32 s68, s68, s78
    s_lshl_b32 s78, s19, 2
    s_add_u32 s78, s78, s20
    s_mul_i32 s78, s78, 3584
    s_add_u32 s78, s78, s68
    v_add_u32 v39, s78, v38
    s_mul_i32 s78, s19, 3584
    s_add_u32 s78, s78, s68
    s_add_u32 s78, s78, 57344
    v_add_u32 v40, s78, v38
    s_mov_b32 s97, s89
    s_cmp_eq_u32 s20, 1
    s_cselect_b32 s97, s90, s97
    s_cmp_eq_u32 s20, 2
    s_cselect_b32 s97, s91, s97
    s_cmp_eq_u32 s20, 3
    s_cselect_b32 s97, s92, s97
    s_mov_b32 s98, s93
    s_cmp_eq_u32 s20, 1
    s_cselect_b32 s98, s94, s98
    s_cmp_eq_u32 s20, 2
    s_cselect_b32 s98, s95, s98
    s_cmp_eq_u32 s20, 3
    s_cselect_b32 s78, 0x1000000, 0
    v_add_u32 v41, s78, v5
    v_add_u32 v42, s78, v40
    s_waitcnt vmcnt(10)
    v_mov_b32 v25, 7
    buffer_atomic_umax v25, v3, s[52:55], 0 offen sc1
    s_mov_b32 s69, 0
    s_waitcnt vmcnt(9)
    s_cmp_eq_u32 s84, 0
    s_cbranch_scc1 L_n0
L_c0:
    v_cmp_gt_u32 vcc, 1, v24
    s_and_b32 s3, vcc_lo, 0xffff
    s_cbranch_scc0 L_go0
    v_mov_b32 v24, 0
    buffer_atomic_or v24, v2, s[52:55], 0 offen sc0 sc1
    s_waitcnt vmcnt(0)
    s_add_u32 s69, s69, 1
    s_cmp_gt_u32 s69, 200000
    s_cbranch_scc1 L_end
    s_branch L_c0
L_go0:
    s_mov_b32 s22, 0
    buffer_load_dwordx4 a[0:3], v4, s[48:51], s22 offen sc1
    s_mov_b32 s22, 573440
    buffer_load_dwordx4 a[4:7], v4, s[48:51], s22 offen sc1
    s_mov_b32 s22, 1146880
    buffer_load_dwordx4 a[8:11], v4, s[48:51], s22 offen sc1
    s_mov_b32 s22, 1720320
    buffer_load_dwordx4 a[12:15], v4, s[48:51], s22 offen sc1
L_n0:
    s_cmp_eq_u32 s85, 0
    s_cbranch_scc1 L_n1
L_c1:
    v_cmp_gt_u32 vcc, 2, v24
    s_and_b32 s3, vcc_lo, 0xffff
    s_cbranch_scc0 L_go1
    v_mov_b32 v24, 0
    buffer_atomic_or v24, v2, s[52:55], 0 offen sc0 sc1
    s_waitcnt vmcnt(0)
    s_add_u32 s69, s69, 1
    s_cmp_gt_u32 s69, 200000
    s_cbranch_scc1 L_end
    s_branch L_c1
L_go1:
    s_mov_b32 s22, 20480
    buffer_load_dwordx4 a[16:19], v4, s[48:51], s22 offen sc1
    s_mov_b32 s22, 593920
    buffer_load_dwordx4 a[20:23], v4, s[48:51], s22 offen sc1
    s_mov_b32 s22, 1167360
    buffer_load_dwordx4 a[24:27], v4, s[48:51], s22 offen sc1
    s_mov_b32 s22, 1740800
    buffer_load_dwordx4 a[28:31], v4, s[48:51], s22 offen sc1
L_n1:
    s_cmp_eq_u32 s86, 0
    s_cbranch_scc1 L_n2
L_c2:
    v_cmp_gt_u32 vcc, 3, v24
    s_and_b32 s3, vcc_lo, 0xffff
    s_cbranch_scc0 L_go2
    v_mov_b32 v24, 0
    buffer_atomic_or v24, v2, s[52:55], 0 offen sc0 sc1
    s_waitcnt vmcnt(0)
    s_add_u32 s69, s69, 1
    s_cmp_gt_u32 s69, 200000
    s_cbranch_scc1 L_end
    s_branch L_c2
L_go2:
    s_mov_b32 s22, 40960
    buffer_load_dwordx4 a[32:35], v4, s[48:51], s22 offen sc1
    s_mov_b32 s22, 614400
    buffer_load_dwordx4 a[36:39], v4, s[48:51], s22 offen sc1
    s_mov_b32 s22, 1187840
    buffer_load_dwordx4 a[40:43], v4, s[48:51], s22 offen sc1
    s_mov_b32 s22, 1761280
    buffer_load_dwordx4 a[44:47], v4, s[48:51], s22 offen sc1
L_n2:
    s_cmp_eq_u32 s87, 0
    s_cbranch_scc1 L_n3
L_c3:
    v_cmp_gt_u32 vcc, 4, v24
    s_and_b32 s3, vcc_lo, 0xffff
    s_cbranch_scc0 L_go3
    v_mov_b32 v24, 0
    buffer_atomic_or v24, v2, s[52:55], 0 offen sc0 sc1
    s_waitcnt vmcnt(0)
    s_add_u32 s69, s69, 1
    s_cmp_gt_u32 s69, 200000
    s_cbranch_scc1 L_end
    s_branch L_c3
L_go3:
    s_mov_b32 s22, 61440
    s_waitcnt vmcnt(20)
    buffer_load_dwordx4 a[48:51], v4, s[48:51], s22 offen sc1
    s_mov_b32 s22, 634880
    s_waitcnt vmcnt(20)
    buffer_load_dwordx4 a[52:55], v4, s[48:51], s22 offen sc1
    s_mov_b32 s22, 1208320
    s_waitcnt vmcnt(20)
    buffer_load_dwordx4 a[56:59], v4, s[48:51], s22 offen sc1
    s_mov_b32 s22, 1781760
    s_waitcnt vmcnt(20)
    buffer_load_dwordx4 a[60:63], v4, s[48:51], s22 offen sc1
    s_mov_b32 s22, 0
    s_waitcnt vmcnt(20)
    buffer_load_dwordx4 a[112:115], v5, s[48:51], s22 offen sc1
    s_mov_b32 s22, 573440
    s_waitcnt vmcnt(20)
    buffer_load_dwordx4 a[116:119], v5, s[48:51], s22 offen sc1
    s_mov_b32 s22, 1146880
    s_waitcnt vmcnt(20)
    buffer_load_dwordx4 a[120:123], v5, s[48:51], s22 offen sc1
    s_mov_b32 s22, 1720320
    s_waitcnt vmcnt(20)
    buffer_load_dwordx4 a[124:127], v5, s[48:51], s22 offen sc1
L_n3:
L_c4:
    v_cmp_gt_u32 vcc, 5, v24
    s_and_b32 s3, vcc_lo, 0xffff
    s_cbranch_scc0 L_go4
    v_mov_b32 v24, 0
    buffer_atomic_or v24, v2, s[52:55], 0 offen sc0 sc1
    s_waitcnt vmcnt(0)
    s_add_u32 s69, s69, 1
    s_cmp_gt_u32 s69, 200000
    s_cbranch_scc1 L_end
    s_branch L_c4
L_go4:
    s_mov_b32 s22, 81920
    buffer_load_dwordx4 a[64:67], v4, s[48:51], s22 offen sc1
    s_mov_b32 s22, 655360
    buffer_load_dwordx4 a[68:71], v4, s[48:51], s22 offen sc1
    s_mov_b32 s22, 1228800
    buffer_load_dwordx4 a[72:75], v4, s[48:51], s22 offen sc1
    s_mov_b32 s22, 1802240
    buffer_load_dwordx4 a[76:79], v4, s[48:51], s22 offen sc1
L_c5:
    v_cmp_gt_u32 vcc, 6, v24
    s_and_b32 s3, vcc_lo, 0xffff
    s_cbranch_scc0 L_go5
    v_mov_b32 v24, 0
    buffer_atomic_or v24, v2, s[52:55], 0 offen sc0 sc1
    s_waitcnt vmcnt(0)
    s_add_u32 s69, s69, 1
    s_cmp_gt_u32 s69, 200000
    s_cbranch_scc1 L_end
    s_branch L_c5
L_go5:
    s_mov_b32 s22, 102400
    buffer_load_dwordx4 a[80:83], v4, s[48:51], s22 offen sc1
    s_mov_b32 s22, 675840
    buffer_load_dwordx4 a[84:87], v4, s[48:51], s22 offen sc1
    s_mov_b32 s22, 1249280
    buffer_load_dwordx4 a[88:91], v4, s[48:51], s22 offen sc1
    s_mov_b32 s22, 1822720
    buffer_load_dwordx4 a[92:95], v4, s[48:51], s22 offen sc1
L_c6:
    v_cmp_gt_u32 vcc, 7, v24
    s_and_b32 s3, vcc_lo, 0xffff
    s_cbranch_scc0 L_go6
    v_mov_b32 v24, 0
    buffer_atomic_or v24, v2, s[52:55], 0 offen sc0 sc1
    s_waitcnt vmcnt(0)
    s_add_u32 s69, s69, 1
    s_cmp_gt_u32 s69, 200000
    s_cbranch_scc1 L_end
    s_branch L_c6
L_go6:
    s_mov_b32 s22, 122880
    buffer_load_dwordx4 a[96:99], v4, s[48:51], s22 offen sc1
    s_mov_b32 s22, 696320
    buffer_load_dwordx4 a[100:103], v4, s[48:51], s22 offen sc1
    s_mov_b32 s22, 1269760
    buffer_load_dwordx4 a[104:107], v4, s[48:51], s22 offen sc1
    s_mov_b32 s22, 1843200
    buffer_load_dwordx4 a[108:111], v4, s[48:51], s22 offen sc1
    s_mov_b32 s22, 81920
    buffer_load_dwordx4 a[128:131], v41, s[48:51], s22 offen sc1
    s_mov_b32 s22, 655360
    buffer_load_dwordx4 a[132:135], v41, s[48:51], s22 offen sc1
    s_mov_b32 s22, 1228800
    buffer_load_dwordx4 a[136:139], v41, s[48:51], s22 offen sc1
    s_mov_b32 s22, 1802240
    buffer_load_dwordx4 a[140:143], v41, s[48:51], s22 offen sc1
    s_waitcnt vmcnt(16)
    v_mfma_f32_16x16x32_bf16 v[96:99], v[44:47], a[0:3], 0
    v_mfma_f32_16x16x32_bf16 v[96:99], v[44:47], a[4:7], v[96:99]
    v_mfma_f32_16x16x32_bf16 v[96:99], v[44:47], a[8:11], v[96:99]
    v_mfma_f32_16x16x32_bf16 v[96:99], v[44:47], a[12:15], v[96:99]
    v_mfma_f32_16x16x32_bf16 v[100:103], v[44:47], a[16:19], 0
    v_mfma_f32_16x16x32_bf16 v[100:103], v[44:47], a[20:23], v[100:103]
    v_mfma_f32_16x16x32_bf16 v[100:103], v[44:47], a[24:27], v[100:103]
    v_mfma_f32_16x16x32_bf16 v[100:103], v[44:47], a[28:31], v[100:103]
    v_mfma_f32_16x16x32_bf16 v[104:107], v[44:47], a[32:35], 0
    v_mfma_f32_16x16x32_bf16 v[104:107], v[44:47], a[36:39], v[104:107]
    v_mfma_f32_16x16x32_bf16 v[104:107], v[44:47], a[40:43], v[104:107]
    v_mfma_f32_16x16x32_bf16 v[104:107], v[44:47], a[44:47], v[104:107]
    v_cvt_pk_bf16_f32 v96, v96, v97
    v_cvt_pk_bf16_f32 v97, v98, v99
    buffer_store_dwordx2 v[96:97], v39, s[64:67], s89 offen sc1
    v_mfma_f32_16x16x32_bf16 v[108:111], v[44:47], a[48:51], 0
    v_mfma_f32_16x16x32_bf16 v[108:111], v[44:47], a[52:55], v[108:111]
    v_mfma_f32_16x16x32_bf16 v[108:111], v[44:47], a[56:59], v[108:111]
    v_mfma_f32_16x16x32_bf16 v[108:111], v[44:47], a[60:63], v[108:111]
    v_cvt_pk_bf16_f32 v100, v100, v101
    v_cvt_pk_bf16_f32 v101, v102, v103
    buffer_store_dwordx2 v[100:101], v39, s[64:67], s90 offen sc1
    v_mfma_f32_16x16x32_bf16 v[124:127], v[44:47], a[112:115], 0
    v_mfma_f32_16x16x32_bf16 v[124:127], v[44:47], a[116:119], v[124:127]
    v_mfma_f32_16x16x32_bf16 v[124:127], v[44:47], a[120:123], v[124:127]
    v_mfma_f32_16x16x32_bf16 v[124:127], v[44:47], a[124:127], v[124:127]
    v_cvt_pk_bf16_f32 v104, v104, v105
    v_cvt_pk_bf16_f32 v105, v106, v107
    buffer_store_dwordx2 v[104:105], v39, s[64:67], s91 offen sc1
    s_waitcnt vmcnt(18)
    v_mfma_f32_16x16x32_bf16 v[112:115], v[44:47], a[64:67], 0
    s_waitcnt vmcnt(17)
    v_mfma_f32_16x16x32_bf16 v[112:115], v[44:47], a[68:71], v[112:115]
    s_waitcnt vmcnt(16)
    v_mfma_f32_16x16x32_bf16 v[112:115], v[44:47], a[72:75], v[112:115]
    s_waitcnt vmcnt(15)
    v_mfma_f32_16x16x32_bf16 v[112:115], v[44:47], a[76:79], v[112:115]
    v_cvt_pk_bf16_f32 v108, v108, v109
    v_cvt_pk_bf16_f32 v109, v110, v111
    buffer_store_dwordx2 v[108:109], v39, s[64:67], s92 offen sc1
    s_waitcnt vmcnt(15)
    v_mfma_f32_16x16x32_bf16 v[116:119], v[44:47], a[80:83], 0
    s_waitcnt vmcnt(14)
    v_mfma_f32_16x16x32_bf16 v[116:119], v[44:47], a[84:87], v[116:119]
    s_waitcnt vmcnt(13)
    v_mfma_f32_16x16x32_bf16 v[116:119], v[44:47], a[88:91], v[116:119]
    s_waitcnt vmcnt(12)
    v_mfma_f32_16x16x32_bf16 v[116:119], v[44:47], a[92:95], v[116:119]
    v_cvt_pk_bf16_f32 v124, v124, v125
    v_cvt_pk_bf16_f32 v125, v126, v127
    buffer_store_dwordx2 v[124:125], v40, s[64:67], s97 offen sc1
    v_cvt_pk_bf16_f32 v112, v112, v113
    v_cvt_pk_bf16_f32 v113, v114, v115
    buffer_store_dwordx2 v[112:113], v39, s[64:67], s93 offen sc1
    s_nop 1
    v_cvt_pk_bf16_f32 v116, v116, v117
    v_cvt_pk_bf16_f32 v117, v118, v119
    buffer_store_dwordx2 v[116:117], v39, s[64:67], s94 offen sc1
    s_waitcnt vmcnt(14)
    v_mfma_f32_16x16x32_bf16 v[120:123], v[44:47], a[96:99], 0
    s_waitcnt vmcnt(13)
    v_mfma_f32_16x16x32_bf16 v[120:123], v[44:47], a[100:103], v[120:123]
    s_waitcnt vmcnt(12)
    v_mfma_f32_16x16x32_bf16 v[120:123], v[44:47], a[104:107], v[120:123]
    s_waitcnt vmcnt(11)
    v_mfma_f32_16x16x32_bf16 v[120:123], v[44:47], a[108:111], v[120:123]
    s_waitcnt vmcnt(10)
    v_mfma_f32_16x16x32_bf16 v[128:131], v[44:47], a[128:131], 0
    s_waitcnt vmcnt(9)
    v_mfma_f32_16x16x32_bf16 v[128:131], v[44:47], a[132:135], v[128:131]
    s_waitcnt vmcnt(8)
    v_mfma_f32_16x16x32_bf16 v[128:131], v[44:47], a[136:139], v[128:131]
    s_waitcnt vmcnt(7)
    v_mfma_f32_16x16x32_bf16 v[128:131], v[44:47], a[140:143], v[128:131]
    v_cvt_pk_bf16_f32 v120, v120, v121
    v_cvt_pk_bf16_f32 v121, v122, v123
    buffer_store_dwordx2 v[120:121], v39, s[64:67], s95 offen sc1
    s_nop 4
    v_cvt_pk_bf16_f32 v128, v128, v129
    v_cvt_pk_bf16_f32 v129, v130, v131
    buffer_store_dwordx2 v[128:129], v42, s[64:67], s98 offen sc1
L_end:
    s_endpgm
L_hs:
    s_mov_b32 s69, 0
L_hs1:
    buffer_load_dword v33, off, s[56:59], 0 sc1
    s_waitcnt vmcnt(0)
    s_add_u32 s69, s69, 1
    s_cmp_gt_u32 s69, 200000
    s_cbranch_scc1 L_end
    v_cmp_eq_u32 vcc, 0, v33
    s_cbranch_vccnz L_hs1
    s_branch L_hsr
L_fb:
    s_waitcnt vmcnt(0) lgkmcnt(0)
    s_barrier
    s_nop 15
    v_and_b32 v4, 15, v0
    v_bfe_u32 v5, v0, 6, 1
    v_lshl_add_u32 v4, v5, 4, v4
    v_lshlrev_b32 v4, 9, v4
    v_and_b32 v6, 48, v0
    v_add_u32 v4, v4, v6
    v_lshl_add_u32 v2, v5, 6, v4
    v_xor_b32 v3, 64, v2
    v_mov_b32 v31, 0xff800000
    v_mov_b32 v32, 0xff800000
    v_mov_b32 v33, 0xff800000
    v_mov_b32 v34, 0xff800000
    v_mov_b32 v35, 0xff800000
    s_mov_b32 s22, 0
L_fbl:
    buffer_load_dwordx4 a[200:203], v2, s[32:35], s22 offen offset:0
    buffer_load_dwordx4 a[204:207], v3, s[32:35], s22 offen offset:0
    buffer_load_dwordx4 a[208:211], v2, s[32:35], s22 offen offset:128
    buffer_load_dwordx4 a[212:215], v3, s[32:35], s22 offen offset:128
    buffer_load_dwordx4 a[216:219], v2, s[32:35], s22 offen offset:256
    buffer_load_dwordx4 a[220:223], v3, s[32:35], s22 offen offset:256
    buffer_load_dwordx4 a[224:227], v2, s[32:35], s22 offen offset:384
    buffer_load_dwordx4 a[228:231], v3, s[32:35], s22 offen offset:384
    s_waitcnt vmcnt(7)
    v_mfma_f32_16x16x32_bf16 v[36:39], a[200:203], a[0:3], 0
    v_mfma_f32_16x16x32_bf16 v[40:43], a[200:203], a[4:7], 0
    v_mfma_f32_16x16x32_bf16 v[44:47], a[200:203], a[8:11], 0
    v_mfma_f32_16x16x32_bf16 v[48:51], a[200:203], a[12:15], 0
    v_mfma_f32_16x16x32_bf16 v[52:55], a[200:203], a[16:19], 0
    s_waitcnt vmcnt(6)
    v_mfma_f32_16x16x32_bf16 v[36:39], a[204:207], a[20:23], v[36:39]
    v_mfma_f32_16x16x32_bf16 v[40:43], a[204:207], a[24:27], v[40:43]
    v_mfma_f32_16x16x32_bf16 v[44:47], a[204:207], a[28:31], v[44:47]
    v_mfma_f32_16x16x32_bf16 v[48:51], a[204:207], a[32:35], v[48:51]
    v_mfma_f32_16x16x32_bf16 v[52:55], a[204:207], a[36:39], v[52:55]
    s_waitcnt vmcnt(5)
    v_mfma_f32_16x16x32_bf16 v[36:39], a[208:211], a[40:43], v[36:39]
    v_mfma_f32_16x16x32_bf16 v[40:43], a[208:211], a[44:47], v[40:43]
    v_mfma_f32_16x16x32_bf16 v[44:47], a[208:211], a[48:51], v[44:47]
    v_mfma_f32_16x16x32_bf16 v[48:51], a[208:211], a[52:55], v[48:51]
    v_mfma_f32_16x16x32_bf16 v[52:55], a[208:211], a[56:59], v[52:55]
    s_waitcnt vmcnt(4)
    v_mfma_f32_16x16x32_bf16 v[36:39], a[212:215], a[60:63], v[36:39]
    v_mfma_f32_16x16x32_bf16 v[40:43], a[212:215], a[64:67], v[40:43]
    v_mfma_f32_16x16x32_bf16 v[44:47], a[212:215], a[68:71], v[44:47]
    v_mfma_f32_16x16x32_bf16 v[48:51], a[212:215], a[72:75], v[48:51]
    v_mfma_f32_16x16x32_bf16 v[52:55], a[212:215], a[76:79], v[52:55]
    s_waitcnt vmcnt(3)
    v_mfma_f32_16x16x32_bf16 v[36:39], a[216:219], a[80:83], v[36:39]
    v_mfma_f32_16x16x32_bf16 v[40:43], a[216:219], a[84:87], v[40:43]
    v_mfma_f32_16x16x32_bf16 v[44:47], a[216:219], a[88:91], v[44:47]
    v_mfma_f32_16x16x32_bf16 v[48:51], a[216:219], a[92:95], v[48:51]
    v_mfma_f32_16x16x32_bf16 v[52:55], a[216:219], a[96:99], v[52:55]
    s_waitcnt vmcnt(2)
    v_mfma_f32_16x16x32_bf16 v[36:39], a[220:223], a[100:103], v[36:39]
    v_mfma_f32_16x16x32_bf16 v[40:43], a[220:223], a[104:107], v[40:43]
    v_mfma_f32_16x16x32_bf16 v[44:47], a[220:223], a[108:111], v[44:47]
    v_mfma_f32_16x16x32_bf16 v[48:51], a[220:223], a[112:115], v[48:51]
    v_mfma_f32_16x16x32_bf16 v[52:55], a[220:223], a[116:119], v[52:55]
    s_waitcnt vmcnt(1)
    v_mfma_f32_16x16x32_bf16 v[36:39], a[224:227], a[120:123], v[36:39]
    v_mfma_f32_16x16x32_bf16 v[40:43], a[224:227], a[124:127], v[40:43]
    v_mfma_f32_16x16x32_bf16 v[44:47], a[224:227], a[128:131], v[44:47]
    v_mfma_f32_16x16x32_bf16 v[48:51], a[224:227], a[132:135], v[48:51]
    v_mfma_f32_16x16x32_bf16 v[52:55], a[224:227], a[136:139], v[52:55]
    s_waitcnt vmcnt(0)
    v_mfma_f32_16x16x32_bf16 v[36:39], a[228:231], a[140:143], v[36:39]
    v_mfma_f32_16x16x32_bf16 v[40:43], a[228:231], a[144:147], v[40:43]
    v_mfma_f32_16x16x32_bf16 v[44:47], a[228:231], a[148:151], v[44:47]
    v_mfma_f32_16x16x32_bf16 v[48:51], a[228:231], a[152:155], v[48:51]
    v_mfma_f32_16x16x32_bf16 v[52:55], a[228:231], a[156:159], v[52:55]
    s_nop 3
    v_max3_f32 v31, v31, v36, v37
    v_max3_f32 v31, v31, v38, v39
    v_max3_f32 v32, v32, v40, v41
    v_max3_f32 v32, v32, v42, v43
    v_max3_f32 v33, v33, v44, v45
    v_max3_f32 v33, v33, v46, v47
    v_max3_f32 v34, v34, v48, v49
    v_max3_f32 v34, v34, v50, v51
    v_max3_f32 v35, v35, v52, v53
    v_max3_f32 v35, v35, v54, v55
    s_add_u32 s22, s22, 16384
    s_cmp_lt_u32 s22, 262144
    s_cbranch_scc1 L_fbl
    v_mov_b32 v26, v31
    s_nop 1
    v_permlane32_swap_b32 v26, v31
    v_max_f32 v31, v26, v31
    v_mov_b32 v27, v32
    s_nop 1
    v_permlane32_swap_b32 v27, v32
    v_max_f32 v32, v27, v32
    v_mov_b32 v28, v33
    s_nop 1
    v_permlane32_swap_b32 v28, v33
    v_max_f32 v33, v28, v33
    v_mov_b32 v29, v34
    s_nop 1
    v_permlane32_swap_b32 v29, v34
    v_max_f32 v34, v29, v34
    v_mov_b32 v30, v35
    s_nop 1
    v_permlane32_swap_b32 v30, v35
    v_max_f32 v35, v30, v35
    v_mov_b32 v26, v31
    s_nop 1
    v_permlane16_swap_b32 v26, v31
    v_max_f32 v31, v26, v31
    v_mov_b32 v27, v32
    s_nop 1
    v_permlane16_swap_b32 v27, v32
    v_max_f32 v32, v27, v32
    v_mov_b32 v28, v33
    s_nop 1
    v_permlane16_swap_b32 v28, v33
    v_max_f32 v33, v28, v33
    v_mov_b32 v29, v34
    s_nop 1
    v_permlane16_swap_b32 v29, v34
    v_max_f32 v34, v29, v34
    v_mov_b32 v30, v35
    s_nop 1
    v_permlane16_swap_b32 v30, v35
    v_max_f32 v35, v30, v35
    v_lshrrev_b32 v3, 7, v0
    v_mul_u32_u24 v3, 80, v3
    v_and_b32 v4, 15, v0
    v_add_u32 v3, v3, v4
    v_bfe_u32 v4, v0, 6, 1
    v_lshlrev_b32 v4, 2, v4
    v_lshl_add_u32 v2, v3, 3, v4
    ds_write_b32 v2, v31 offset:0
    ds_write_b32 v2, v32 offset:128
    ds_write_b32 v2, v33 offset:256
    ds_write_b32 v2, v34 offset:384
    ds_write_b32 v2, v35 offset:512
    s_waitcnt lgkmcnt(0)
    s_barrier
    v_xor_b32 v2, 4, v2
    ds_read_b32 v26, v2 offset:0
    ds_read_b32 v27, v2 offset:128
    ds_read_b32 v28, v2 offset:256
    ds_read_b32 v29, v2 offset:384
    ds_read_b32 v30, v2 offset:512
    s_waitcnt lgkmcnt(4)
    v_max_f32 v31, v26, v31
    s_waitcnt lgkmcnt(3)
    v_max_f32 v32, v27, v32
    s_waitcnt lgkmcnt(2)
    v_max_f32 v33, v28, v33
    s_waitcnt lgkmcnt(1)
    v_max_f32 v34, v29, v34
    s_waitcnt lgkmcnt(0)
    v_max_f32 v35, v30, v35
    v_mul_f32 v31, 0xbdb8aa3b, v31
    v_mul_f32 v32, 0xbdb8aa3b, v32
    v_mul_f32 v33, 0xbdb8aa3b, v33
    v_mul_f32 v34, 0xbdb8aa3b, v34
    v_mul_f32 v35, 0xbdb8aa3b, v35
    s_barrier
    s_cmp_ge_u32 s2, 256
    s_cbranch_scc1 S_end
    s_load_dwordx4 s[4:7], s[0:1], 0
    s_load_dwordx4 s[8:11], s[0:1], 16
    s_load_dwordx4 s[12:15], s[0:1], 32
    s_load_dwordx4 s[72:75], s[0:1], 48
    s_and_b32 s18, s2, 7
    s_lshr_b32 s19, s2, 3
    s_lshr_b32 s16, s18, 1
    s_lshl_b32 s16, s16, 2
    s_lshr_b32 s68, s19, 3
    s_add_u32 s16, s16, s68
    s_and_b32 s17, s18, 1
    s_lshl_b32 s17, s17, 3
    s_and_b32 s68, s19, 7
    s_add_u32 s17, s17, s68
    v_lshrrev_b32 v36, 6, v0
    v_and_b32 v37, 63, v0
    v_bfe_u32 v38, v0, 5, 1
    v_readfirstlane_b32 s20, v36
    v_lshlrev_b32 v39, 1, v38
    v_xor_b32 v39, v39, v0
    v_and_b32 v39, 31, v39
    v_lshlrev_b32 v41, 4, v39
    v_bfe_u32 v39, v0, 6, 1
    v_lshl_add_u32 v39, v39, 4, v38
    v_lshrrev_b32 v40, 7, v0
    v_lshl_add_u32 v39, v40, 2, v39
    v_lshl_add_u32 v6, v39, 13, v41
    v_add_u32 v7, 15296, v6
    v_add_u32 v8, 63360, v6
    v_add_u32 v9, 78656, v6
    v_lshrrev_b32 v39, 3, v0
    v_mul_u32_u24 v39, 896, v39
    v_lshrrev_b32 v40, 4, v0
    v_xor_b32 v40, v40, v0
    v_and_b32 v40, 7, v40
    v_lshl_add_u32 v14, v40, 4, v39
    s_mul_i32 s21, s20, 4352
    s_lshl_b32 s60, s20, 12
    s_lshl_b32 s61, s20, 10
    s_lshl_b32 s18, s17, 1
    s_add_u32 s18, s18, s16
    s_mul_i32 s19, s18, 37
    s_lshr_b32 s19, s19, 8
    s_mul_i32 s19, s19, 7
    s_sub_u32 s89, s18, s19
    s_lshl_b32 s89, s89, 7
    s_add_u32 s90, s89, 128
    s_cmp_eq_u32 s90, 896
    s_cselect_b32 s90, 0, s90
    s_add_u32 s91, s90, 128
    s_cmp_eq_u32 s91, 896
    s_cselect_b32 s91, 0, s91
    s_add_u32 s92, s91, 128
    s_cmp_eq_u32 s92, 896
    s_cselect_b32 s92, 0, s92
    s_add_u32 s93, s92, 128
    s_cmp_eq_u32 s93, 896
    s_cselect_b32 s93, 0, s93
    s_add_u32 s94, s93, 128
    s_cmp_eq_u32 s94, 896
    s_cselect_b32 s94, 0, s94
    s_add_u32 s95, s94, 128
    s_cmp_eq_u32 s95, 896
    s_cselect_b32 s95, 0, s95
    s_cmp_lt_u32 s20, 2
    s_cselect_b32 s96, s94, s95
    s_lshl_b32 s96, s96, 12
    s_waitcnt lgkmcnt(0)
    s_lshl_b32 s18, s17, 9
    s_add_u32 s28, s10, s18
    s_addc_u32 s29, s11, 0
    s_sub_u32 s30, 3670016, s18
    s_mov_b32 s31, 0x20000
    s_mul_i32 s18, s16, 143360
    s_add_u32 s24, s4, s18
    s_addc_u32 s25, s5, 0
    s_mov_b32 s26, 143360
    s_mov_b32 s27, 0x20000
    s_add_u32 m0, s21, 0
    s_lshl_b32 s22, s89, 12
    buffer_load_dwordx4 v6, s[28:31], s22 offen lds
    buffer_load_dwordx4 v7, s[28:31], s22 offen offset:1088 lds
    buffer_load_dwordx4 v8, s[28:31], s22 offen offset:2176 lds
    buffer_load_dwordx4 v9, s[28:31], s22 offen offset:3264 lds
    s_add_u32 m0, s61, 143360
    s_add_u32 s22, s89, 0
    buffer_load_dwordx4 v14, s[24:27], s22 offen lds
    s_add_u32 m0, s61, 147456
    s_add_u32 s22, s89, 28672
    buffer_load_dwordx4 v14, s[24:27], s22 offen lds
    s_add_u32 m0, s61, 151552
    s_add_u32 s22, s89, 57344
    buffer_load_dwordx4 v14, s[24:27], s22 offen lds
    s_add_u32 m0, s61, 155648
    s_add_u32 s22, s89, 86016
    buffer_load_dwordx4 v14, s[24:27], s22 offen lds
    s_add_u32 m0, s61, 159744
    s_add_u32 s22, s89, 114688
    buffer_load_dwordx4 v14, s[24:27], s22 offen lds
    s_add_u32 m0, s21, 17408
    s_lshl_b32 s22, s89, 12
    s_bitset1_b32 s22, 18
    buffer_load_dwordx4 v6, s[28:31], s22 offen lds
    buffer_load_dwordx4 v7, s[28:31], s22 offen offset:1088 lds
    buffer_load_dwordx4 v8, s[28:31], s22 offen offset:2176 lds
    buffer_load_dwordx4 v9, s[28:31], s22 offen offset:3264 lds
    s_add_u32 s64, s14, s18
    s_addc_u32 s65, s15, 0
    s_mov_b32 s66, 143360
    s_mov_b32 s67, 0x20000
    s_lshl_b32 s18, s16, 4
    s_add_u32 s18, s18, s17
    s_lshl_b32 s19, s18, 18
    s_add_u32 s32, s6, s19
    s_addc_u32 s33, s7, 0
    s_mov_b32 s34, 262144
    s_mov_b32 s35, 0x20000
    s_add_u32 s36, s8, s19
    s_addc_u32 s37, s9, 0
    s_mov_b32 s38, 262144
    s_mov_b32 s39, 0x20000
    s_mul_i32 s19, s17, 229376
    s_add_u32 s40, s12, s19
    s_addc_u32 s41, s13, 0
    s_mov_b32 s42, 229376
    s_mov_b32 s43, 0x20000
    s_mul_i32 s19, s18, 143360
    s_add_u32 s19, s19, 0
    s_add_u32 s44, s74, s19
    s_addc_u32 s45, s75, 0
    s_mov_b32 s46, 143360
    s_mov_b32 s47, 0x20000
    s_mul_i32 s19, s16, 2293760
    s_add_u32 s19, s19, 0
    s_add_u32 s48, s74, s19
    s_addc_u32 s49, s75, 0
    s_mov_b32 s50, 2293760
    s_mov_b32 s51, 0x20000
    s_mul_i32 s19, s16, 1024
    s_add_u32 s19, s19, 37748736
    s_add_u32 s52, s74, s19
    s_addc_u32 s53, s75, 0
    s_mov_b32 s54, 1024
    s_mov_b32 s55, 0x20000
    s_lshl_b32 s19, s16, 2
    s_add_u32 s19, s19, 128
    s_add_u32 s56, s72, s19
    s_addc_u32 s57, s73, 0
    s_mov_b32 s58, 4
    s_mov_b32 s59, 0x20000
    s_xor_b32 s19, s17, 1
    s_mul_i32 s19, s19, 229376
    s_add_u32 s80, s12, s19
    s_addc_u32 s81, s13, 0
    s_mov_b32 s82, 229376
    s_mov_b32 s83, 0x20000
    s_mul_i32 s62, s20, 5120
    s_add_u32 s63, s62, 4096
    s_mov_b32 s23, 0x3db8aa3b
    s_mov_b32 s76, s23
    s_mov_b32 s77, s23
    v_lshrrev_b32 v39, 5, v0
    v_lshl_add_u32 v2, v39, 9, v41
    v_add_u32 v3, 3008, v2
    v_add_u32 v4, 6016, v2
    v_add_u32 v5, 9024, v2
    v_and_b32 v42, 15, v0
    v_bfe_u32 v43, v0, 4, 2
    v_bfe_u32 v44, v0, 2, 2
    v_and_b32 v45, 3, v0
    v_bfe_u32 v46, v0, 6, 1
    v_lshlrev_b32 v47, 1, v43
    v_xor_b32 v47, v47, v0
    v_and_b32 v47, 7, v47
    v_lshlrev_b32 v47, 4, v47
    v_bfe_u32 v39, v0, 3, 3
    v_mul_u32_u24 v39, 1088, v39
    v_lshl_add_u32 v39, v45, 3, v39
    v_lshl_add_u32 v39, v46, 6, v39
    v_and_b32 v40, 1, v44
    v_lshl_add_u32 v39, v40, 9, v39
    v_lshl_add_u32 v15, v40, 5, v39
    v_xor_b32 v40, 1, v40
    v_lshl_add_u32 v16, v40, 5, v39
    v_lshrrev_b32 v39, 7, v0
    v_mul_u32_u24 v39, 80, v39
    v_add_u32 v39, v39, v42
    v_lshlrev_b32 v39, 7, v39
    v_lshrrev_b32 v40, 1, v42
    v_xor_b32 v40, v40, v43
    v_lshl_add_u32 v19, v40, 4, v39
    v_xor_b32 v20, 64, v19
    v_bfe_u32 v39, v0, 2, 4
    v_lshlrev_b32 v39, 7, v39
    v_lshl_add_u32 v39, v45, 3, v39
    v_bfe_u32 v40, v0, 3, 2
    v_lshlrev_b32 v18, 1, v46
    v_xor_b32 v40, v40, v18
    v_lshl_add_u32 v17, v40, 5, v39
    v_xor_b32 v18, 32, v17
    v_bfe_u32 v39, v0, 3, 2
    v_lshl_add_u32 v39, v38, 3, v39
    v_lshl_add_u32 v39, v46, 5, v39
    v_lshl_add_u32 v26, v39, 13, v47
    v_add_u32 v27, 130048, v26
    v_add_u32 v28, 30720, v26
    v_add_u32 v29, 160768, v26
    v_lshrrev_b32 v39, 1, v42
    v_lshl_add_u32 v39, v46, 3, v39
    v_mul_u32_u24 v39, 1088, v39
    v_and_b32 v40, 1, v42
    v_lshl_add_u32 v39, v40, 9, v39
    v_lshlrev_b32 v40, 1, v40
    v_xor_b32 v40, v40, v43
    v_lshl_add_u32 v39, v40, 4, v39
    v_lshl_add_u32 v24, v46, 6, v39
    v_xor_b32 v40, 1, v46
    v_lshl_add_u32 v25, v40, 6, v39
    v_mul_u32_u24 v39, 5120, v36
    v_lshl_add_u32 v22, v37, 4, v39
    v_lshl_add_u32 v39, v42, 4, v39
    v_lshl_add_u32 v39, v38, 8, v39
    v_and_b32 v40, 1, v43
    v_lshl_add_u32 v21, v40, 3, v39
    v_xor_b32 v39, 1, v36
    v_mul_u32_u24 v39, 5120, v39
    v_lshl_add_u32 v23, v37, 4, v39
    s_waitcnt vmcnt(4)
    s_barrier
    ds_read_b64_tr_b16 a[200:201], v15
    ds_read_b64_tr_b16 a[202:203], v15 offset:8704
    ds_read_b64_tr_b16 a[204:205], v16
    ds_read_b64_tr_b16 a[206:207], v16 offset:8704
    v_add_u32 v19, 0x23000, v19
    ds_read_b128 a[160:163], v19
    ds_read_b128 a[164:167], v19 offset:2048
    ds_read_b128 a[168:171], v19 offset:4096
    ds_read_b128 a[172:175], v19 offset:6144
    ds_read_b128 a[176:179], v19 offset:8192
    s_waitcnt lgkmcnt(4)
    v_mfma_f32_16x16x32_bf16 v[96:99], a[200:203], a[160:163], 0
    ds_read_b64_tr_b16 a[208:209], v15 offset:128
    s_waitcnt lgkmcnt(4)
    v_mfma_f32_16x16x32_bf16 v[100:103], a[200:203], a[164:167], 0
    ds_read_b64_tr_b16 a[210:211], v15 offset:8832
    s_waitcnt lgkmcnt(4)
    v_mfma_f32_16x16x32_bf16 v[104:107], a[200:203], a[168:171], 0
    s_add_u32 m0, s61, 121856
    s_add_u32 s22, s90, 0
    buffer_load_dwordx4 v14, s[24:27], s22 offen lds
    s_waitcnt lgkmcnt(3)
    v_mfma_f32_16x16x32_bf16 v[108:111], a[200:203], a[172:175], 0
    s_add_u32 m0, s61, 125952
    s_add_u32 s22, s90, 28672
    buffer_load_dwordx4 v14, s[24:27], s22 offen lds
    s_waitcnt lgkmcnt(2)
    v_mfma_f32_16x16x32_bf16 v[112:115], a[200:203], a[176:179], 0
    s_add_u32 m0, s61, 130048
    s_add_u32 s22, s90, 57344
    buffer_load_dwordx4 v14, s[24:27], s22 offen lds
    v_mfma_f32_16x16x32_bf16 v[116:119], a[204:207], a[160:163], 0
    ds_read_b64_tr_b16 a[212:213], v16 offset:128
    ds_read_b64_tr_b16 a[214:215], v16 offset:8832
    v_mfma_f32_16x16x32_bf16 v[120:123], a[204:207], a[164:167], 0
    s_add_u32 m0, s61, 134144
    s_add_u32 s22, s90, 86016
    buffer_load_dwordx4 v14, s[24:27], s22 offen lds
    v_mfma_f32_16x16x32_bf16 v[124:127], a[204:207], a[168:171], 0
    s_add_u32 m0, s61, 138240
    s_add_u32 s22, s90, 114688
    buffer_load_dwordx4 v14, s[24:27], s22 offen lds
    v_mfma_f32_16x16x32_bf16 v[128:131], a[204:207], a[172:175], 0
    ds_read_b64_tr_b16 a[216:217], v15 offset:256
    ds_read_b64_tr_b16 a[218:219], v15 offset:8960
    v_mfma_f32_16x16x32_bf16 v[132:135], a[204:207], a[176:179], 0
    s_add_u32 m0, s21, 34816
    s_lshl_b32 s22, s90, 12
    buffer_load_dwordx4 v6, s[28:31], s22 offen lds
    s_waitcnt lgkmcnt(4)
    v_mfma_f32_16x16x32_bf16 v[136:139], a[208:211], a[160:163], 0
    ds_read_b64_tr_b16 a[220:221], v16 offset:256
    ds_read_b64_tr_b16 a[222:223], v16 offset:8960
    v_mfma_f32_16x16x32_bf16 v[140:143], a[208:211], a[164:167], 0
    buffer_load_dwordx4 v7, s[28:31], s22 offen offset:1088 lds
    v_add_u32 v20, 0x23000, v20
    ds_read_b128 a[180:183], v20
    v_mfma_f32_16x16x32_bf16 v[144:147], a[208:211], a[168:171], 0
    ds_read_b64_tr_b16 a[200:201], v15 offset:384
    ds_read_b64_tr_b16 a[202:203], v15 offset:9088
    v_mfma_f32_16x16x32_bf16 v[148:151], a[208:211], a[172:175], 0
    buffer_load_dwordx4 v8, s[28:31], s22 offen offset:2176 lds
    ds_read_b128 a[184:187], v20 offset:2048
    v_mfma_f32_16x16x32_bf16 v[152:155], a[208:211], a[176:179], 0
    ds_read_b128 a[188:191], v20 offset:4096
    s_waitcnt lgkmcnt(9)
    v_mfma_f32_16x16x32_bf16 v[156:159], a[212:215], a[160:163], 0
    buffer_load_dwordx4 v9, s[28:31], s22 offen offset:3264 lds
    ds_read_b64_tr_b16 a[204:205], v16 offset:384
    v_mfma_f32_16x16x32_bf16 v[160:163], a[212:215], a[164:167], 0
    ds_read_b64_tr_b16 a[206:207], v16 offset:9088
    ds_read_b128 a[192:195], v20 offset:6144
    v_mfma_f32_16x16x32_bf16 v[164:167], a[212:215], a[168:171], 0
    s_add_u32 m0, s60, 69632
    s_add_u32 s22, s96, 384
    buffer_load_dwordx4 v26, s[28:31], s22 offen lds
    v_mfma_f32_16x16x32_bf16 v[168:171], a[212:215], a[172:175], 0
    ds_read_b128 a[196:199], v20 offset:8192
    v_mfma_f32_16x16x32_bf16 v[172:175], a[212:215], a[176:179], 0
    buffer_load_dwordx4 v27, s[28:31], s22 offen offset:1024 lds
    s_waitcnt lgkmcnt(11)
    v_mfma_f32_16x16x32_bf16 v[176:179], a[216:219], a[160:163], 0
    v_mfma_f32_16x16x32_bf16 v[180:183], a[216:219], a[164:167], 0
    buffer_load_dwordx4 v28, s[28:31], s22 offen offset:2048 lds
    v_mfma_f32_16x16x32_bf16 v[184:187], a[216:219], a[168:171], 0
    v_mfma_f32_16x16x32_bf16 v[188:191], a[216:219], a[172:175], 0
    buffer_load_dwordx4 v29, s[28:31], s22 offen offset:3072 lds
    v_mfma_f32_16x16x32_bf16 v[192:195], a[216:219], a[176:179], 0
    s_waitcnt lgkmcnt(9)
    v_mfma_f32_16x16x32_bf16 v[196:199], a[220:223], a[160:163], 0
    s_add_u32 m0, s21, 52224
    s_lshl_b32 s22, s90, 12
    s_bitset1_b32 s22, 18
    buffer_load_dwordx4 v6, s[28:31], s22 offen lds
    v_mfma_f32_16x16x32_bf16 v[200:203], a[220:223], a[164:167], 0
    v_mfma_f32_16x16x32_bf16 v[204:207], a[220:223], a[168:171], 0
    buffer_load_dwordx4 v7, s[28:31], s22 offen offset:1088 lds
    v_mfma_f32_16x16x32_bf16 v[208:211], a[220:223], a[172:175], 0
    v_mfma_f32_16x16x32_bf16 v[212:215], a[220:223], a[176:179], 0
    s_waitcnt vmcnt(10) lgkmcnt(0)
    s_barrier
    v_mfma_f32_16x16x32_bf16 v[216:219], a[200:203], a[160:163], 0
    ds_read_b64_tr_b16 a[208:209], v15 offset:17408
    ds_read_b64_tr_b16 a[210:211], v15 offset:26112
    v_mfma_f32_16x16x32_bf16 v[220:223], a[200:203], a[164:167], 0
    buffer_load_dwordx4 v8, s[28:31], s22 offen offset:2176 lds
    buffer_load_dwordx4 v9, s[28:31], s22 offen offset:3264 lds
    v_mfma_f32_16x16x32_bf16 v[224:227], a[200:203], a[168:171], 0
    ds_read_b64_tr_b16 a[212:213], v16 offset:17408
    ds_read_b64_tr_b16 a[214:215], v16 offset:26112
    v_mfma_f32_16x16x32_bf16 v[228:231], a[200:203], a[172:175], 0
    s_add_u32 m0, s60, 87040
    s_add_u32 s22, s96, 256
    buffer_load_dwordx4 v26, s[28:31], s22 offen lds
    v_mfma_f32_16x16x32_bf16 v[232:235], a[200:203], a[176:179], 0
    ds_read_b64_tr_b16 a[216:217], v15 offset:17536
    ds_read_b64_tr_b16 a[218:219], v15 offset:26240
    v_mfma_f32_16x16x32_bf16 v[236:239], a[204:207], a[160:163], 0
    buffer_load_dwordx4 v27, s[28:31], s22 offen offset:1024 lds
    ds_read_b64_tr_b16 a[220:221], v16 offset:17536
    v_mfma_f32_16x16x32_bf16 v[240:243], a[204:207], a[164:167], 0
    ds_read_b64_tr_b16 a[222:223], v16 offset:26240
    v_add_u32 v19, 0xffffac00, v19
    ds_read_b128 a[120:123], v19
    v_mfma_f32_16x16x32_bf16 v[244:247], a[204:207], a[168:171], 0
    buffer_load_dwordx4 v28, s[28:31], s22 offen offset:2048 lds
    ds_read_b64_tr_b16 a[200:201], v15 offset:17664
    v_mfma_f32_16x16x32_bf16 v[248:251], a[204:207], a[172:175], 0
    ds_read_b64_tr_b16 a[202:203], v15 offset:26368
    ds_read_b128 a[124:127], v19 offset:2048
    v_mfma_f32_16x16x32_bf16 v[252:255], a[204:207], a[176:179], 0
    buffer_load_dwordx4 v29, s[28:31], s22 offen offset:3072 lds
    s_waitcnt lgkmcnt(10)
    v_mfma_f32_16x16x32_bf16 v[96:99], a[208:211], a[180:183], v[96:99]
    ds_read_b128 a[128:131], v19 offset:4096
    ds_read_b128 a[132:135], v19 offset:6144
    v_mfma_f32_16x16x32_bf16 v[100:103], a[208:211], a[184:187], v[100:103]
    s_add_u32 m0, s60, 104448
    s_add_u32 s22, s96, 128
    buffer_load_dwordx4 v26, s[28:31], s22 offen lds
    v_mfma_f32_16x16x32_bf16 v[104:107], a[208:211], a[188:191], v[104:107]
    ds_read_b64_tr_b16 a[204:205], v16 offset:17664
    ds_read_b64_tr_b16 a[206:207], v16 offset:26368
    v_mfma_f32_16x16x32_bf16 v[108:111], a[208:211], a[192:195], v[108:111]
    buffer_load_dwordx4 v27, s[28:31], s22 offen offset:1024 lds
    ds_read_b128 a[136:139], v19 offset:8192
    v_mfma_f32_16x16x32_bf16 v[112:115], a[208:211], a[196:199], v[112:115]
    v_add_u32 v20, 0xffffac00, v20
    ds_read_b128 a[140:143], v20
    s_waitcnt lgkmcnt(14)
    v_mfma_f32_16x16x32_bf16 v[116:119], a[212:215], a[180:183], v[116:119]
    buffer_load_dwordx4 v28, s[28:31], s22 offen offset:2048 lds
    ds_read_b128 a[144:147], v20 offset:2048
    v_mfma_f32_16x16x32_bf16 v[120:123], a[212:215], a[184:187], v[120:123]
    ds_read_b128 a[148:151], v20 offset:4096
    ds_read_b128 a[152:155], v20 offset:6144
    v_mfma_f32_16x16x32_bf16 v[124:127], a[212:215], a[188:191], v[124:127]
    buffer_load_dwordx4 v29, s[28:31], s22 offen offset:3072 lds
    ds_read_b64_tr_b16 a[208:209], v15 offset:17792
    v_mfma_f32_16x16x32_bf16 v[128:131], a[212:215], a[192:195], v[128:131]
    ds_read_b64_tr_b16 a[210:211], v15 offset:26496
    ds_read_b128 a[156:159], v20 offset:8192
    v_mfma_f32_16x16x32_bf16 v[132:135], a[212:215], a[196:199], v[132:135]
    s_waitcnt lgkmcnt(15)
    v_mfma_f32_16x16x32_bf16 v[136:139], a[216:219], a[180:183], v[136:139]
    v_mfma_f32_16x16x32_bf16 v[140:143], a[216:219], a[184:187], v[140:143]
    s_add_u32 m0, s61, 143360
    s_add_u32 s22, s91, 0
    buffer_load_dwordx4 v14, s[24:27], s22 offen lds
    v_mfma_f32_16x16x32_bf16 v[144:147], a[216:219], a[188:191], v[144:147]
    ds_read_b64_tr_b16 a[212:213], v16 offset:17792
    ds_read_b64_tr_b16 a[214:215], v16 offset:26496
    v_mfma_f32_16x16x32_bf16 v[148:151], a[216:219], a[192:195], v[148:151]
    v_mfma_f32_16x16x32_bf16 v[152:155], a[216:219], a[196:199], v[152:155]
    v_mfma_f32_16x16x32_bf16 v[156:159], a[220:223], a[180:183], v[156:159]
    s_add_u32 m0, s61, 147456
    s_add_u32 s22, s91, 28672
    buffer_load_dwordx4 v14, s[24:27], s22 offen lds
    v_mfma_f32_16x16x32_bf16 v[160:163], a[220:223], a[184:187], v[160:163]
    v_mfma_f32_16x16x32_bf16 v[164:167], a[220:223], a[188:191], v[164:167]
    v_mfma_f32_16x16x32_bf16 v[168:171], a[220:223], a[192:195], v[168:171]
    v_mfma_f32_16x16x32_bf16 v[172:175], a[220:223], a[196:199], v[172:175]
    s_add_u32 m0, s61, 151552
    s_add_u32 s22, s91, 57344
    buffer_load_dwordx4 v14, s[24:27], s22 offen lds
    s_waitcnt lgkmcnt(15)
    v_mfma_f32_16x16x32_bf16 v[176:179], a[200:203], a[180:183], v[176:179]
    v_mfma_f32_16x16x32_bf16 v[180:183], a[200:203], a[184:187], v[180:183]
    v_mfma_f32_16x16x32_bf16 v[184:187], a[200:203], a[188:191], v[184:187]
    v_mfma_f32_16x16x32_bf16 v[188:191], a[200:203], a[192:195], v[188:191]
    s_add_u32 m0, s61, 155648
    s_add_u32 s22, s91, 86016
    buffer_load_dwordx4 v14, s[24:27], s22 offen lds
    v_mfma_f32_16x16x32_bf16 v[192:195], a[200:203], a[196:199], v[192:195]
    s_waitcnt lgkmcnt(10)
    v_mfma_f32_16x16x32_bf16 v[196:199], a[204:207], a[180:183], v[196:199]
    v_mfma_f32_16x16x32_bf16 v[200:203], a[204:207], a[184:187], v[200:203]
    v_mfma_f32_16x16x32_bf16 v[204:207], a[204:207], a[188:191], v[204:207]
    s_add_u32 m0, s61, 159744
    s_add_u32 s22, s91, 114688
    buffer_load_dwordx4 v14, s[24:27], s22 offen lds
    v_mfma_f32_16x16x32_bf16 v[208:211], a[204:207], a[192:195], v[208:211]
    v_mfma_f32_16x16x32_bf16 v[212:215], a[204:207], a[196:199], v[212:215]
    s_waitcnt vmcnt(17) lgkmcnt(0)
    s_barrier
    v_mfma_f32_16x16x32_bf16 v[216:219], a[208:211], a[180:183], v[216:219]
    ds_read_b64_tr_b16 a[216:217], v15 offset:34816
    ds_read_b64_tr_b16 a[218:219], v15 offset:43520
    v_mfma_f32_16x16x32_bf16 v[220:223], a[208:211], a[184:187], v[220:223]
    v_add_u32 v17, 0x11000, v17
    ds_read_b64_tr_b16 a[80:81], v17
    v_mfma_f32_16x16x32_bf16 v[224:227], a[208:211], a[188:191], v[224:227]
    s_add_u32 m0, s21, 0
    s_lshl_b32 s22, s91, 12
    buffer_load_dwordx4 v6, s[28:31], s22 offen lds
    v_mfma_f32_16x16x32_bf16 v[228:231], a[208:211], a[192:195], v[228:231]
    ds_read_b64_tr_b16 a[82:83], v17 offset:2048
    ds_read_b64_tr_b16 a[220:221], v16 offset:34816
    v_mfma_f32_16x16x32_bf16 v[232:235], a[208:211], a[196:199], v[232:235]
    ds_read_b64_tr_b16 a[222:223], v16 offset:43520
    v_add_u32 v18, 0x11000, v18
    ds_read_b64_tr_b16 a[84:85], v18
    v_mfma_f32_16x16x32_bf16 v[236:239], a[212:215], a[180:183], v[236:239]
    buffer_load_dwordx4 v7, s[28:31], s22 offen offset:1088 lds
    ds_read_b64_tr_b16 a[86:87], v18 offset:2048
    v_mfma_f32_16x16x32_bf16 v[240:243], a[212:215], a[184:187], v[240:243]
    ds_read_b64_tr_b16 a[200:201], v15 offset:34944
    ds_read_b64_tr_b16 a[202:203], v15 offset:43648
    v_mfma_f32_16x16x32_bf16 v[244:247], a[212:215], a[188:191], v[244:247]
    ds_read_b64_tr_b16 a[88:89], v17 offset:4096
    ds_read_b64_tr_b16 a[90:91], v17 offset:6144
    v_mfma_f32_16x16x32_bf16 v[248:251], a[212:215], a[192:195], v[248:251]
    ds_read_b64_tr_b16 a[92:93], v18 offset:4096
    ds_read_b64_tr_b16 a[204:205], v16 offset:34944
    v_mfma_f32_16x16x32_bf16 v[252:255], a[212:215], a[196:199], v[252:255]
    buffer_load_dwordx4 v8, s[28:31], s22 offen offset:2176 lds
    s_waitcnt lgkmcnt(12)
    v_mfma_f32_16x16x32_bf16 v[96:99], a[216:219], a[120:123], v[96:99]
    ds_read_b64_tr_b16 a[206:207], v16 offset:43648
    ds_read_b64_tr_b16 a[94:95], v18 offset:6144
    v_mfma_f32_16x16x32_bf16 v[100:103], a[216:219], a[124:127], v[100:103]
    ds_read_b64_tr_b16 a[96:97], v17 offset:8192
    ds_read_b64_tr_b16 a[98:99], v17 offset:10240
    v_mfma_f32_16x16x32_bf16 v[104:107], a[216:219], a[128:131], v[104:107]
    ds_read_b64_tr_b16 a[208:209], v15 offset:35072
    ds_read_b64_tr_b16 a[210:211], v15 offset:43776
    v_mfma_f32_16x16x32_bf16 v[108:111], a[216:219], a[132:135], v[108:111]
    buffer_load_dwordx4 v9, s[28:31], s22 offen offset:3264 lds
    ds_read_b64_tr_b16 a[100:101], v18 offset:8192
    v_mfma_f32_16x16x32_bf16 v[112:115], a[216:219], a[136:139], v[112:115]
    ds_read_b64_tr_b16 a[102:103], v18 offset:10240
    s_waitcnt lgkmcnt(15)
    v_mfma_f32_16x16x32_bf16 v[116:119], a[220:223], a[120:123], v[116:119]
    ds_read_b64_tr_b16 a[212:213], v16 offset:35072
    ds_read_b64_tr_b16 a[214:215], v16 offset:43776
    v_mfma_f32_16x16x32_bf16 v[120:123], a[220:223], a[124:127], v[120:123]
    ds_read_b64_tr_b16 a[104:105], v17 offset:12288
    ds_read_b64_tr_b16 a[106:107], v17 offset:14336
    v_mfma_f32_16x16x32_bf16 v[124:127], a[220:223], a[128:131], v[124:127]
    s_add_u32 m0, s61, 121856
    s_add_u32 s22, s92, 0
    buffer_load_dwordx4 v14, s[24:27], s22 offen lds
    v_mfma_f32_16x16x32_bf16 v[128:131], a[220:223], a[132:135], v[128:131]
    ds_read_b64_tr_b16 a[108:109], v18 offset:12288
    ds_read_b64_tr_b16 a[216:217], v15 offset:35200
    v_mfma_f32_16x16x32_bf16 v[132:135], a[220:223], a[136:139], v[132:135]
    ds_read_b64_tr_b16 a[218:219], v15 offset:43904
    s_waitcnt lgkmcnt(15)
    v_mfma_f32_16x16x32_bf16 v[136:139], a[200:203], a[120:123], v[136:139]
    ds_read_b64_tr_b16 a[110:111], v18 offset:14336
    v_mfma_f32_16x16x32_bf16 v[140:143], a[200:203], a[124:127], v[140:143]
    s_add_u32 m0, s61, 125952
    s_add_u32 s22, s92, 28672
    buffer_load_dwordx4 v14, s[24:27], s22 offen lds
    v_mfma_f32_16x16x32_bf16 v[144:147], a[200:203], a[128:131], v[144:147]
    ds_read_b64_tr_b16 a[220:221], v16 offset:35200
    ds_read_b64_tr_b16 a[222:223], v16 offset:43904
    v_mfma_f32_16x16x32_bf16 v[148:151], a[200:203], a[132:135], v[148:151]
    v_mfma_f32_16x16x32_bf16 v[152:155], a[200:203], a[136:139], v[152:155]
    s_waitcnt lgkmcnt(15)
    v_mfma_f32_16x16x32_bf16 v[156:159], a[204:207], a[120:123], v[156:159]
    s_add_u32 m0, s61, 130048
    s_add_u32 s22, s92, 57344
    buffer_load_dwordx4 v14, s[24:27], s22 offen lds
    v_mfma_f32_16x16x32_bf16 v[160:163], a[204:207], a[124:127], v[160:163]
    v_mfma_f32_16x16x32_bf16 v[164:167], a[204:207], a[128:131], v[164:167]
    v_mfma_f32_16x16x32_bf16 v[168:171], a[204:207], a[132:135], v[168:171]
    v_mfma_f32_16x16x32_bf16 v[172:175], a[204:207], a[136:139], v[172:175]
    s_add_u32 m0, s61, 134144
    s_add_u32 s22, s92, 86016
    buffer_load_dwordx4 v14, s[24:27], s22 offen lds
    s_waitcnt lgkmcnt(12)
    v_mfma_f32_16x16x32_bf16 v[176:179], a[208:211], a[120:123], v[176:179]
    v_mfma_f32_16x16x32_bf16 v[180:183], a[208:211], a[124:127], v[180:183]
    v_mfma_f32_16x16x32_bf16 v[184:187], a[208:211], a[128:131], v[184:187]
    v_mfma_f32_16x16x32_bf16 v[188:191], a[208:211], a[132:135], v[188:191]
    s_add_u32 m0, s61, 138240
    s_add_u32 s22, s92, 114688
    buffer_load_dwordx4 v14, s[24:27], s22 offen lds
    v_mfma_f32_16x16x32_bf16 v[192:195], a[208:211], a[136:139], v[192:195]
    s_waitcnt lgkmcnt(8)
    v_mfma_f32_16x16x32_bf16 v[196:199], a[212:215], a[120:123], v[196:199]
    v_mfma_f32_16x16x32_bf16 v[200:203], a[212:215], a[124:127], v[200:203]
    v_mfma_f32_16x16x32_bf16 v[204:207], a[212:215], a[128:131], v[204:207]
    s_add_u32 m0, s21, 17408
    s_lshl_b32 s22, s91, 12
    s_bitset1_b32 s22, 18
    buffer_load_dwordx4 v6, s[28:31], s22 offen lds
    v_mfma_f32_16x16x32_bf16 v[208:211], a[212:215], a[132:135], v[208:211]
    v_mfma_f32_16x16x32_bf16 v[212:215], a[212:215], a[136:139], v[212:215]
    s_waitcnt vmcnt(10) lgkmcnt(0)
    s_barrier
    v_mfma_f32_16x16x32_bf16 v[216:219], a[216:219], a[120:123], v[216:219]
    ds_read_b64_tr_b16 a[200:201], v15 offset:52224
    ds_read_b64_tr_b16 a[202:203], v15 offset:60928
    v_mfma_f32_16x16x32_bf16 v[220:223], a[216:219], a[124:127], v[220:223]
    ds_read_b64_tr_b16 a[40:41], v17 offset:17408
    buffer_load_dwordx4 v7, s[28:31], s22 offen offset:1088 lds
    v_mfma_f32_16x16x32_bf16 v[224:227], a[216:219], a[128:131], v[224:227]
    ds_read_b64_tr_b16 a[42:43], v17 offset:19456
    ds_read_b64_tr_b16 a[204:205], v16 offset:52224
    v_mfma_f32_16x16x32_bf16 v[228:231], a[216:219], a[132:135], v[228:231]
    ds_read_b64_tr_b16 a[206:207], v16 offset:60928
    ds_read_b64_tr_b16 a[44:45], v18 offset:17408
    v_mfma_f32_16x16x32_bf16 v[232:235], a[216:219], a[136:139], v[232:235]
    ds_read_b64_tr_b16 a[46:47], v18 offset:19456
    ds_read_b64_tr_b16 a[208:209], v15 offset:52352
    v_mfma_f32_16x16x32_bf16 v[236:239], a[220:223], a[120:123], v[236:239]
    buffer_load_dwordx4 v8, s[28:31], s22 offen offset:2176 lds
    ds_read_b64_tr_b16 a[210:211], v15 offset:61056
    v_mfma_f32_16x16x32_bf16 v[240:243], a[220:223], a[124:127], v[240:243]
    ds_read_b64_tr_b16 a[48:49], v17 offset:21504
    ds_read_b64_tr_b16 a[50:51], v17 offset:23552
    v_mfma_f32_16x16x32_bf16 v[244:247], a[220:223], a[128:131], v[244:247]
    ds_read_b64_tr_b16 a[52:53], v18 offset:21504
    ds_read_b64_tr_b16 a[212:213], v16 offset:52352
    v_mfma_f32_16x16x32_bf16 v[248:251], a[220:223], a[132:135], v[248:251]
    ds_read_b64_tr_b16 a[214:215], v16 offset:61056
    ds_read_b64_tr_b16 a[54:55], v18 offset:23552
    v_mfma_f32_16x16x32_bf16 v[252:255], a[220:223], a[136:139], v[252:255]
    buffer_load_dwordx4 v9, s[28:31], s22 offen offset:3264 lds
    s_waitcnt lgkmcnt(14)
    v_mfma_f32_16x16x32_bf16 v[96:99], a[200:203], a[140:143], v[96:99]
    ds_read_b64_tr_b16 a[56:57], v17 offset:25600
    ds_read_b64_tr_b16 a[58:59], v17 offset:27648
    v_mfma_f32_16x16x32_bf16 v[100:103], a[200:203], a[144:147], v[100:103]
    ds_read_b64_tr_b16 a[216:217], v15 offset:52480
    ds_read_b64_tr_b16 a[218:219], v15 offset:61184
    v_mfma_f32_16x16x32_bf16 v[104:107], a[200:203], a[148:151], v[104:107]
    ds_read_b64_tr_b16 a[60:61], v18 offset:25600
    ds_read_b64_tr_b16 a[62:63], v18 offset:27648
    v_mfma_f32_16x16x32_bf16 v[108:111], a[200:203], a[152:155], v[108:111]
    s_add_u32 m0, s21, 34816
    s_lshl_b32 s22, s92, 12
    buffer_load_dwordx4 v6, s[28:31], s22 offen lds
    v_mfma_f32_16x16x32_bf16 v[112:115], a[200:203], a[156:159], v[112:115]
    ds_read_b64_tr_b16 a[220:221], v16 offset:52480
    s_waitcnt lgkmcnt(15)
    v_mfma_f32_16x16x32_bf16 v[116:119], a[204:207], a[140:143], v[116:119]
    ds_read_b64_tr_b16 a[222:223], v16 offset:61184
    ds_read_b64_tr_b16 a[64:65], v17 offset:29696
    v_mfma_f32_16x16x32_bf16 v[120:123], a[204:207], a[144:147], v[120:123]
    ds_read_b64_tr_b16 a[66:67], v17 offset:31744
    ds_read_b128 a[160:163], v19 offset:21504
    v_mfma_f32_16x16x32_bf16 v[124:127], a[204:207], a[148:151], v[124:127]
    buffer_load_dwordx4 v7, s[28:31], s22 offen offset:1088 lds
    ds_read_b128 a[164:167], v19 offset:23552
    v_mfma_f32_16x16x32_bf16 v[128:131], a[204:207], a[152:155], v[128:131]
    ds_read_b128 a[168:171], v19 offset:25600
    ds_read_b128 a[172:175], v19 offset:27648
    v_mfma_f32_16x16x32_bf16 v[132:135], a[204:207], a[156:159], v[132:135]
    ds_read_b64_tr_b16 a[68:69], v18 offset:29696
    s_waitcnt lgkmcnt(15)
    v_mfma_f32_16x16x32_bf16 v[136:139], a[208:211], a[140:143], v[136:139]
    ds_read_b128 a[176:179], v19 offset:29696
    ds_read_b128 a[180:183], v20 offset:21504
    v_mfma_f32_16x16x32_bf16 v[140:143], a[208:211], a[144:147], v[140:143]
    buffer_load_dwordx4 v8, s[28:31], s22 offen offset:2176 lds
    ds_read_b64_tr_b16 a[200:201], v15 offset:52608
    v_mfma_f32_16x16x32_bf16 v[144:147], a[208:211], a[148:151], v[144:147]
    ds_read_b64_tr_b16 a[202:203], v15 offset:61312
    ds_read_b128 a[184:187], v20 offset:23552
    v_mfma_f32_16x16x32_bf16 v[148:151], a[208:211], a[152:155], v[148:151]
    ds_read_b128 a[188:191], v20 offset:25600
    ds_read_b64_tr_b16 a[204:205], v16 offset:52608
    v_mfma_f32_16x16x32_bf16 v[152:155], a[208:211], a[156:159], v[152:155]
    ds_read_b64_tr_b16 a[206:207], v16 offset:61312
    ds_read_b64_tr_b16 a[70:71], v18 offset:31744
    v_mfma_f32_16x16x32_bf16 v[156:159], a[212:215], a[140:143], v[156:159]
    buffer_load_dwordx4 v9, s[28:31], s22 offen offset:3264 lds
    ds_read_b128 a[192:195], v20 offset:27648
    v_mfma_f32_16x16x32_bf16 v[160:163], a[212:215], a[144:147], v[160:163]
    ds_read_b128 a[196:199], v20 offset:29696
    v_mfma_f32_16x16x32_bf16 v[164:167], a[212:215], a[148:151], v[164:167]
    v_mfma_f32_16x16x32_bf16 v[168:171], a[212:215], a[152:155], v[168:171]
    v_mfma_f32_16x16x32_bf16 v[172:175], a[212:215], a[156:159], v[172:175]
    s_add_u32 m0, s21, 69632
    s_lshl_b32 s22, s92, 12
    s_bitset1_b32 s22, 18
    buffer_load_dwordx4 v6, s[28:31], s22 offen lds
    s_waitcnt lgkmcnt(15)
    v_mfma_f32_16x16x32_bf16 v[176:179], a[216:219], a[140:143], v[176:179]
    v_mfma_f32_16x16x32_bf16 v[180:183], a[216:219], a[144:147], v[180:183]
    v_mfma_f32_16x16x32_bf16 v[184:187], a[216:219], a[148:151], v[184:187]
    v_mfma_f32_16x16x32_bf16 v[188:191], a[216:219], a[152:155], v[188:191]
    buffer_load_dwordx4 v7, s[28:31], s22 offen offset:1088 lds
    v_mfma_f32_16x16x32_bf16 v[192:195], a[216:219], a[156:159], v[192:195]
    v_mfma_f32_16x16x32_bf16 v[196:199], a[220:223], a[140:143], v[196:199]
    v_mfma_f32_16x16x32_bf16 v[200:203], a[220:223], a[144:147], v[200:203]
    v_mfma_f32_16x16x32_bf16 v[204:207], a[220:223], a[148:151], v[204:207]
    buffer_load_dwordx4 v8, s[28:31], s22 offen offset:2176 lds
    v_mfma_f32_16x16x32_bf16 v[208:211], a[220:223], a[152:155], v[208:211]
    v_mfma_f32_16x16x32_bf16 v[212:215], a[220:223], a[156:159], v[212:215]
    s_waitcnt vmcnt(11) lgkmcnt(0)
    s_barrier
    v_mfma_f32_16x16x32_bf16 v[216:219], a[200:203], a[140:143], v[216:219]
    ds_read_b64_tr_b16 a[208:209], v15
    ds_read_b64_tr_b16 a[210:211], v15 offset:8704
    v_mfma_f32_16x16x32_bf16 v[220:223], a[200:203], a[144:147], v[220:223]
    ds_read_b64_tr_b16 v[48:49], v17 offset:34816
    buffer_load_dwordx4 v9, s[28:31], s22 offen offset:3264 lds
    v_mfma_f32_16x16x32_bf16 v[224:227], a[200:203], a[148:151], v[224:227]
    ds_read_b64_tr_b16 v[50:51], v17 offset:36864
    ds_read_b64_tr_b16 a[212:213], v16
    v_mfma_f32_16x16x32_bf16 v[228:231], a[200:203], a[152:155], v[228:231]
    ds_read_b64_tr_b16 a[214:215], v16 offset:8704
    ds_read_b64_tr_b16 v[52:53], v18 offset:34816
    v_mfma_f32_16x16x32_bf16 v[232:235], a[200:203], a[156:159], v[232:235]
    ds_read_b64_tr_b16 v[54:55], v18 offset:36864
    ds_read_b64_tr_b16 a[216:217], v15 offset:128
    v_mfma_f32_16x16x32_bf16 v[236:239], a[204:207], a[140:143], v[236:239]
    s_add_u32 m0, s61, 143360
    s_add_u32 s22, s93, 0
    buffer_load_dwordx4 v14, s[24:27], s22 offen lds
    v_mfma_f32_16x16x32_bf16 v[240:243], a[204:207], a[144:147], v[240:243]
    ds_read_b64_tr_b16 a[218:219], v15 offset:8832
    ds_read_b64_tr_b16 v[88:89], v17 offset:38912
    v_mfma_f32_16x16x32_bf16 v[244:247], a[204:207], a[148:151], v[244:247]
    ds_read_b64_tr_b16 v[90:91], v17 offset:40960
    ds_read_b64_tr_b16 v[92:93], v18 offset:38912
    v_mfma_f32_16x16x32_bf16 v[248:251], a[204:207], a[152:155], v[248:251]
    ds_read_b64_tr_b16 a[220:221], v16 offset:128
    ds_read_b64_tr_b16 a[222:223], v16 offset:8832
    v_mfma_f32_16x16x32_bf16 v[252:255], a[204:207], a[156:159], v[252:255]
    s_add_u32 m0, s61, 147456
    s_add_u32 s22, s93, 28672
    buffer_load_dwordx4 v14, s[24:27], s22 offen lds
    s_waitcnt lgkmcnt(13)
    v_mfma_f32_16x16x32_bf16 v[96:99], a[208:211], a[160:163], v[96:99]
    ds_read_b64_tr_b16 v[94:95], v18 offset:40960
    ds_read_b64_tr_b16 a[72:73], v17 offset:43008
    v_mfma_f32_16x16x32_bf16 v[100:103], a[208:211], a[164:167], v[100:103]
    ds_read_b64_tr_b16 a[74:75], v17 offset:45056
    ds_read_b64_tr_b16 a[200:201], v15 offset:256
    v_mfma_f32_16x16x32_bf16 v[104:107], a[208:211], a[168:171], v[104:107]
    ds_read_b64_tr_b16 a[202:203], v15 offset:8960
    ds_read_b64_tr_b16 a[76:77], v18 offset:43008
    v_mfma_f32_16x16x32_bf16 v[108:111], a[208:211], a[172:175], v[108:111]
    s_add_u32 m0, s61, 151552
    s_add_u32 s22, s93, 57344
    buffer_load_dwordx4 v14, s[24:27], s22 offen lds
    v_mfma_f32_16x16x32_bf16 v[112:115], a[208:211], a[176:179], v[112:115]
    ds_read_b64_tr_b16 a[78:79], v18 offset:45056
    s_waitcnt lgkmcnt(15)
    v_mfma_f32_16x16x32_bf16 v[116:119], a[212:215], a[160:163], v[116:119]
    ds_read_b64_tr_b16 a[204:205], v16 offset:256
    ds_read_b64_tr_b16 a[206:207], v16 offset:8960
    v_mfma_f32_16x16x32_bf16 v[120:123], a[212:215], a[164:167], v[120:123]
    ds_read_b64_tr_b16 a[112:113], v17 offset:47104
    ds_read_b64_tr_b16 a[114:115], v17 offset:49152
    v_mfma_f32_16x16x32_bf16 v[124:127], a[212:215], a[168:171], v[124:127]
    s_add_u32 m0, s61, 155648
    s_add_u32 s22, s93, 86016
    buffer_load_dwordx4 v14, s[24:27], s22 offen lds
    v_mfma_f32_16x16x32_bf16 v[128:131], a[212:215], a[172:175], v[128:131]
    ds_read_b128 a[120:123], v19
    ds_read_b128 a[124:127], v19 offset:2048
    v_mfma_f32_16x16x32_bf16 v[132:135], a[212:215], a[176:179], v[132:135]
    ds_read_b128 a[128:131], v19 offset:4096
    s_waitcnt lgkmcnt(15)
    v_mfma_f32_16x16x32_bf16 v[136:139], a[216:219], a[160:163], v[136:139]
    ds_read_b128 a[132:135], v19 offset:6144
    ds_read_b64_tr_b16 a[116:117], v18 offset:47104
    v_mfma_f32_16x16x32_bf16 v[140:143], a[216:219], a[164:167], v[140:143]
    s_add_u32 m0, s61, 159744
    s_add_u32 s22, s93, 114688
    buffer_load_dwordx4 v14, s[24:27], s22 offen lds
    v_mfma_f32_16x16x32_bf16 v[144:147], a[216:219], a[168:171], v[144:147]
    ds_read_b128 a[136:139], v19 offset:8192
    ds_read_b128 a[140:143], v20
    v_mfma_f32_16x16x32_bf16 v[148:151], a[216:219], a[172:175], v[148:151]
    ds_read_b64_tr_b16 a[208:209], v15 offset:384
    ds_read_b64_tr_b16 a[210:211], v15 offset:9088
    v_mfma_f32_16x16x32_bf16 v[152:155], a[216:219], a[176:179], v[152:155]
    ds_read_b128 a[144:147], v20 offset:2048
    s_waitcnt lgkmcnt(15)
    v_mfma_f32_16x16x32_bf16 v[156:159], a[220:223], a[160:163], v[156:159]
    s_add_u32 m0, s21, 87040
    s_lshl_b32 s22, s93, 12
    buffer_load_dwordx4 v6, s[28:31], s22 offen lds
    v_mfma_f32_16x16x32_bf16 v[160:163], a[220:223], a[164:167], v[160:163]
    ds_read_b128 a[148:151], v20 offset:4096
    ds_read_b64_tr_b16 a[212:213], v16 offset:384
    v_mfma_f32_16x16x32_bf16 v[164:167], a[220:223], a[168:171], v[164:167]
    ds_read_b64_tr_b16 a[214:215], v16 offset:9088
    ds_read_b64_tr_b16 a[118:119], v18 offset:49152
    v_mfma_f32_16x16x32_bf16 v[168:171], a[220:223], a[172:175], v[168:171]
    ds_read_b128 a[152:155], v20 offset:6144
    ds_read_b128 a[156:159], v20 offset:8192
    v_mfma_f32_16x16x32_bf16 v[172:175], a[220:223], a[176:179], v[172:175]
    buffer_load_dwordx4 v7, s[28:31], s22 offen offset:1088 lds
    v_mfma_f32_16x16x32_bf16 v[176:179], a[200:203], a[160:163], v[176:179]
    v_mfma_f32_16x16x32_bf16 v[180:183], a[200:203], a[164:167], v[180:183]
    v_mfma_f32_16x16x32_bf16 v[184:187], a[200:203], a[168:171], v[184:187]
    v_mfma_f32_16x16x32_bf16 v[188:191], a[200:203], a[172:175], v[188:191]
    buffer_load_dwordx4 v8, s[28:31], s22 offen offset:2176 lds
    v_mfma_f32_16x16x32_bf16 v[192:195], a[200:203], a[176:179], v[192:195]
    s_waitcnt lgkmcnt(15)
    v_mfma_f32_16x16x32_bf16 v[196:199], a[204:207], a[160:163], v[196:199]
    v_mfma_f32_16x16x32_bf16 v[200:203], a[204:207], a[164:167], v[200:203]
    v_mfma_f32_16x16x32_bf16 v[204:207], a[204:207], a[168:171], v[204:207]
    buffer_load_dwordx4 v9, s[28:31], s22 offen offset:3264 lds
    v_mfma_f32_16x16x32_bf16 v[208:211], a[204:207], a[172:175], v[208:211]
    v_mfma_f32_16x16x32_bf16 v[212:215], a[204:207], a[176:179], v[212:215]
    s_waitcnt vmcnt(17) lgkmcnt(0)
    s_barrier
    v_mfma_f32_16x16x32_bf16 v[216:219], a[208:211], a[160:163], v[216:219]
    ds_read_b64_tr_b16 a[216:217], v15 offset:17408
    ds_read_b64_tr_b16 a[218:219], v15 offset:26112
    v_mfma_f32_16x16x32_bf16 v[220:223], a[208:211], a[164:167], v[220:223]
    s_add_u32 m0, s21, 0
    s_mov_b32 s22, 0
    buffer_load_dwordx4 v2, s[32:35], s22 offen nt lds
    v_mfma_f32_16x16x32_bf16 v[224:227], a[208:211], a[168:171], v[224:227]
    s_add_u32 m0, s21, 52224
    s_lshl_b32 s22, s93, 12
    s_bitset1_b32 s22, 18
    buffer_load_dwordx4 v6, s[28:31], s22 offen lds
    v_mfma_f32_16x16x32_bf16 v[228:231], a[208:211], a[172:175], v[228:231]
    ds_read_b64_tr_b16 a[220:221], v16 offset:17408
    ds_read_b64_tr_b16 a[222:223], v16 offset:26112
    v_mfma_f32_16x16x32_bf16 v[232:235], a[208:211], a[176:179], v[232:235]
    ds_read_b64_tr_b16 a[200:201], v15 offset:17536
    ds_read_b64_tr_b16 a[202:203], v15 offset:26240
    v_mfma_f32_16x16x32_bf16 v[236:239], a[212:215], a[160:163], v[236:239]
    buffer_load_dwordx4 v7, s[28:31], s22 offen offset:1088 lds
    ds_read_b64_tr_b16 a[204:205], v16 offset:17536
    v_mfma_f32_16x16x32_bf16 v[240:243], a[212:215], a[164:167], v[240:243]
    ds_read_b64_tr_b16 a[206:207], v16 offset:26240
    v_mfma_f32_16x16x32_bf16 v[244:247], a[212:215], a[168:171], v[244:247]
    s_add_u32 m0, s21, 0
    s_mov_b32 s22, 0
    buffer_load_dwordx4 v3, s[32:35], s22 offen offset:1088 nt lds
    v_mfma_f32_16x16x32_bf16 v[248:251], a[212:215], a[172:175], v[248:251]
    ds_read_b64_tr_b16 a[208:209], v15 offset:17664
    ds_read_b64_tr_b16 a[210:211], v15 offset:26368
    v_mfma_f32_16x16x32_bf16 v[252:255], a[212:215], a[176:179], v[252:255]
    s_add_u32 m0, s21, 52224
    s_lshl_b32 s22, s93, 12
    s_bitset1_b32 s22, 18
    buffer_load_dwordx4 v8, s[28:31], s22 offen offset:2176 lds
    s_waitcnt lgkmcnt(8)
    v_mfma_f32_16x16x32_bf16 v[96:99], a[216:219], a[180:183], v[96:99]
    v_mfma_f32_16x16x32_bf16 v[100:103], a[216:219], a[184:187], v[100:103]
    v_mfma_f32_16x16x32_bf16 v[104:107], a[216:219], a[188:191], v[104:107]
    ds_read_b64_tr_b16 a[212:213], v16 offset:17664
    ds_read_b64_tr_b16 a[214:215], v16 offset:26368
    v_mfma_f32_16x16x32_bf16 v[108:111], a[216:219], a[192:195], v[108:111]
    buffer_load_dwordx4 v9, s[28:31], s22 offen offset:3264 lds
    v_mfma_f32_16x16x32_bf16 v[112:115], a[216:219], a[196:199], v[112:115]
    s_waitcnt lgkmcnt(8)
    v_mfma_f32_16x16x32_bf16 v[116:119], a[220:223], a[180:183], v[116:119]
    s_add_u32 m0, s21, 0
    s_mov_b32 s22, 0
    buffer_load_dwordx4 v4, s[32:35], s22 offen offset:2176 nt lds
    v_mfma_f32_16x16x32_bf16 v[120:123], a[220:223], a[184:187], v[120:123]
    v_mfma_f32_16x16x32_bf16 v[124:127], a[220:223], a[188:191], v[124:127]
    s_add_u32 m0, s61, 121856
    s_add_u32 s22, s94, 0
    buffer_load_dwordx4 v14, s[24:27], s22 offen lds
    v_mfma_f32_16x16x32_bf16 v[128:131], a[220:223], a[192:195], v[128:131]
    ds_read_b64_tr_b16 a[216:217], v15 offset:17792
    ds_read_b64_tr_b16 a[218:219], v15 offset:26496
    v_mfma_f32_16x16x32_bf16 v[132:135], a[220:223], a[196:199], v[132:135]
    s_waitcnt lgkmcnt(8)
    v_mfma_f32_16x16x32_bf16 v[136:139], a[200:203], a[180:183], v[136:139]
    v_mfma_f32_16x16x32_bf16 v[140:143], a[200:203], a[184:187], v[140:143]
    s_add_u32 m0, s61, 125952
    s_add_u32 s22, s94, 28672
    buffer_load_dwordx4 v14, s[24:27], s22 offen lds
    v_mfma_f32_16x16x32_bf16 v[144:147], a[200:203], a[188:191], v[144:147]
    ds_read_b64_tr_b16 a[220:221], v16 offset:17792
    ds_read_b64_tr_b16 a[222:223], v16 offset:26496
    v_mfma_f32_16x16x32_bf16 v[148:151], a[200:203], a[192:195], v[148:151]
    s_add_u32 m0, s21, 0
    s_mov_b32 s22, 0
    buffer_load_dwordx4 v5, s[32:35], s22 offen offset:3264 nt lds
    v_mfma_f32_16x16x32_bf16 v[152:155], a[200:203], a[196:199], v[152:155]
    v_bfe_u32 v39, v0, 3, 3
    s_waitcnt lgkmcnt(8)
    v_mfma_f32_16x16x32_bf16 v[156:159], a[204:207], a[180:183], v[156:159]
    s_add_u32 m0, s61, 130048
    s_add_u32 s22, s94, 57344
    buffer_load_dwordx4 v14, s[24:27], s22 offen lds
    v_mfma_f32_16x16x32_bf16 v[160:163], a[204:207], a[184:187], v[160:163]
    v_mul_u32_u24 v39, 1088, v39
    v_lshl_add_u32 v39, v45, 3, v39
    v_mfma_f32_16x16x32_bf16 v[164:167], a[204:207], a[188:191], v[164:167]
    v_lshl_add_u32 v39, v46, 6, v39
    v_and_b32 v40, 1, v44
    v_mfma_f32_16x16x32_bf16 v[168:171], a[204:207], a[192:195], v[168:171]
    v_lshl_add_u32 v39, v40, 9, v39
    v_lshl_add_u32 v10, v40, 5, v39
    v_mfma_f32_16x16x32_bf16 v[172:175], a[204:207], a[196:199], v[172:175]
    s_add_u32 m0, s61, 134144
    s_add_u32 s22, s94, 86016
    buffer_load_dwordx4 v14, s[24:27], s22 offen lds
    s_waitcnt lgkmcnt(6)
    v_mfma_f32_16x16x32_bf16 v[176:179], a[208:211], a[180:183], v[176:179]
    v_xor_b32 v40, 1, v40
    v_lshl_add_u32 v11, v40, 5, v39
    v_mfma_f32_16x16x32_bf16 v[180:183], a[208:211], a[184:187], v[180:183]
    v_xor_b32 v40, 1, v46
    v_mul_u32_u24 v40, 8704, v40
    v_mfma_f32_16x16x32_bf16 v[184:187], a[208:211], a[188:191], v[184:187]
    v_mul_u32_u24 v39, 8704, v46
    v_add_u32 v12, v40, v10
    v_mfma_f32_16x16x32_bf16 v[188:191], a[208:211], a[192:195], v[188:191]
    s_add_u32 m0, s61, 138240
    s_add_u32 s22, s94, 114688
    buffer_load_dwordx4 v14, s[24:27], s22 offen lds
    v_mfma_f32_16x16x32_bf16 v[192:195], a[208:211], a[196:199], v[192:195]
    v_add_u32 v10, v39, v10
    s_waitcnt lgkmcnt(4)
    v_mfma_f32_16x16x32_bf16 v[196:199], a[212:215], a[180:183], v[196:199]
    v_add_u32 v13, v40, v11
    v_add_u32 v11, v39, v11
    v_mfma_f32_16x16x32_bf16 v[200:203], a[212:215], a[184:187], v[200:203]
    v_mfma_f32_16x16x32_bf16 v[204:207], a[212:215], a[188:191], v[204:207]
    s_add_u32 m0, s60, 104448
    s_add_u32 s22, s96, 0
    buffer_load_dwordx4 v26, s[28:31], s22 offen lds
    v_mfma_f32_16x16x32_bf16 v[208:211], a[212:215], a[192:195], v[208:211]
    v_mfma_f32_16x16x32_bf16 v[212:215], a[212:215], a[196:199], v[212:215]
    s_waitcnt vmcnt(18) lgkmcnt(0)
    s_barrier
    v_mfma_f32_16x16x32_bf16 v[216:219], a[216:219], a[180:183], v[216:219]
    ds_read_b64_tr_b16 a[200:201], v15 offset:34816
    ds_read_b64_tr_b16 a[202:203], v15 offset:43520
    v_mfma_f32_16x16x32_bf16 v[220:223], a[216:219], a[184:187], v[220:223]
    s_add_u32 m0, s21, 17408
    s_mov_b32 s22, 0
    buffer_load_dwordx4 v2, s[36:39], s22 offen nt lds
    v_mfma_f32_16x16x32_bf16 v[224:227], a[216:219], a[188:191], v[224:227]
    s_add_u32 m0, s60, 104448
    s_add_u32 s22, s96, 0
    buffer_load_dwordx4 v27, s[28:31], s22 offen offset:1024 lds
    v_mfma_f32_16x16x32_bf16 v[228:231], a[216:219], a[192:195], v[228:231]
    ds_read_b64_tr_b16 a[204:205], v16 offset:34816
    ds_read_b64_tr_b16 a[206:207], v16 offset:43520
    v_mfma_f32_16x16x32_bf16 v[232:235], a[216:219], a[196:199], v[232:235]
    ds_read_b64_tr_b16 a[208:209], v15 offset:34944
    ds_read_b64_tr_b16 a[210:211], v15 offset:43648
    v_mfma_f32_16x16x32_bf16 v[236:239], a[220:223], a[180:183], v[236:239]
    buffer_load_dwordx4 v28, s[28:31], s22 offen offset:2048 lds
    ds_read_b64_tr_b16 a[212:213], v16 offset:34944
    v_mfma_f32_16x16x32_bf16 v[240:243], a[220:223], a[184:187], v[240:243]
    ds_read_b64_tr_b16 a[214:215], v16 offset:43648
    ds_read_b128 a[0:3], v19 offset:21504
    v_mfma_f32_16x16x32_bf16 v[244:247], a[220:223], a[188:191], v[244:247]
    s_add_u32 m0, s21, 17408
    s_mov_b32 s22, 0
    buffer_load_dwordx4 v3, s[36:39], s22 offen offset:1088 nt lds
    v_mfma_f32_16x16x32_bf16 v[248:251], a[220:223], a[192:195], v[248:251]
    ds_read_b64_tr_b16 a[216:217], v15 offset:35072
    ds_read_b64_tr_b16 a[218:219], v15 offset:43776
    v_mfma_f32_16x16x32_bf16 v[252:255], a[220:223], a[196:199], v[252:255]
    s_add_u32 m0, s60, 104448
    s_add_u32 s22, s96, 0
    buffer_load_dwordx4 v29, s[28:31], s22 offen offset:3072 lds
    s_waitcnt lgkmcnt(9)
    v_mfma_f32_16x16x32_bf16 v[96:99], a[200:203], a[120:123], v[96:99]
    ds_read_b128 a[4:7], v19 offset:23552
    ds_read_b128 a[8:11], v19 offset:25600
    v_mfma_f32_16x16x32_bf16 v[100:103], a[200:203], a[124:127], v[100:103]
    ds_read_b128 a[12:15], v19 offset:27648
    ds_read_b128 a[16:19], v19 offset:29696
    v_mfma_f32_16x16x32_bf16 v[104:107], a[200:203], a[128:131], v[104:107]
    ds_read_b64_tr_b16 a[220:221], v16 offset:35072
    ds_read_b64_tr_b16 a[222:223], v16 offset:43776
    v_mfma_f32_16x16x32_bf16 v[108:111], a[200:203], a[132:135], v[108:111]
    ds_read_b128 a[20:23], v20 offset:21504
    ds_read_b128 a[24:27], v20 offset:23552
    v_mfma_f32_16x16x32_bf16 v[112:115], a[200:203], a[136:139], v[112:115]
    ds_read_b128 a[28:31], v20 offset:25600
    s_waitcnt lgkmcnt(15)
    v_mfma_f32_16x16x32_bf16 v[116:119], a[204:207], a[120:123], v[116:119]
    s_add_u32 m0, s21, 17408
    s_mov_b32 s22, 0
    buffer_load_dwordx4 v4, s[36:39], s22 offen offset:2176 nt lds
    v_mfma_f32_16x16x32_bf16 v[120:123], a[204:207], a[124:127], v[120:123]
    ds_read_b128 a[32:35], v20 offset:27648
    ds_read_b128 a[36:39], v20 offset:29696
    v_mfma_f32_16x16x32_bf16 v[124:127], a[204:207], a[128:131], v[124:127]
    ds_read_b64_tr_b16 a[200:201], v15 offset:35200
    ds_read_b64_tr_b16 a[202:203], v15 offset:43904
    v_mfma_f32_16x16x32_bf16 v[128:131], a[204:207], a[132:135], v[128:131]
    v_mfma_f32_16x16x32_bf16 v[132:135], a[204:207], a[136:139], v[132:135]
    s_waitcnt lgkmcnt(15)
    v_mfma_f32_16x16x32_bf16 v[136:139], a[208:211], a[120:123], v[136:139]
    v_mfma_f32_16x16x32_bf16 v[140:143], a[208:211], a[124:127], v[140:143]
    v_mfma_f32_16x16x32_bf16 v[144:147], a[208:211], a[128:131], v[144:147]
    ds_read_b64_tr_b16 a[204:205], v16 offset:35200
    ds_read_b64_tr_b16 a[206:207], v16 offset:43904
    v_mfma_f32_16x16x32_bf16 v[148:151], a[208:211], a[132:135], v[148:151]
    buffer_load_dwordx4 v5, s[36:39], s22 offen offset:3264 nt lds
    v_mfma_f32_16x16x32_bf16 v[152:155], a[208:211], a[136:139], v[152:155]
    v_mfma_f32_16x16x32_bf16 v[156:159], a[212:215], a[120:123], v[156:159]
    v_mfma_f32_16x16x32_bf16 v[160:163], a[212:215], a[124:127], v[160:163]
    v_mfma_f32_16x16x32_bf16 v[164:167], a[212:215], a[128:131], v[164:167]
    v_mfma_f32_16x16x32_bf16 v[168:171], a[212:215], a[132:135], v[168:171]
    v_mfma_f32_16x16x32_bf16 v[172:175], a[212:215], a[136:139], v[172:175]
    s_waitcnt lgkmcnt(15)
    v_mfma_f32_16x16x32_bf16 v[176:179], a[216:219], a[120:123], v[176:179]
    v_mfma_f32_16x16x32_bf16 v[180:183], a[216:219], a[124:127], v[180:183]
    v_mfma_f32_16x16x32_bf16 v[184:187], a[216:219], a[128:131], v[184:187]
    v_mfma_f32_16x16x32_bf16 v[188:191], a[216:219], a[132:135], v[188:191]
    v_mfma_f32_16x16x32_bf16 v[192:195], a[216:219], a[136:139], v[192:195]
    s_waitcnt lgkmcnt(9)
    v_mfma_f32_16x16x32_bf16 v[196:199], a[220:223], a[120:123], v[196:199]
    v_mfma_f32_16x16x32_bf16 v[200:203], a[220:223], a[124:127], v[200:203]
    v_mfma_f32_16x16x32_bf16 v[204:207], a[220:223], a[128:131], v[204:207]
    v_mfma_f32_16x16x32_bf16 v[208:211], a[220:223], a[132:135], v[208:211]
    v_mfma_f32_16x16x32_bf16 v[212:215], a[220:223], a[136:139], v[212:215]
    s_waitcnt lgkmcnt(0)
    s_barrier
    v_mfma_f32_16x16x32_bf16 v[216:219], a[200:203], a[120:123], v[216:219]
    v_add_u32 v15, 0x11000, v15
    ds_read_b64_tr_b16 a[208:209], v15
    v_mfma_f32_16x16x32_bf16 v[220:223], a[200:203], a[124:127], v[220:223]
    ds_read_b64_tr_b16 a[210:211], v15 offset:8704
    s_add_u32 m0, s61, 143360
    s_add_u32 s22, s95, 0
    buffer_load_dwordx4 v14, s[24:27], s22 offen lds
    v_mfma_f32_16x16x32_bf16 v[224:227], a[200:203], a[128:131], v[224:227]
    v_add_u32 v16, 0x11000, v16
    ds_read_b64_tr_b16 a[212:213], v16
    v_mfma_f32_16x16x32_bf16 v[228:231], a[200:203], a[132:135], v[228:231]
    s_add_u32 m0, s61, 147456
    s_add_u32 s22, s95, 28672
    buffer_load_dwordx4 v14, s[24:27], s22 offen lds
    v_mfma_f32_16x16x32_bf16 v[232:235], a[200:203], a[136:139], v[232:235]
    ds_read_b64_tr_b16 a[214:215], v16 offset:8704
    ds_read_b64_tr_b16 a[216:217], v15 offset:128
    v_mfma_f32_16x16x32_bf16 v[236:239], a[204:207], a[120:123], v[236:239]
    ds_read_b64_tr_b16 a[218:219], v15 offset:8832
    ds_read_b64_tr_b16 a[220:221], v16 offset:128
    v_mfma_f32_16x16x32_bf16 v[240:243], a[204:207], a[124:127], v[240:243]
    ds_read_b64_tr_b16 a[222:223], v16 offset:8832
    v_mfma_f32_16x16x32_bf16 v[244:247], a[204:207], a[128:131], v[244:247]
    s_add_u32 m0, s61, 151552
    s_add_u32 s22, s95, 57344
    buffer_load_dwordx4 v14, s[24:27], s22 offen lds
    v_mfma_f32_16x16x32_bf16 v[248:251], a[204:207], a[132:135], v[248:251]
    s_add_u32 m0, s21, 34816
    s_mov_b32 s22, 16384
    buffer_load_dwordx4 v2, s[32:35], s22 offen nt lds
    v_mfma_f32_16x16x32_bf16 v[252:255], a[204:207], a[136:139], v[252:255]
    ds_read_b64_tr_b16 a[200:201], v15 offset:256
    s_waitcnt lgkmcnt(7)
    v_mfma_f32_16x16x32_bf16 v[96:99], a[208:211], a[140:143], v[96:99]
    ds_read_b64_tr_b16 a[202:203], v15 offset:8960
    v_mfma_f32_16x16x32_bf16 v[100:103], a[208:211], a[144:147], v[100:103]
    s_add_u32 m0, s61, 155648
    s_add_u32 s22, s95, 86016
    buffer_load_dwordx4 v14, s[24:27], s22 offen lds
    v_mfma_f32_16x16x32_bf16 v[104:107], a[208:211], a[148:151], v[104:107]
    ds_read_b64_tr_b16 a[204:205], v16 offset:256
    ds_read_b64_tr_b16 a[206:207], v16 offset:8960
    v_mfma_f32_16x16x32_bf16 v[108:111], a[208:211], a[152:155], v[108:111]
    v_mfma_f32_16x16x32_bf16 v[112:115], a[208:211], a[156:159], v[112:115]
    s_waitcnt lgkmcnt(8)
    v_mfma_f32_16x16x32_bf16 v[116:119], a[212:215], a[140:143], v[116:119]
    s_add_u32 m0, s61, 159744
    s_add_u32 s22, s95, 114688
    buffer_load_dwordx4 v14, s[24:27], s22 offen lds
    v_mfma_f32_16x16x32_bf16 v[120:123], a[212:215], a[144:147], v[120:123]
    v_mfma_f32_16x16x32_bf16 v[124:127], a[212:215], a[148:151], v[124:127]
    ds_read_b64_tr_b16 a[208:209], v15 offset:384
    ds_read_b64_tr_b16 a[210:211], v15 offset:9088
    v_mfma_f32_16x16x32_bf16 v[128:131], a[212:215], a[152:155], v[128:131]
    s_add_u32 m0, s21, 34816
    s_mov_b32 s22, 16384
    buffer_load_dwordx4 v3, s[32:35], s22 offen offset:1088 nt lds
    v_mfma_f32_16x16x32_bf16 v[132:135], a[212:215], a[156:159], v[132:135]
    s_waitcnt lgkmcnt(8)
    v_mfma_f32_16x16x32_bf16 v[136:139], a[216:219], a[140:143], v[136:139]
    v_mfma_f32_16x16x32_bf16 v[140:143], a[216:219], a[144:147], v[140:143]
    v_mfma_f32_16x16x32_bf16 v[144:147], a[216:219], a[148:151], v[144:147]
    ds_read_b64_tr_b16 a[212:213], v16 offset:384
    ds_read_b64_tr_b16 a[214:215], v16 offset:9088
    v_mfma_f32_16x16x32_bf16 v[148:151], a[216:219], a[152:155], v[148:151]
    v_mfma_f32_16x16x32_bf16 v[152:155], a[216:219], a[156:159], v[152:155]
    s_waitcnt lgkmcnt(8)
    v_mfma_f32_16x16x32_bf16 v[156:159], a[220:223], a[140:143], v[156:159]
    v_mfma_f32_16x16x32_bf16 v[160:163], a[220:223], a[144:147], v[160:163]
    v_mfma_f32_16x16x32_bf16 v[164:167], a[220:223], a[148:151], v[164:167]
    v_mfma_f32_16x16x32_bf16 v[168:171], a[220:223], a[152:155], v[168:171]
    v_mfma_f32_16x16x32_bf16 v[172:175], a[220:223], a[156:159], v[172:175]
    buffer_load_dwordx4 v4, s[32:35], s22 offen offset:2176 nt lds
    s_waitcnt lgkmcnt(6)
    v_mfma_f32_16x16x32_bf16 v[176:179], a[200:203], a[140:143], v[176:179]
    v_mfma_f32_16x16x32_bf16 v[180:183], a[200:203], a[144:147], v[180:183]
    v_mfma_f32_16x16x32_bf16 v[184:187], a[200:203], a[148:151], v[184:187]
    v_mfma_f32_16x16x32_bf16 v[188:191], a[200:203], a[152:155], v[188:191]
    v_mfma_f32_16x16x32_bf16 v[192:195], a[200:203], a[156:159], v[192:195]
    s_waitcnt lgkmcnt(4)
    v_mfma_f32_16x16x32_bf16 v[196:199], a[204:207], a[140:143], v[196:199]
    v_mfma_f32_16x16x32_bf16 v[200:203], a[204:207], a[144:147], v[200:203]
    v_mfma_f32_16x16x32_bf16 v[204:207], a[204:207], a[148:151], v[204:207]
    v_mfma_f32_16x16x32_bf16 v[208:211], a[204:207], a[152:155], v[208:211]
    v_mfma_f32_16x16x32_bf16 v[212:215], a[204:207], a[156:159], v[212:215]
    s_waitcnt vmcnt(16) lgkmcnt(0)
    s_barrier
    v_mfma_f32_16x16x32_bf16 v[216:219], a[208:211], a[140:143], v[216:219]
    ds_read_b64_tr_b16 a[216:217], v15 offset:17408
    ds_read_b64_tr_b16 a[218:219], v15 offset:26112
    v_mfma_f32_16x16x32_bf16 v[220:223], a[208:211], a[144:147], v[220:223]
    buffer_load_dwordx4 v5, s[32:35], s22 offen offset:3264 nt lds
    ds_read_b128 v[56:59], v24
    v_mfma_f32_16x16x32_bf16 v[224:227], a[208:211], a[148:151], v[224:227]
    ds_read_b64_tr_b16 a[220:221], v16 offset:17408
    ds_read_b64_tr_b16 a[222:223], v16 offset:26112
    v_mfma_f32_16x16x32_bf16 v[228:231], a[208:211], a[152:155], v[228:231]
    ds_read_b128 v[60:63], v25
    ds_read_b64_tr_b16 a[200:201], v15 offset:17536
    v_mfma_f32_16x16x32_bf16 v[232:235], a[208:211], a[156:159], v[232:235]
    ds_read_b64_tr_b16 a[202:203], v15 offset:26240
    ds_read_b128 v[64:67], v24 offset:128
    v_mfma_f32_16x16x32_bf16 v[236:239], a[212:215], a[140:143], v[236:239]
    ds_read_b64_tr_b16 a[204:205], v16 offset:17536
    ds_read_b64_tr_b16 a[206:207], v16 offset:26240
    v_mfma_f32_16x16x32_bf16 v[240:243], a[212:215], a[144:147], v[240:243]
    ds_read_b128 v[68:71], v25 offset:128
    ds_read_b128 v[72:75], v24 offset:256
    v_mfma_f32_16x16x32_bf16 v[244:247], a[212:215], a[148:151], v[244:247]
    ds_read_b64_tr_b16 a[208:209], v15 offset:17664
    ds_read_b64_tr_b16 a[210:211], v15 offset:26368
    v_mfma_f32_16x16x32_bf16 v[248:251], a[212:215], a[152:155], v[248:251]
    ds_read_b128 v[76:79], v25 offset:256
    ds_read_b128 a[160:163], v19
    v_mfma_f32_16x16x32_bf16 v[252:255], a[212:215], a[156:159], v[252:255]
    ds_read_b128 a[164:167], v19 offset:2048
    s_waitcnt lgkmcnt(15)
    v_mfma_f32_16x16x32_bf16 v[96:99], a[216:219], a[0:3], v[96:99]
    ds_read_b128 v[80:83], v24 offset:384
    ds_read_b128 a[168:171], v19 offset:4096
    v_mfma_f32_16x16x32_bf16 v[100:103], a[216:219], a[4:7], v[100:103]
    s_add_u32 m0, s21, 69632
    s_mov_b32 s22, 32768
    buffer_load_dwordx4 v2, s[32:35], s22 offen nt lds
    v_mfma_f32_16x16x32_bf16 v[104:107], a[216:219], a[8:11], v[104:107]
    ds_read_b64_tr_b16 a[212:213], v16 offset:17664
    ds_read_b64_tr_b16 a[214:215], v16 offset:26368
    v_mfma_f32_16x16x32_bf16 v[108:111], a[216:219], a[12:15], v[108:111]
    ds_read_b128 a[172:175], v19 offset:6144
    ds_read_b128 a[176:179], v19 offset:8192
    v_mfma_f32_16x16x32_bf16 v[112:115], a[216:219], a[16:19], v[112:115]
    ds_read_b128 a[180:183], v20
    s_waitcnt lgkmcnt(15)
    v_mfma_f32_16x16x32_bf16 v[116:119], a[220:223], a[0:3], v[116:119]
    ds_read_b128 a[184:187], v20 offset:2048
    ds_read_b128 a[188:191], v20 offset:4096
    v_mfma_f32_16x16x32_bf16 v[120:123], a[220:223], a[4:7], v[120:123]
    ds_read_b128 a[192:195], v20 offset:6144
    ds_read_b128 a[196:199], v20 offset:8192
    v_mfma_f32_16x16x32_bf16 v[124:127], a[220:223], a[8:11], v[124:127]
    ds_read_b64_tr_b16 a[216:217], v15 offset:17792
    ds_read_b64_tr_b16 a[218:219], v15 offset:26496
    v_mfma_f32_16x16x32_bf16 v[128:131], a[220:223], a[12:15], v[128:131]
    ds_read_b128 v[84:87], v25 offset:384
    v_mfma_f32_16x16x32_bf16 v[132:135], a[220:223], a[16:19], v[132:135]
    v_mfma_f32_16x16x32_bf16 v[136:139], a[200:203], a[0:3], v[136:139]
    v_mfma_f32_16x16x32_bf16 v[140:143], a[200:203], a[4:7], v[140:143]
    v_mfma_f32_16x16x32_bf16 v[144:147], a[200:203], a[8:11], v[144:147]
    buffer_load_dwordx4 v3, s[32:35], s22 offen offset:1088 nt lds
    ds_read_b64_tr_b16 a[220:221], v16 offset:17792
    v_mfma_f32_16x16x32_bf16 v[148:151], a[200:203], a[12:15], v[148:151]
    ds_read_b64_tr_b16 a[222:223], v16 offset:26496
    v_mfma_f32_16x16x32_bf16 v[152:155], a[200:203], a[16:19], v[152:155]
    s_waitcnt lgkmcnt(15)
    v_mfma_f32_16x16x32_bf16 v[156:159], a[204:207], a[0:3], v[156:159]
    v_mfma_f32_16x16x32_bf16 v[160:163], a[204:207], a[4:7], v[160:163]
    v_mfma_f32_16x16x32_bf16 v[164:167], a[204:207], a[8:11], v[164:167]
    v_mfma_f32_16x16x32_bf16 v[168:171], a[204:207], a[12:15], v[168:171]
    v_mfma_f32_16x16x32_bf16 v[172:175], a[204:207], a[16:19], v[172:175]
    v_mfma_f32_16x16x32_bf16 v[176:179], a[208:211], a[0:3], v[176:179]
    v_mfma_f32_16x16x32_bf16 v[180:183], a[208:211], a[4:7], v[180:183]
    v_mfma_f32_16x16x32_bf16 v[184:187], a[208:211], a[8:11], v[184:187]
    v_mfma_f32_16x16x32_bf16 v[188:191], a[208:211], a[12:15], v[188:191]
    buffer_load_dwordx4 v4, s[32:35], s22 offen offset:2176 nt lds
    v_mfma_f32_16x16x32_bf16 v[192:195], a[208:211], a[16:19], v[192:195]
    s_waitcnt lgkmcnt(12)
    v_mfma_f32_16x16x32_bf16 v[196:199], a[212:215], a[0:3], v[196:199]
    v_mfma_f32_16x16x32_bf16 v[200:203], a[212:215], a[4:7], v[200:203]
    v_mfma_f32_16x16x32_bf16 v[204:207], a[212:215], a[8:11], v[204:207]
    v_mfma_f32_16x16x32_bf16 v[208:211], a[212:215], a[12:15], v[208:211]
    v_mfma_f32_16x16x32_bf16 v[212:215], a[212:215], a[16:19], v[212:215]
    s_waitcnt vmcnt(6) lgkmcnt(0)
    s_barrier
    v_mfma_f32_16x16x32_bf16 v[216:219], a[216:219], a[0:3], v[216:219]
    v_add_u32 v15, 0xffffbc00, v15
    ds_read_b64_tr_b16 a[200:201], v15
    v_mfma_f32_16x16x32_bf16 v[220:223], a[216:219], a[4:7], v[220:223]
    ds_read_b64_tr_b16 a[202:203], v15 offset:8704
    ds_read_b64_tr_b16 a[224:225], v10 offset:17408
    v_mfma_f32_16x16x32_bf16 v[224:227], a[216:219], a[8:11], v[224:227]
    ds_read_b64_tr_b16 a[226:227], v12 offset:17408
    v_add_u32 v16, 0xffffbc00, v16
    ds_read_b64_tr_b16 a[204:205], v16
    v_mfma_f32_16x16x32_bf16 v[228:231], a[216:219], a[12:15], v[228:231]
    ds_read_b64_tr_b16 a[206:207], v16 offset:8704
    ds_read_b64_tr_b16 a[228:229], v11 offset:17408
    v_mfma_f32_16x16x32_bf16 v[232:235], a[216:219], a[16:19], v[232:235]
    buffer_load_dwordx4 v5, s[32:35], s22 offen offset:3264 nt lds
    ds_read_b64_tr_b16 a[230:231], v13 offset:17408
    v_mfma_f32_16x16x32_bf16 v[236:239], a[220:223], a[0:3], v[236:239]
    ds_read_b64_tr_b16 a[208:209], v15 offset:128
    ds_read_b64_tr_b16 a[210:211], v15 offset:8832
    v_mfma_f32_16x16x32_bf16 v[240:243], a[220:223], a[4:7], v[240:243]
    ds_read_b64_tr_b16 a[232:233], v10 offset:17536
    ds_read_b64_tr_b16 a[234:235], v12 offset:17536
    v_mfma_f32_16x16x32_bf16 v[244:247], a[220:223], a[8:11], v[244:247]
    ds_read_b64_tr_b16 a[236:237], v11 offset:17536
    ds_read_b64_tr_b16 a[212:213], v16 offset:128
    v_mfma_f32_16x16x32_bf16 v[248:251], a[220:223], a[12:15], v[248:251]
    ds_read_b64_tr_b16 a[214:215], v16 offset:8832
    ds_read_b64_tr_b16 a[238:239], v13 offset:17536
    v_mfma_f32_16x16x32_bf16 v[252:255], a[220:223], a[16:19], v[252:255]
    ds_read_b64_tr_b16 a[240:241], v10 offset:17664
    s_waitcnt lgkmcnt(15)
    v_mfma_f32_16x16x32_bf16 v[96:99], a[200:203], a[20:23], v[96:99]
    ds_read_b64_tr_b16 a[242:243], v12 offset:17664
    ds_read_b64_tr_b16 a[216:217], v15 offset:256
    v_mfma_f32_16x16x32_bf16 v[100:103], a[200:203], a[24:27], v[100:103]
    ds_read_b64_tr_b16 a[218:219], v15 offset:8960
    ds_read_b64_tr_b16 a[244:245], v11 offset:17664
    v_mfma_f32_16x16x32_bf16 v[104:107], a[200:203], a[28:31], v[104:107]
    ds_read_b64_tr_b16 a[246:247], v13 offset:17664
    ds_read_b64_tr_b16 a[220:221], v16 offset:256
    v_mfma_f32_16x16x32_bf16 v[108:111], a[200:203], a[32:35], v[108:111]
    ds_read_b64_tr_b16 a[222:223], v16 offset:8960
    ds_read_b64_tr_b16 a[248:249], v10 offset:17792
    v_mfma_f32_16x16x32_bf16 v[112:115], a[200:203], a[36:39], v[112:115]
    ds_read_b128 a[120:123], v19 offset:21504
    s_waitcnt lgkmcnt(15)
    v_mfma_f32_16x16x32_bf16 v[116:119], a[204:207], a[20:23], v[116:119]
    s_add_u32 m0, s21, 87040
    s_mov_b32 s22, 49152
    buffer_load_dwordx4 v2, s[32:35], s22 offen nt lds
    v_mfma_f32_16x16x32_bf16 v[120:123], a[204:207], a[24:27], v[120:123]
    ds_read_b128 a[124:127], v19 offset:23552
    ds_read_b64_tr_b16 a[250:251], v12 offset:17792
    v_mfma_f32_16x16x32_bf16 v[124:127], a[204:207], a[28:31], v[124:127]
    ds_read_b128 a[128:131], v19 offset:25600
    ds_read_b128 a[132:135], v19 offset:27648
    v_mfma_f32_16x16x32_bf16 v[128:131], a[204:207], a[32:35], v[128:131]
    ds_read_b128 a[136:139], v19 offset:29696
    ds_read_b128 a[140:143], v20 offset:21504
    v_mfma_f32_16x16x32_bf16 v[132:135], a[204:207], a[36:39], v[132:135]
    ds_read_b64_tr_b16 a[252:253], v11 offset:17792
    ds_read_b64_tr_b16 a[200:201], v15 offset:384
    v_mfma_f32_16x16x32_bf16 v[136:139], a[208:211], a[20:23], v[136:139]
    ds_read_b64_tr_b16 a[202:203], v15 offset:9088
    ds_read_b128 a[144:147], v20 offset:23552
    v_mfma_f32_16x16x32_bf16 v[140:143], a[208:211], a[24:27], v[140:143]
    ds_read_b128 a[148:151], v20 offset:25600
    ds_read_b128 a[152:155], v20 offset:27648
    v_mfma_f32_16x16x32_bf16 v[144:147], a[208:211], a[28:31], v[144:147]
    ds_read_b64_tr_b16 a[204:205], v16 offset:384
    ds_read_b64_tr_b16 a[206:207], v16 offset:9088
    v_mfma_f32_16x16x32_bf16 v[148:151], a[208:211], a[32:35], v[148:151]
    ds_read_b128 a[156:159], v20 offset:29696
    ds_read_b64_tr_b16 a[254:255], v13 offset:17792
    v_mfma_f32_16x16x32_bf16 v[152:155], a[208:211], a[36:39], v[152:155]
    s_waitcnt lgkmcnt(15)
    v_mfma_f32_16x16x32_bf16 v[156:159], a[212:215], a[20:23], v[156:159]
    v_mfma_f32_16x16x32_bf16 v[160:163], a[212:215], a[24:27], v[160:163]
    buffer_load_dwordx4 v3, s[32:35], s22 offen offset:1088 nt lds
    v_mfma_f32_16x16x32_bf16 v[164:167], a[212:215], a[28:31], v[164:167]
    v_mfma_f32_16x16x32_bf16 v[168:171], a[212:215], a[32:35], v[168:171]
    v_mfma_f32_16x16x32_bf16 v[172:175], a[212:215], a[36:39], v[172:175]
    v_mfma_f32_16x16x32_bf16 v[176:179], a[216:219], a[20:23], v[176:179]
    v_mfma_f32_16x16x32_bf16 v[180:183], a[216:219], a[24:27], v[180:183]
    v_mfma_f32_16x16x32_bf16 v[184:187], a[216:219], a[28:31], v[184:187]
    v_mfma_f32_16x16x32_bf16 v[188:191], a[216:219], a[32:35], v[188:191]
    v_mfma_f32_16x16x32_bf16 v[192:195], a[216:219], a[36:39], v[192:195]
    v_mfma_f32_16x16x32_bf16 v[196:199], a[220:223], a[20:23], v[196:199]
    v_mfma_f32_16x16x32_bf16 v[200:203], a[220:223], a[24:27], v[200:203]
    v_mfma_f32_16x16x32_bf16 v[204:207], a[220:223], a[28:31], v[204:207]
    buffer_load_dwordx4 v4, s[32:35], s22 offen offset:2176 nt lds
    v_mfma_f32_16x16x32_bf16 v[208:211], a[220:223], a[32:35], v[208:211]
    v_mfma_f32_16x16x32_bf16 v[212:215], a[220:223], a[36:39], v[212:215]
    s_waitcnt lgkmcnt(0)
    s_barrier
    v_mfma_f32_16x16x32_bf16 v[216:219], a[200:203], a[20:23], v[216:219]
    s_and_b32 s18, s16, 3
    s_mov_b32 s19, 106181136
    s_cmp_eq_u32 s18, 1
    s_cselect_b32 s19, 40190721, s19
    v_mfma_f32_16x16x32_bf16 v[220:223], a[200:203], a[24:27], v[220:223]
    ds_read_b64_tr_b16 a[208:209], v17 offset:34816
    ds_read_b64_tr_b16 a[210:211], v17 offset:36864
    v_mfma_f32_16x16x32_bf16 v[224:227], a[200:203], a[28:31], v[224:227]
    s_nop 0
    s_cmp_eq_u32 s18, 2
    s_cselect_b32 s19, 52843536, s19
    s_nop 0
    s_cmp_eq_u32 s18, 3
    s_cselect_b32 s19, 70411521, s19
    v_mfma_f32_16x16x32_bf16 v[228:231], a[200:203], a[32:35], v[228:231]
    s_lshr_b32 s18, s16, 2
    s_mul_i32 s18, s18, 0
    v_mfma_f32_16x16x32_bf16 v[232:235], a[200:203], a[36:39], v[232:235]
    s_bfe_u32 s89, s19, 262144
    s_add_u32 s89, s89, s18
    v_mfma_f32_16x16x32_bf16 v[236:239], a[204:207], a[20:23], v[236:239]
    s_lshl_b32 s89, s89, 7
    ds_read_b64_tr_b16 a[212:213], v18 offset:34816
    v_mfma_f32_16x16x32_bf16 v[240:243], a[204:207], a[24:27], v[240:243]
    ds_read_b64_tr_b16 a[214:215], v18 offset:36864
    s_sub_u32 s90, s89, 896
    v_mfma_f32_16x16x32_bf16 v[244:247], a[204:207], a[28:31], v[244:247]
    s_min_u32 s89, s89, s90
    s_bfe_u32 s90, s19, 262148
    v_mfma_f32_16x16x32_bf16 v[248:251], a[204:207], a[32:35], v[248:251]
    s_add_u32 s90, s90, s18
    s_lshl_b32 s90, s90, 7
    v_mfma_f32_16x16x32_bf16 v[252:255], a[204:207], a[36:39], v[252:255]
    s_sub_u32 s91, s90, 896
    s_waitcnt lgkmcnt(2)
    v_mfma_f32_16x16x32_bf16 v[96:99], a[208:211], a[160:163], v[96:99]
    s_min_u32 s90, s90, s91
    buffer_load_dwordx4 v5, s[32:35], s22 offen offset:3264 nt lds
    v_mfma_f32_16x16x32_bf16 v[100:103], a[208:211], a[164:167], v[100:103]
    ds_read_b64_tr_b16 a[216:217], v17 offset:38912
    ds_read_b64_tr_b16 a[218:219], v17 offset:40960
    v_mfma_f32_16x16x32_bf16 v[104:107], a[208:211], a[168:171], v[104:107]
    s_bfe_u32 s91, s19, 262152
    s_add_u32 s91, s91, s18
    v_mfma_f32_16x16x32_bf16 v[108:111], a[208:211], a[172:175], v[108:111]
    s_lshl_b32 s91, s91, 7
    s_sub_u32 s92, s91, 896
    v_mfma_f32_16x16x32_bf16 v[112:115], a[208:211], a[176:179], v[112:115]
    s_min_u32 s91, s91, s92
    s_waitcnt lgkmcnt(2)
    v_mfma_f32_16x16x32_bf16 v[116:119], a[212:215], a[160:163], v[116:119]
    s_bfe_u32 s92, s19, 262156
    ds_read_b64_tr_b16 a[220:221], v18 offset:38912
    v_mfma_f32_16x16x32_bf16 v[120:123], a[212:215], a[164:167], v[120:123]
    ds_read_b64_tr_b16 a[222:223], v18 offset:40960
    s_add_u32 s92, s92, s18
    v_mfma_f32_16x16x32_bf16 v[124:127], a[212:215], a[168:171], v[124:127]
    s_lshl_b32 s92, s92, 7
    s_sub_u32 s93, s92, 896
    v_mfma_f32_16x16x32_bf16 v[128:131], a[212:215], a[172:175], v[128:131]
    s_min_u32 s92, s92, s93
    s_bfe_u32 s93, s19, 262160
    v_mfma_f32_16x16x32_bf16 v[132:135], a[212:215], a[176:179], v[132:135]
    s_add_u32 s93, s93, s18
    s_waitcnt lgkmcnt(2)
    v_mfma_f32_16x16x32_bf16 v[96:99], a[216:219], a[180:183], v[96:99]
    s_lshl_b32 s93, s93, 7
    ds_read_b64_tr_b16 a[200:201], v17 offset:43008
    v_mfma_f32_16x16x32_bf16 v[100:103], a[216:219], a[184:187], v[100:103]
    ds_read_b64_tr_b16 a[202:203], v17 offset:45056
    s_sub_u32 s94, s93, 896
    v_mfma_f32_16x16x32_bf16 v[104:107], a[216:219], a[188:191], v[104:107]
    s_add_u32 m0, s21, 0
    s_mov_b32 s22, 16384
    buffer_load_dwordx4 v2, s[36:39], s22 offen nt lds
    v_mfma_f32_16x16x32_bf16 v[108:111], a[216:219], a[192:195], v[108:111]
    s_min_u32 s93, s93, s94
    s_bfe_u32 s94, s19, 262164
    v_mfma_f32_16x16x32_bf16 v[112:115], a[216:219], a[196:199], v[112:115]
    s_add_u32 s94, s94, s18
    s_waitcnt lgkmcnt(2)
    v_mfma_f32_16x16x32_bf16 v[116:119], a[220:223], a[180:183], v[116:119]
    s_lshl_b32 s94, s94, 7
    s_sub_u32 s95, s94, 896
    v_mfma_f32_16x16x32_bf16 v[120:123], a[220:223], a[184:187], v[120:123]
    ds_read_b64_tr_b16 a[204:205], v18 offset:43008
    ds_read_b64_tr_b16 a[206:207], v18 offset:45056
    v_mfma_f32_16x16x32_bf16 v[124:127], a[220:223], a[188:191], v[124:127]
    s_min_u32 s94, s94, s95
    s_bfe_u32 s95, s19, 262168
    v_mfma_f32_16x16x32_bf16 v[128:131], a[220:223], a[192:195], v[128:131]
    s_add_u32 s95, s95, s18
    s_lshl_b32 s95, s95, 7
    v_mfma_f32_16x16x32_bf16 v[132:135], a[220:223], a[196:199], v[132:135]
    s_sub_u32 s19, s95, 896
    s_waitcnt lgkmcnt(2)
    v_mfma_f32_16x16x32_bf16 v[96:99], a[200:203], a[120:123], v[96:99]
    s_min_u32 s95, s95, s19
    v_bfe_u32 v39, v0, 2, 4
    v_mfma_f32_16x16x32_bf16 v[100:103], a[200:203], a[124:127], v[100:103]
    ds_read_b64_tr_b16 a[208:209], v17 offset:47104
    ds_read_b64_tr_b16 a[210:211], v17 offset:49152
    v_mfma_f32_16x16x32_bf16 v[104:107], a[200:203], a[128:131], v[104:107]
    v_lshlrev_b32 v39, 7, v39
    ds_read_b64_tr_b16 a[212:213], v18 offset:47104
    v_mfma_f32_16x16x32_bf16 v[108:111], a[200:203], a[132:135], v[108:111]
    ds_read_b64_tr_b16 a[214:215], v18 offset:49152
    v_lshl_add_u32 v39, v45, 3, v39
    v_bfe_u32 v40, v0, 3, 2
    buffer_load_dwordx4 v3, s[36:39], s22 offen offset:1088 nt lds
    v_mfma_f32_16x16x32_bf16 v[112:115], a[200:203], a[136:139], v[112:115]
    v_lshlrev_b32 v16, 1, v46
    s_waitcnt lgkmcnt(4)
    v_mfma_f32_16x16x32_bf16 v[116:119], a[204:207], a[120:123], v[116:119]
    v_xor_b32 v40, v40, v16
    v_lshl_add_u32 v15, v40, 5, v39
    v_mfma_f32_16x16x32_bf16 v[120:123], a[204:207], a[124:127], v[120:123]
    v_xor_b32 v16, 32, v15
    v_lshl_add_u32 v15, v46, 12, v15
    v_mfma_f32_16x16x32_bf16 v[124:127], a[204:207], a[128:131], v[124:127]
    v_lshl_add_u32 v16, v46, 12, v16
    v_bfe_u32 v39, v0, 3, 3
    v_mfma_f32_16x16x32_bf16 v[128:131], a[204:207], a[132:135], v[128:131]
    v_lshl_add_u32 v39, v36, 5, v39
    v_mul_u32_u24 v39, 896, v39
    v_mfma_f32_16x16x32_bf16 v[132:135], a[204:207], a[136:139], v[132:135]
    s_waitcnt lgkmcnt(0)
    s_barrier
    v_mfma_f32_16x16x32_bf16 v[96:99], a[208:211], a[140:143], v[96:99]
    v_add_u32 v6, v39, v47
    v_add_u32 v7, 6144, v6
    v_mfma_f32_16x16x32_bf16 v[100:103], a[208:211], a[144:147], v[100:103]
    v_add_u32 v8, 12288, v6
    v_add_u32 v9, 18432, v6
    v_mfma_f32_16x16x32_bf16 v[104:107], a[208:211], a[148:151], v[104:107]
    v_mul_u32_u24 v39, 2560, v36
    buffer_load_dwordx4 v4, s[36:39], s22 offen offset:2176 nt lds
    v_mfma_f32_16x16x32_bf16 v[108:111], a[208:211], a[152:155], v[108:111]
    v_cvt_pk_bf16_f32 v96, v96, v97
    v_cvt_pk_bf16_f32 v97, v98, v99
    v_mfma_f32_16x16x32_bf16 v[112:115], a[208:211], a[156:159], v[112:115]
    v_lshl_add_u32 v14, v37, 3, v39
    v_xor_b32 v39, 1, v36
    v_mfma_f32_16x16x32_bf16 v[116:119], a[212:215], a[140:143], v[116:119]
    v_cvt_pk_bf16_f32 v100, v100, v101
    v_mul_u32_u24 v39, 2560, v39
    v_mfma_f32_16x16x32_bf16 v[120:123], a[212:215], a[144:147], v[120:123]
    v_lshl_add_u32 v19, v37, 3, v39
    v_cvt_pk_bf16_f32 v101, v102, v103
    v_mfma_f32_16x16x32_bf16 v[124:127], a[212:215], a[148:151], v[124:127]
    v_lshl_add_u32 v39, v42, 2, v43
    v_cvt_pk_bf16_f32 v104, v104, v105
    v_mfma_f32_16x16x32_bf16 v[128:131], a[212:215], a[152:155], v[128:131]
    v_add_u32 v21, 0x23000, v21
    ds_write_b64 v21, v[96:97]
    v_mfma_f32_16x16x32_bf16 v[132:135], a[212:215], a[156:159], v[132:135]
    v_lshlrev_b32 v20, 4, v39
    v_cvt_pk_bf16_f32 v105, v106, v107
    v_mfma_f32_16x16x32_bf16 v[136:139], v[48:51], a[160:163], v[136:139]
    v_cvt_pk_bf16_f32 v108, v108, v109
    v_cvt_pk_bf16_f32 v109, v110, v111
    v_mfma_f32_16x16x32_bf16 v[140:143], v[48:51], a[164:167], v[140:143]
    ds_write_b64 v21, v[100:101] offset:1024
    v_mfma_f32_16x16x32_bf16 v[144:147], v[48:51], a[168:171], v[144:147]
    v_cvt_pk_bf16_f32 v112, v112, v113
    buffer_load_dwordx4 v5, s[36:39], s22 offen offset:3264 nt lds
    v_mfma_f32_16x16x32_bf16 v[148:151], v[48:51], a[172:175], v[148:151]
    ds_write_b64 v21, v[104:105] offset:2048
    v_mfma_f32_16x16x32_bf16 v[152:155], v[48:51], a[176:179], v[152:155]
    v_cvt_pk_bf16_f32 v113, v114, v115
    v_cvt_pk_bf16_f32 v116, v116, v117
    v_mfma_f32_16x16x32_bf16 v[156:159], v[52:55], a[160:163], v[156:159]
    ds_write_b64 v21, v[108:109] offset:3072
    v_mfma_f32_16x16x32_bf16 v[160:163], v[52:55], a[164:167], v[160:163]
    v_cvt_pk_bf16_f32 v117, v118, v119
    v_cvt_pk_bf16_f32 v120, v120, v121
    v_mfma_f32_16x16x32_bf16 v[164:167], v[52:55], a[168:171], v[164:167]
    ds_write_b64 v21, v[112:113] offset:4096
    v_mfma_f32_16x16x32_bf16 v[168:171], v[52:55], a[172:175], v[168:171]
    v_cvt_pk_bf16_f32 v121, v122, v123
    v_cvt_pk_bf16_f32 v124, v124, v125
    v_mfma_f32_16x16x32_bf16 v[172:175], v[52:55], a[176:179], v[172:175]
    ds_write_b64 v21, v[116:117] offset:512
    v_mfma_f32_16x16x32_bf16 v[136:139], v[88:91], a[180:183], v[136:139]
    v_cvt_pk_bf16_f32 v125, v126, v127
    v_cvt_pk_bf16_f32 v128, v128, v129
    v_mfma_f32_16x16x32_bf16 v[140:143], v[88:91], a[184:187], v[140:143]
    ds_write_b64 v21, v[120:121] offset:1536
    v_mfma_f32_16x16x32_bf16 v[144:147], v[88:91], a[188:191], v[144:147]
    v_cvt_pk_bf16_f32 v129, v130, v131
    v_cvt_pk_bf16_f32 v132, v132, v133
    v_mfma_f32_16x16x32_bf16 v[148:151], v[88:91], a[192:195], v[148:151]
    s_add_u32 m0, s21, 17408
    s_mov_b32 s22, 65536
    buffer_load_dwordx4 v2, s[32:35], s22 offen nt lds
    v_mfma_f32_16x16x32_bf16 v[152:155], v[88:91], a[196:199], v[152:155]
    ds_write_b64 v21, v[124:125] offset:2560
    v_mfma_f32_16x16x32_bf16 v[156:159], v[92:95], a[180:183], v[156:159]
    v_cvt_pk_bf16_f32 v133, v134, v135
    v_mfma_f32_16x16x32_bf16 v[160:163], v[92:95], a[184:187], v[160:163]
    ds_write_b64 v21, v[128:129] offset:3584
    v_mfma_f32_16x16x32_bf16 v[164:167], v[92:95], a[188:191], v[164:167]
    ds_write_b64 v21, v[132:133] offset:4608
    v_mfma_f32_16x16x32_bf16 v[168:171], v[92:95], a[192:195], v[168:171]
    v_mfma_f32_16x16x32_bf16 v[172:175], v[92:95], a[196:199], v[172:175]
    v_mfma_f32_16x16x32_bf16 v[136:139], a[72:75], a[120:123], v[136:139]
    v_mfma_f32_16x16x32_bf16 v[140:143], a[72:75], a[124:127], v[140:143]
    v_mfma_f32_16x16x32_bf16 v[144:147], a[72:75], a[128:131], v[144:147]
    v_mfma_f32_16x16x32_bf16 v[148:151], a[72:75], a[132:135], v[148:151]
    v_mfma_f32_16x16x32_bf16 v[152:155], a[72:75], a[136:139], v[152:155]
    buffer_load_dwordx4 v3, s[32:35], s22 offen offset:1088 nt lds
    v_mfma_f32_16x16x32_bf16 v[156:159], a[76:79], a[120:123], v[156:159]
    v_mfma_f32_16x16x32_bf16 v[160:163], a[76:79], a[124:127], v[160:163]
    v_mfma_f32_16x16x32_bf16 v[164:167], a[76:79], a[128:131], v[164:167]
    v_mfma_f32_16x16x32_bf16 v[168:171], a[76:79], a[132:135], v[168:171]
    v_mfma_f32_16x16x32_bf16 v[172:175], a[76:79], a[136:139], v[172:175]
    s_waitcnt vmcnt(14) lgkmcnt(0)
    s_barrier
    v_mfma_f32_16x16x32_bf16 v[136:139], a[112:115], a[140:143], v[136:139]
    ds_read_b128 v[96:99], v24 offset:34816
    ds_read_b128 v[100:103], v25 offset:34816
    v_mfma_f32_16x16x32_bf16 v[140:143], a[112:115], a[144:147], v[140:143]
    ds_read_b128 v[104:107], v24 offset:34944
    ds_read_b128 v[108:111], v25 offset:34944
    v_mfma_f32_16x16x32_bf16 v[144:147], a[112:115], a[148:151], v[144:147]
    ds_read_b128 v[112:115], v24 offset:35072
    ds_read_b128 v[116:119], v25 offset:35072
    v_mfma_f32_16x16x32_bf16 v[148:151], a[112:115], a[152:155], v[148:151]
    v_cvt_pk_bf16_f32 v136, v136, v137
    v_cvt_pk_bf16_f32 v137, v138, v139
    v_mfma_f32_16x16x32_bf16 v[152:155], a[112:115], a[156:159], v[152:155]
    v_cvt_pk_bf16_f32 v140, v140, v141
    v_cvt_pk_bf16_f32 v141, v142, v143
    v_mfma_f32_16x16x32_bf16 v[156:159], a[116:119], a[140:143], v[156:159]
    buffer_load_dwordx4 v4, s[32:35], s22 offen offset:2176 nt lds
    v_cvt_pk_bf16_f32 v144, v144, v145
    v_mfma_f32_16x16x32_bf16 v[160:163], a[116:119], a[144:147], v[160:163]
    v_add_u32 v21, 0xffffac00, v21
    ds_write_b64 v21, v[136:137]
    v_mfma_f32_16x16x32_bf16 v[164:167], a[116:119], a[148:151], v[164:167]
    v_cvt_pk_bf16_f32 v145, v146, v147
    v_cvt_pk_bf16_f32 v148, v148, v149
    v_mfma_f32_16x16x32_bf16 v[168:171], a[116:119], a[152:155], v[168:171]
    ds_write_b64 v21, v[140:141] offset:1024
    v_mfma_f32_16x16x32_bf16 v[172:175], a[116:119], a[156:159], v[172:175]
    v_cvt_pk_bf16_f32 v149, v150, v151
    v_cvt_pk_bf16_f32 v152, v152, v153
    v_mfma_f32_16x16x32_bf16 v[176:179], a[40:43], a[160:163], v[176:179]
    ds_write_b64 v21, v[144:145] offset:2048
    v_mfma_f32_16x16x32_bf16 v[180:183], a[40:43], a[164:167], v[180:183]
    v_cvt_pk_bf16_f32 v153, v154, v155
    v_cvt_pk_bf16_f32 v156, v156, v157
    v_mfma_f32_16x16x32_bf16 v[184:187], a[40:43], a[168:171], v[184:187]
    ds_write_b64 v21, v[148:149] offset:3072
    v_mfma_f32_16x16x32_bf16 v[188:191], a[40:43], a[172:175], v[188:191]
    v_cvt_pk_bf16_f32 v157, v158, v159
    v_cvt_pk_bf16_f32 v160, v160, v161
    v_mfma_f32_16x16x32_bf16 v[192:195], a[40:43], a[176:179], v[192:195]
    ds_write_b64 v21, v[152:153] offset:4096
    v_mfma_f32_16x16x32_bf16 v[196:199], a[44:47], a[160:163], v[196:199]
    v_cvt_pk_bf16_f32 v161, v162, v163
    v_cvt_pk_bf16_f32 v164, v164, v165
    v_mfma_f32_16x16x32_bf16 v[200:203], a[44:47], a[164:167], v[200:203]
    buffer_load_dwordx4 v5, s[32:35], s22 offen offset:3264 nt lds
    v_cvt_pk_bf16_f32 v165, v166, v167
    v_mfma_f32_16x16x32_bf16 v[204:207], a[44:47], a[168:171], v[204:207]
    ds_write_b64 v21, v[156:157] offset:512
    v_mfma_f32_16x16x32_bf16 v[208:211], a[44:47], a[172:175], v[208:211]
    ds_write_b64 v21, v[160:161] offset:1536
    v_mfma_f32_16x16x32_bf16 v[212:215], a[44:47], a[176:179], v[212:215]
    v_cvt_pk_bf16_f32 v168, v168, v169
    ds_read_b128 v[120:123], v24 offset:35200
    v_mfma_f32_16x16x32_bf16 v[176:179], a[48:51], a[180:183], v[176:179]
    v_cvt_pk_bf16_f32 v169, v170, v171
    v_cvt_pk_bf16_f32 v172, v172, v173
    v_mfma_f32_16x16x32_bf16 v[180:183], a[48:51], a[184:187], v[180:183]
    ds_write_b64 v21, v[164:165] offset:2560
    v_mfma_f32_16x16x32_bf16 v[184:187], a[48:51], a[188:191], v[184:187]
    ds_read_b128 v[124:127], v25 offset:35200
    v_add_u32 v22, 0x23000, v22
    ds_read_b128 a[0:3], v22
    v_mfma_f32_16x16x32_bf16 v[188:191], a[48:51], a[192:195], v[188:191]
    ds_read_b128 a[4:7], v22 offset:1024
    ds_read_b128 a[8:11], v22 offset:2048
    v_mfma_f32_16x16x32_bf16 v[192:195], a[48:51], a[196:199], v[192:195]
    ds_read_b128 a[12:15], v22 offset:3072
    ds_read_b128 a[16:19], v22 offset:4096
    v_mfma_f32_16x16x32_bf16 v[196:199], a[52:55], a[180:183], v[196:199]
    v_add_u32 v23, 0x23000, v23
    ds_read_b128 a[20:23], v23
    v_mfma_f32_16x16x32_bf16 v[200:203], a[52:55], a[184:187], v[200:203]
    ds_read_b128 a[24:27], v23 offset:1024
    ds_read_b128 a[28:31], v23 offset:2048
    v_mfma_f32_16x16x32_bf16 v[204:207], a[52:55], a[188:191], v[204:207]
    s_add_u32 m0, s21, 52224
    s_mov_b32 s22, 32768
    buffer_load_dwordx4 v2, s[36:39], s22 offen nt lds
    v_mfma_f32_16x16x32_bf16 v[208:211], a[52:55], a[192:195], v[208:211]
    ds_read_b128 a[32:35], v23 offset:3072
    ds_read_b128 a[36:39], v23 offset:4096
    v_mfma_f32_16x16x32_bf16 v[212:215], a[52:55], a[196:199], v[212:215]
    v_cvt_pk_bf16_f32 v173, v174, v175
    v_mfma_f32_16x16x32_bf16 v[176:179], a[56:59], a[120:123], v[176:179]
    ds_write_b64 v21, v[168:169] offset:3584
    v_mfma_f32_16x16x32_bf16 v[180:183], a[56:59], a[124:127], v[180:183]
    ds_write_b64 v21, v[172:173] offset:4608
    v_mfma_f32_16x16x32_bf16 v[184:187], a[56:59], a[128:131], v[184:187]
    v_mfma_f32_16x16x32_bf16 v[188:191], a[56:59], a[132:135], v[188:191]
    v_mfma_f32_16x16x32_bf16 v[192:195], a[56:59], a[136:139], v[192:195]
    v_mfma_f32_16x16x32_bf16 v[196:199], a[60:63], a[120:123], v[196:199]
    v_mfma_f32_16x16x32_bf16 v[200:203], a[60:63], a[124:127], v[200:203]
    v_mfma_f32_16x16x32_bf16 v[204:207], a[60:63], a[128:131], v[204:207]
    v_mfma_f32_16x16x32_bf16 v[208:211], a[60:63], a[132:135], v[208:211]
    buffer_load_dwordx4 v3, s[36:39], s22 offen offset:1088 nt lds
    v_mfma_f32_16x16x32_bf16 v[212:215], a[60:63], a[136:139], v[212:215]
    s_waitcnt vmcnt(14) lgkmcnt(0)
    s_barrier
    v_mfma_f32_16x16x32_bf16 v[176:179], a[64:67], a[140:143], v[176:179]
    v_add_u32 v24, 0x11000, v24
    ds_read_b128 v[136:139], v24
    v_mfma_f32_16x16x32_bf16 v[180:183], a[64:67], a[144:147], v[180:183]
    v_add_u32 v25, 0x11000, v25
    ds_read_b128 v[140:143], v25
    v_mfma_f32_16x16x32_bf16 v[184:187], a[64:67], a[148:151], v[184:187]
    ds_read_b128 v[144:147], v24 offset:128
    ds_read_b128 v[148:151], v25 offset:128
    v_mfma_f32_16x16x32_bf16 v[188:191], a[64:67], a[152:155], v[188:191]
    v_cvt_pk_bf16_f32 v176, v176, v177
    v_cvt_pk_bf16_f32 v177, v178, v179
    v_mfma_f32_16x16x32_bf16 v[192:195], a[64:67], a[156:159], v[192:195]
    v_cvt_pk_bf16_f32 v180, v180, v181
    v_cvt_pk_bf16_f32 v181, v182, v183
    v_mfma_f32_16x16x32_bf16 v[196:199], a[68:71], a[140:143], v[196:199]
    v_cvt_pk_bf16_f32 v184, v184, v185
    v_cvt_pk_bf16_f32 v185, v186, v187
    v_mfma_f32_16x16x32_bf16 v[200:203], a[68:71], a[144:147], v[200:203]
    ds_write_b64 v21, v[176:177] offset:21504
    v_mfma_f32_16x16x32_bf16 v[204:207], a[68:71], a[148:151], v[204:207]
    v_cvt_pk_bf16_f32 v188, v188, v189
    v_cvt_pk_bf16_f32 v189, v190, v191
    v_mfma_f32_16x16x32_bf16 v[208:211], a[68:71], a[152:155], v[208:211]
    ds_write_b64 v21, v[180:181] offset:22528
    v_mfma_f32_16x16x32_bf16 v[212:215], a[68:71], a[156:159], v[212:215]
    buffer_load_dwordx4 v4, s[36:39], s22 offen offset:2176 nt lds
    v_cvt_pk_bf16_f32 v192, v192, v193
    v_mfma_f32_16x16x32_bf16 v[216:219], a[80:83], a[160:163], v[216:219]
    ds_write_b64 v21, v[184:185] offset:23552
    v_mfma_f32_16x16x32_bf16 v[220:223], a[80:83], a[164:167], v[220:223]
    v_cvt_pk_bf16_f32 v193, v194, v195
    v_cvt_pk_bf16_f32 v196, v196, v197
    v_mfma_f32_16x16x32_bf16 v[224:227], a[80:83], a[168:171], v[224:227]
    ds_write_b64 v21, v[188:189] offset:24576
    v_mfma_f32_16x16x32_bf16 v[228:231], a[80:83], a[172:175], v[228:231]
    v_cvt_pk_bf16_f32 v197, v198, v199
    ds_read_b128 v[152:155], v24 offset:256
    v_mfma_f32_16x16x32_bf16 v[232:235], a[80:83], a[176:179], v[232:235]
    ds_write_b64 v21, v[192:193] offset:25600
    v_mfma_f32_16x16x32_bf16 v[236:239], a[84:87], a[160:163], v[236:239]
    v_cvt_pk_bf16_f32 v200, v200, v201
    v_cvt_pk_bf16_f32 v201, v202, v203
    v_mfma_f32_16x16x32_bf16 v[240:243], a[84:87], a[164:167], v[240:243]
    ds_write_b64 v21, v[196:197] offset:22016
    v_mfma_f32_16x16x32_bf16 v[244:247], a[84:87], a[168:171], v[244:247]
    v_cvt_pk_bf16_f32 v204, v204, v205
    ds_read_b128 v[156:159], v25 offset:256
    v_mfma_f32_16x16x32_bf16 v[248:251], a[84:87], a[172:175], v[248:251]
    v_cvt_pk_bf16_f32 v205, v206, v207
    v_cvt_pk_bf16_f32 v208, v208, v209
    v_mfma_f32_16x16x32_bf16 v[252:255], a[84:87], a[176:179], v[252:255]
    ds_write_b64 v21, v[200:201] offset:23040
    v_mfma_f32_16x16x32_bf16 v[216:219], a[88:91], a[180:183], v[216:219]
    buffer_load_dwordx4 v5, s[36:39], s22 offen offset:3264 nt lds
    v_cvt_pk_bf16_f32 v209, v210, v211
    v_mfma_f32_16x16x32_bf16 v[220:223], a[88:91], a[184:187], v[220:223]
    ds_read_b128 v[160:163], v24 offset:384
    v_cvt_pk_bf16_f32 v212, v212, v213
    v_mfma_f32_16x16x32_bf16 v[224:227], a[88:91], a[188:191], v[224:227]
    ds_write_b64 v21, v[204:205] offset:24064
    v_mfma_f32_16x16x32_bf16 v[228:231], a[88:91], a[192:195], v[228:231]
    v_add_u32 v22, 0xffffac00, v22
    ds_read_b128 a[40:43], v22
    v_mfma_f32_16x16x32_bf16 v[232:235], a[88:91], a[196:199], v[232:235]
    ds_read_b128 a[44:47], v22 offset:1024
    ds_read_b128 a[48:51], v22 offset:2048
    v_mfma_f32_16x16x32_bf16 v[236:239], a[92:95], a[180:183], v[236:239]
    ds_read_b128 a[52:55], v22 offset:3072
    ds_read_b128 a[56:59], v22 offset:4096
    v_mfma_f32_16x16x32_bf16 v[240:243], a[92:95], a[184:187], v[240:243]
    v_add_u32 v23, 0xffffac00, v23
    ds_read_b128 a[60:63], v23
    v_mfma_f32_16x16x32_bf16 v[244:247], a[92:95], a[188:191], v[244:247]
    ds_read_b128 a[64:67], v23 offset:1024
    ds_read_b128 a[68:71], v23 offset:2048
    v_mfma_f32_16x16x32_bf16 v[248:251], a[92:95], a[192:195], v[248:251]
    ds_read_b128 a[72:75], v23 offset:3072
    ds_read_b128 a[76:79], v23 offset:4096
    v_mfma_f32_16x16x32_bf16 v[252:255], a[92:95], a[196:199], v[252:255]
    v_cvt_pk_bf16_f32 v213, v214, v215
    ds_read_b128 v[164:167], v25 offset:384
    v_mfma_f32_16x16x32_bf16 v[216:219], a[96:99], a[120:123], v[216:219]
    ds_write_b64 v21, v[208:209] offset:25088
    v_mfma_f32_16x16x32_bf16 v[220:223], a[96:99], a[124:127], v[220:223]
    s_add_u32 m0, s21, 104448
    s_mov_b32 s22, 81920
    buffer_load_dwordx4 v2, s[32:35], s22 offen nt lds
    v_mfma_f32_16x16x32_bf16 v[224:227], a[96:99], a[128:131], v[224:227]
    ds_write_b64 v21, v[212:213] offset:26112
    v_mfma_f32_16x16x32_bf16 v[228:231], a[96:99], a[132:135], v[228:231]
    v_mfma_f32_16x16x32_bf16 v[232:235], a[96:99], a[136:139], v[232:235]
    v_mfma_f32_16x16x32_bf16 v[236:239], a[100:103], a[120:123], v[236:239]
    v_mfma_f32_16x16x32_bf16 v[240:243], a[100:103], a[124:127], v[240:243]
    v_mfma_f32_16x16x32_bf16 v[244:247], a[100:103], a[128:131], v[244:247]
    v_mfma_f32_16x16x32_bf16 v[248:251], a[100:103], a[132:135], v[248:251]
    v_mfma_f32_16x16x32_bf16 v[252:255], a[100:103], a[136:139], v[252:255]
    s_waitcnt vmcnt(13) lgkmcnt(0)
    s_barrier
    v_mfma_f32_16x16x32_bf16 v[216:219], a[104:107], a[140:143], v[216:219]
    ds_read_b128 a[216:219], v24 offset:17408
    ds_read_b128 a[220:223], v25 offset:17408
    v_mfma_f32_16x16x32_bf16 v[220:223], a[104:107], a[144:147], v[220:223]
    ds_read_b128 a[200:203], v24 offset:17536
    ds_read_b128 a[80:83], v22 offset:21504
    v_mfma_f32_16x16x32_bf16 v[224:227], a[104:107], a[148:151], v[224:227]
    buffer_load_dwordx4 v3, s[32:35], s22 offen offset:1088 nt lds
    ds_read_b128 a[84:87], v22 offset:22528
    v_mfma_f32_16x16x32_bf16 v[228:231], a[104:107], a[152:155], v[228:231]
    v_cvt_pk_bf16_f32 v216, v216, v217
    v_cvt_pk_bf16_f32 v217, v218, v219
    v_mfma_f32_16x16x32_bf16 v[232:235], a[104:107], a[156:159], v[232:235]
    v_cvt_pk_bf16_f32 v220, v220, v221
    v_cvt_pk_bf16_f32 v221, v222, v223
    v_mfma_f32_16x16x32_bf16 v[236:239], a[108:111], a[140:143], v[236:239]
    ds_write_b64 v21, v[216:217]
    v_mfma_f32_16x16x32_bf16 v[240:243], a[108:111], a[144:147], v[240:243]
    v_cvt_pk_bf16_f32 v224, v224, v225
    v_cvt_pk_bf16_f32 v225, v226, v227
    v_mfma_f32_16x16x32_bf16 v[244:247], a[108:111], a[148:151], v[244:247]
    ds_write_b64 v21, v[220:221] offset:1024
    v_mfma_f32_16x16x32_bf16 v[248:251], a[108:111], a[152:155], v[248:251]
    v_cvt_pk_bf16_f32 v228, v228, v229
    v_cvt_pk_bf16_f32 v229, v230, v231
    v_mfma_f32_16x16x32_bf16 v[252:255], a[108:111], a[156:159], v[252:255]
    v_xor_b32 v17, 4096, v15
    v_xor_b32 v18, 4096, v16
    v_mfma_f32_16x16x32_bf16 v[36:39], v[56:59], a[0:3], 0
    ds_write_b64 v21, v[224:225] offset:2048
    v_mfma_f32_16x16x32_bf16 v[40:43], v[56:59], a[4:7], 0
    v_cvt_pk_bf16_f32 v232, v232, v233
    ds_read_b128 a[88:91], v22 offset:23552
    v_mfma_f32_16x16x32_bf16 v[44:47], v[56:59], a[8:11], 0
    ds_write_b64 v21, v[228:229] offset:3072
    v_mfma_f32_16x16x32_bf16 v[48:51], v[56:59], a[12:15], 0
    buffer_load_dwordx4 v4, s[32:35], s22 offen offset:2176 nt lds
    ds_read_b128 a[92:95], v22 offset:24576
    v_mfma_f32_16x16x32_bf16 v[52:55], v[56:59], a[16:19], 0
    v_cvt_pk_bf16_f32 v233, v234, v235
    ds_read_b128 a[96:99], v22 offset:25600
    v_mfma_f32_16x16x32_bf16 v[36:39], v[60:63], a[20:23], v[36:39]
    ds_read_b128 a[204:207], v25 offset:17536
    ds_read_b128 a[100:103], v23 offset:21504
    v_mfma_f32_16x16x32_bf16 v[40:43], v[60:63], a[24:27], v[40:43]
    v_cvt_pk_bf16_f32 v236, v236, v237
    ds_read_b128 a[104:107], v23 offset:22528
    v_mfma_f32_16x16x32_bf16 v[44:47], v[60:63], a[28:31], v[44:47]
    ds_read_b128 a[108:111], v23 offset:23552
    ds_read_b128 a[112:115], v23 offset:24576
    v_mfma_f32_16x16x32_bf16 v[48:51], v[60:63], a[32:35], v[48:51]
    ds_write_b64 v21, v[232:233] offset:4096
    v_mfma_f32_16x16x32_bf16 v[52:55], v[60:63], a[36:39], v[52:55]
    v_cvt_pk_bf16_f32 v237, v238, v239
    ds_read_b128 a[116:119], v23 offset:25600
    v_mfma_f32_16x16x32_bf16 v[36:39], v[64:67], a[40:43], v[36:39]
    ds_read_b128 a[208:211], v24 offset:17664
    v_cvt_pk_bf16_f32 v240, v240, v241
    v_mfma_f32_16x16x32_bf16 v[40:43], v[64:67], a[44:47], v[40:43]
    v_cvt_pk_bf16_f32 v241, v242, v243
    v_cvt_pk_bf16_f32 v244, v244, v245
    v_mfma_f32_16x16x32_bf16 v[44:47], v[64:67], a[48:51], v[44:47]
    ds_write_b64 v21, v[236:237] offset:512
    v_mfma_f32_16x16x32_bf16 v[48:51], v[64:67], a[52:55], v[48:51]
    ds_read_b128 a[212:215], v25 offset:17664
    v_cvt_pk_bf16_f32 v245, v246, v247
    v_mfma_f32_16x16x32_bf16 v[52:55], v[64:67], a[56:59], v[52:55]
    buffer_load_dwordx4 v5, s[32:35], s22 offen offset:3264 nt lds
    v_cvt_pk_bf16_f32 v248, v248, v249
    v_mfma_f32_16x16x32_bf16 v[36:39], v[68:71], a[60:63], v[36:39]
    ds_write_b64 v21, v[240:241] offset:1536
    v_mfma_f32_16x16x32_bf16 v[40:43], v[68:71], a[64:67], v[40:43]
    ds_write_b64 v21, v[244:245] offset:2560
    v_mfma_f32_16x16x32_bf16 v[44:47], v[68:71], a[68:71], v[44:47]
    ds_read_b128 a[160:163], v24 offset:17792
    v_cvt_pk_bf16_f32 v249, v250, v251
    v_mfma_f32_16x16x32_bf16 v[48:51], v[68:71], a[72:75], v[48:51]
    v_cvt_pk_bf16_f32 v252, v252, v253
    v_cvt_pk_bf16_f32 v253, v254, v255
    v_mfma_f32_16x16x32_bf16 v[52:55], v[68:71], a[76:79], v[52:55]
    ds_write_b64 v21, v[248:249] offset:3584
    s_waitcnt lgkmcnt(15)
    v_mfma_f32_16x16x32_bf16 v[36:39], v[72:75], a[80:83], v[36:39]
    ds_read_b128 a[164:167], v25 offset:17792
    v_mfma_f32_16x16x32_bf16 v[40:43], v[72:75], a[84:87], v[40:43]
    ds_write_b64 v21, v[252:253] offset:4608
    v_mfma_f32_16x16x32_bf16 v[44:47], v[72:75], a[88:91], v[44:47]
    v_mfma_f32_16x16x32_bf16 v[48:51], v[72:75], a[92:95], v[48:51]
    s_waitcnt lgkmcnt(15)
    v_mfma_f32_16x16x32_bf16 v[52:55], v[72:75], a[96:99], v[52:55]
    s_waitcnt lgkmcnt(14)
    v_mfma_f32_16x16x32_bf16 v[36:39], v[76:79], a[100:103], v[36:39]
    s_add_u32 m0, s21, 34816
    s_mov_b32 s22, 49152
    buffer_load_dwordx4 v2, s[36:39], s22 offen nt lds
    s_waitcnt lgkmcnt(13)
    v_mfma_f32_16x16x32_bf16 v[40:43], v[76:79], a[104:107], v[40:43]
    s_waitcnt lgkmcnt(12)
    v_mfma_f32_16x16x32_bf16 v[44:47], v[76:79], a[108:111], v[44:47]
    s_waitcnt lgkmcnt(11)
    v_mfma_f32_16x16x32_bf16 v[48:51], v[76:79], a[112:115], v[48:51]
    s_waitcnt lgkmcnt(9)
    v_mfma_f32_16x16x32_bf16 v[52:55], v[76:79], a[116:119], v[52:55]
    v_mfma_f32_16x16x32_bf16 v[56:59], v[96:99], a[0:3], 0
    v_mfma_f32_16x16x32_bf16 v[60:63], v[96:99], a[4:7], 0
    v_mfma_f32_16x16x32_bf16 v[64:67], v[96:99], a[8:11], 0
    v_mfma_f32_16x16x32_bf16 v[68:71], v[96:99], a[12:15], 0
    v_mfma_f32_16x16x32_bf16 v[72:75], v[96:99], a[16:19], 0
    v_mfma_f32_16x16x32_bf16 v[56:59], v[100:103], a[20:23], v[56:59]
    v_mfma_f32_16x16x32_bf16 v[60:63], v[100:103], a[24:27], v[60:63]
    buffer_load_dwordx4 v3, s[36:39], s22 offen offset:1088 nt lds
    v_mfma_f32_16x16x32_bf16 v[64:67], v[100:103], a[28:31], v[64:67]
    v_mfma_f32_16x16x32_bf16 v[68:71], v[100:103], a[32:35], v[68:71]
    v_mfma_f32_16x16x32_bf16 v[72:75], v[100:103], a[36:39], v[72:75]
    v_mfma_f32_16x16x32_bf16 v[56:59], v[104:107], a[40:43], v[56:59]
    v_mfma_f32_16x16x32_bf16 v[60:63], v[104:107], a[44:47], v[60:63]
    v_mfma_f32_16x16x32_bf16 v[64:67], v[104:107], a[48:51], v[64:67]
    v_mfma_f32_16x16x32_bf16 v[68:71], v[104:107], a[52:55], v[68:71]
    v_mfma_f32_16x16x32_bf16 v[72:75], v[104:107], a[56:59], v[72:75]
    v_mfma_f32_16x16x32_bf16 v[56:59], v[108:111], a[60:63], v[56:59]
    s_waitcnt vmcnt(14) lgkmcnt(0)
    s_barrier
    v_mfma_f32_16x16x32_bf16 v[60:63], v[108:111], a[64:67], v[60:63]
    ds_read_b128 a[120:123], v22
    ds_read_b64_tr_b16 a[168:169], v10
    v_mfma_f32_16x16x32_bf16 v[64:67], v[108:111], a[68:71], v[64:67]
    buffer_load_dwordx4 v4, s[36:39], s22 offen offset:2176 nt lds
    ds_read_b128 a[124:127], v22 offset:1024
    v_mfma_f32_16x16x32_bf16 v[68:71], v[108:111], a[72:75], v[68:71]
    ds_read_b128 a[128:131], v22 offset:2048
    ds_read_b128 a[132:135], v22 offset:3072
    v_mfma_f32_16x16x32_bf16 v[72:75], v[108:111], a[76:79], v[72:75]
    ds_read_b64_tr_b16 a[170:171], v12
    ds_read_b128 a[136:139], v22 offset:4096
    v_mfma_f32_16x16x32_bf16 v[56:59], v[112:115], a[80:83], v[56:59]
    ds_read_b128 a[140:143], v23
    ds_read_b128 a[144:147], v23 offset:1024
    v_mfma_f32_16x16x32_bf16 v[60:63], v[112:115], a[84:87], v[60:63]
    ds_read_b128 a[148:151], v23 offset:2048
    ds_read_b64_tr_b16 a[172:173], v11
    v_mfma_f32_16x16x32_bf16 v[64:67], v[112:115], a[88:91], v[64:67]
    ds_read_b128 a[152:155], v23 offset:3072
    ds_read_b128 a[156:159], v23 offset:4096
    v_mfma_f32_16x16x32_bf16 v[68:71], v[112:115], a[92:95], v[68:71]
    ds_read_b64_tr_b16 a[174:175], v13
    ds_read_b64_tr_b16 a[176:177], v10 offset:128
    v_mfma_f32_16x16x32_bf16 v[72:75], v[112:115], a[96:99], v[72:75]
    ds_read_b64_tr_b16 a[178:179], v12 offset:128
    ds_read_b64_tr_b16 a[180:181], v11 offset:128
    v_mfma_f32_16x16x32_bf16 v[56:59], v[116:119], a[100:103], v[56:59]
    ds_read_b64_tr_b16 a[182:183], v13 offset:128
    ds_read_b64_tr_b16 a[184:185], v10 offset:256
    v_mfma_f32_16x16x32_bf16 v[60:63], v[116:119], a[104:107], v[60:63]
    ds_read_b64_tr_b16 a[186:187], v12 offset:256
    ds_read_b64_tr_b16 a[188:189], v11 offset:256
    v_mfma_f32_16x16x32_bf16 v[64:67], v[116:119], a[108:111], v[64:67]
    ds_read_b64_tr_b16 a[190:191], v13 offset:256
    ds_read_b64_tr_b16 a[192:193], v10 offset:384
    v_mfma_f32_16x16x32_bf16 v[68:71], v[116:119], a[112:115], v[68:71]
    buffer_load_dwordx4 v5, s[36:39], s22 offen offset:3264 nt lds
    ds_read_b64_tr_b16 a[194:195], v12 offset:384
    v_mfma_f32_16x16x32_bf16 v[72:75], v[116:119], a[116:119], v[72:75]
    ds_read_b64_tr_b16 a[196:197], v11 offset:384
    s_waitcnt lgkmcnt(15)
    v_mfma_f32_16x16x32_bf16 v[36:39], v[80:83], a[120:123], v[36:39]
    ds_read_b64_tr_b16 a[198:199], v13 offset:384
    v_mfma_f32_16x16x32_bf16 v[40:43], v[80:83], a[124:127], v[40:43]
    v_mfma_f32_16x16x32_bf16 v[44:47], v[80:83], a[128:131], v[44:47]
    v_mfma_f32_16x16x32_bf16 v[48:51], v[80:83], a[132:135], v[48:51]
    v_mfma_f32_16x16x32_bf16 v[52:55], v[80:83], a[136:139], v[52:55]
    v_mfma_f32_16x16x32_bf16 v[36:39], v[84:87], a[140:143], v[36:39]
    v_mfma_f32_16x16x32_bf16 v[40:43], v[84:87], a[144:147], v[40:43]
    v_mfma_f32_16x16x32_bf16 v[44:47], v[84:87], a[148:151], v[44:47]
    s_nop 5
    v_fma_f32 v36, v36, s23, v31
    v_fma_f32 v37, v37, s23, v31
    s_waitcnt lgkmcnt(14)
    v_mfma_f32_16x16x32_bf16 v[48:51], v[84:87], a[152:155], v[48:51]
    v_fma_f32 v38, v38, s23, v31
    v_fma_f32 v39, v39, s23, v31
    s_waitcnt lgkmcnt(13)
    v_mfma_f32_16x16x32_bf16 v[52:55], v[84:87], a[156:159], v[52:55]
    v_exp_f32 v36, v36
    v_exp_f32 v37, v37
    v_mfma_f32_16x16x32_bf16 v[56:59], v[120:123], a[120:123], v[56:59]
    v_exp_f32 v38, v38
    v_exp_f32 v39, v39
    v_add_f32 v26, v36, v37
    v_mfma_f32_16x16x32_bf16 v[60:63], v[120:123], a[124:127], v[60:63]
    v_add_f32 v26, v26, v38
    v_add_f32 v26, v26, v39
    v_mfma_f32_16x16x32_bf16 v[64:67], v[120:123], a[128:131], v[64:67]
    v_cvt_pk_bf16_f32 v36, v36, v37
    v_cvt_pk_bf16_f32 v37, v38, v39
    s_add_u32 m0, s21, 69632
    s_mov_b32 s22, 98304
    buffer_load_dwordx4 v2, s[32:35], s22 offen nt lds
    v_mfma_f32_16x16x32_bf16 v[68:71], v[120:123], a[132:135], v[68:71]
    v_add_u32 v14, 0x23000, v14
    ds_write_b64 v14, v[36:37]
    v_mfma_f32_16x16x32_bf16 v[72:75], v[120:123], a[136:139], v[72:75]
    v_fma_f32 v40, v40, s23, v32
    v_fma_f32 v41, v41, s23, v32
    v_mfma_f32_16x16x32_bf16 v[56:59], v[124:127], a[140:143], v[56:59]
    v_fma_f32 v42, v42, s23, v32
    v_fma_f32 v43, v43, s23, v32
    v_mfma_f32_16x16x32_bf16 v[60:63], v[124:127], a[144:147], v[60:63]
    v_exp_f32 v40, v40
    v_mfma_f32_16x16x32_bf16 v[64:67], v[124:127], a[148:151], v[64:67]
    v_exp_f32 v41, v41
    v_exp_f32 v42, v42
    v_exp_f32 v43, v43
    v_fma_f32 v44, v44, s23, v33
    v_fma_f32 v45, v45, s23, v33
    v_fma_f32 v46, v46, s23, v33
    v_fma_f32 v47, v47, s23, v33
    v_exp_f32 v44, v44
    v_exp_f32 v45, v45
    v_exp_f32 v46, v46
    v_exp_f32 v47, v47
    v_fma_f32 v48, v48, s23, v34
    v_fma_f32 v49, v49, s23, v34
    v_fma_f32 v50, v50, s23, v34
    v_fma_f32 v51, v51, s23, v34
    v_exp_f32 v48, v48
    v_exp_f32 v49, v49
    v_exp_f32 v50, v50
    v_exp_f32 v51, v51
    v_fma_f32 v52, v52, s23, v35
    v_fma_f32 v53, v53, s23, v35
    v_fma_f32 v54, v54, s23, v35
    v_fma_f32 v55, v55, s23, v35
    v_exp_f32 v52, v52
    v_exp_f32 v53, v53
    v_exp_f32 v54, v54
    v_exp_f32 v55, v55
    v_fma_f32 v56, v56, s23, v31
    v_mfma_f32_16x16x32_bf16 v[68:71], v[124:127], a[152:155], v[68:71]
    v_add_f32 v27, v40, v41
    v_fma_f32 v57, v57, s23, v31
    v_mfma_f32_16x16x32_bf16 v[72:75], v[124:127], a[156:159], v[72:75]
    v_add_f32 v27, v27, v42
    v_fma_f32 v58, v58, s23, v31
    v_mfma_f32_16x16x32_bf16 v[76:79], v[136:139], a[0:3], 0
    v_add_f32 v27, v27, v43
    v_cvt_pk_bf16_f32 v40, v40, v41
    v_fma_f32 v59, v59, s23, v31
    v_mfma_f32_16x16x32_bf16 v[80:83], v[136:139], a[4:7], 0
    v_cvt_pk_bf16_f32 v41, v42, v43
    v_exp_f32 v56, v56
    v_exp_f32 v57, v57
    v_mfma_f32_16x16x32_bf16 v[84:87], v[136:139], a[8:11], 0
    ds_write_b64 v14, v[40:41] offset:512
    v_exp_f32 v58, v58
    v_mfma_f32_16x16x32_bf16 v[88:91], v[136:139], a[12:15], 0
    v_exp_f32 v59, v59
    v_add_f32 v26, v26, v56
    buffer_load_dwordx4 v3, s[32:35], s22 offen offset:1088 nt lds
    v_mfma_f32_16x16x32_bf16 v[92:95], v[136:139], a[16:19], 0
    v_add_f32 v26, v26, v57
    v_add_f32 v28, v44, v45
    v_mfma_f32_16x16x32_bf16 v[76:79], v[140:143], a[20:23], v[76:79]
    v_add_f32 v26, v26, v58
    v_add_f32 v28, v28, v46
    v_mfma_f32_16x16x32_bf16 v[80:83], v[140:143], a[24:27], v[80:83]
    v_add_f32 v28, v28, v47
    v_add_f32 v26, v26, v59
    v_mfma_f32_16x16x32_bf16 v[84:87], v[140:143], a[28:31], v[84:87]
    v_cvt_pk_bf16_f32 v44, v44, v45
    v_cvt_pk_bf16_f32 v45, v46, v47
    v_cvt_pk_bf16_f32 v56, v56, v57
    v_mfma_f32_16x16x32_bf16 v[88:91], v[140:143], a[32:35], v[88:91]
    v_cvt_pk_bf16_f32 v57, v58, v59
    v_fma_f32 v60, v60, s23, v32
    v_mfma_f32_16x16x32_bf16 v[92:95], v[140:143], a[36:39], v[92:95]
    ds_write_b64 v14, v[44:45] offset:1024
    v_mfma_f32_16x16x32_bf16 v[76:79], v[144:147], a[40:43], v[76:79]
    v_fma_f32 v61, v61, s23, v32
    v_fma_f32 v62, v62, s23, v32
    v_mfma_f32_16x16x32_bf16 v[80:83], v[144:147], a[44:47], v[80:83]
    v_add_f32 v29, v48, v49
    v_fma_f32 v63, v63, s23, v32
    v_mfma_f32_16x16x32_bf16 v[84:87], v[144:147], a[48:51], v[84:87]
    v_add_f32 v29, v29, v50
    buffer_load_dwordx4 v4, s[32:35], s22 offen offset:2176 nt lds
    v_mfma_f32_16x16x32_bf16 v[88:91], v[144:147], a[52:55], v[88:91]
    v_exp_f32 v60, v60
    v_mfma_f32_16x16x32_bf16 v[92:95], v[144:147], a[56:59], v[92:95]
    v_add_f32 v29, v29, v51
    v_cvt_pk_bf16_f32 v48, v48, v49
    v_mfma_f32_16x16x32_bf16 v[76:79], v[148:151], a[60:63], v[76:79]
    v_exp_f32 v61, v61
    v_mfma_f32_16x16x32_bf16 v[80:83], v[148:151], a[64:67], v[80:83]
    v_cvt_pk_bf16_f32 v49, v50, v51
    v_exp_f32 v62, v62
    v_mfma_f32_16x16x32_bf16 v[84:87], v[148:151], a[68:71], v[84:87]
    ds_write_b64 v14, v[48:49] offset:1536
    v_exp_f32 v63, v63
    v_mfma_f32_16x16x32_bf16 v[88:91], v[148:151], a[72:75], v[88:91]
    v_add_f32 v27, v27, v60
    v_add_f32 v27, v27, v61
    v_mfma_f32_16x16x32_bf16 v[92:95], v[148:151], a[76:79], v[92:95]
    v_add_f32 v27, v27, v62
    v_add_f32 v30, v52, v53
    v_mfma_f32_16x16x32_bf16 v[76:79], v[152:155], a[80:83], v[76:79]
    v_add_f32 v27, v27, v63
    v_add_f32 v30, v30, v54
    v_mfma_f32_16x16x32_bf16 v[80:83], v[152:155], a[84:87], v[80:83]
    v_cvt_pk_bf16_f32 v60, v60, v61
    v_add_f32 v30, v30, v55
    v_mfma_f32_16x16x32_bf16 v[84:87], v[152:155], a[88:91], v[84:87]
    v_cvt_pk_bf16_f32 v52, v52, v53
    v_cvt_pk_bf16_f32 v61, v62, v63
    v_mfma_f32_16x16x32_bf16 v[88:91], v[152:155], a[92:95], v[88:91]
    v_cvt_pk_bf16_f32 v53, v54, v55
    v_fma_f32 v64, v64, s23, v33
    v_mfma_f32_16x16x32_bf16 v[92:95], v[152:155], a[96:99], v[92:95]
    ds_write_b64 v14, v[52:53] offset:2048
    v_mfma_f32_16x16x32_bf16 v[76:79], v[156:159], a[100:103], v[76:79]
    v_fma_f32 v65, v65, s23, v33
    buffer_load_dwordx4 v5, s[32:35], s22 offen offset:3264 nt lds
    v_mfma_f32_16x16x32_bf16 v[80:83], v[156:159], a[104:107], v[80:83]
    v_fma_f32 v66, v66, s23, v33
    v_fma_f32 v67, v67, s23, v33
    v_mfma_f32_16x16x32_bf16 v[84:87], v[156:159], a[108:111], v[84:87]
    v_exp_f32 v64, v64
    v_mfma_f32_16x16x32_bf16 v[88:91], v[156:159], a[112:115], v[88:91]
    v_exp_f32 v65, v65
    v_mfma_f32_16x16x32_bf16 v[92:95], v[156:159], a[116:119], v[92:95]
    s_waitcnt lgkmcnt(0)
    s_barrier
    ds_write_b64 v14, v[56:57] offset:10240
    ds_write_b64 v14, v[60:61] offset:10752
    v_exp_f32 v66, v66
    v_mfma_f32_16x16x32_bf16 v[76:79], v[160:163], a[120:123], v[76:79]
    v_exp_f32 v67, v67
    v_add_f32 v28, v28, v64
    v_mfma_f32_16x16x32_bf16 v[80:83], v[160:163], a[124:127], v[80:83]
    v_add_f32 v28, v28, v65
    v_add_u32 v19, 0x23000, v19
    ds_read_b64 v[38:39], v19
    v_mfma_f32_16x16x32_bf16 v[84:87], v[160:163], a[128:131], v[84:87]
    v_add_f32 v28, v28, v66
    ds_read_b64 v[42:43], v19 offset:512
    v_mfma_f32_16x16x32_bf16 v[88:91], v[160:163], a[132:135], v[88:91]
    v_add_f32 v28, v28, v67
    ds_read_b64 v[46:47], v19 offset:1024
    v_mfma_f32_16x16x32_bf16 v[92:95], v[160:163], a[136:139], v[92:95]
    v_cvt_pk_bf16_f32 v64, v64, v65
    ds_read_b64 v[50:51], v19 offset:1536
    v_mfma_f32_16x16x32_bf16 v[76:79], v[164:167], a[140:143], v[76:79]
    v_cvt_pk_bf16_f32 v65, v66, v67
    ds_read_b64 v[54:55], v19 offset:2048
    v_mfma_f32_16x16x32_bf16 v[80:83], v[164:167], a[144:147], v[80:83]
    s_add_u32 m0, s21, 87040
    s_mov_b32 s22, 65536
    buffer_load_dwordx4 v2, s[36:39], s22 offen nt lds
    v_mfma_f32_16x16x32_bf16 v[84:87], v[164:167], a[148:151], v[84:87]
    ds_write_b64 v14, v[64:65] offset:11264
    v_fma_f32 v68, v68, s23, v34
    v_mfma_f32_16x16x32_bf16 v[88:91], v[164:167], a[152:155], v[88:91]
    v_fma_f32 v69, v69, s23, v34
    v_fma_f32 v70, v70, s23, v34
    v_mfma_f32_16x16x32_bf16 v[92:95], v[164:167], a[156:159], v[92:95]
    v_fma_f32 v71, v71, s23, v34
    s_waitcnt lgkmcnt(5)
    v_mfma_f32_16x16x32_bf16 v[96:99], a[224:227], v[36:39], 0
    v_exp_f32 v68, v68
    s_waitcnt lgkmcnt(4)
    v_mfma_f32_16x16x32_bf16 v[100:103], a[224:227], v[40:43], 0
    v_exp_f32 v69, v69
    s_waitcnt lgkmcnt(3)
    v_mfma_f32_16x16x32_bf16 v[104:107], a[224:227], v[44:47], 0
    v_exp_f32 v70, v70
    s_waitcnt lgkmcnt(2)
    v_mfma_f32_16x16x32_bf16 v[108:111], a[224:227], v[48:51], 0
    v_exp_f32 v71, v71
    s_waitcnt lgkmcnt(1)
    v_mfma_f32_16x16x32_bf16 v[112:115], a[224:227], v[52:55], 0
    v_add_f32 v29, v29, v68
    v_add_f32 v29, v29, v69
    v_mfma_f32_16x16x32_bf16 v[116:119], a[228:231], v[36:39], 0
    v_add_f32 v29, v29, v70
    buffer_load_dwordx4 v3, s[36:39], s22 offen offset:1088 nt lds
    v_mfma_f32_16x16x32_bf16 v[120:123], a[228:231], v[40:43], 0
    v_add_f32 v29, v29, v71
    v_cvt_pk_bf16_f32 v68, v68, v69
    v_mfma_f32_16x16x32_bf16 v[124:127], a[228:231], v[44:47], 0
    v_cvt_pk_bf16_f32 v69, v70, v71
    v_fma_f32 v72, v72, s23, v35
    v_mfma_f32_16x16x32_bf16 v[128:131], a[228:231], v[48:51], 0
    ds_write_b64 v14, v[68:69] offset:11776
    v_mfma_f32_16x16x32_bf16 v[132:135], a[228:231], v[52:55], 0
    v_fma_f32 v73, v73, s23, v35
    v_fma_f32 v74, v74, s23, v35
    v_mfma_f32_16x16x32_bf16 v[136:139], a[232:235], v[36:39], 0
    v_fma_f32 v75, v75, s23, v35
    v_mfma_f32_16x16x32_bf16 v[140:143], a[232:235], v[40:43], 0
    v_exp_f32 v72, v72
    v_mfma_f32_16x16x32_bf16 v[144:147], a[232:235], v[44:47], 0
    v_exp_f32 v73, v73
    v_mfma_f32_16x16x32_bf16 v[148:151], a[232:235], v[48:51], 0
    v_exp_f32 v74, v74
    v_mfma_f32_16x16x32_bf16 v[152:155], a[232:235], v[52:55], 0
    v_exp_f32 v75, v75
    v_mfma_f32_16x16x32_bf16 v[156:159], a[236:239], v[36:39], 0
    buffer_load_dwordx4 v4, s[36:39], s22 offen offset:2176 nt lds
    v_add_f32 v30, v30, v72
    v_mfma_f32_16x16x32_bf16 v[160:163], a[236:239], v[40:43], 0
    v_add_f32 v30, v30, v73
    v_add_f32 v30, v30, v74
    v_mfma_f32_16x16x32_bf16 v[164:167], a[236:239], v[44:47], 0
    v_add_f32 v30, v30, v75
    v_cvt_pk_bf16_f32 v72, v72, v73
    v_mfma_f32_16x16x32_bf16 v[168:171], a[236:239], v[48:51], 0
    v_cvt_pk_bf16_f32 v73, v74, v75
    v_fma_f32 v76, v76, s23, v31
    v_mfma_f32_16x16x32_bf16 v[172:175], a[236:239], v[52:55], 0
    ds_write_b64 v14, v[72:73] offset:12288
    v_mfma_f32_16x16x32_bf16 v[176:179], a[240:243], v[36:39], 0
    v_fma_f32 v77, v77, s23, v31
    v_fma_f32 v78, v78, s23, v31
    v_mfma_f32_16x16x32_bf16 v[180:183], a[240:243], v[40:43], 0
    v_fma_f32 v79, v79, s23, v31
    v_mfma_f32_16x16x32_bf16 v[184:187], a[240:243], v[44:47], 0
    v_exp_f32 v76, v76
    v_mfma_f32_16x16x32_bf16 v[188:191], a[240:243], v[48:51], 0
    v_exp_f32 v77, v77
    v_mfma_f32_16x16x32_bf16 v[192:195], a[240:243], v[52:55], 0
    v_exp_f32 v78, v78
    v_mfma_f32_16x16x32_bf16 v[196:199], a[244:247], v[36:39], 0
    v_exp_f32 v79, v79
    v_mfma_f32_16x16x32_bf16 v[200:203], a[244:247], v[40:43], 0
    buffer_load_dwordx4 v5, s[36:39], s22 offen offset:3264 nt lds
    v_add_f32 v26, v26, v76
    v_mfma_f32_16x16x32_bf16 v[204:207], a[244:247], v[44:47], 0
    v_add_f32 v26, v26, v77
    v_add_f32 v26, v26, v78
    v_mfma_f32_16x16x32_bf16 v[208:211], a[244:247], v[48:51], 0
    v_add_f32 v26, v26, v79
    v_cvt_pk_bf16_f32 v76, v76, v77
    v_mfma_f32_16x16x32_bf16 v[212:215], a[244:247], v[52:55], 0
    s_waitcnt vmcnt(16) lgkmcnt(0)
    s_barrier
    v_mfma_f32_16x16x32_bf16 v[216:219], a[248:251], v[36:39], 0
    v_add_u32 v24, 0xffff3400, v24
    ds_read_b128 a[224:227], v24
    v_mfma_f32_16x16x32_bf16 v[220:223], a[248:251], v[40:43], 0
    v_add_u32 v25, 0xffff3400, v25
    ds_read_b128 a[228:231], v25
    v_mfma_f32_16x16x32_bf16 v[224:227], a[248:251], v[44:47], 0
    v_cvt_pk_bf16_f32 v77, v78, v79
    ds_read_b128 a[232:235], v24 offset:128
    v_mfma_f32_16x16x32_bf16 v[228:231], a[248:251], v[48:51], 0
    ds_read_b64 v[58:59], v19 offset:10240
    ds_read_b64 v[62:63], v19 offset:10752
    v_mfma_f32_16x16x32_bf16 v[232:235], a[248:251], v[52:55], 0
    ds_write_b64 v14, v[76:77]
    v_mfma_f32_16x16x32_bf16 v[236:239], a[252:255], v[36:39], 0
    v_fma_f32 v80, v80, s23, v32
    ds_read_b64 v[66:67], v19 offset:11264
    v_mfma_f32_16x16x32_bf16 v[240:243], a[252:255], v[40:43], 0
    v_fma_f32 v81, v81, s23, v32
    ds_read_b128 a[236:239], v25 offset:128
    v_mfma_f32_16x16x32_bf16 v[244:247], a[252:255], v[44:47], 0
    s_add_u32 m0, s21, 121856
    s_mov_b32 s22, 114688
    buffer_load_dwordx4 v2, s[32:35], s22 offen nt lds
    v_mfma_f32_16x16x32_bf16 v[248:251], a[252:255], v[48:51], 0
    ds_read_b64 v[70:71], v19 offset:11776
    v_fma_f32 v82, v82, s23, v32
    v_mfma_f32_16x16x32_bf16 v[252:255], a[252:255], v[52:55], 0
    ds_read_b64 v[74:75], v19 offset:12288
    v_fma_f32 v83, v83, s23, v32
    v_mfma_f32_16x16x32_bf16 v[36:39], a[216:219], a[0:3], 0
    v_exp_f32 v80, v80
    v_mfma_f32_16x16x32_bf16 v[40:43], a[216:219], a[4:7], 0
    ds_read_b128 a[240:243], v24 offset:256
    ds_read_b128 a[244:247], v25 offset:256
    v_mfma_f32_16x16x32_bf16 v[44:47], a[216:219], a[8:11], 0
    v_exp_f32 v81, v81
    v_mfma_f32_16x16x32_bf16 v[48:51], a[216:219], a[12:15], 0
    v_exp_f32 v82, v82
    v_mfma_f32_16x16x32_bf16 v[52:55], a[216:219], a[16:19], 0
    v_exp_f32 v83, v83
    v_mfma_f32_16x16x32_bf16 v[36:39], a[220:223], a[20:23], v[36:39]
    v_add_f32 v27, v27, v80
    v_add_f32 v27, v27, v81
    v_mfma_f32_16x16x32_bf16 v[40:43], a[220:223], a[24:27], v[40:43]
    v_add_f32 v27, v27, v82
    ds_read_b128 a[248:251], v24 offset:384
    v_mfma_f32_16x16x32_bf16 v[44:47], a[220:223], a[28:31], v[44:47]
    v_add_f32 v27, v27, v83
    v_cvt_pk_bf16_f32 v80, v80, v81
    v_mfma_f32_16x16x32_bf16 v[48:51], a[220:223], a[32:35], v[48:51]
    buffer_load_dwordx4 v3, s[32:35], s22 offen offset:1088 nt lds
    v_cvt_pk_bf16_f32 v81, v82, v83
    v_mfma_f32_16x16x32_bf16 v[52:55], a[220:223], a[36:39], v[52:55]
    ds_read_b128 a[252:255], v25 offset:384
    v_fma_f32 v84, v84, s23, v33
    v_mfma_f32_16x16x32_bf16 v[36:39], a[200:203], a[40:43], v[36:39]
    ds_write_b64 v14, v[80:81] offset:512
    v_mfma_f32_16x16x32_bf16 v[40:43], a[200:203], a[44:47], v[40:43]
    ds_read_b64_tr_b16 a[216:217], v10 offset:52224
    v_fma_f32 v85, v85, s23, v33
    v_mfma_f32_16x16x32_bf16 v[44:47], a[200:203], a[48:51], v[44:47]
    v_fma_f32 v86, v86, s23, v33
    v_fma_f32 v87, v87, s23, v33
    v_mfma_f32_16x16x32_bf16 v[48:51], a[200:203], a[52:55], v[48:51]
    ds_read_b64_tr_b16 a[218:219], v12 offset:52224
    ds_read_b64_tr_b16 a[220:221], v11 offset:52224
    v_mfma_f32_16x16x32_bf16 v[52:55], a[200:203], a[56:59], v[52:55]
    v_exp_f32 v84, v84
    v_mfma_f32_16x16x32_bf16 v[36:39], a[204:207], a[60:63], v[36:39]
    v_exp_f32 v85, v85
    v_mfma_f32_16x16x32_bf16 v[40:43], a[204:207], a[64:67], v[40:43]
    v_exp_f32 v86, v86
    v_mfma_f32_16x16x32_bf16 v[44:47], a[204:207], a[68:71], v[44:47]
    v_exp_f32 v87, v87
    v_mfma_f32_16x16x32_bf16 v[48:51], a[204:207], a[72:75], v[48:51]
    v_add_f32 v28, v28, v84
    v_add_f32 v28, v28, v85
    v_mfma_f32_16x16x32_bf16 v[52:55], a[204:207], a[76:79], v[52:55]
    buffer_load_dwordx4 v4, s[32:35], s22 offen offset:2176 nt lds
    ds_read_b64_tr_b16 a[222:223], v13 offset:52224
    v_mfma_f32_16x16x32_bf16 v[36:39], a[208:211], a[80:83], v[36:39]
    v_add_f32 v28, v28, v86
    v_add_f32 v28, v28, v87
    v_mfma_f32_16x16x32_bf16 v[40:43], a[208:211], a[84:87], v[40:43]
    ds_read_b64_tr_b16 a[200:201], v10 offset:52352
    v_cvt_pk_bf16_f32 v84, v84, v85
    v_mfma_f32_16x16x32_bf16 v[44:47], a[208:211], a[88:91], v[44:47]
    v_cvt_pk_bf16_f32 v85, v86, v87
    ds_read_b64_tr_b16 a[202:203], v12 offset:52352
    v_mfma_f32_16x16x32_bf16 v[48:51], a[208:211], a[92:95], v[48:51]
    ds_write_b64 v14, v[84:85] offset:1024
    v_mfma_f32_16x16x32_bf16 v[52:55], a[208:211], a[96:99], v[52:55]
    v_fma_f32 v88, v88, s23, v34
    v_fma_f32 v89, v89, s23, v34
    v_mfma_f32_16x16x32_bf16 v[36:39], a[212:215], a[100:103], v[36:39]
    ds_read_b64_tr_b16 a[204:205], v11 offset:52352
    v_fma_f32 v90, v90, s23, v34
    v_mfma_f32_16x16x32_bf16 v[40:43], a[212:215], a[104:107], v[40:43]
    v_fma_f32 v91, v91, s23, v34
    ds_read_b64_tr_b16 a[206:207], v13 offset:52352
    v_mfma_f32_16x16x32_bf16 v[44:47], a[212:215], a[108:111], v[44:47]
    v_exp_f32 v88, v88
    v_mfma_f32_16x16x32_bf16 v[48:51], a[212:215], a[112:115], v[48:51]
    v_exp_f32 v89, v89
    v_mfma_f32_16x16x32_bf16 v[52:55], a[212:215], a[116:119], v[52:55]
    v_exp_f32 v90, v90
    v_mfma_f32_16x16x32_bf16 v[36:39], a[160:163], a[120:123], v[36:39]
    buffer_load_dwordx4 v5, s[32:35], s22 offen offset:3264 nt lds
    ds_read_b64_tr_b16 a[208:209], v10 offset:52480
    v_mfma_f32_16x16x32_bf16 v[40:43], a[160:163], a[124:127], v[40:43]
    v_exp_f32 v91, v91
    v_mfma_f32_16x16x32_bf16 v[44:47], a[160:163], a[128:131], v[44:47]
    v_add_f32 v29, v29, v88
    v_add_f32 v29, v29, v89
    v_mfma_f32_16x16x32_bf16 v[48:51], a[160:163], a[132:135], v[48:51]
    v_add_f32 v29, v29, v90
    ds_read_b64_tr_b16 a[210:211], v12 offset:52480
    v_mfma_f32_16x16x32_bf16 v[52:55], a[160:163], a[136:139], v[52:55]
    v_add_f32 v29, v29, v91
    v_cvt_pk_bf16_f32 v88, v88, v89
    v_mfma_f32_16x16x32_bf16 v[36:39], a[164:167], a[140:143], v[36:39]
    v_cvt_pk_bf16_f32 v89, v90, v91
    ds_read_b64_tr_b16 a[212:213], v11 offset:52480
    v_mfma_f32_16x16x32_bf16 v[40:43], a[164:167], a[144:147], v[40:43]
    ds_write_b64 v14, v[88:89] offset:1536
    v_mfma_f32_16x16x32_bf16 v[44:47], a[164:167], a[148:151], v[44:47]
    v_fma_f32 v92, v92, s23, v35
    ds_read_b64_tr_b16 a[214:215], v13 offset:52480
    v_mfma_f32_16x16x32_bf16 v[48:51], a[164:167], a[152:155], v[48:51]
    v_fma_f32 v93, v93, s23, v35
    v_fma_f32 v94, v94, s23, v35
    v_mfma_f32_16x16x32_bf16 v[52:55], a[164:167], a[156:159], v[52:55]
    v_fma_f32 v95, v95, s23, v35
    s_waitcnt lgkmcnt(15)
    v_mfma_f32_16x16x32_bf16 v[96:99], a[168:171], v[56:59], v[96:99]
    ds_read_b64_tr_b16 a[160:161], v10 offset:52608
    ds_read_b64_tr_b16 a[162:163], v12 offset:52608
    v_mfma_f32_16x16x32_bf16 v[100:103], a[168:171], v[60:63], v[100:103]
    s_add_u32 m0, s21, 0
    s_mov_b32 s22, 81920
    buffer_load_dwordx4 v2, s[36:39], s22 offen nt lds
    v_mfma_f32_16x16x32_bf16 v[104:107], a[168:171], v[64:67], v[104:107]
    v_exp_f32 v92, v92
    v_mfma_f32_16x16x32_bf16 v[108:111], a[168:171], v[68:71], v[108:111]
    v_exp_f32 v93, v93
    v_mfma_f32_16x16x32_bf16 v[112:115], a[168:171], v[72:75], v[112:115]
    v_exp_f32 v94, v94
    v_mfma_f32_16x16x32_bf16 v[116:119], a[172:175], v[56:59], v[116:119]
    v_exp_f32 v95, v95
    v_mfma_f32_16x16x32_bf16 v[120:123], a[172:175], v[60:63], v[120:123]
    v_add_f32 v30, v30, v92
    v_add_f32 v30, v30, v93
    v_mfma_f32_16x16x32_bf16 v[124:127], a[172:175], v[64:67], v[124:127]
    ds_read_b64_tr_b16 a[164:165], v11 offset:52608
    v_add_f32 v30, v30, v94
    v_mfma_f32_16x16x32_bf16 v[128:131], a[172:175], v[68:71], v[128:131]
    v_add_f32 v30, v30, v95
    v_cvt_pk_bf16_f32 v92, v92, v93
    v_mfma_f32_16x16x32_bf16 v[132:135], a[172:175], v[72:75], v[132:135]
    ds_read_b64_tr_b16 a[166:167], v13 offset:52608
    v_cvt_pk_bf16_f32 v93, v94, v95
    v_mfma_f32_16x16x32_bf16 v[136:139], a[176:179], v[56:59], v[136:139]
    ds_write_b64 v14, v[92:93] offset:2048
    v_mfma_f32_16x16x32_bf16 v[140:143], a[176:179], v[60:63], v[140:143]
    v_fma_f32 v36, v36, s23, v31
    v_fma_f32 v37, v37, s23, v31
    v_mfma_f32_16x16x32_bf16 v[144:147], a[176:179], v[64:67], v[144:147]
    buffer_load_dwordx4 v3, s[36:39], s22 offen offset:1088 nt lds
    v_fma_f32 v38, v38, s23, v31
    v_mfma_f32_16x16x32_bf16 v[148:151], a[176:179], v[68:71], v[148:151]
    v_fma_f32 v39, v39, s23, v31
    v_mfma_f32_16x16x32_bf16 v[152:155], a[176:179], v[72:75], v[152:155]
    v_exp_f32 v36, v36
    v_mfma_f32_16x16x32_bf16 v[156:159], a[180:183], v[56:59], v[156:159]
    v_exp_f32 v37, v37
    v_mfma_f32_16x16x32_bf16 v[160:163], a[180:183], v[60:63], v[160:163]
    v_exp_f32 v38, v38
    v_mfma_f32_16x16x32_bf16 v[164:167], a[180:183], v[64:67], v[164:167]
    v_exp_f32 v39, v39
    v_mfma_f32_16x16x32_bf16 v[168:171], a[180:183], v[68:71], v[168:171]
    v_add_f32 v26, v26, v36
    v_add_f32 v26, v26, v37
    v_mfma_f32_16x16x32_bf16 v[172:175], a[180:183], v[72:75], v[172:175]
    v_add_f32 v26, v26, v38
    v_add_f32 v26, v26, v39
    v_mfma_f32_16x16x32_bf16 v[176:179], a[184:187], v[56:59], v[176:179]
    v_cvt_pk_bf16_f32 v36, v36, v37
    v_cvt_pk_bf16_f32 v37, v38, v39
    v_mfma_f32_16x16x32_bf16 v[180:183], a[184:187], v[60:63], v[180:183]
    v_fma_f32 v40, v40, s23, v32
    v_fma_f32 v41, v41, s23, v32
    v_mfma_f32_16x16x32_bf16 v[184:187], a[184:187], v[64:67], v[184:187]
    v_fma_f32 v42, v42, s23, v32
    v_fma_f32 v43, v43, s23, v32
    v_mfma_f32_16x16x32_bf16 v[188:191], a[184:187], v[68:71], v[188:191]
    buffer_load_dwordx4 v4, s[36:39], s22 offen offset:2176 nt lds
    v_mfma_f32_16x16x32_bf16 v[192:195], a[184:187], v[72:75], v[192:195]
    v_exp_f32 v40, v40
    v_mfma_f32_16x16x32_bf16 v[196:199], a[188:191], v[56:59], v[196:199]
    v_exp_f32 v41, v41
    v_mfma_f32_16x16x32_bf16 v[200:203], a[188:191], v[60:63], v[200:203]
    v_exp_f32 v42, v42
    v_mfma_f32_16x16x32_bf16 v[204:207], a[188:191], v[64:67], v[204:207]
    v_exp_f32 v43, v43
    v_mfma_f32_16x16x32_bf16 v[208:211], a[188:191], v[68:71], v[208:211]
    v_add_f32 v27, v27, v40
    v_add_f32 v27, v27, v41
    v_mfma_f32_16x16x32_bf16 v[212:215], a[188:191], v[72:75], v[212:215]
    s_waitcnt vmcnt(15) lgkmcnt(0)
    s_barrier
    v_mfma_f32_16x16x32_bf16 v[216:219], a[192:195], v[56:59], v[216:219]
    v_add_u32 v24, 0x15400, v24
    ds_read_b128 a[168:171], v24
    v_mfma_f32_16x16x32_bf16 v[220:223], a[192:195], v[60:63], v[220:223]
    v_add_u32 v25, 0x15400, v25
    ds_read_b128 a[172:175], v25
    v_mfma_f32_16x16x32_bf16 v[224:227], a[192:195], v[64:67], v[224:227]
    ds_read_b128 a[176:179], v24 offset:128
    ds_read_b64 v[78:79], v19
    v_mfma_f32_16x16x32_bf16 v[228:231], a[192:195], v[68:71], v[228:231]
    ds_write_b64 v14, v[36:37] offset:10240
    v_mfma_f32_16x16x32_bf16 v[232:235], a[192:195], v[72:75], v[232:235]
    buffer_load_dwordx4 v5, s[36:39], s22 offen offset:3264 nt lds
    ds_read_b64 v[82:83], v19 offset:512
    v_mfma_f32_16x16x32_bf16 v[236:239], a[196:199], v[56:59], v[236:239]
    ds_read_b64 v[86:87], v19 offset:1024
    ds_read_b128 a[180:183], v25 offset:128
    v_mfma_f32_16x16x32_bf16 v[240:243], a[196:199], v[60:63], v[240:243]
    ds_read_b64 v[90:91], v19 offset:1536
    ds_read_b64 v[94:95], v19 offset:2048
    v_mfma_f32_16x16x32_bf16 v[244:247], a[196:199], v[64:67], v[244:247]
    ds_read_b128 a[184:187], v24 offset:256
    ds_read_b128 a[188:191], v25 offset:256
    v_mfma_f32_16x16x32_bf16 v[248:251], a[196:199], v[68:71], v[248:251]
    v_add_f32 v27, v27, v42
    ds_read_b128 a[192:195], v24 offset:384
    v_mfma_f32_16x16x32_bf16 v[252:255], a[196:199], v[72:75], v[252:255]
    v_add_f32 v27, v27, v43
    v_cvt_pk_bf16_f32 v40, v40, v41
    v_mfma_f32_16x16x32_bf16 v[56:59], a[224:227], a[0:3], 0
    v_cvt_pk_bf16_f32 v41, v42, v43
    ds_read_b128 a[196:199], v25 offset:384
    v_mfma_f32_16x16x32_bf16 v[60:63], a[224:227], a[4:7], 0
    ds_write_b64 v14, v[40:41] offset:10752
    v_mfma_f32_16x16x32_bf16 v[64:67], a[224:227], a[8:11], 0
    v_fma_f32 v44, v44, s23, v33
    v_fma_f32 v45, v45, s23, v33
    v_mfma_f32_16x16x32_bf16 v[68:71], a[224:227], a[12:15], 0
    v_fma_f32 v46, v46, s23, v33
    v_fma_f32 v47, v47, s23, v33
    v_mfma_f32_16x16x32_bf16 v[72:75], a[224:227], a[16:19], 0
    ds_read_b64_tr_b16 a[224:225], v10 offset:34816
    ds_read_b64_tr_b16 a[226:227], v12 offset:34816
    v_mfma_f32_16x16x32_bf16 v[56:59], a[228:231], a[20:23], v[56:59]
    s_add_u32 m0, s21, 17408
    s_mov_b32 s22, 131072
    buffer_load_dwordx4 v2, s[32:35], s22 offen nt lds
    v_mfma_f32_16x16x32_bf16 v[60:63], a[228:231], a[24:27], v[60:63]
    v_exp_f32 v44, v44
    v_mfma_f32_16x16x32_bf16 v[64:67], a[228:231], a[28:31], v[64:67]
    v_exp_f32 v45, v45
    v_mfma_f32_16x16x32_bf16 v[68:71], a[228:231], a[32:35], v[68:71]
    v_exp_f32 v46, v46
    v_mfma_f32_16x16x32_bf16 v[72:75], a[228:231], a[36:39], v[72:75]
    ds_read_b64_tr_b16 a[228:229], v11 offset:34816
    ds_read_b64_tr_b16 a[230:231], v13 offset:34816
    v_mfma_f32_16x16x32_bf16 v[56:59], a[232:235], a[40:43], v[56:59]
    v_exp_f32 v47, v47
    v_mfma_f32_16x16x32_bf16 v[60:63], a[232:235], a[44:47], v[60:63]
    v_add_f32 v28, v28, v44
    v_add_f32 v28, v28, v45
    v_mfma_f32_16x16x32_bf16 v[64:67], a[232:235], a[48:51], v[64:67]
    v_add_f32 v28, v28, v46
    v_add_f32 v28, v28, v47
    v_mfma_f32_16x16x32_bf16 v[68:71], a[232:235], a[52:55], v[68:71]
    v_cvt_pk_bf16_f32 v44, v44, v45
    v_cvt_pk_bf16_f32 v45, v46, v47
    v_mfma_f32_16x16x32_bf16 v[72:75], a[232:235], a[56:59], v[72:75]
    ds_read_b64_tr_b16 a[232:233], v10 offset:34944
    ds_read_b64_tr_b16 a[234:235], v12 offset:34944
    v_mfma_f32_16x16x32_bf16 v[56:59], a[236:239], a[60:63], v[56:59]
    ds_write_b64 v14, v[44:45] offset:11264
    v_mfma_f32_16x16x32_bf16 v[60:63], a[236:239], a[64:67], v[60:63]
    buffer_load_dwordx4 v3, s[32:35], s22 offen offset:1088 nt lds
    v_fma_f32 v48, v48, s23, v34
    v_mfma_f32_16x16x32_bf16 v[64:67], a[236:239], a[68:71], v[64:67]
    v_fma_f32 v49, v49, s23, v34
    v_fma_f32 v50, v50, s23, v34
    v_mfma_f32_16x16x32_bf16 v[68:71], a[236:239], a[72:75], v[68:71]
    v_fma_f32 v51, v51, s23, v34
    v_mfma_f32_16x16x32_bf16 v[72:75], a[236:239], a[76:79], v[72:75]
    ds_read_b64_tr_b16 a[236:237], v11 offset:34944
    ds_read_b64_tr_b16 a[238:239], v13 offset:34944
    v_mfma_f32_16x16x32_bf16 v[56:59], a[240:243], a[80:83], v[56:59]
    v_exp_f32 v48, v48
    v_mfma_f32_16x16x32_bf16 v[60:63], a[240:243], a[84:87], v[60:63]
    v_exp_f32 v49, v49
    v_mfma_f32_16x16x32_bf16 v[64:67], a[240:243], a[88:91], v[64:67]
    v_exp_f32 v50, v50
    v_mfma_f32_16x16x32_bf16 v[68:71], a[240:243], a[92:95], v[68:71]
    v_exp_f32 v51, v51
    v_mfma_f32_16x16x32_bf16 v[72:75], a[240:243], a[96:99], v[72:75]
    ds_read_b64_tr_b16 a[240:241], v10 offset:35072
    v_add_f32 v29, v29, v48
    v_mfma_f32_16x16x32_bf16 v[56:59], a[244:247], a[100:103], v[56:59]
    v_add_f32 v29, v29, v49
    v_add_f32 v29, v29, v50
    v_mfma_f32_16x16x32_bf16 v[60:63], a[244:247], a[104:107], v[60:63]
    ds_read_b64_tr_b16 a[242:243], v12 offset:35072
    v_add_f32 v29, v29, v51
    v_mfma_f32_16x16x32_bf16 v[64:67], a[244:247], a[108:111], v[64:67]
    buffer_load_dwordx4 v4, s[32:35], s22 offen offset:2176 nt lds
    v_cvt_pk_bf16_f32 v48, v48, v49
    v_mfma_f32_16x16x32_bf16 v[68:71], a[244:247], a[112:115], v[68:71]
    v_cvt_pk_bf16_f32 v49, v50, v51
    v_fma_f32 v52, v52, s23, v35
    v_mfma_f32_16x16x32_bf16 v[72:75], a[244:247], a[116:119], v[72:75]
    ds_read_b64_tr_b16 a[244:245], v11 offset:35072
    ds_read_b64_tr_b16 a[246:247], v13 offset:35072
    v_mfma_f32_16x16x32_bf16 v[56:59], a[248:251], a[120:123], v[56:59]
    ds_write_b64 v14, v[48:49] offset:11776
    v_mfma_f32_16x16x32_bf16 v[60:63], a[248:251], a[124:127], v[60:63]
    v_fma_f32 v53, v53, s23, v35
    v_fma_f32 v54, v54, s23, v35
    v_mfma_f32_16x16x32_bf16 v[64:67], a[248:251], a[128:131], v[64:67]
    v_fma_f32 v55, v55, s23, v35
    v_mfma_f32_16x16x32_bf16 v[68:71], a[248:251], a[132:135], v[68:71]
    v_exp_f32 v52, v52
    v_mfma_f32_16x16x32_bf16 v[72:75], a[248:251], a[136:139], v[72:75]
    ds_read_b64_tr_b16 a[248:249], v10 offset:35200
    ds_read_b64_tr_b16 a[250:251], v12 offset:35200
    v_mfma_f32_16x16x32_bf16 v[56:59], a[252:255], a[140:143], v[56:59]
    v_exp_f32 v53, v53
    v_mfma_f32_16x16x32_bf16 v[60:63], a[252:255], a[144:147], v[60:63]
    v_exp_f32 v54, v54
    v_mfma_f32_16x16x32_bf16 v[64:67], a[252:255], a[148:151], v[64:67]
    v_exp_f32 v55, v55
    v_mfma_f32_16x16x32_bf16 v[68:71], a[252:255], a[152:155], v[68:71]
    buffer_load_dwordx4 v5, s[32:35], s22 offen offset:3264 nt lds
    v_add_f32 v30, v30, v52
    v_mfma_f32_16x16x32_bf16 v[72:75], a[252:255], a[156:159], v[72:75]
    v_add_f32 v30, v30, v53
    s_waitcnt lgkmcnt(15)
    v_mfma_f32_16x16x32_bf16 v[96:99], a[216:219], v[76:79], v[96:99]
    ds_read_b64_tr_b16 a[252:253], v11 offset:35200
    v_add_f32 v30, v30, v54
    v_mfma_f32_16x16x32_bf16 v[100:103], a[216:219], v[80:83], v[100:103]
    v_add_f32 v30, v30, v55
    v_cvt_pk_bf16_f32 v52, v52, v53
    v_mfma_f32_16x16x32_bf16 v[104:107], a[216:219], v[84:87], v[104:107]
    ds_read_b64_tr_b16 a[254:255], v13 offset:35200
    v_cvt_pk_bf16_f32 v53, v54, v55
    v_mfma_f32_16x16x32_bf16 v[108:111], a[216:219], v[88:91], v[108:111]
    ds_write_b64 v14, v[52:53] offset:12288
    v_mfma_f32_16x16x32_bf16 v[112:115], a[216:219], v[92:95], v[112:115]
    v_fma_f32 v56, v56, s23, v31
    v_fma_f32 v57, v57, s23, v31
    v_mfma_f32_16x16x32_bf16 v[116:119], a[220:223], v[76:79], v[116:119]
    v_fma_f32 v58, v58, s23, v31
    v_fma_f32 v59, v59, s23, v31
    v_mfma_f32_16x16x32_bf16 v[120:123], a[220:223], v[80:83], v[120:123]
    v_exp_f32 v56, v56
    v_mfma_f32_16x16x32_bf16 v[124:127], a[220:223], v[84:87], v[124:127]
    v_exp_f32 v57, v57
    v_mfma_f32_16x16x32_bf16 v[128:131], a[220:223], v[88:91], v[128:131]
    v_exp_f32 v58, v58
    v_mfma_f32_16x16x32_bf16 v[132:135], a[220:223], v[92:95], v[132:135]
    s_add_u32 m0, s21, 52224
    s_mov_b32 s22, 98304
    buffer_load_dwordx4 v2, s[36:39], s22 offen nt lds
    v_mfma_f32_16x16x32_bf16 v[136:139], a[200:203], v[76:79], v[136:139]
    v_exp_f32 v59, v59
    v_mfma_f32_16x16x32_bf16 v[140:143], a[200:203], v[80:83], v[140:143]
    v_add_f32 v26, v26, v56
    v_add_f32 v26, v26, v57
    v_mfma_f32_16x16x32_bf16 v[144:147], a[200:203], v[84:87], v[144:147]
    v_add_f32 v26, v26, v58
    v_add_f32 v26, v26, v59
    v_mfma_f32_16x16x32_bf16 v[148:151], a[200:203], v[88:91], v[148:151]
    v_cvt_pk_bf16_f32 v56, v56, v57
    v_cvt_pk_bf16_f32 v57, v58, v59
    v_mfma_f32_16x16x32_bf16 v[152:155], a[200:203], v[92:95], v[152:155]
    v_fma_f32 v60, v60, s23, v32
    v_fma_f32 v61, v61, s23, v32
    v_mfma_f32_16x16x32_bf16 v[156:159], a[204:207], v[76:79], v[156:159]
    v_fma_f32 v62, v62, s23, v32
    v_fma_f32 v63, v63, s23, v32
    v_mfma_f32_16x16x32_bf16 v[160:163], a[204:207], v[80:83], v[160:163]
    v_exp_f32 v60, v60
    v_mfma_f32_16x16x32_bf16 v[164:167], a[204:207], v[84:87], v[164:167]
    v_exp_f32 v61, v61
    v_mfma_f32_16x16x32_bf16 v[168:171], a[204:207], v[88:91], v[168:171]
    v_exp_f32 v62, v62
    v_mfma_f32_16x16x32_bf16 v[172:175], a[204:207], v[92:95], v[172:175]
    v_exp_f32 v63, v63
    v_mfma_f32_16x16x32_bf16 v[176:179], a[208:211], v[76:79], v[176:179]
    buffer_load_dwordx4 v3, s[36:39], s22 offen offset:1088 nt lds
    v_add_f32 v27, v27, v60
    v_mfma_f32_16x16x32_bf16 v[180:183], a[208:211], v[80:83], v[180:183]
    v_add_f32 v27, v27, v61
    v_add_f32 v27, v27, v62
    v_mfma_f32_16x16x32_bf16 v[184:187], a[208:211], v[84:87], v[184:187]
    v_add_f32 v27, v27, v63
    v_cvt_pk_bf16_f32 v60, v60, v61
    v_mfma_f32_16x16x32_bf16 v[188:191], a[208:211], v[88:91], v[188:191]
    v_cvt_pk_bf16_f32 v61, v62, v63
    v_fma_f32 v64, v64, s23, v33
    v_mfma_f32_16x16x32_bf16 v[192:195], a[208:211], v[92:95], v[192:195]
    v_fma_f32 v65, v65, s23, v33
    v_fma_f32 v66, v66, s23, v33
    v_mfma_f32_16x16x32_bf16 v[196:199], a[212:215], v[76:79], v[196:199]
    v_fma_f32 v67, v67, s23, v33
    v_mfma_f32_16x16x32_bf16 v[200:203], a[212:215], v[80:83], v[200:203]
    v_exp_f32 v64, v64
    v_mfma_f32_16x16x32_bf16 v[204:207], a[212:215], v[84:87], v[204:207]
    v_exp_f32 v65, v65
    v_mfma_f32_16x16x32_bf16 v[208:211], a[212:215], v[88:91], v[208:211]
    v_exp_f32 v66, v66
    v_mfma_f32_16x16x32_bf16 v[212:215], a[212:215], v[92:95], v[212:215]
    s_waitcnt vmcnt(14) lgkmcnt(0)
    s_barrier
    v_mfma_f32_16x16x32_bf16 v[216:219], a[160:163], v[76:79], v[216:219]
    v_add_u32 v24, 0xffff7800, v24
    ds_read_b128 a[216:219], v24
    v_mfma_f32_16x16x32_bf16 v[220:223], a[160:163], v[80:83], v[220:223]
    buffer_load_dwordx4 v4, s[36:39], s22 offen offset:2176 nt lds
    v_add_u32 v25, 0xffff7800, v25
    ds_read_b128 a[220:223], v25
    v_mfma_f32_16x16x32_bf16 v[224:227], a[160:163], v[84:87], v[224:227]
    ds_read_b128 a[200:203], v24 offset:128
    ds_read_b64 v[38:39], v19 offset:10240
    v_mfma_f32_16x16x32_bf16 v[228:231], a[160:163], v[88:91], v[228:231]
    ds_write_b64 v14, v[56:57]
    v_mfma_f32_16x16x32_bf16 v[232:235], a[160:163], v[92:95], v[232:235]
    ds_read_b64 v[42:43], v19 offset:10752
    ds_read_b64 v[46:47], v19 offset:11264
    v_mfma_f32_16x16x32_bf16 v[236:239], a[164:167], v[76:79], v[236:239]
    ds_read_b128 a[204:207], v25 offset:128
    ds_read_b64 v[50:51], v19 offset:11776
    v_mfma_f32_16x16x32_bf16 v[240:243], a[164:167], v[80:83], v[240:243]
    ds_read_b64 v[54:55], v19 offset:12288
    ds_read_b128 a[208:211], v24 offset:256
    v_mfma_f32_16x16x32_bf16 v[244:247], a[164:167], v[84:87], v[244:247]
    ds_read_b128 a[212:215], v25 offset:256
    ds_read_b128 a[160:163], v24 offset:384
    v_mfma_f32_16x16x32_bf16 v[248:251], a[164:167], v[88:91], v[248:251]
    ds_write_b64 v14, v[60:61] offset:512
    v_mfma_f32_16x16x32_bf16 v[252:255], a[164:167], v[92:95], v[252:255]
    ds_read_b128 a[164:167], v25 offset:384
    v_mfma_f32_16x16x32_bf16 v[76:79], a[168:171], a[0:3], 0
    v_exp_f32 v67, v67
    v_mfma_f32_16x16x32_bf16 v[80:83], a[168:171], a[4:7], 0
    v_add_f32 v28, v28, v64
    v_add_f32 v28, v28, v65
    v_mfma_f32_16x16x32_bf16 v[84:87], a[168:171], a[8:11], 0
    buffer_load_dwordx4 v5, s[36:39], s22 offen offset:3264 nt lds
    v_add_f32 v28, v28, v66
    v_mfma_f32_16x16x32_bf16 v[88:91], a[168:171], a[12:15], 0
    v_add_f32 v28, v28, v67
    v_cvt_pk_bf16_f32 v64, v64, v65
    v_mfma_f32_16x16x32_bf16 v[92:95], a[168:171], a[16:19], 0
    v_add_u32 v10, 0x15400, v10
    ds_read_b64_tr_b16 a[168:169], v10
    v_mfma_f32_16x16x32_bf16 v[76:79], a[172:175], a[20:23], v[76:79]
    v_add_u32 v12, 0x15400, v12
    ds_read_b64_tr_b16 a[170:171], v12
    v_mfma_f32_16x16x32_bf16 v[80:83], a[172:175], a[24:27], v[80:83]
    v_cvt_pk_bf16_f32 v65, v66, v67
    v_fma_f32 v68, v68, s23, v34
    v_mfma_f32_16x16x32_bf16 v[84:87], a[172:175], a[28:31], v[84:87]
    ds_write_b64 v14, v[64:65] offset:1024
    v_mfma_f32_16x16x32_bf16 v[88:91], a[172:175], a[32:35], v[88:91]
    v_fma_f32 v69, v69, s23, v34
    v_fma_f32 v70, v70, s23, v34
    v_mfma_f32_16x16x32_bf16 v[92:95], a[172:175], a[36:39], v[92:95]
    v_add_u32 v11, 0x15400, v11
    ds_read_b64_tr_b16 a[172:173], v11
    v_mfma_f32_16x16x32_bf16 v[76:79], a[176:179], a[40:43], v[76:79]
    v_add_u32 v13, 0x15400, v13
    ds_read_b64_tr_b16 a[174:175], v13
    v_mfma_f32_16x16x32_bf16 v[80:83], a[176:179], a[44:47], v[80:83]
    v_fma_f32 v71, v71, s23, v34
    v_mfma_f32_16x16x32_bf16 v[84:87], a[176:179], a[48:51], v[84:87]
    v_exp_f32 v68, v68
    v_mfma_f32_16x16x32_bf16 v[88:91], a[176:179], a[52:55], v[88:91]
    s_add_u32 m0, s21, 104448
    s_mov_b32 s22, 147456
    buffer_load_dwordx4 v2, s[32:35], s22 offen nt lds
    v_mfma_f32_16x16x32_bf16 v[92:95], a[176:179], a[56:59], v[92:95]
    ds_read_b64_tr_b16 a[176:177], v10 offset:128
    ds_read_b64_tr_b16 a[178:179], v12 offset:128
    v_mfma_f32_16x16x32_bf16 v[76:79], a[180:183], a[60:63], v[76:79]
    v_exp_f32 v69, v69
    v_mfma_f32_16x16x32_bf16 v[80:83], a[180:183], a[64:67], v[80:83]
    v_exp_f32 v70, v70
    v_mfma_f32_16x16x32_bf16 v[84:87], a[180:183], a[68:71], v[84:87]
    v_exp_f32 v71, v71
    v_mfma_f32_16x16x32_bf16 v[88:91], a[180:183], a[72:75], v[88:91]
    v_add_f32 v29, v29, v68
    v_add_f32 v29, v29, v69
    v_mfma_f32_16x16x32_bf16 v[92:95], a[180:183], a[76:79], v[92:95]
    ds_read_b64_tr_b16 a[180:181], v11 offset:128
    ds_read_b64_tr_b16 a[182:183], v13 offset:128
    v_mfma_f32_16x16x32_bf16 v[76:79], a[184:187], a[80:83], v[76:79]
    v_add_f32 v29, v29, v70
    v_add_f32 v29, v29, v71
    v_mfma_f32_16x16x32_bf16 v[80:83], a[184:187], a[84:87], v[80:83]
    v_cvt_pk_bf16_f32 v68, v68, v69
    v_cvt_pk_bf16_f32 v69, v70, v71
    v_mfma_f32_16x16x32_bf16 v[84:87], a[184:187], a[88:91], v[84:87]
    ds_write_b64 v14, v[68:69] offset:1536
    v_mfma_f32_16x16x32_bf16 v[88:91], a[184:187], a[92:95], v[88:91]
    v_fma_f32 v72, v72, s23, v35
    v_fma_f32 v73, v73, s23, v35
    v_mfma_f32_16x16x32_bf16 v[92:95], a[184:187], a[96:99], v[92:95]
    buffer_load_dwordx4 v3, s[32:35], s22 offen offset:1088 nt lds
    ds_read_b64_tr_b16 a[184:185], v10 offset:256
    v_mfma_f32_16x16x32_bf16 v[76:79], a[188:191], a[100:103], v[76:79]
    ds_read_b64_tr_b16 a[186:187], v12 offset:256
    v_fma_f32 v74, v74, s23, v35
    v_mfma_f32_16x16x32_bf16 v[80:83], a[188:191], a[104:107], v[80:83]
    v_fma_f32 v75, v75, s23, v35
    v_mfma_f32_16x16x32_bf16 v[84:87], a[188:191], a[108:111], v[84:87]
    v_exp_f32 v72, v72
    v_mfma_f32_16x16x32_bf16 v[88:91], a[188:191], a[112:115], v[88:91]
    v_exp_f32 v73, v73
    v_mfma_f32_16x16x32_bf16 v[92:95], a[188:191], a[116:119], v[92:95]
    ds_read_b64_tr_b16 a[188:189], v11 offset:256
    ds_read_b64_tr_b16 a[190:191], v13 offset:256
    v_mfma_f32_16x16x32_bf16 v[76:79], a[192:195], a[120:123], v[76:79]
    v_exp_f32 v74, v74
    v_mfma_f32_16x16x32_bf16 v[80:83], a[192:195], a[124:127], v[80:83]
    v_exp_f32 v75, v75
    v_mfma_f32_16x16x32_bf16 v[84:87], a[192:195], a[128:131], v[84:87]
    v_add_f32 v30, v30, v72
    v_add_f32 v30, v30, v73
    v_mfma_f32_16x16x32_bf16 v[88:91], a[192:195], a[132:135], v[88:91]
    v_add_f32 v30, v30, v74
    v_add_f32 v30, v30, v75
    v_mfma_f32_16x16x32_bf16 v[92:95], a[192:195], a[136:139], v[92:95]
    ds_read_b64_tr_b16 a[192:193], v10 offset:384
    ds_read_b64_tr_b16 a[194:195], v12 offset:384
    v_mfma_f32_16x16x32_bf16 v[76:79], a[196:199], a[140:143], v[76:79]
    buffer_load_dwordx4 v4, s[32:35], s22 offen offset:2176 nt lds
    v_cvt_pk_bf16_f32 v72, v72, v73
    v_mfma_f32_16x16x32_bf16 v[80:83], a[196:199], a[144:147], v[80:83]
    v_cvt_pk_bf16_f32 v73, v74, v75
    v_mfma_f32_16x16x32_bf16 v[84:87], a[196:199], a[148:151], v[84:87]
    ds_write_b64 v14, v[72:73] offset:2048
    v_mfma_f32_16x16x32_bf16 v[88:91], a[196:199], a[152:155], v[88:91]
    v_mfma_f32_16x16x32_bf16 v[92:95], a[196:199], a[156:159], v[92:95]
    ds_read_b64_tr_b16 a[196:197], v11 offset:384
    s_waitcnt lgkmcnt(15)
    v_mfma_f32_16x16x32_bf16 v[96:99], a[224:227], v[36:39], v[96:99]
    ds_read_b64_tr_b16 a[198:199], v13 offset:384
    v_fma_f32 v76, v76, s23, v31
    v_mfma_f32_16x16x32_bf16 v[100:103], a[224:227], v[40:43], v[100:103]
    v_fma_f32 v77, v77, s23, v31
    v_fma_f32 v78, v78, s23, v31
    v_mfma_f32_16x16x32_bf16 v[104:107], a[224:227], v[44:47], v[104:107]
    v_fma_f32 v79, v79, s23, v31
    v_mfma_f32_16x16x32_bf16 v[108:111], a[224:227], v[48:51], v[108:111]
    v_exp_f32 v76, v76
    v_mfma_f32_16x16x32_bf16 v[112:115], a[224:227], v[52:55], v[112:115]
    v_exp_f32 v77, v77
    v_mfma_f32_16x16x32_bf16 v[116:119], a[228:231], v[36:39], v[116:119]
    v_exp_f32 v78, v78
    v_mfma_f32_16x16x32_bf16 v[120:123], a[228:231], v[40:43], v[120:123]
    buffer_load_dwordx4 v5, s[32:35], s22 offen offset:3264 nt lds
    v_mfma_f32_16x16x32_bf16 v[124:127], a[228:231], v[44:47], v[124:127]
    v_exp_f32 v79, v79
    v_mfma_f32_16x16x32_bf16 v[128:131], a[228:231], v[48:51], v[128:131]
    v_add_f32 v26, v26, v76
    v_add_f32 v26, v26, v77
    v_mfma_f32_16x16x32_bf16 v[132:135], a[228:231], v[52:55], v[132:135]
    v_add_f32 v26, v26, v78
    v_add_f32 v26, v26, v79
    v_mfma_f32_16x16x32_bf16 v[136:139], a[232:235], v[36:39], v[136:139]
    v_cvt_pk_bf16_f32 v76, v76, v77
    v_cvt_pk_bf16_f32 v77, v78, v79
    v_mfma_f32_16x16x32_bf16 v[140:143], a[232:235], v[40:43], v[140:143]
    v_fma_f32 v80, v80, s23, v32
    v_fma_f32 v81, v81, s23, v32
    v_mfma_f32_16x16x32_bf16 v[144:147], a[232:235], v[44:47], v[144:147]
    v_fma_f32 v82, v82, s23, v32
    v_fma_f32 v83, v83, s23, v32
    v_mfma_f32_16x16x32_bf16 v[148:151], a[232:235], v[48:51], v[148:151]
    v_exp_f32 v80, v80
    v_mfma_f32_16x16x32_bf16 v[152:155], a[232:235], v[52:55], v[152:155]
    v_exp_f32 v81, v81
    v_mfma_f32_16x16x32_bf16 v[156:159], a[236:239], v[36:39], v[156:159]
    v_exp_f32 v82, v82
    v_mfma_f32_16x16x32_bf16 v[160:163], a[236:239], v[40:43], v[160:163]
    v_exp_f32 v83, v83
    v_mfma_f32_16x16x32_bf16 v[164:167], a[236:239], v[44:47], v[164:167]
    s_add_u32 m0, s21, 34816
    s_mov_b32 s22, 114688
    buffer_load_dwordx4 v2, s[36:39], s22 offen nt lds
    v_mfma_f32_16x16x32_bf16 v[168:171], a[236:239], v[48:51], v[168:171]
    v_add_f32 v27, v27, v80
    v_add_f32 v27, v27, v81
    v_mfma_f32_16x16x32_bf16 v[172:175], a[236:239], v[52:55], v[172:175]
    v_add_f32 v27, v27, v82
    v_add_f32 v27, v27, v83
    v_mfma_f32_16x16x32_bf16 v[176:179], a[240:243], v[36:39], v[176:179]
    v_cvt_pk_bf16_f32 v80, v80, v81
    v_cvt_pk_bf16_f32 v81, v82, v83
    v_mfma_f32_16x16x32_bf16 v[180:183], a[240:243], v[40:43], v[180:183]
    v_fma_f32 v84, v84, s23, v33
    v_fma_f32 v85, v85, s23, v33
    v_mfma_f32_16x16x32_bf16 v[184:187], a[240:243], v[44:47], v[184:187]
    v_fma_f32 v86, v86, s23, v33
    v_fma_f32 v87, v87, s23, v33
    v_mfma_f32_16x16x32_bf16 v[188:191], a[240:243], v[48:51], v[188:191]
    v_exp_f32 v84, v84
    v_mfma_f32_16x16x32_bf16 v[192:195], a[240:243], v[52:55], v[192:195]
    v_exp_f32 v85, v85
    v_mfma_f32_16x16x32_bf16 v[196:199], a[244:247], v[36:39], v[196:199]
    v_exp_f32 v86, v86
    v_mfma_f32_16x16x32_bf16 v[200:203], a[244:247], v[40:43], v[200:203]
    v_exp_f32 v87, v87
    v_mfma_f32_16x16x32_bf16 v[204:207], a[244:247], v[44:47], v[204:207]
    v_add_f32 v28, v28, v84
    v_add_f32 v28, v28, v85
    v_mfma_f32_16x16x32_bf16 v[208:211], a[244:247], v[48:51], v[208:211]
    buffer_load_dwordx4 v3, s[36:39], s22 offen offset:1088 nt lds
    v_add_f32 v28, v28, v86
    v_mfma_f32_16x16x32_bf16 v[212:215], a[244:247], v[52:55], v[212:215]
    s_waitcnt vmcnt(18) lgkmcnt(0)
    s_barrier
    v_mfma_f32_16x16x32_bf16 v[216:219], a[248:251], v[36:39], v[216:219]
    ds_read_b128 a[224:227], v24 offset:52224
    ds_read_b64 v[58:59], v19
    v_mfma_f32_16x16x32_bf16 v[220:223], a[248:251], v[40:43], v[220:223]
    ds_write_b64 v14, v[76:77] offset:10240
    v_mfma_f32_16x16x32_bf16 v[224:227], a[248:251], v[44:47], v[224:227]
    ds_read_b64 v[62:63], v19 offset:512
    ds_read_b64 v[66:67], v19 offset:1024
    v_mfma_f32_16x16x32_bf16 v[228:231], a[248:251], v[48:51], v[228:231]
    ds_read_b64 v[70:71], v19 offset:1536
    ds_read_b64 v[74:75], v19 offset:2048
    v_mfma_f32_16x16x32_bf16 v[232:235], a[248:251], v[52:55], v[232:235]
    ds_read_b128 a[228:231], v25 offset:52224
    ds_read_b128 a[232:235], v24 offset:52352
    v_mfma_f32_16x16x32_bf16 v[236:239], a[252:255], v[36:39], v[236:239]
    ds_write_b64 v14, v[80:81] offset:10752
    v_mfma_f32_16x16x32_bf16 v[240:243], a[252:255], v[40:43], v[240:243]
    ds_read_b128 a[236:239], v25 offset:52352
    v_add_f32 v28, v28, v87
    v_mfma_f32_16x16x32_bf16 v[244:247], a[252:255], v[44:47], v[244:247]
    v_cvt_pk_bf16_f32 v84, v84, v85
    v_cvt_pk_bf16_f32 v85, v86, v87
    v_mfma_f32_16x16x32_bf16 v[248:251], a[252:255], v[48:51], v[248:251]
    ds_write_b64 v14, v[84:85] offset:11264
    v_mfma_f32_16x16x32_bf16 v[252:255], a[252:255], v[52:55], v[252:255]
    buffer_load_dwordx4 v4, s[36:39], s22 offen offset:2176 nt lds
    v_fma_f32 v88, v88, s23, v34
    v_mfma_f32_16x16x32_bf16 v[36:39], a[216:219], a[0:3], 0
    v_fma_f32 v89, v89, s23, v34
    ds_read_b128 a[240:243], v24 offset:52480
    v_mfma_f32_16x16x32_bf16 v[40:43], a[216:219], a[4:7], 0
    v_fma_f32 v90, v90, s23, v34
    v_fma_f32 v91, v91, s23, v34
    v_mfma_f32_16x16x32_bf16 v[44:47], a[216:219], a[8:11], 0
    v_exp_f32 v88, v88
    v_mfma_f32_16x16x32_bf16 v[48:51], a[216:219], a[12:15], 0
    v_exp_f32 v89, v89
    v_mfma_f32_16x16x32_bf16 v[52:55], a[216:219], a[16:19], 0
    v_exp_f32 v90, v90
    v_mfma_f32_16x16x32_bf16 v[36:39], a[220:223], a[20:23], v[36:39]
    v_exp_f32 v91, v91
    v_mfma_f32_16x16x32_bf16 v[40:43], a[220:223], a[24:27], v[40:43]
    v_add_f32 v29, v29, v88
    v_add_f32 v29, v29, v89
    v_mfma_f32_16x16x32_bf16 v[44:47], a[220:223], a[28:31], v[44:47]
    v_add_f32 v29, v29, v90
    ds_read_b128 a[244:247], v25 offset:52480
    v_mfma_f32_16x16x32_bf16 v[48:51], a[220:223], a[32:35], v[48:51]
    v_add_f32 v29, v29, v91
    v_cvt_pk_bf16_f32 v88, v88, v89
    v_mfma_f32_16x16x32_bf16 v[52:55], a[220:223], a[36:39], v[52:55]
    v_cvt_pk_bf16_f32 v89, v90, v91
    v_fma_f32 v92, v92, s23, v35
    v_mfma_f32_16x16x32_bf16 v[36:39], a[200:203], a[40:43], v[36:39]
    buffer_load_dwordx4 v5, s[36:39], s22 offen offset:3264 nt lds
    v_fma_f32 v93, v93, s23, v35
    v_mfma_f32_16x16x32_bf16 v[40:43], a[200:203], a[44:47], v[40:43]
    ds_write_b64 v14, v[88:89] offset:11776
    v_mfma_f32_16x16x32_bf16 v[44:47], a[200:203], a[48:51], v[44:47]
    v_fma_f32 v94, v94, s23, v35
    v_fma_f32 v95, v95, s23, v35
    v_mfma_f32_16x16x32_bf16 v[48:51], a[200:203], a[52:55], v[48:51]
    ds_read_b128 a[248:251], v24 offset:52608
    ds_read_b128 a[252:255], v25 offset:52608
    v_mfma_f32_16x16x32_bf16 v[52:55], a[200:203], a[56:59], v[52:55]
    v_exp_f32 v92, v92
    v_mfma_f32_16x16x32_bf16 v[36:39], a[204:207], a[60:63], v[36:39]
    v_exp_f32 v93, v93
    v_mfma_f32_16x16x32_bf16 v[40:43], a[204:207], a[64:67], v[40:43]
    v_exp_f32 v94, v94
    v_mfma_f32_16x16x32_bf16 v[44:47], a[204:207], a[68:71], v[44:47]
    v_exp_f32 v95, v95
    v_mfma_f32_16x16x32_bf16 v[48:51], a[204:207], a[72:75], v[48:51]
    v_add_f32 v30, v30, v92
    v_add_f32 v30, v30, v93
    v_mfma_f32_16x16x32_bf16 v[52:55], a[204:207], a[76:79], v[52:55]
    v_add_f32 v30, v30, v94
    v_add_f32 v30, v30, v95
    v_mfma_f32_16x16x32_bf16 v[36:39], a[208:211], a[80:83], v[36:39]
    v_cvt_pk_bf16_f32 v92, v92, v93
    v_cvt_pk_bf16_f32 v93, v94, v95
    v_mfma_f32_16x16x32_bf16 v[40:43], a[208:211], a[84:87], v[40:43]
    s_add_u32 m0, s21, 69632
    s_mov_b32 s22, 163840
    buffer_load_dwordx4 v2, s[32:35], s22 offen nt lds
    v_mfma_f32_16x16x32_bf16 v[44:47], a[208:211], a[88:91], v[44:47]
    ds_write_b64 v14, v[92:93] offset:12288
    v_mfma_f32_16x16x32_bf16 v[48:51], a[208:211], a[92:95], v[48:51]
    v_mfma_f32_16x16x32_bf16 v[52:55], a[208:211], a[96:99], v[52:55]
    v_mfma_f32_16x16x32_bf16 v[36:39], a[212:215], a[100:103], v[36:39]
    v_mfma_f32_16x16x32_bf16 v[40:43], a[212:215], a[104:107], v[40:43]
    v_mfma_f32_16x16x32_bf16 v[44:47], a[212:215], a[108:111], v[44:47]
    v_mfma_f32_16x16x32_bf16 v[48:51], a[212:215], a[112:115], v[48:51]
    v_mfma_f32_16x16x32_bf16 v[52:55], a[212:215], a[116:119], v[52:55]
    v_mfma_f32_16x16x32_bf16 v[36:39], a[160:163], a[120:123], v[36:39]
    v_mfma_f32_16x16x32_bf16 v[40:43], a[160:163], a[124:127], v[40:43]
    v_mfma_f32_16x16x32_bf16 v[44:47], a[160:163], a[128:131], v[44:47]
    buffer_load_dwordx4 v3, s[32:35], s22 offen offset:1088 nt lds
    v_mfma_f32_16x16x32_bf16 v[48:51], a[160:163], a[132:135], v[48:51]
    v_mfma_f32_16x16x32_bf16 v[52:55], a[160:163], a[136:139], v[52:55]
    v_mfma_f32_16x16x32_bf16 v[36:39], a[164:167], a[140:143], v[36:39]
    v_mfma_f32_16x16x32_bf16 v[40:43], a[164:167], a[144:147], v[40:43]
    v_mfma_f32_16x16x32_bf16 v[44:47], a[164:167], a[148:151], v[44:47]
    v_mfma_f32_16x16x32_bf16 v[48:51], a[164:167], a[152:155], v[48:51]
    v_mfma_f32_16x16x32_bf16 v[52:55], a[164:167], a[156:159], v[52:55]
    s_waitcnt lgkmcnt(15)
    v_mfma_f32_16x16x32_bf16 v[96:99], a[168:171], v[56:59], v[96:99]
    s_waitcnt lgkmcnt(14)
    v_mfma_f32_16x16x32_bf16 v[100:103], a[168:171], v[60:63], v[100:103]
    v_fma_f32 v36, v36, s23, v31
    s_waitcnt lgkmcnt(13)
    v_mfma_f32_16x16x32_bf16 v[104:107], a[168:171], v[64:67], v[104:107]
    v_fma_f32 v37, v37, s23, v31
    s_waitcnt lgkmcnt(12)
    v_mfma_f32_16x16x32_bf16 v[108:111], a[168:171], v[68:71], v[108:111]
    buffer_load_dwordx4 v4, s[32:35], s22 offen offset:2176 nt lds
    s_waitcnt lgkmcnt(11)
    v_mfma_f32_16x16x32_bf16 v[112:115], a[168:171], v[72:75], v[112:115]
    v_fma_f32 v38, v38, s23, v31
    v_fma_f32 v39, v39, s23, v31
    v_mfma_f32_16x16x32_bf16 v[116:119], a[172:175], v[56:59], v[116:119]
    v_exp_f32 v36, v36
    v_mfma_f32_16x16x32_bf16 v[120:123], a[172:175], v[60:63], v[120:123]
    v_exp_f32 v37, v37
    v_mfma_f32_16x16x32_bf16 v[124:127], a[172:175], v[64:67], v[124:127]
    v_exp_f32 v38, v38
    v_mfma_f32_16x16x32_bf16 v[128:131], a[172:175], v[68:71], v[128:131]
    v_exp_f32 v39, v39
    v_mfma_f32_16x16x32_bf16 v[132:135], a[172:175], v[72:75], v[132:135]
    v_add_f32 v26, v26, v36
    v_add_f32 v26, v26, v37
    v_mfma_f32_16x16x32_bf16 v[136:139], a[176:179], v[56:59], v[136:139]
    v_add_f32 v26, v26, v38
    v_add_f32 v26, v26, v39
    v_mfma_f32_16x16x32_bf16 v[140:143], a[176:179], v[60:63], v[140:143]
    v_cvt_pk_bf16_f32 v36, v36, v37
    v_cvt_pk_bf16_f32 v37, v38, v39
    v_mfma_f32_16x16x32_bf16 v[144:147], a[176:179], v[64:67], v[144:147]
    v_fma_f32 v40, v40, s23, v32
    v_fma_f32 v41, v41, s23, v32
    v_mfma_f32_16x16x32_bf16 v[148:151], a[176:179], v[68:71], v[148:151]
    v_fma_f32 v42, v42, s23, v32
    v_fma_f32 v43, v43, s23, v32
    v_mfma_f32_16x16x32_bf16 v[152:155], a[176:179], v[72:75], v[152:155]
    buffer_load_dwordx4 v5, s[32:35], s22 offen offset:3264 nt lds
    v_mfma_f32_16x16x32_bf16 v[156:159], a[180:183], v[56:59], v[156:159]
    v_exp_f32 v40, v40
    v_mfma_f32_16x16x32_bf16 v[160:163], a[180:183], v[60:63], v[160:163]
    v_exp_f32 v41, v41
    v_mfma_f32_16x16x32_bf16 v[164:167], a[180:183], v[64:67], v[164:167]
    v_exp_f32 v42, v42
    v_mfma_f32_16x16x32_bf16 v[168:171], a[180:183], v[68:71], v[168:171]
    v_exp_f32 v43, v43
    v_mfma_f32_16x16x32_bf16 v[172:175], a[180:183], v[72:75], v[172:175]
    v_add_f32 v27, v27, v40
    v_add_f32 v27, v27, v41
    v_mfma_f32_16x16x32_bf16 v[176:179], a[184:187], v[56:59], v[176:179]
    v_add_f32 v27, v27, v42
    v_add_f32 v27, v27, v43
    v_mfma_f32_16x16x32_bf16 v[180:183], a[184:187], v[60:63], v[180:183]
    v_cvt_pk_bf16_f32 v40, v40, v41
    v_cvt_pk_bf16_f32 v41, v42, v43
    v_mfma_f32_16x16x32_bf16 v[184:187], a[184:187], v[64:67], v[184:187]
    v_fma_f32 v44, v44, s23, v33
    v_fma_f32 v45, v45, s23, v33
    v_mfma_f32_16x16x32_bf16 v[188:191], a[184:187], v[68:71], v[188:191]
    v_fma_f32 v46, v46, s23, v33
    v_fma_f32 v47, v47, s23, v33
    v_mfma_f32_16x16x32_bf16 v[192:195], a[184:187], v[72:75], v[192:195]
    v_exp_f32 v44, v44
    v_mfma_f32_16x16x32_bf16 v[196:199], a[188:191], v[56:59], v[196:199]
    s_add_u32 m0, s21, 87040
    s_mov_b32 s22, 131072
    buffer_load_dwordx4 v2, s[36:39], s22 offen nt lds
    v_mfma_f32_16x16x32_bf16 v[200:203], a[188:191], v[60:63], v[200:203]
    v_exp_f32 v45, v45
    v_mfma_f32_16x16x32_bf16 v[204:207], a[188:191], v[64:67], v[204:207]
    v_exp_f32 v46, v46
    v_mfma_f32_16x16x32_bf16 v[208:211], a[188:191], v[68:71], v[208:211]
    v_exp_f32 v47, v47
    v_mfma_f32_16x16x32_bf16 v[212:215], a[188:191], v[72:75], v[212:215]
    s_waitcnt vmcnt(17) lgkmcnt(0)
    s_barrier
    v_mfma_f32_16x16x32_bf16 v[216:219], a[192:195], v[56:59], v[216:219]
    v_add_u32 v24, 0xffff3400, v24
    ds_read_b128 a[168:171], v24
    v_mfma_f32_16x16x32_bf16 v[220:223], a[192:195], v[60:63], v[220:223]
    ds_read_b64 v[78:79], v19 offset:10240
    ds_read_b64 v[82:83], v19 offset:10752
    v_mfma_f32_16x16x32_bf16 v[224:227], a[192:195], v[64:67], v[224:227]
    ds_write_b64 v14, v[36:37]
    v_mfma_f32_16x16x32_bf16 v[228:231], a[192:195], v[68:71], v[228:231]
    ds_read_b64 v[86:87], v19 offset:11264
    ds_read_b64 v[90:91], v19 offset:11776
    v_mfma_f32_16x16x32_bf16 v[232:235], a[192:195], v[72:75], v[232:235]
    ds_read_b64 v[94:95], v19 offset:12288
    v_add_u32 v25, 0xffff3400, v25
    ds_read_b128 a[172:175], v25
    v_mfma_f32_16x16x32_bf16 v[236:239], a[196:199], v[56:59], v[236:239]
    ds_write_b64 v14, v[40:41] offset:512
    v_mfma_f32_16x16x32_bf16 v[240:243], a[196:199], v[60:63], v[240:243]
    ds_read_b128 a[176:179], v24 offset:128
    v_add_f32 v28, v28, v44
    v_mfma_f32_16x16x32_bf16 v[244:247], a[196:199], v[64:67], v[244:247]
    v_add_f32 v28, v28, v45
    ds_read_b128 a[180:183], v25 offset:128
    v_mfma_f32_16x16x32_bf16 v[248:251], a[196:199], v[68:71], v[248:251]
    buffer_load_dwordx4 v3, s[36:39], s22 offen offset:1088 nt lds
    v_add_f32 v28, v28, v46
    v_mfma_f32_16x16x32_bf16 v[252:255], a[196:199], v[72:75], v[252:255]
    v_add_f32 v28, v28, v47
    v_cvt_pk_bf16_f32 v44, v44, v45
    v_mfma_f32_16x16x32_bf16 v[56:59], a[224:227], a[0:3], 0
    v_cvt_pk_bf16_f32 v45, v46, v47
    v_fma_f32 v48, v48, s23, v34
    v_mfma_f32_16x16x32_bf16 v[60:63], a[224:227], a[4:7], 0
    ds_write_b64 v14, v[44:45] offset:1024
    v_mfma_f32_16x16x32_bf16 v[64:67], a[224:227], a[8:11], 0
    v_fma_f32 v49, v49, s23, v34
    ds_read_b128 a[184:187], v24 offset:256
    v_mfma_f32_16x16x32_bf16 v[68:71], a[224:227], a[12:15], 0
    v_fma_f32 v50, v50, s23, v34
    v_fma_f32 v51, v51, s23, v34
    v_mfma_f32_16x16x32_bf16 v[72:75], a[224:227], a[16:19], 0
    v_exp_f32 v48, v48
    v_mfma_f32_16x16x32_bf16 v[56:59], a[228:231], a[20:23], v[56:59]
    v_exp_f32 v49, v49
    v_mfma_f32_16x16x32_bf16 v[60:63], a[228:231], a[24:27], v[60:63]
    v_exp_f32 v50, v50
    v_mfma_f32_16x16x32_bf16 v[64:67], a[228:231], a[28:31], v[64:67]
    v_exp_f32 v51, v51
    v_mfma_f32_16x16x32_bf16 v[68:71], a[228:231], a[32:35], v[68:71]
    v_add_f32 v29, v29, v48
    v_add_f32 v29, v29, v49
    v_mfma_f32_16x16x32_bf16 v[72:75], a[228:231], a[36:39], v[72:75]
    v_add_f32 v29, v29, v50
    ds_read_b128 a[188:191], v25 offset:256
    v_mfma_f32_16x16x32_bf16 v[56:59], a[232:235], a[40:43], v[56:59]
    v_add_f32 v29, v29, v51
    v_cvt_pk_bf16_f32 v48, v48, v49
    v_mfma_f32_16x16x32_bf16 v[60:63], a[232:235], a[44:47], v[60:63]
    v_cvt_pk_bf16_f32 v49, v50, v51
    v_fma_f32 v52, v52, s23, v35
    v_mfma_f32_16x16x32_bf16 v[64:67], a[232:235], a[48:51], v[64:67]
    buffer_load_dwordx4 v4, s[36:39], s22 offen offset:2176 nt lds
    v_fma_f32 v53, v53, s23, v35
    v_mfma_f32_16x16x32_bf16 v[68:71], a[232:235], a[52:55], v[68:71]
    ds_write_b64 v14, v[48:49] offset:1536
    v_mfma_f32_16x16x32_bf16 v[72:75], a[232:235], a[56:59], v[72:75]
    v_fma_f32 v54, v54, s23, v35
    v_fma_f32 v55, v55, s23, v35
    v_mfma_f32_16x16x32_bf16 v[56:59], a[236:239], a[60:63], v[56:59]
    ds_read_b128 a[192:195], v24 offset:384
    ds_read_b128 a[196:199], v25 offset:384
    v_mfma_f32_16x16x32_bf16 v[60:63], a[236:239], a[64:67], v[60:63]
    v_exp_f32 v52, v52
    v_mfma_f32_16x16x32_bf16 v[64:67], a[236:239], a[68:71], v[64:67]
    v_add_u32 v10, 0xfffeac00, v10
    ds_read_b64_tr_b16 a[216:217], v10
    v_mfma_f32_16x16x32_bf16 v[68:71], a[236:239], a[72:75], v[68:71]
    v_add_u32 v12, 0xfffeac00, v12
    ds_read_b64_tr_b16 a[218:219], v12
    v_mfma_f32_16x16x32_bf16 v[72:75], a[236:239], a[76:79], v[72:75]
    v_exp_f32 v53, v53
    v_mfma_f32_16x16x32_bf16 v[56:59], a[240:243], a[80:83], v[56:59]
    v_exp_f32 v54, v54
    v_mfma_f32_16x16x32_bf16 v[60:63], a[240:243], a[84:87], v[60:63]
    v_exp_f32 v55, v55
    v_mfma_f32_16x16x32_bf16 v[64:67], a[240:243], a[88:91], v[64:67]
    v_add_u32 v11, 0xfffeac00, v11
    ds_read_b64_tr_b16 a[220:221], v11
    v_mfma_f32_16x16x32_bf16 v[68:71], a[240:243], a[92:95], v[68:71]
    v_add_u32 v13, 0xfffeac00, v13
    ds_read_b64_tr_b16 a[222:223], v13
    v_mfma_f32_16x16x32_bf16 v[72:75], a[240:243], a[96:99], v[72:75]
    v_add_f32 v30, v30, v52
    v_add_f32 v30, v30, v53
    v_mfma_f32_16x16x32_bf16 v[56:59], a[244:247], a[100:103], v[56:59]
    buffer_load_dwordx4 v5, s[36:39], s22 offen offset:3264 nt lds
    v_add_f32 v30, v30, v54
    v_mfma_f32_16x16x32_bf16 v[60:63], a[244:247], a[104:107], v[60:63]
    v_add_f32 v30, v30, v55
    v_cvt_pk_bf16_f32 v52, v52, v53
    v_mfma_f32_16x16x32_bf16 v[64:67], a[244:247], a[108:111], v[64:67]
    ds_read_b64_tr_b16 a[200:201], v10 offset:128
    ds_read_b64_tr_b16 a[202:203], v12 offset:128
    v_mfma_f32_16x16x32_bf16 v[68:71], a[244:247], a[112:115], v[68:71]
    v_cvt_pk_bf16_f32 v53, v54, v55
    v_mfma_f32_16x16x32_bf16 v[72:75], a[244:247], a[116:119], v[72:75]
    ds_write_b64 v14, v[52:53] offset:2048
    v_mfma_f32_16x16x32_bf16 v[56:59], a[248:251], a[120:123], v[56:59]
    v_mfma_f32_16x16x32_bf16 v[60:63], a[248:251], a[124:127], v[60:63]
    v_mfma_f32_16x16x32_bf16 v[64:67], a[248:251], a[128:131], v[64:67]
    ds_read_b64_tr_b16 a[204:205], v11 offset:128
    ds_read_b64_tr_b16 a[206:207], v13 offset:128
    v_mfma_f32_16x16x32_bf16 v[68:71], a[248:251], a[132:135], v[68:71]
    v_mfma_f32_16x16x32_bf16 v[72:75], a[248:251], a[136:139], v[72:75]
    v_mfma_f32_16x16x32_bf16 v[56:59], a[252:255], a[140:143], v[56:59]
    v_mfma_f32_16x16x32_bf16 v[60:63], a[252:255], a[144:147], v[60:63]
    v_mfma_f32_16x16x32_bf16 v[64:67], a[252:255], a[148:151], v[64:67]
    ds_read_b64_tr_b16 a[208:209], v10 offset:256
    ds_read_b64_tr_b16 a[210:211], v12 offset:256
    v_mfma_f32_16x16x32_bf16 v[68:71], a[252:255], a[152:155], v[68:71]
    v_mfma_f32_16x16x32_bf16 v[72:75], a[252:255], a[156:159], v[72:75]
    s_add_u32 m0, s21, 121856
    s_mov_b32 s22, 180224
    buffer_load_dwordx4 v2, s[32:35], s22 offen nt lds
    s_waitcnt lgkmcnt(9)
    v_mfma_f32_16x16x32_bf16 v[96:99], a[216:219], v[76:79], v[96:99]
    v_fma_f32 v56, v56, s23, v31
    v_fma_f32 v57, v57, s23, v31
    v_mfma_f32_16x16x32_bf16 v[100:103], a[216:219], v[80:83], v[100:103]
    v_fma_f32 v58, v58, s23, v31
    v_fma_f32 v59, v59, s23, v31
    v_mfma_f32_16x16x32_bf16 v[104:107], a[216:219], v[84:87], v[104:107]
    ds_read_b64_tr_b16 a[212:213], v11 offset:256
    ds_read_b64_tr_b16 a[214:215], v13 offset:256
    v_mfma_f32_16x16x32_bf16 v[108:111], a[216:219], v[88:91], v[108:111]
    v_exp_f32 v56, v56
    v_mfma_f32_16x16x32_bf16 v[112:115], a[216:219], v[92:95], v[112:115]
    v_exp_f32 v57, v57
    s_waitcnt lgkmcnt(9)
    v_mfma_f32_16x16x32_bf16 v[116:119], a[220:223], v[76:79], v[116:119]
    v_exp_f32 v58, v58
    v_mfma_f32_16x16x32_bf16 v[120:123], a[220:223], v[80:83], v[120:123]
    v_exp_f32 v59, v59
    v_mfma_f32_16x16x32_bf16 v[124:127], a[220:223], v[84:87], v[124:127]
    ds_read_b64_tr_b16 a[160:161], v10 offset:384
    ds_read_b64_tr_b16 a[162:163], v12 offset:384
    v_mfma_f32_16x16x32_bf16 v[128:131], a[220:223], v[88:91], v[128:131]
    v_add_f32 v26, v26, v56
    v_add_f32 v26, v26, v57
    v_mfma_f32_16x16x32_bf16 v[132:135], a[220:223], v[92:95], v[132:135]
    v_add_f32 v26, v26, v58
    s_waitcnt lgkmcnt(9)
    v_mfma_f32_16x16x32_bf16 v[136:139], a[200:203], v[76:79], v[136:139]
    v_add_f32 v26, v26, v59
    v_cvt_pk_bf16_f32 v56, v56, v57
    v_mfma_f32_16x16x32_bf16 v[140:143], a[200:203], v[80:83], v[140:143]
    v_cvt_pk_bf16_f32 v57, v58, v59
    v_fma_f32 v60, v60, s23, v32
    v_mfma_f32_16x16x32_bf16 v[144:147], a[200:203], v[84:87], v[144:147]
    buffer_load_dwordx4 v3, s[32:35], s22 offen offset:1088 nt lds
    ds_read_b64_tr_b16 a[164:165], v11 offset:384
    v_mfma_f32_16x16x32_bf16 v[148:151], a[200:203], v[88:91], v[148:151]
    ds_read_b64_tr_b16 a[166:167], v13 offset:384
    v_fma_f32 v61, v61, s23, v32
    v_mfma_f32_16x16x32_bf16 v[152:155], a[200:203], v[92:95], v[152:155]
    v_fma_f32 v62, v62, s23, v32
    s_waitcnt lgkmcnt(8)
    v_mfma_f32_16x16x32_bf16 v[156:159], a[204:207], v[76:79], v[156:159]
    v_fma_f32 v63, v63, s23, v32
    v_mfma_f32_16x16x32_bf16 v[160:163], a[204:207], v[80:83], v[160:163]
    v_exp_f32 v60, v60
    v_mfma_f32_16x16x32_bf16 v[164:167], a[204:207], v[84:87], v[164:167]
    v_exp_f32 v61, v61
    v_mfma_f32_16x16x32_bf16 v[168:171], a[204:207], v[88:91], v[168:171]
    v_exp_f32 v62, v62
    v_mfma_f32_16x16x32_bf16 v[172:175], a[204:207], v[92:95], v[172:175]
    v_exp_f32 v63, v63
    s_waitcnt lgkmcnt(6)
    v_mfma_f32_16x16x32_bf16 v[176:179], a[208:211], v[76:79], v[176:179]
    v_add_f32 v27, v27, v60
    v_add_f32 v27, v27, v61
    v_mfma_f32_16x16x32_bf16 v[180:183], a[208:211], v[80:83], v[180:183]
    v_add_f32 v27, v27, v62
    v_add_f32 v27, v27, v63
    v_mfma_f32_16x16x32_bf16 v[184:187], a[208:211], v[84:87], v[184:187]
    v_cvt_pk_bf16_f32 v60, v60, v61
    v_cvt_pk_bf16_f32 v61, v62, v63
    v_mfma_f32_16x16x32_bf16 v[188:191], a[208:211], v[88:91], v[188:191]
    v_fma_f32 v64, v64, s23, v33
    v_fma_f32 v65, v65, s23, v33
    v_mfma_f32_16x16x32_bf16 v[192:195], a[208:211], v[92:95], v[192:195]
    v_fma_f32 v66, v66, s23, v33
    s_waitcnt lgkmcnt(4)
    v_mfma_f32_16x16x32_bf16 v[196:199], a[212:215], v[76:79], v[196:199]
    v_fma_f32 v67, v67, s23, v33
    v_mfma_f32_16x16x32_bf16 v[200:203], a[212:215], v[80:83], v[200:203]
    buffer_load_dwordx4 v4, s[32:35], s22 offen offset:2176 nt lds
    v_mfma_f32_16x16x32_bf16 v[204:207], a[212:215], v[84:87], v[204:207]
    v_exp_f32 v64, v64
    v_mfma_f32_16x16x32_bf16 v[208:211], a[212:215], v[88:91], v[208:211]
    v_exp_f32 v65, v65
    v_mfma_f32_16x16x32_bf16 v[212:215], a[212:215], v[92:95], v[212:215]
    s_waitcnt vmcnt(19) lgkmcnt(0)
    s_barrier
    v_mfma_f32_16x16x32_bf16 v[216:219], a[160:163], v[76:79], v[216:219]
    ds_read_b64 v[38:39], v19
    ds_read_b64 v[42:43], v19 offset:512
    v_mfma_f32_16x16x32_bf16 v[220:223], a[160:163], v[80:83], v[220:223]
    ds_write_b64 v14, v[56:57] offset:10240
    v_mfma_f32_16x16x32_bf16 v[224:227], a[160:163], v[84:87], v[224:227]
    ds_read_b64 v[46:47], v19 offset:1024
    ds_read_b64 v[50:51], v19 offset:1536
    v_mfma_f32_16x16x32_bf16 v[228:231], a[160:163], v[88:91], v[228:231]
    ds_read_b64 v[54:55], v19 offset:2048
    v_mfma_f32_16x16x32_bf16 v[232:235], a[160:163], v[92:95], v[232:235]
    ds_write_b64 v14, v[60:61] offset:10752
    v_mfma_f32_16x16x32_bf16 v[236:239], a[164:167], v[76:79], v[236:239]
    v_exp_f32 v66, v66
    v_mfma_f32_16x16x32_bf16 v[240:243], a[164:167], v[80:83], v[240:243]
    v_exp_f32 v67, v67
    v_mfma_f32_16x16x32_bf16 v[244:247], a[164:167], v[84:87], v[244:247]
    v_add_f32 v28, v28, v64
    v_add_f32 v28, v28, v65
    v_mfma_f32_16x16x32_bf16 v[248:251], a[164:167], v[88:91], v[248:251]
    v_add_f32 v28, v28, v66
    v_add_f32 v28, v28, v67
    v_mfma_f32_16x16x32_bf16 v[252:255], a[164:167], v[92:95], v[252:255]
    buffer_load_dwordx4 v5, s[32:35], s22 offen offset:3264 nt lds
    v_cvt_pk_bf16_f32 v64, v64, v65
    v_mfma_f32_16x16x32_bf16 v[76:79], a[168:171], a[0:3], 0
    v_cvt_pk_bf16_f32 v65, v66, v67
    v_fma_f32 v68, v68, s23, v34
    v_mfma_f32_16x16x32_bf16 v[80:83], a[168:171], a[4:7], 0
    ds_write_b64 v14, v[64:65] offset:11264
    v_mfma_f32_16x16x32_bf16 v[84:87], a[168:171], a[8:11], 0
    v_fma_f32 v69, v69, s23, v34
    v_fma_f32 v70, v70, s23, v34
    v_mfma_f32_16x16x32_bf16 v[88:91], a[168:171], a[12:15], 0
    v_fma_f32 v71, v71, s23, v34
    v_mfma_f32_16x16x32_bf16 v[92:95], a[168:171], a[16:19], 0
    v_exp_f32 v68, v68
    v_mfma_f32_16x16x32_bf16 v[76:79], a[172:175], a[20:23], v[76:79]
    v_exp_f32 v69, v69
    v_mfma_f32_16x16x32_bf16 v[80:83], a[172:175], a[24:27], v[80:83]
    v_exp_f32 v70, v70
    v_mfma_f32_16x16x32_bf16 v[84:87], a[172:175], a[28:31], v[84:87]
    v_exp_f32 v71, v71
    v_mfma_f32_16x16x32_bf16 v[88:91], a[172:175], a[32:35], v[88:91]
    v_add_f32 v29, v29, v68
    v_add_f32 v29, v29, v69
    v_mfma_f32_16x16x32_bf16 v[92:95], a[172:175], a[36:39], v[92:95]
    v_add_f32 v29, v29, v70
    v_add_f32 v29, v29, v71
    v_mfma_f32_16x16x32_bf16 v[76:79], a[176:179], a[40:43], v[76:79]
    v_cvt_pk_bf16_f32 v68, v68, v69
    v_cvt_pk_bf16_f32 v69, v70, v71
    v_mfma_f32_16x16x32_bf16 v[80:83], a[176:179], a[44:47], v[80:83]
    ds_write_b64 v14, v[68:69] offset:11776
    v_mfma_f32_16x16x32_bf16 v[84:87], a[176:179], a[48:51], v[84:87]
    v_fma_f32 v72, v72, s23, v35
    v_fma_f32 v73, v73, s23, v35
    v_mfma_f32_16x16x32_bf16 v[88:91], a[176:179], a[52:55], v[88:91]
    s_add_u32 m0, s21, 0
    s_mov_b32 s22, 147456
    buffer_load_dwordx4 v2, s[36:39], s22 offen nt lds
    v_mfma_f32_16x16x32_bf16 v[92:95], a[176:179], a[56:59], v[92:95]
    v_fma_f32 v74, v74, s23, v35
    v_fma_f32 v75, v75, s23, v35
    v_mfma_f32_16x16x32_bf16 v[76:79], a[180:183], a[60:63], v[76:79]
    v_exp_f32 v72, v72
    v_mfma_f32_16x16x32_bf16 v[80:83], a[180:183], a[64:67], v[80:83]
    v_exp_f32 v73, v73
    v_mfma_f32_16x16x32_bf16 v[84:87], a[180:183], a[68:71], v[84:87]
    ds_read_b64_tr_b16 a[224:225], v10 offset:52224
    ds_read_b64_tr_b16 a[226:227], v12 offset:52224
    v_mfma_f32_16x16x32_bf16 v[88:91], a[180:183], a[72:75], v[88:91]
    v_exp_f32 v74, v74
    v_mfma_f32_16x16x32_bf16 v[92:95], a[180:183], a[76:79], v[92:95]
    v_exp_f32 v75, v75
    v_mfma_f32_16x16x32_bf16 v[76:79], a[184:187], a[80:83], v[76:79]
    v_add_f32 v30, v30, v72
    v_add_f32 v30, v30, v73
    v_mfma_f32_16x16x32_bf16 v[80:83], a[184:187], a[84:87], v[80:83]
    v_add_f32 v30, v30, v74
    v_add_f32 v30, v30, v75
    v_mfma_f32_16x16x32_bf16 v[84:87], a[184:187], a[88:91], v[84:87]
    ds_read_b64_tr_b16 a[228:229], v11 offset:52224
    ds_read_b64_tr_b16 a[230:231], v13 offset:52224
    v_mfma_f32_16x16x32_bf16 v[88:91], a[184:187], a[92:95], v[88:91]
    v_cvt_pk_bf16_f32 v72, v72, v73
    v_cvt_pk_bf16_f32 v73, v74, v75
    v_mfma_f32_16x16x32_bf16 v[92:95], a[184:187], a[96:99], v[92:95]
    ds_write_b64 v14, v[72:73] offset:12288
    v_mfma_f32_16x16x32_bf16 v[76:79], a[188:191], a[100:103], v[76:79]
    v_mfma_f32_16x16x32_bf16 v[80:83], a[188:191], a[104:107], v[80:83]
    buffer_load_dwordx4 v3, s[36:39], s22 offen offset:1088 nt lds
    v_mfma_f32_16x16x32_bf16 v[84:87], a[188:191], a[108:111], v[84:87]
    ds_read_b64_tr_b16 a[232:233], v10 offset:52352
    ds_read_b64_tr_b16 a[234:235], v12 offset:52352
    v_mfma_f32_16x16x32_bf16 v[88:91], a[188:191], a[112:115], v[88:91]
    v_mfma_f32_16x16x32_bf16 v[92:95], a[188:191], a[116:119], v[92:95]
    v_mfma_f32_16x16x32_bf16 v[76:79], a[192:195], a[120:123], v[76:79]
    v_mfma_f32_16x16x32_bf16 v[80:83], a[192:195], a[124:127], v[80:83]
    v_mfma_f32_16x16x32_bf16 v[84:87], a[192:195], a[128:131], v[84:87]
    ds_read_b64_tr_b16 a[236:237], v11 offset:52352
    ds_read_b64_tr_b16 a[238:239], v13 offset:52352
    v_mfma_f32_16x16x32_bf16 v[88:91], a[192:195], a[132:135], v[88:91]
    v_mfma_f32_16x16x32_bf16 v[92:95], a[192:195], a[136:139], v[92:95]
    v_mfma_f32_16x16x32_bf16 v[76:79], a[196:199], a[140:143], v[76:79]
    v_mfma_f32_16x16x32_bf16 v[80:83], a[196:199], a[144:147], v[80:83]
    v_mfma_f32_16x16x32_bf16 v[84:87], a[196:199], a[148:151], v[84:87]
    ds_read_b64_tr_b16 a[240:241], v10 offset:52480
    ds_read_b64_tr_b16 a[242:243], v12 offset:52480
    v_mfma_f32_16x16x32_bf16 v[88:91], a[196:199], a[152:155], v[88:91]
    v_mfma_f32_16x16x32_bf16 v[92:95], a[196:199], a[156:159], v[92:95]
    s_waitcnt lgkmcnt(9)
    v_mfma_f32_16x16x32_bf16 v[96:99], a[224:227], v[36:39], v[96:99]
    buffer_load_dwordx4 v4, s[36:39], s22 offen offset:2176 nt lds
    v_fma_f32 v76, v76, s23, v31
    v_mfma_f32_16x16x32_bf16 v[100:103], a[224:227], v[40:43], v[100:103]
    v_fma_f32 v77, v77, s23, v31
    v_fma_f32 v78, v78, s23, v31
    v_mfma_f32_16x16x32_bf16 v[104:107], a[224:227], v[44:47], v[104:107]
    ds_read_b64_tr_b16 a[244:245], v11 offset:52480
    ds_read_b64_tr_b16 a[246:247], v13 offset:52480
    v_mfma_f32_16x16x32_bf16 v[108:111], a[224:227], v[48:51], v[108:111]
    v_fma_f32 v79, v79, s23, v31
    v_mfma_f32_16x16x32_bf16 v[112:115], a[224:227], v[52:55], v[112:115]
    v_exp_f32 v76, v76
    s_waitcnt lgkmcnt(9)
    v_mfma_f32_16x16x32_bf16 v[116:119], a[228:231], v[36:39], v[116:119]
    v_exp_f32 v77, v77
    v_mfma_f32_16x16x32_bf16 v[120:123], a[228:231], v[40:43], v[120:123]
    v_exp_f32 v78, v78
    v_mfma_f32_16x16x32_bf16 v[124:127], a[228:231], v[44:47], v[124:127]
    ds_read_b64_tr_b16 a[248:249], v10 offset:52608
    ds_read_b64_tr_b16 a[250:251], v12 offset:52608
    v_mfma_f32_16x16x32_bf16 v[128:131], a[228:231], v[48:51], v[128:131]
    v_exp_f32 v79, v79
    v_mfma_f32_16x16x32_bf16 v[132:135], a[228:231], v[52:55], v[132:135]
    v_add_f32 v26, v26, v76
    s_waitcnt lgkmcnt(8)
    v_mfma_f32_16x16x32_bf16 v[136:139], a[232:235], v[36:39], v[136:139]
    v_add_f32 v26, v26, v77
    v_add_f32 v26, v26, v78
    v_mfma_f32_16x16x32_bf16 v[140:143], a[232:235], v[40:43], v[140:143]
    v_add_f32 v26, v26, v79
    v_cvt_pk_bf16_f32 v76, v76, v77
    v_mfma_f32_16x16x32_bf16 v[144:147], a[232:235], v[44:47], v[144:147]
    ds_read_b64_tr_b16 a[252:253], v11 offset:52608
    ds_read_b64_tr_b16 a[254:255], v13 offset:52608
    v_mfma_f32_16x16x32_bf16 v[148:151], a[232:235], v[48:51], v[148:151]
    buffer_load_dwordx4 v5, s[36:39], s22 offen offset:3264 nt lds
    v_cvt_pk_bf16_f32 v77, v78, v79
    v_mfma_f32_16x16x32_bf16 v[152:155], a[232:235], v[52:55], v[152:155]
    v_fma_f32 v80, v80, s23, v32
    s_waitcnt lgkmcnt(8)
    v_mfma_f32_16x16x32_bf16 v[156:159], a[236:239], v[36:39], v[156:159]
    v_fma_f32 v81, v81, s23, v32
    v_fma_f32 v82, v82, s23, v32
    v_mfma_f32_16x16x32_bf16 v[160:163], a[236:239], v[40:43], v[160:163]
    v_fma_f32 v83, v83, s23, v32
    v_mfma_f32_16x16x32_bf16 v[164:167], a[236:239], v[44:47], v[164:167]
    v_exp_f32 v80, v80
    v_mfma_f32_16x16x32_bf16 v[168:171], a[236:239], v[48:51], v[168:171]
    v_exp_f32 v81, v81
    v_mfma_f32_16x16x32_bf16 v[172:175], a[236:239], v[52:55], v[172:175]
    v_exp_f32 v82, v82
    s_waitcnt lgkmcnt(6)
    v_mfma_f32_16x16x32_bf16 v[176:179], a[240:243], v[36:39], v[176:179]
    v_exp_f32 v83, v83
    v_mfma_f32_16x16x32_bf16 v[180:183], a[240:243], v[40:43], v[180:183]
    v_add_f32 v27, v27, v80
    v_add_f32 v27, v27, v81
    v_mfma_f32_16x16x32_bf16 v[184:187], a[240:243], v[44:47], v[184:187]
    v_add_f32 v27, v27, v82
    v_add_f32 v27, v27, v83
    v_mfma_f32_16x16x32_bf16 v[188:191], a[240:243], v[48:51], v[188:191]
    v_cvt_pk_bf16_f32 v80, v80, v81
    v_cvt_pk_bf16_f32 v81, v82, v83
    v_mfma_f32_16x16x32_bf16 v[192:195], a[240:243], v[52:55], v[192:195]
    v_fma_f32 v84, v84, s23, v33
    s_waitcnt lgkmcnt(4)
    v_mfma_f32_16x16x32_bf16 v[196:199], a[244:247], v[36:39], v[196:199]
    v_fma_f32 v85, v85, s23, v33
    v_fma_f32 v86, v86, s23, v33
    v_mfma_f32_16x16x32_bf16 v[200:203], a[244:247], v[40:43], v[200:203]
    v_fma_f32 v87, v87, s23, v33
    v_mfma_f32_16x16x32_bf16 v[204:207], a[244:247], v[44:47], v[204:207]
    s_add_u32 m0, s21, 17408
    s_mov_b32 s22, 196608
    buffer_load_dwordx4 v2, s[32:35], s22 offen nt lds
    v_mfma_f32_16x16x32_bf16 v[208:211], a[244:247], v[48:51], v[208:211]
    v_exp_f32 v84, v84
    v_mfma_f32_16x16x32_bf16 v[212:215], a[244:247], v[52:55], v[212:215]
    s_waitcnt vmcnt(17) lgkmcnt(0)
    s_barrier
    v_mfma_f32_16x16x32_bf16 v[216:219], a[248:251], v[36:39], v[216:219]
    v_add_u32 v24, 0x15400, v24
    ds_read_b128 a[216:219], v24
    v_mfma_f32_16x16x32_bf16 v[220:223], a[248:251], v[40:43], v[220:223]
    v_add_u32 v25, 0x15400, v25
    ds_read_b128 a[220:223], v25
    v_mfma_f32_16x16x32_bf16 v[224:227], a[248:251], v[44:47], v[224:227]
    ds_read_b64 v[58:59], v19 offset:10240
    ds_read_b128 a[200:203], v24 offset:128
    v_mfma_f32_16x16x32_bf16 v[228:231], a[248:251], v[48:51], v[228:231]
    ds_write_b64 v14, v[76:77]
    v_mfma_f32_16x16x32_bf16 v[232:235], a[248:251], v[52:55], v[232:235]
    ds_read_b64 v[62:63], v19 offset:10752
    ds_read_b64 v[66:67], v19 offset:11264
    v_mfma_f32_16x16x32_bf16 v[236:239], a[252:255], v[36:39], v[236:239]
    ds_read_b64 v[70:71], v19 offset:11776
    ds_read_b64 v[74:75], v19 offset:12288
    v_mfma_f32_16x16x32_bf16 v[240:243], a[252:255], v[40:43], v[240:243]
    ds_read_b128 a[204:207], v25 offset:128
    v_mfma_f32_16x16x32_bf16 v[244:247], a[252:255], v[44:47], v[244:247]
    ds_read_b128 a[208:211], v24 offset:256
    v_mfma_f32_16x16x32_bf16 v[248:251], a[252:255], v[48:51], v[248:251]
    ds_write_b64 v14, v[80:81] offset:512
    v_mfma_f32_16x16x32_bf16 v[252:255], a[252:255], v[52:55], v[252:255]
    v_exp_f32 v85, v85
    s_waitcnt lgkmcnt(11)
    v_mfma_f32_16x16x32_bf16 v[36:39], a[216:219], a[0:3], 0
    buffer_load_dwordx4 v3, s[32:35], s22 offen offset:1088 nt lds
    v_mfma_f32_16x16x32_bf16 v[40:43], a[216:219], a[4:7], 0
    v_exp_f32 v86, v86
    v_mfma_f32_16x16x32_bf16 v[44:47], a[216:219], a[8:11], 0
    ds_read_b128 a[212:215], v25 offset:256
    v_mfma_f32_16x16x32_bf16 v[48:51], a[216:219], a[12:15], 0
    v_exp_f32 v87, v87
    v_mfma_f32_16x16x32_bf16 v[52:55], a[216:219], a[16:19], 0
    v_add_f32 v28, v28, v84
    s_waitcnt lgkmcnt(11)
    v_mfma_f32_16x16x32_bf16 v[36:39], a[220:223], a[20:23], v[36:39]
    v_add_f32 v28, v28, v85
    v_add_f32 v28, v28, v86
    v_mfma_f32_16x16x32_bf16 v[40:43], a[220:223], a[24:27], v[40:43]
    v_add_f32 v28, v28, v87
    v_cvt_pk_bf16_f32 v84, v84, v85
    v_mfma_f32_16x16x32_bf16 v[44:47], a[220:223], a[28:31], v[44:47]
    ds_read_b128 a[160:163], v24 offset:384
    v_cvt_pk_bf16_f32 v85, v86, v87
    v_mfma_f32_16x16x32_bf16 v[48:51], a[220:223], a[32:35], v[48:51]
    ds_write_b64 v14, v[84:85] offset:1024
    v_mfma_f32_16x16x32_bf16 v[52:55], a[220:223], a[36:39], v[52:55]
    v_fma_f32 v88, v88, s23, v34
    s_waitcnt lgkmcnt(11)
    v_mfma_f32_16x16x32_bf16 v[36:39], a[200:203], a[40:43], v[36:39]
    v_fma_f32 v89, v89, s23, v34
    v_fma_f32 v90, v90, s23, v34
    v_mfma_f32_16x16x32_bf16 v[40:43], a[200:203], a[44:47], v[40:43]
    v_fma_f32 v91, v91, s23, v34
    v_mfma_f32_16x16x32_bf16 v[44:47], a[200:203], a[48:51], v[44:47]
    ds_read_b128 a[164:167], v25 offset:384
    v_mfma_f32_16x16x32_bf16 v[48:51], a[200:203], a[52:55], v[48:51]
    v_exp_f32 v88, v88
    v_mfma_f32_16x16x32_bf16 v[52:55], a[200:203], a[56:59], v[52:55]
    buffer_load_dwordx4 v4, s[32:35], s22 offen offset:2176 nt lds
    s_waitcnt lgkmcnt(6)
    v_mfma_f32_16x16x32_bf16 v[36:39], a[204:207], a[60:63], v[36:39]
    v_exp_f32 v89, v89
    v_mfma_f32_16x16x32_bf16 v[40:43], a[204:207], a[64:67], v[40:43]
    v_exp_f32 v90, v90
    v_mfma_f32_16x16x32_bf16 v[44:47], a[204:207], a[68:71], v[44:47]
    ds_read_b64_tr_b16 a[168:169], v10 offset:34816
    ds_read_b64_tr_b16 a[170:171], v12 offset:34816
    v_mfma_f32_16x16x32_bf16 v[48:51], a[204:207], a[72:75], v[48:51]
    v_exp_f32 v91, v91
    v_mfma_f32_16x16x32_bf16 v[52:55], a[204:207], a[76:79], v[52:55]
    v_add_f32 v29, v29, v88
    s_waitcnt lgkmcnt(7)
    v_mfma_f32_16x16x32_bf16 v[36:39], a[208:211], a[80:83], v[36:39]
    v_add_f32 v29, v29, v89
    v_add_f32 v29, v29, v90
    v_mfma_f32_16x16x32_bf16 v[40:43], a[208:211], a[84:87], v[40:43]
    v_add_f32 v29, v29, v91
    v_cvt_pk_bf16_f32 v88, v88, v89
    v_mfma_f32_16x16x32_bf16 v[44:47], a[208:211], a[88:91], v[44:47]
    ds_read_b64_tr_b16 a[172:173], v11 offset:34816
    ds_read_b64_tr_b16 a[174:175], v13 offset:34816
    v_mfma_f32_16x16x32_bf16 v[48:51], a[208:211], a[92:95], v[48:51]
    v_cvt_pk_bf16_f32 v89, v90, v91
    v_fma_f32 v92, v92, s23, v35
    v_mfma_f32_16x16x32_bf16 v[52:55], a[208:211], a[96:99], v[52:55]
    ds_write_b64 v14, v[88:89] offset:1536
    s_waitcnt lgkmcnt(8)
    v_mfma_f32_16x16x32_bf16 v[36:39], a[212:215], a[100:103], v[36:39]
    v_fma_f32 v93, v93, s23, v35
    v_fma_f32 v94, v94, s23, v35
    v_mfma_f32_16x16x32_bf16 v[40:43], a[212:215], a[104:107], v[40:43]
    v_fma_f32 v95, v95, s23, v35
    v_mfma_f32_16x16x32_bf16 v[44:47], a[212:215], a[108:111], v[44:47]
    buffer_load_dwordx4 v5, s[32:35], s22 offen offset:3264 nt lds
    ds_read_b64_tr_b16 a[176:177], v10 offset:34944
    v_mfma_f32_16x16x32_bf16 v[48:51], a[212:215], a[112:115], v[48:51]
    ds_read_b64_tr_b16 a[178:179], v12 offset:34944
    v_mfma_f32_16x16x32_bf16 v[52:55], a[212:215], a[116:119], v[52:55]
    v_exp_f32 v92, v92
    s_waitcnt lgkmcnt(9)
    v_mfma_f32_16x16x32_bf16 v[36:39], a[160:163], a[120:123], v[36:39]
    v_exp_f32 v93, v93
    v_mfma_f32_16x16x32_bf16 v[40:43], a[160:163], a[124:127], v[40:43]
    v_exp_f32 v94, v94
    v_mfma_f32_16x16x32_bf16 v[44:47], a[160:163], a[128:131], v[44:47]
    ds_read_b64_tr_b16 a[180:181], v11 offset:34944
    ds_read_b64_tr_b16 a[182:183], v13 offset:34944
    v_mfma_f32_16x16x32_bf16 v[48:51], a[160:163], a[132:135], v[48:51]
    v_exp_f32 v95, v95
    v_mfma_f32_16x16x32_bf16 v[52:55], a[160:163], a[136:139], v[52:55]
    v_add_f32 v30, v30, v92
    s_waitcnt lgkmcnt(9)
    v_mfma_f32_16x16x32_bf16 v[36:39], a[164:167], a[140:143], v[36:39]
    v_add_f32 v30, v30, v93
    v_add_f32 v30, v30, v94
    v_mfma_f32_16x16x32_bf16 v[40:43], a[164:167], a[144:147], v[40:43]
    v_add_f32 v30, v30, v95
    v_cvt_pk_bf16_f32 v92, v92, v93
    v_mfma_f32_16x16x32_bf16 v[44:47], a[164:167], a[148:151], v[44:47]
    ds_read_b64_tr_b16 a[184:185], v10 offset:35072
    ds_read_b64_tr_b16 a[186:187], v12 offset:35072
    v_mfma_f32_16x16x32_bf16 v[48:51], a[164:167], a[152:155], v[48:51]
    v_cvt_pk_bf16_f32 v93, v94, v95
    v_fma_f32 v36, v36, s23, v31
    v_mfma_f32_16x16x32_bf16 v[52:55], a[164:167], a[156:159], v[52:55]
    ds_write_b64 v14, v[92:93] offset:2048
    s_waitcnt lgkmcnt(10)
    v_mfma_f32_16x16x32_bf16 v[96:99], a[168:171], v[56:59], v[96:99]
    v_fma_f32 v37, v37, s23, v31
    v_fma_f32 v38, v38, s23, v31
    v_mfma_f32_16x16x32_bf16 v[100:103], a[168:171], v[60:63], v[100:103]
    s_add_u32 m0, s21, 52224
    s_mov_b32 s22, 163840
    buffer_load_dwordx4 v2, s[36:39], s22 offen nt lds
    v_mfma_f32_16x16x32_bf16 v[104:107], a[168:171], v[64:67], v[104:107]
    ds_read_b64_tr_b16 a[188:189], v11 offset:35072
    ds_read_b64_tr_b16 a[190:191], v13 offset:35072
    v_mfma_f32_16x16x32_bf16 v[108:111], a[168:171], v[68:71], v[108:111]
    v_fma_f32 v39, v39, s23, v31
    v_mfma_f32_16x16x32_bf16 v[112:115], a[168:171], v[72:75], v[112:115]
    v_exp_f32 v36, v36
    s_waitcnt lgkmcnt(10)
    v_mfma_f32_16x16x32_bf16 v[116:119], a[172:175], v[56:59], v[116:119]
    v_exp_f32 v37, v37
    v_mfma_f32_16x16x32_bf16 v[120:123], a[172:175], v[60:63], v[120:123]
    v_exp_f32 v38, v38
    v_mfma_f32_16x16x32_bf16 v[124:127], a[172:175], v[64:67], v[124:127]
    ds_read_b64_tr_b16 a[192:193], v10 offset:35200
    ds_read_b64_tr_b16 a[194:195], v12 offset:35200
    v_mfma_f32_16x16x32_bf16 v[128:131], a[172:175], v[68:71], v[128:131]
    v_exp_f32 v39, v39
    v_mfma_f32_16x16x32_bf16 v[132:135], a[172:175], v[72:75], v[132:135]
    v_add_f32 v26, v26, v36
    s_waitcnt lgkmcnt(9)
    v_mfma_f32_16x16x32_bf16 v[136:139], a[176:179], v[56:59], v[136:139]
    v_add_f32 v26, v26, v37
    v_add_f32 v26, v26, v38
    v_mfma_f32_16x16x32_bf16 v[140:143], a[176:179], v[60:63], v[140:143]
    v_add_f32 v26, v26, v39
    v_cvt_pk_bf16_f32 v36, v36, v37
    v_mfma_f32_16x16x32_bf16 v[144:147], a[176:179], v[64:67], v[144:147]
    ds_read_b64_tr_b16 a[196:197], v11 offset:35200
    ds_read_b64_tr_b16 a[198:199], v13 offset:35200
    v_mfma_f32_16x16x32_bf16 v[148:151], a[176:179], v[68:71], v[148:151]
    v_cvt_pk_bf16_f32 v37, v38, v39
    v_fma_f32 v40, v40, s23, v32
    v_mfma_f32_16x16x32_bf16 v[152:155], a[176:179], v[72:75], v[152:155]
    buffer_load_dwordx4 v3, s[36:39], s22 offen offset:1088 nt lds
    s_waitcnt lgkmcnt(9)
    v_mfma_f32_16x16x32_bf16 v[156:159], a[180:183], v[56:59], v[156:159]
    v_fma_f32 v41, v41, s23, v32
    v_fma_f32 v42, v42, s23, v32
    v_mfma_f32_16x16x32_bf16 v[160:163], a[180:183], v[60:63], v[160:163]
    v_fma_f32 v43, v43, s23, v32
    v_mfma_f32_16x16x32_bf16 v[164:167], a[180:183], v[64:67], v[164:167]
    v_exp_f32 v40, v40
    v_mfma_f32_16x16x32_bf16 v[168:171], a[180:183], v[68:71], v[168:171]
    v_exp_f32 v41, v41
    v_mfma_f32_16x16x32_bf16 v[172:175], a[180:183], v[72:75], v[172:175]
    v_exp_f32 v42, v42
    s_waitcnt lgkmcnt(7)
    v_mfma_f32_16x16x32_bf16 v[176:179], a[184:187], v[56:59], v[176:179]
    v_exp_f32 v43, v43
    v_mfma_f32_16x16x32_bf16 v[180:183], a[184:187], v[60:63], v[180:183]
    v_add_f32 v27, v27, v40
    v_add_f32 v27, v27, v41
    v_mfma_f32_16x16x32_bf16 v[184:187], a[184:187], v[64:67], v[184:187]
    v_add_f32 v27, v27, v42
    v_add_f32 v27, v27, v43
    v_mfma_f32_16x16x32_bf16 v[188:191], a[184:187], v[68:71], v[188:191]
    v_cvt_pk_bf16_f32 v40, v40, v41
    v_cvt_pk_bf16_f32 v41, v42, v43
    v_mfma_f32_16x16x32_bf16 v[192:195], a[184:187], v[72:75], v[192:195]
    v_fma_f32 v44, v44, s23, v33
    s_waitcnt lgkmcnt(4)
    v_mfma_f32_16x16x32_bf16 v[196:199], a[188:191], v[56:59], v[196:199]
    v_fma_f32 v45, v45, s23, v33
    v_fma_f32 v46, v46, s23, v33
    v_mfma_f32_16x16x32_bf16 v[200:203], a[188:191], v[60:63], v[200:203]
    v_fma_f32 v47, v47, s23, v33
    v_mfma_f32_16x16x32_bf16 v[204:207], a[188:191], v[64:67], v[204:207]
    v_exp_f32 v44, v44
    v_mfma_f32_16x16x32_bf16 v[208:211], a[188:191], v[68:71], v[208:211]
    buffer_load_dwordx4 v4, s[36:39], s22 offen offset:2176 nt lds
    v_mfma_f32_16x16x32_bf16 v[212:215], a[188:191], v[72:75], v[212:215]
    s_waitcnt vmcnt(15) lgkmcnt(0)
    s_barrier
    v_mfma_f32_16x16x32_bf16 v[216:219], a[192:195], v[56:59], v[216:219]
    v_add_u32 v24, 0xffff7800, v24
    ds_read_b128 a[224:227], v24
    v_mfma_f32_16x16x32_bf16 v[220:223], a[192:195], v[60:63], v[220:223]
    v_add_u32 v25, 0xffff7800, v25
    ds_read_b128 a[228:231], v25
    v_mfma_f32_16x16x32_bf16 v[224:227], a[192:195], v[64:67], v[224:227]
    ds_read_b64 v[78:79], v19
    ds_read_b128 a[232:235], v24 offset:128
    v_mfma_f32_16x16x32_bf16 v[228:231], a[192:195], v[68:71], v[228:231]
    ds_write_b64 v14, v[36:37] offset:10240
    v_mfma_f32_16x16x32_bf16 v[232:235], a[192:195], v[72:75], v[232:235]
    ds_read_b64 v[82:83], v19 offset:512
    ds_read_b64 v[86:87], v19 offset:1024
    v_mfma_f32_16x16x32_bf16 v[236:239], a[196:199], v[56:59], v[236:239]
    ds_read_b64 v[90:91], v19 offset:1536
    ds_read_b64 v[94:95], v19 offset:2048
    v_mfma_f32_16x16x32_bf16 v[240:243], a[196:199], v[60:63], v[240:243]
    ds_read_b128 a[236:239], v25 offset:128
    v_mfma_f32_16x16x32_bf16 v[244:247], a[196:199], v[64:67], v[244:247]
    ds_read_b128 a[240:243], v24 offset:256
    v_mfma_f32_16x16x32_bf16 v[248:251], a[196:199], v[68:71], v[248:251]
    ds_write_b64 v14, v[40:41] offset:10752
    v_mfma_f32_16x16x32_bf16 v[252:255], a[196:199], v[72:75], v[252:255]
    v_exp_f32 v45, v45
    s_waitcnt lgkmcnt(11)
    v_mfma_f32_16x16x32_bf16 v[56:59], a[224:227], a[0:3], 0
    v_exp_f32 v46, v46
    v_mfma_f32_16x16x32_bf16 v[60:63], a[224:227], a[4:7], 0
    buffer_load_dwordx4 v5, s[36:39], s22 offen offset:3264 nt lds
    v_mfma_f32_16x16x32_bf16 v[64:67], a[224:227], a[8:11], 0
    ds_read_b128 a[244:247], v25 offset:256
    v_mfma_f32_16x16x32_bf16 v[68:71], a[224:227], a[12:15], 0
    v_exp_f32 v47, v47
    v_mfma_f32_16x16x32_bf16 v[72:75], a[224:227], a[16:19], 0
    v_add_f32 v28, v28, v44
    s_waitcnt lgkmcnt(11)
    v_mfma_f32_16x16x32_bf16 v[56:59], a[228:231], a[20:23], v[56:59]
    v_add_f32 v28, v28, v45
    v_add_f32 v28, v28, v46
    v_mfma_f32_16x16x32_bf16 v[60:63], a[228:231], a[24:27], v[60:63]
    v_add_f32 v28, v28, v47
    v_cvt_pk_bf16_f32 v44, v44, v45
    v_mfma_f32_16x16x32_bf16 v[64:67], a[228:231], a[28:31], v[64:67]
    ds_read_b128 a[248:251], v24 offset:384
    v_cvt_pk_bf16_f32 v45, v46, v47
    v_mfma_f32_16x16x32_bf16 v[68:71], a[228:231], a[32:35], v[68:71]
    ds_write_b64 v14, v[44:45] offset:11264
    v_mfma_f32_16x16x32_bf16 v[72:75], a[228:231], a[36:39], v[72:75]
    v_fma_f32 v48, v48, s23, v34
    s_waitcnt lgkmcnt(11)
    v_mfma_f32_16x16x32_bf16 v[56:59], a[232:235], a[40:43], v[56:59]
    v_fma_f32 v49, v49, s23, v34
    v_fma_f32 v50, v50, s23, v34
    v_mfma_f32_16x16x32_bf16 v[60:63], a[232:235], a[44:47], v[60:63]
    v_fma_f32 v51, v51, s23, v34
    v_mfma_f32_16x16x32_bf16 v[64:67], a[232:235], a[48:51], v[64:67]
    ds_read_b128 a[252:255], v25 offset:384
    v_mfma_f32_16x16x32_bf16 v[68:71], a[232:235], a[52:55], v[68:71]
    v_exp_f32 v48, v48
    v_mfma_f32_16x16x32_bf16 v[72:75], a[232:235], a[56:59], v[72:75]
    v_exp_f32 v49, v49
    s_waitcnt lgkmcnt(6)
    v_mfma_f32_16x16x32_bf16 v[56:59], a[236:239], a[60:63], v[56:59]
    s_add_u32 m0, s21, 104448
    s_mov_b32 s22, 212992
    buffer_load_dwordx4 v2, s[32:35], s22 offen nt lds
    v_mfma_f32_16x16x32_bf16 v[60:63], a[236:239], a[64:67], v[60:63]
    v_exp_f32 v50, v50
    v_mfma_f32_16x16x32_bf16 v[64:67], a[236:239], a[68:71], v[64:67]
    v_add_u32 v10, 0x15400, v10
    ds_read_b64_tr_b16 a[216:217], v10
    v_mfma_f32_16x16x32_bf16 v[68:71], a[236:239], a[72:75], v[68:71]
    v_add_u32 v12, 0x15400, v12
    ds_read_b64_tr_b16 a[218:219], v12
    v_mfma_f32_16x16x32_bf16 v[72:75], a[236:239], a[76:79], v[72:75]
    v_exp_f32 v51, v51
    s_waitcnt lgkmcnt(7)
    v_mfma_f32_16x16x32_bf16 v[56:59], a[240:243], a[80:83], v[56:59]
    v_add_f32 v29, v29, v48
    v_add_f32 v29, v29, v49
    v_mfma_f32_16x16x32_bf16 v[60:63], a[240:243], a[84:87], v[60:63]
    v_add_f32 v29, v29, v50
    v_add_f32 v29, v29, v51
    v_mfma_f32_16x16x32_bf16 v[64:67], a[240:243], a[88:91], v[64:67]
    v_add_u32 v11, 0x15400, v11
    ds_read_b64_tr_b16 a[220:221], v11
    v_mfma_f32_16x16x32_bf16 v[68:71], a[240:243], a[92:95], v[68:71]
    v_add_u32 v13, 0x15400, v13
    ds_read_b64_tr_b16 a[222:223], v13
    v_mfma_f32_16x16x32_bf16 v[72:75], a[240:243], a[96:99], v[72:75]
    v_cvt_pk_bf16_f32 v48, v48, v49
    s_waitcnt lgkmcnt(7)
    v_mfma_f32_16x16x32_bf16 v[56:59], a[244:247], a[100:103], v[56:59]
    v_cvt_pk_bf16_f32 v49, v50, v51
    v_fma_f32 v52, v52, s23, v35
    v_mfma_f32_16x16x32_bf16 v[60:63], a[244:247], a[104:107], v[60:63]
    ds_write_b64 v14, v[48:49] offset:11776
    v_mfma_f32_16x16x32_bf16 v[64:67], a[244:247], a[108:111], v[64:67]
    ds_read_b64_tr_b16 a[200:201], v10 offset:128
    ds_read_b64_tr_b16 a[202:203], v12 offset:128
    v_mfma_f32_16x16x32_bf16 v[68:71], a[244:247], a[112:115], v[68:71]
    buffer_load_dwordx4 v3, s[32:35], s22 offen offset:1088 nt lds
    v_fma_f32 v53, v53, s23, v35
    v_mfma_f32_16x16x32_bf16 v[72:75], a[244:247], a[116:119], v[72:75]
    v_fma_f32 v54, v54, s23, v35
    s_waitcnt lgkmcnt(9)
    v_mfma_f32_16x16x32_bf16 v[56:59], a[248:251], a[120:123], v[56:59]
    v_fma_f32 v55, v55, s23, v35
    v_mfma_f32_16x16x32_bf16 v[60:63], a[248:251], a[124:127], v[60:63]
    v_exp_f32 v52, v52
    v_mfma_f32_16x16x32_bf16 v[64:67], a[248:251], a[128:131], v[64:67]
    ds_read_b64_tr_b16 a[204:205], v11 offset:128
    ds_read_b64_tr_b16 a[206:207], v13 offset:128
    v_mfma_f32_16x16x32_bf16 v[68:71], a[248:251], a[132:135], v[68:71]
    v_exp_f32 v53, v53
    v_mfma_f32_16x16x32_bf16 v[72:75], a[248:251], a[136:139], v[72:75]
    v_exp_f32 v54, v54
    s_waitcnt lgkmcnt(9)
    v_mfma_f32_16x16x32_bf16 v[56:59], a[252:255], a[140:143], v[56:59]
    v_exp_f32 v55, v55
    v_mfma_f32_16x16x32_bf16 v[60:63], a[252:255], a[144:147], v[60:63]
    v_add_f32 v30, v30, v52
    v_add_f32 v30, v30, v53
    v_mfma_f32_16x16x32_bf16 v[64:67], a[252:255], a[148:151], v[64:67]
    ds_read_b64_tr_b16 a[208:209], v10 offset:256
    ds_read_b64_tr_b16 a[210:211], v12 offset:256
    v_mfma_f32_16x16x32_bf16 v[68:71], a[252:255], a[152:155], v[68:71]
    v_add_f32 v30, v30, v54
    v_add_f32 v30, v30, v55
    v_mfma_f32_16x16x32_bf16 v[72:75], a[252:255], a[156:159], v[72:75]
    v_cvt_pk_bf16_f32 v52, v52, v53
    s_waitcnt lgkmcnt(9)
    v_mfma_f32_16x16x32_bf16 v[96:99], a[216:219], v[76:79], v[96:99]
    v_cvt_pk_bf16_f32 v53, v54, v55
    v_fma_f32 v56, v56, s23, v31
    v_mfma_f32_16x16x32_bf16 v[100:103], a[216:219], v[80:83], v[100:103]
    ds_write_b64 v14, v[52:53] offset:12288
    v_mfma_f32_16x16x32_bf16 v[104:107], a[216:219], v[84:87], v[104:107]
    buffer_load_dwordx4 v4, s[32:35], s22 offen offset:2176 nt lds
    ds_read_b64_tr_b16 a[212:213], v11 offset:256
    v_mfma_f32_16x16x32_bf16 v[108:111], a[216:219], v[88:91], v[108:111]
    ds_read_b64_tr_b16 a[214:215], v13 offset:256
    v_fma_f32 v57, v57, s23, v31
    v_mfma_f32_16x16x32_bf16 v[112:115], a[216:219], v[92:95], v[112:115]
    v_fma_f32 v58, v58, s23, v31
    s_waitcnt lgkmcnt(10)
    v_mfma_f32_16x16x32_bf16 v[116:119], a[220:223], v[76:79], v[116:119]
    v_fma_f32 v59, v59, s23, v31
    v_mfma_f32_16x16x32_bf16 v[120:123], a[220:223], v[80:83], v[120:123]
    v_exp_f32 v56, v56
    v_mfma_f32_16x16x32_bf16 v[124:127], a[220:223], v[84:87], v[124:127]
    ds_read_b64_tr_b16 a[160:161], v10 offset:384
    ds_read_b64_tr_b16 a[162:163], v12 offset:384
    v_mfma_f32_16x16x32_bf16 v[128:131], a[220:223], v[88:91], v[128:131]
    v_exp_f32 v57, v57
    v_mfma_f32_16x16x32_bf16 v[132:135], a[220:223], v[92:95], v[132:135]
    v_exp_f32 v58, v58
    s_waitcnt lgkmcnt(9)
    v_mfma_f32_16x16x32_bf16 v[136:139], a[200:203], v[76:79], v[136:139]
    v_exp_f32 v59, v59
    v_mfma_f32_16x16x32_bf16 v[140:143], a[200:203], v[80:83], v[140:143]
    v_add_f32 v26, v26, v56
    v_add_f32 v26, v26, v57
    v_mfma_f32_16x16x32_bf16 v[144:147], a[200:203], v[84:87], v[144:147]
    ds_read_b64_tr_b16 a[164:165], v11 offset:384
    ds_read_b64_tr_b16 a[166:167], v13 offset:384
    v_mfma_f32_16x16x32_bf16 v[148:151], a[200:203], v[88:91], v[148:151]
    v_add_f32 v26, v26, v58
    v_add_f32 v26, v26, v59
    v_mfma_f32_16x16x32_bf16 v[152:155], a[200:203], v[92:95], v[152:155]
    v_cvt_pk_bf16_f32 v56, v56, v57
    s_waitcnt lgkmcnt(9)
    v_mfma_f32_16x16x32_bf16 v[156:159], a[204:207], v[76:79], v[156:159]
    buffer_load_dwordx4 v5, s[32:35], s22 offen offset:3264 nt lds
    v_cvt_pk_bf16_f32 v57, v58, v59
    v_mfma_f32_16x16x32_bf16 v[160:163], a[204:207], v[80:83], v[160:163]
    v_fma_f32 v60, v60, s23, v32
    v_fma_f32 v61, v61, s23, v32
    v_mfma_f32_16x16x32_bf16 v[164:167], a[204:207], v[84:87], v[164:167]
    v_fma_f32 v62, v62, s23, v32
    v_fma_f32 v63, v63, s23, v32
    v_mfma_f32_16x16x32_bf16 v[168:171], a[204:207], v[88:91], v[168:171]
    v_exp_f32 v60, v60
    v_mfma_f32_16x16x32_bf16 v[172:175], a[204:207], v[92:95], v[172:175]
    v_exp_f32 v61, v61
    s_waitcnt lgkmcnt(7)
    v_mfma_f32_16x16x32_bf16 v[176:179], a[208:211], v[76:79], v[176:179]
    v_exp_f32 v62, v62
    v_mfma_f32_16x16x32_bf16 v[180:183], a[208:211], v[80:83], v[180:183]
    v_exp_f32 v63, v63
    v_mfma_f32_16x16x32_bf16 v[184:187], a[208:211], v[84:87], v[184:187]
    v_add_f32 v27, v27, v60
    v_add_f32 v27, v27, v61
    v_mfma_f32_16x16x32_bf16 v[188:191], a[208:211], v[88:91], v[188:191]
    v_add_f32 v27, v27, v62
    v_add_f32 v27, v27, v63
    v_mfma_f32_16x16x32_bf16 v[192:195], a[208:211], v[92:95], v[192:195]
    v_cvt_pk_bf16_f32 v60, v60, v61
    s_waitcnt lgkmcnt(4)
    v_mfma_f32_16x16x32_bf16 v[196:199], a[212:215], v[76:79], v[196:199]
    v_cvt_pk_bf16_f32 v61, v62, v63
    v_fma_f32 v64, v64, s23, v33
    v_mfma_f32_16x16x32_bf16 v[200:203], a[212:215], v[80:83], v[200:203]
    v_fma_f32 v65, v65, s23, v33
    v_fma_f32 v66, v66, s23, v33
    v_mfma_f32_16x16x32_bf16 v[204:207], a[212:215], v[84:87], v[204:207]
    v_fma_f32 v67, v67, s23, v33
    v_mfma_f32_16x16x32_bf16 v[208:211], a[212:215], v[88:91], v[208:211]
    v_exp_f32 v64, v64
    v_mfma_f32_16x16x32_bf16 v[212:215], a[212:215], v[92:95], v[212:215]
    s_waitcnt vmcnt(12) lgkmcnt(0)
    s_barrier
    v_mfma_f32_16x16x32_bf16 v[216:219], a[160:163], v[76:79], v[216:219]
    ds_read_b128 a[168:171], v24 offset:52224
    s_add_u32 m0, s21, 34816
    s_mov_b32 s22, 180224
    buffer_load_dwordx4 v2, s[36:39], s22 offen nt lds
    v_mfma_f32_16x16x32_bf16 v[220:223], a[160:163], v[80:83], v[220:223]
    ds_read_b128 a[172:175], v25 offset:52224
    ds_read_b64 v[38:39], v19 offset:10240
    v_mfma_f32_16x16x32_bf16 v[224:227], a[160:163], v[84:87], v[224:227]
    ds_write_b64 v14, v[56:57]
    v_mfma_f32_16x16x32_bf16 v[228:231], a[160:163], v[88:91], v[228:231]
    ds_read_b128 a[176:179], v24 offset:52352
    ds_read_b64 v[42:43], v19 offset:10752
    v_mfma_f32_16x16x32_bf16 v[232:235], a[160:163], v[92:95], v[232:235]
    ds_read_b64 v[46:47], v19 offset:11264
    ds_read_b64 v[50:51], v19 offset:11776
    v_mfma_f32_16x16x32_bf16 v[236:239], a[164:167], v[76:79], v[236:239]
    ds_read_b64 v[54:55], v19 offset:12288
    ds_read_b128 a[180:183], v25 offset:52352
    v_mfma_f32_16x16x32_bf16 v[240:243], a[164:167], v[80:83], v[240:243]
    ds_write_b64 v14, v[60:61] offset:512
    v_mfma_f32_16x16x32_bf16 v[244:247], a[164:167], v[84:87], v[244:247]
    ds_read_b128 a[184:187], v24 offset:52480
    v_mfma_f32_16x16x32_bf16 v[248:251], a[164:167], v[88:91], v[248:251]
    v_exp_f32 v65, v65
    v_mfma_f32_16x16x32_bf16 v[252:255], a[164:167], v[92:95], v[252:255]
    v_exp_f32 v66, v66
    s_waitcnt lgkmcnt(11)
    v_mfma_f32_16x16x32_bf16 v[76:79], a[168:171], a[0:3], 0
    v_exp_f32 v67, v67
    v_mfma_f32_16x16x32_bf16 v[80:83], a[168:171], a[4:7], 0
    v_add_f32 v28, v28, v64
    v_add_f32 v28, v28, v65
    v_mfma_f32_16x16x32_bf16 v[84:87], a[168:171], a[8:11], 0
    buffer_load_dwordx4 v3, s[36:39], s22 offen offset:1088 nt lds
    ds_read_b128 a[188:191], v25 offset:52480
    v_mfma_f32_16x16x32_bf16 v[88:91], a[168:171], a[12:15], 0
    v_add_f32 v28, v28, v66
    v_add_f32 v28, v28, v67
    v_mfma_f32_16x16x32_bf16 v[92:95], a[168:171], a[16:19], 0
    v_cvt_pk_bf16_f32 v64, v64, v65
    s_waitcnt lgkmcnt(11)
    v_mfma_f32_16x16x32_bf16 v[76:79], a[172:175], a[20:23], v[76:79]
    v_cvt_pk_bf16_f32 v65, v66, v67
    v_fma_f32 v68, v68, s23, v34
    v_mfma_f32_16x16x32_bf16 v[80:83], a[172:175], a[24:27], v[80:83]
    ds_write_b64 v14, v[64:65] offset:1024
    v_mfma_f32_16x16x32_bf16 v[84:87], a[172:175], a[28:31], v[84:87]
    ds_read_b128 a[192:195], v24 offset:52608
    v_fma_f32 v69, v69, s23, v34
    v_mfma_f32_16x16x32_bf16 v[88:91], a[172:175], a[32:35], v[88:91]
    v_fma_f32 v70, v70, s23, v34
    v_fma_f32 v71, v71, s23, v34
    v_mfma_f32_16x16x32_bf16 v[92:95], a[172:175], a[36:39], v[92:95]
    v_exp_f32 v68, v68
    s_waitcnt lgkmcnt(10)
    v_mfma_f32_16x16x32_bf16 v[76:79], a[176:179], a[40:43], v[76:79]
    v_exp_f32 v69, v69
    v_mfma_f32_16x16x32_bf16 v[80:83], a[176:179], a[44:47], v[80:83]
    v_exp_f32 v70, v70
    v_mfma_f32_16x16x32_bf16 v[84:87], a[176:179], a[48:51], v[84:87]
    ds_read_b128 a[196:199], v25 offset:52608
    v_mfma_f32_16x16x32_bf16 v[88:91], a[176:179], a[52:55], v[88:91]
    v_exp_f32 v71, v71
    v_mfma_f32_16x16x32_bf16 v[92:95], a[176:179], a[56:59], v[92:95]
    buffer_load_dwordx4 v4, s[36:39], s22 offen offset:2176 nt lds
    s_waitcnt lgkmcnt(6)
    v_mfma_f32_16x16x32_bf16 v[76:79], a[180:183], a[60:63], v[76:79]
    v_add_f32 v29, v29, v68
    v_add_f32 v29, v29, v69
    v_mfma_f32_16x16x32_bf16 v[80:83], a[180:183], a[64:67], v[80:83]
    v_add_f32 v29, v29, v70
    v_add_f32 v29, v29, v71
    v_mfma_f32_16x16x32_bf16 v[84:87], a[180:183], a[68:71], v[84:87]
    v_add_u32 v10, 0xfffeac00, v10
    ds_read_b64_tr_b16 a[224:225], v10
    v_mfma_f32_16x16x32_bf16 v[88:91], a[180:183], a[72:75], v[88:91]
    v_add_u32 v12, 0xfffeac00, v12
    ds_read_b64_tr_b16 a[226:227], v12
    v_mfma_f32_16x16x32_bf16 v[92:95], a[180:183], a[76:79], v[92:95]
    v_cvt_pk_bf16_f32 v68, v68, v69
    s_waitcnt lgkmcnt(6)
    v_mfma_f32_16x16x32_bf16 v[76:79], a[184:187], a[80:83], v[76:79]
    v_cvt_pk_bf16_f32 v69, v70, v71
    v_fma_f32 v72, v72, s23, v35
    v_mfma_f32_16x16x32_bf16 v[80:83], a[184:187], a[84:87], v[80:83]
    ds_write_b64 v14, v[68:69] offset:1536
    v_mfma_f32_16x16x32_bf16 v[84:87], a[184:187], a[88:91], v[84:87]
    buffer_load_dwordx4 v5, s[36:39], s22 offen offset:3264 nt lds
    v_add_u32 v11, 0xfffeac00, v11
    ds_read_b64_tr_b16 a[228:229], v11
    v_mfma_f32_16x16x32_bf16 v[88:91], a[184:187], a[92:95], v[88:91]
    v_add_u32 v13, 0xfffeac00, v13
    ds_read_b64_tr_b16 a[230:231], v13
    v_mfma_f32_16x16x32_bf16 v[92:95], a[184:187], a[96:99], v[92:95]
    v_fma_f32 v73, v73, s23, v35
    s_waitcnt lgkmcnt(8)
    v_mfma_f32_16x16x32_bf16 v[76:79], a[188:191], a[100:103], v[76:79]
    v_fma_f32 v74, v74, s23, v35
    v_fma_f32 v75, v75, s23, v35
    v_mfma_f32_16x16x32_bf16 v[80:83], a[188:191], a[104:107], v[80:83]
    v_exp_f32 v72, v72
    v_mfma_f32_16x16x32_bf16 v[84:87], a[188:191], a[108:111], v[84:87]
    ds_read_b64_tr_b16 a[232:233], v10 offset:128
    ds_read_b64_tr_b16 a[234:235], v12 offset:128
    v_mfma_f32_16x16x32_bf16 v[88:91], a[188:191], a[112:115], v[88:91]
    v_exp_f32 v73, v73
    v_mfma_f32_16x16x32_bf16 v[92:95], a[188:191], a[116:119], v[92:95]
    v_exp_f32 v74, v74
    s_waitcnt lgkmcnt(8)
    v_mfma_f32_16x16x32_bf16 v[76:79], a[192:195], a[120:123], v[76:79]
    v_exp_f32 v75, v75
    v_mfma_f32_16x16x32_bf16 v[80:83], a[192:195], a[124:127], v[80:83]
    v_add_f32 v30, v30, v72
    v_add_f32 v30, v30, v73
    v_mfma_f32_16x16x32_bf16 v[84:87], a[192:195], a[128:131], v[84:87]
    ds_read_b64_tr_b16 a[236:237], v11 offset:128
    ds_read_b64_tr_b16 a[238:239], v13 offset:128
    v_mfma_f32_16x16x32_bf16 v[88:91], a[192:195], a[132:135], v[88:91]
    v_add_f32 v30, v30, v74
    v_add_f32 v30, v30, v75
    v_mfma_f32_16x16x32_bf16 v[92:95], a[192:195], a[136:139], v[92:95]
    v_cvt_pk_bf16_f32 v72, v72, v73
    s_waitcnt lgkmcnt(9)
    v_mfma_f32_16x16x32_bf16 v[76:79], a[196:199], a[140:143], v[76:79]
    v_cvt_pk_bf16_f32 v73, v74, v75
    v_mfma_f32_16x16x32_bf16 v[80:83], a[196:199], a[144:147], v[80:83]
    ds_write_b64 v14, v[72:73] offset:2048
    v_mfma_f32_16x16x32_bf16 v[84:87], a[196:199], a[148:151], v[84:87]
    ds_read_b64_tr_b16 a[240:241], v10 offset:256
    ds_read_b64_tr_b16 a[242:243], v12 offset:256
    v_mfma_f32_16x16x32_bf16 v[88:91], a[196:199], a[152:155], v[88:91]
    v_mfma_f32_16x16x32_bf16 v[92:95], a[196:199], a[156:159], v[92:95]
    v_fma_f32 v76, v76, s23, v31
    s_waitcnt lgkmcnt(10)
    v_mfma_f32_16x16x32_bf16 v[96:99], a[224:227], v[36:39], v[96:99]
    v_fma_f32 v77, v77, s23, v31
    v_fma_f32 v78, v78, s23, v31
    v_mfma_f32_16x16x32_bf16 v[100:103], a[224:227], v[40:43], v[100:103]
    v_fma_f32 v79, v79, s23, v31
    v_mfma_f32_16x16x32_bf16 v[104:107], a[224:227], v[44:47], v[104:107]
    ds_read_b64_tr_b16 a[244:245], v11 offset:256
    ds_read_b64_tr_b16 a[246:247], v13 offset:256
    v_mfma_f32_16x16x32_bf16 v[108:111], a[224:227], v[48:51], v[108:111]
    s_add_u32 m0, s21, 69632
    s_mov_b32 s22, 229376
    buffer_load_dwordx4 v2, s[32:35], s22 offen nt lds
    v_mfma_f32_16x16x32_bf16 v[112:115], a[224:227], v[52:55], v[112:115]
    v_exp_f32 v76, v76
    s_waitcnt lgkmcnt(9)
    v_mfma_f32_16x16x32_bf16 v[116:119], a[228:231], v[36:39], v[116:119]
    v_exp_f32 v77, v77
    v_mfma_f32_16x16x32_bf16 v[120:123], a[228:231], v[40:43], v[120:123]
    v_exp_f32 v78, v78
    v_mfma_f32_16x16x32_bf16 v[124:127], a[228:231], v[44:47], v[124:127]
    ds_read_b64_tr_b16 a[248:249], v10 offset:384
    ds_read_b64_tr_b16 a[250:251], v12 offset:384
    v_mfma_f32_16x16x32_bf16 v[128:131], a[228:231], v[48:51], v[128:131]
    v_exp_f32 v79, v79
    v_mfma_f32_16x16x32_bf16 v[132:135], a[228:231], v[52:55], v[132:135]
    v_add_f32 v26, v26, v76
    s_waitcnt lgkmcnt(9)
    v_mfma_f32_16x16x32_bf16 v[136:139], a[232:235], v[36:39], v[136:139]
    v_add_f32 v26, v26, v77
    v_add_f32 v26, v26, v78
    v_mfma_f32_16x16x32_bf16 v[140:143], a[232:235], v[40:43], v[140:143]
    v_add_f32 v26, v26, v79
    v_cvt_pk_bf16_f32 v76, v76, v77
    v_mfma_f32_16x16x32_bf16 v[144:147], a[232:235], v[44:47], v[144:147]
    ds_read_b64_tr_b16 a[252:253], v11 offset:384
    ds_read_b64_tr_b16 a[254:255], v13 offset:384
    v_mfma_f32_16x16x32_bf16 v[148:151], a[232:235], v[48:51], v[148:151]
    v_cvt_pk_bf16_f32 v77, v78, v79
    v_fma_f32 v80, v80, s23, v32
    v_mfma_f32_16x16x32_bf16 v[152:155], a[232:235], v[52:55], v[152:155]
    v_fma_f32 v81, v81, s23, v32
    s_waitcnt lgkmcnt(9)
    v_mfma_f32_16x16x32_bf16 v[156:159], a[236:239], v[36:39], v[156:159]
    v_fma_f32 v82, v82, s23, v32
    v_fma_f32 v83, v83, s23, v32
    v_mfma_f32_16x16x32_bf16 v[160:163], a[236:239], v[40:43], v[160:163]
    buffer_load_dwordx4 v3, s[32:35], s22 offen offset:1088 nt lds
    v_mfma_f32_16x16x32_bf16 v[164:167], a[236:239], v[44:47], v[164:167]
    v_exp_f32 v80, v80
    v_mfma_f32_16x16x32_bf16 v[168:171], a[236:239], v[48:51], v[168:171]
    v_exp_f32 v81, v81
    v_mfma_f32_16x16x32_bf16 v[172:175], a[236:239], v[52:55], v[172:175]
    v_exp_f32 v82, v82
    s_waitcnt lgkmcnt(6)
    v_mfma_f32_16x16x32_bf16 v[176:179], a[240:243], v[36:39], v[176:179]
    v_exp_f32 v83, v83
    v_mfma_f32_16x16x32_bf16 v[180:183], a[240:243], v[40:43], v[180:183]
    v_add_f32 v27, v27, v80
    v_add_f32 v27, v27, v81
    v_mfma_f32_16x16x32_bf16 v[184:187], a[240:243], v[44:47], v[184:187]
    v_add_f32 v27, v27, v82
    v_add_f32 v27, v27, v83
    v_mfma_f32_16x16x32_bf16 v[188:191], a[240:243], v[48:51], v[188:191]
    v_cvt_pk_bf16_f32 v80, v80, v81
    v_cvt_pk_bf16_f32 v81, v82, v83
    v_mfma_f32_16x16x32_bf16 v[192:195], a[240:243], v[52:55], v[192:195]
    v_fma_f32 v84, v84, s23, v33
    s_waitcnt lgkmcnt(4)
    v_mfma_f32_16x16x32_bf16 v[196:199], a[244:247], v[36:39], v[196:199]
    v_fma_f32 v85, v85, s23, v33
    v_fma_f32 v86, v86, s23, v33
    v_mfma_f32_16x16x32_bf16 v[200:203], a[244:247], v[40:43], v[200:203]
    v_fma_f32 v87, v87, s23, v33
    v_mfma_f32_16x16x32_bf16 v[204:207], a[244:247], v[44:47], v[204:207]
    v_exp_f32 v84, v84
    v_mfma_f32_16x16x32_bf16 v[208:211], a[244:247], v[48:51], v[208:211]
    v_exp_f32 v85, v85
    v_mfma_f32_16x16x32_bf16 v[212:215], a[244:247], v[52:55], v[212:215]
    s_waitcnt vmcnt(10) lgkmcnt(0)
    s_barrier
    v_mfma_f32_16x16x32_bf16 v[216:219], a[248:251], v[36:39], v[216:219]
    v_add_u32 v24, 0xffff3400, v24
    ds_read_b128 a[216:219], v24
    v_mfma_f32_16x16x32_bf16 v[220:223], a[248:251], v[40:43], v[220:223]
    buffer_load_dwordx4 v4, s[32:35], s22 offen offset:2176 nt lds
    v_add_u32 v25, 0xffff3400, v25
    ds_read_b128 a[220:223], v25
    v_mfma_f32_16x16x32_bf16 v[224:227], a[248:251], v[44:47], v[224:227]
    ds_read_b64 v[58:59], v19
    ds_read_b128 a[200:203], v24 offset:128
    v_mfma_f32_16x16x32_bf16 v[228:231], a[248:251], v[48:51], v[228:231]
    ds_write_b64 v14, v[76:77] offset:10240
    v_mfma_f32_16x16x32_bf16 v[232:235], a[248:251], v[52:55], v[232:235]
    ds_read_b64 v[62:63], v19 offset:512
    ds_read_b64 v[66:67], v19 offset:1024
    v_mfma_f32_16x16x32_bf16 v[236:239], a[252:255], v[36:39], v[236:239]
    ds_read_b64 v[70:71], v19 offset:1536
    ds_read_b64 v[74:75], v19 offset:2048
    v_mfma_f32_16x16x32_bf16 v[240:243], a[252:255], v[40:43], v[240:243]
    ds_read_b128 a[204:207], v25 offset:128
    v_mfma_f32_16x16x32_bf16 v[244:247], a[252:255], v[44:47], v[244:247]
    ds_read_b128 a[208:211], v24 offset:256
    v_mfma_f32_16x16x32_bf16 v[248:251], a[252:255], v[48:51], v[248:251]
    ds_write_b64 v14, v[80:81] offset:10752
    v_mfma_f32_16x16x32_bf16 v[252:255], a[252:255], v[52:55], v[252:255]
    v_exp_f32 v86, v86
    s_waitcnt lgkmcnt(11)
    v_mfma_f32_16x16x32_bf16 v[36:39], a[216:219], a[0:3], 0
    v_exp_f32 v87, v87
    v_mfma_f32_16x16x32_bf16 v[40:43], a[216:219], a[4:7], 0
    v_add_f32 v28, v28, v84
    v_add_f32 v28, v28, v85
    v_mfma_f32_16x16x32_bf16 v[44:47], a[216:219], a[8:11], 0
    ds_read_b128 a[212:215], v25 offset:256
    v_add_f32 v28, v28, v86
    v_mfma_f32_16x16x32_bf16 v[48:51], a[216:219], a[12:15], 0
    buffer_load_dwordx4 v5, s[32:35], s22 offen offset:3264 nt lds
    v_add_f32 v28, v28, v87
    v_mfma_f32_16x16x32_bf16 v[52:55], a[216:219], a[16:19], 0
    v_cvt_pk_bf16_f32 v84, v84, v85
    s_waitcnt lgkmcnt(11)
    v_mfma_f32_16x16x32_bf16 v[36:39], a[220:223], a[20:23], v[36:39]
    v_cvt_pk_bf16_f32 v85, v86, v87
    v_fma_f32 v88, v88, s23, v34
    v_mfma_f32_16x16x32_bf16 v[40:43], a[220:223], a[24:27], v[40:43]
    ds_write_b64 v14, v[84:85] offset:11264
    v_mfma_f32_16x16x32_bf16 v[44:47], a[220:223], a[28:31], v[44:47]
    ds_read_b128 a[160:163], v24 offset:384
    v_fma_f32 v89, v89, s23, v34
    v_mfma_f32_16x16x32_bf16 v[48:51], a[220:223], a[32:35], v[48:51]
    v_fma_f32 v90, v90, s23, v34
    v_fma_f32 v91, v91, s23, v34
    v_mfma_f32_16x16x32_bf16 v[52:55], a[220:223], a[36:39], v[52:55]
    v_exp_f32 v88, v88
    s_waitcnt lgkmcnt(11)
    v_mfma_f32_16x16x32_bf16 v[36:39], a[200:203], a[40:43], v[36:39]
    v_exp_f32 v89, v89
    v_mfma_f32_16x16x32_bf16 v[40:43], a[200:203], a[44:47], v[40:43]
    v_exp_f32 v90, v90
    v_mfma_f32_16x16x32_bf16 v[44:47], a[200:203], a[48:51], v[44:47]
    ds_read_b128 a[164:167], v25 offset:384
    v_mfma_f32_16x16x32_bf16 v[48:51], a[200:203], a[52:55], v[48:51]
    v_exp_f32 v91, v91
    v_mfma_f32_16x16x32_bf16 v[52:55], a[200:203], a[56:59], v[52:55]
    s_add_u32 m0, s21, 87040
    s_mov_b32 s22, 196608
    buffer_load_dwordx4 v2, s[36:39], s22 offen nt lds
    s_waitcnt lgkmcnt(6)
    v_mfma_f32_16x16x32_bf16 v[36:39], a[204:207], a[60:63], v[36:39]
    v_add_f32 v29, v29, v88
    v_add_f32 v29, v29, v89
    v_mfma_f32_16x16x32_bf16 v[40:43], a[204:207], a[64:67], v[40:43]
    v_add_f32 v29, v29, v90
    v_add_f32 v29, v29, v91
    v_mfma_f32_16x16x32_bf16 v[44:47], a[204:207], a[68:71], v[44:47]
    ds_read_b64_tr_b16 a[168:169], v10 offset:52224
    ds_read_b64_tr_b16 a[170:171], v12 offset:52224
    v_mfma_f32_16x16x32_bf16 v[48:51], a[204:207], a[72:75], v[48:51]
    v_cvt_pk_bf16_f32 v88, v88, v89
    v_cvt_pk_bf16_f32 v89, v90, v91
    v_mfma_f32_16x16x32_bf16 v[52:55], a[204:207], a[76:79], v[52:55]
    ds_write_b64 v14, v[88:89] offset:11776
    s_waitcnt lgkmcnt(8)
    v_mfma_f32_16x16x32_bf16 v[36:39], a[208:211], a[80:83], v[36:39]
    v_fma_f32 v92, v92, s23, v35
    v_fma_f32 v93, v93, s23, v35
    v_mfma_f32_16x16x32_bf16 v[40:43], a[208:211], a[84:87], v[40:43]
    v_fma_f32 v94, v94, s23, v35
    v_fma_f32 v95, v95, s23, v35
    v_mfma_f32_16x16x32_bf16 v[44:47], a[208:211], a[88:91], v[44:47]
    buffer_load_dwordx4 v3, s[36:39], s22 offen offset:1088 nt lds
    ds_read_b64_tr_b16 a[172:173], v11 offset:52224
    v_mfma_f32_16x16x32_bf16 v[48:51], a[208:211], a[92:95], v[48:51]
    ds_read_b64_tr_b16 a[174:175], v13 offset:52224
    v_mfma_f32_16x16x32_bf16 v[52:55], a[208:211], a[96:99], v[52:55]
    v_exp_f32 v92, v92
    s_waitcnt lgkmcnt(8)
    v_mfma_f32_16x16x32_bf16 v[36:39], a[212:215], a[100:103], v[36:39]
    v_exp_f32 v93, v93
    v_mfma_f32_16x16x32_bf16 v[40:43], a[212:215], a[104:107], v[40:43]
    v_exp_f32 v94, v94
    v_mfma_f32_16x16x32_bf16 v[44:47], a[212:215], a[108:111], v[44:47]
    ds_read_b64_tr_b16 a[176:177], v10 offset:52352
    ds_read_b64_tr_b16 a[178:179], v12 offset:52352
    v_mfma_f32_16x16x32_bf16 v[48:51], a[212:215], a[112:115], v[48:51]
    v_exp_f32 v95, v95
    v_mfma_f32_16x16x32_bf16 v[52:55], a[212:215], a[116:119], v[52:55]
    v_add_f32 v30, v30, v92
    s_waitcnt lgkmcnt(8)
    v_mfma_f32_16x16x32_bf16 v[36:39], a[160:163], a[120:123], v[36:39]
    buffer_load_dwordx4 v4, s[36:39], s22 offen offset:2176 nt lds
    v_add_f32 v30, v30, v93
    v_mfma_f32_16x16x32_bf16 v[40:43], a[160:163], a[124:127], v[40:43]
    v_add_f32 v30, v30, v94
    v_add_f32 v30, v30, v95
    v_mfma_f32_16x16x32_bf16 v[44:47], a[160:163], a[128:131], v[44:47]
    ds_read_b64_tr_b16 a[180:181], v11 offset:52352
    ds_read_b64_tr_b16 a[182:183], v13 offset:52352
    v_mfma_f32_16x16x32_bf16 v[48:51], a[160:163], a[132:135], v[48:51]
    v_cvt_pk_bf16_f32 v92, v92, v93
    v_cvt_pk_bf16_f32 v93, v94, v95
    v_mfma_f32_16x16x32_bf16 v[52:55], a[160:163], a[136:139], v[52:55]
    ds_write_b64 v14, v[92:93] offset:12288
    s_waitcnt lgkmcnt(10)
    v_mfma_f32_16x16x32_bf16 v[36:39], a[164:167], a[140:143], v[36:39]
    v_mfma_f32_16x16x32_bf16 v[40:43], a[164:167], a[144:147], v[40:43]
    v_mfma_f32_16x16x32_bf16 v[44:47], a[164:167], a[148:151], v[44:47]
    ds_read_b64_tr_b16 a[184:185], v10 offset:52480
    ds_read_b64_tr_b16 a[186:187], v12 offset:52480
    v_mfma_f32_16x16x32_bf16 v[48:51], a[164:167], a[152:155], v[48:51]
    buffer_load_dwordx4 v5, s[36:39], s22 offen offset:3264 nt lds
    v_mfma_f32_16x16x32_bf16 v[52:55], a[164:167], a[156:159], v[52:55]
    s_waitcnt lgkmcnt(10)
    v_mfma_f32_16x16x32_bf16 v[96:99], a[168:171], v[56:59], v[96:99]
    v_fma_f32 v36, v36, s23, v31
    v_fma_f32 v37, v37, s23, v31
    v_mfma_f32_16x16x32_bf16 v[100:103], a[168:171], v[60:63], v[100:103]
    v_fma_f32 v38, v38, s23, v31
    v_fma_f32 v39, v39, s23, v31
    v_mfma_f32_16x16x32_bf16 v[104:107], a[168:171], v[64:67], v[104:107]
    ds_read_b64_tr_b16 a[188:189], v11 offset:52480
    ds_read_b64_tr_b16 a[190:191], v13 offset:52480
    v_mfma_f32_16x16x32_bf16 v[108:111], a[168:171], v[68:71], v[108:111]
    v_exp_f32 v36, v36
    v_mfma_f32_16x16x32_bf16 v[112:115], a[168:171], v[72:75], v[112:115]
    v_exp_f32 v37, v37
    s_waitcnt lgkmcnt(9)
    v_mfma_f32_16x16x32_bf16 v[116:119], a[172:175], v[56:59], v[116:119]
    v_exp_f32 v38, v38
    v_mfma_f32_16x16x32_bf16 v[120:123], a[172:175], v[60:63], v[120:123]
    v_exp_f32 v39, v39
    v_mfma_f32_16x16x32_bf16 v[124:127], a[172:175], v[64:67], v[124:127]
    ds_read_b64_tr_b16 a[192:193], v10 offset:52608
    ds_read_b64_tr_b16 a[194:195], v12 offset:52608
    v_mfma_f32_16x16x32_bf16 v[128:131], a[172:175], v[68:71], v[128:131]
    v_add_f32 v26, v26, v36
    v_add_f32 v26, v26, v37
    v_mfma_f32_16x16x32_bf16 v[132:135], a[172:175], v[72:75], v[132:135]
    v_add_f32 v26, v26, v38
    s_waitcnt lgkmcnt(9)
    v_mfma_f32_16x16x32_bf16 v[136:139], a[176:179], v[56:59], v[136:139]
    v_add_f32 v26, v26, v39
    v_cvt_pk_bf16_f32 v36, v36, v37
    v_mfma_f32_16x16x32_bf16 v[140:143], a[176:179], v[60:63], v[140:143]
    v_cvt_pk_bf16_f32 v37, v38, v39
    v_fma_f32 v40, v40, s23, v32
    v_mfma_f32_16x16x32_bf16 v[144:147], a[176:179], v[64:67], v[144:147]
    ds_read_b64_tr_b16 a[196:197], v11 offset:52608
    ds_read_b64_tr_b16 a[198:199], v13 offset:52608
    v_mfma_f32_16x16x32_bf16 v[148:151], a[176:179], v[68:71], v[148:151]
    v_fma_f32 v41, v41, s23, v32
    v_fma_f32 v42, v42, s23, v32
    v_mfma_f32_16x16x32_bf16 v[152:155], a[176:179], v[72:75], v[152:155]
    v_fma_f32 v43, v43, s23, v32
    s_waitcnt lgkmcnt(9)
    v_mfma_f32_16x16x32_bf16 v[156:159], a[180:183], v[56:59], v[156:159]
    v_exp_f32 v40, v40
    v_mfma_f32_16x16x32_bf16 v[160:163], a[180:183], v[60:63], v[160:163]
    v_exp_f32 v41, v41
    v_mfma_f32_16x16x32_bf16 v[164:167], a[180:183], v[64:67], v[164:167]
    v_exp_f32 v42, v42
    v_mfma_f32_16x16x32_bf16 v[168:171], a[180:183], v[68:71], v[168:171]
    v_exp_f32 v43, v43
    v_mfma_f32_16x16x32_bf16 v[172:175], a[180:183], v[72:75], v[172:175]
    v_add_f32 v27, v27, v40
    s_waitcnt lgkmcnt(6)
    v_mfma_f32_16x16x32_bf16 v[176:179], a[184:187], v[56:59], v[176:179]
    v_add_f32 v27, v27, v41
    v_add_f32 v27, v27, v42
    v_mfma_f32_16x16x32_bf16 v[180:183], a[184:187], v[60:63], v[180:183]
    v_add_f32 v27, v27, v43
    v_cvt_pk_bf16_f32 v40, v40, v41
    v_mfma_f32_16x16x32_bf16 v[184:187], a[184:187], v[64:67], v[184:187]
    v_cvt_pk_bf16_f32 v41, v42, v43
    v_fma_f32 v44, v44, s23, v33
    v_mfma_f32_16x16x32_bf16 v[188:191], a[184:187], v[68:71], v[188:191]
    v_fma_f32 v45, v45, s23, v33
    v_fma_f32 v46, v46, s23, v33
    v_mfma_f32_16x16x32_bf16 v[192:195], a[184:187], v[72:75], v[192:195]
    v_fma_f32 v47, v47, s23, v33
    s_waitcnt lgkmcnt(4)
    v_mfma_f32_16x16x32_bf16 v[196:199], a[188:191], v[56:59], v[196:199]
    v_exp_f32 v44, v44
    v_mfma_f32_16x16x32_bf16 v[200:203], a[188:191], v[60:63], v[200:203]
    v_exp_f32 v45, v45
    v_mfma_f32_16x16x32_bf16 v[204:207], a[188:191], v[64:67], v[204:207]
    v_exp_f32 v46, v46
    v_mfma_f32_16x16x32_bf16 v[208:211], a[188:191], v[68:71], v[208:211]
    v_exp_f32 v47, v47
    v_mfma_f32_16x16x32_bf16 v[212:215], a[188:191], v[72:75], v[212:215]
    s_waitcnt vmcnt(8) lgkmcnt(0)
    s_barrier
    v_mfma_f32_16x16x32_bf16 v[216:219], a[192:195], v[56:59], v[216:219]
    v_add_u32 v24, 0x15400, v24
    ds_read_b128 a[224:227], v24
    v_mfma_f32_16x16x32_bf16 v[220:223], a[192:195], v[60:63], v[220:223]
    s_add_u32 m0, s21, 121856
    s_mov_b32 s22, 245760
    buffer_load_dwordx4 v2, s[32:35], s22 offen nt lds
    v_mfma_f32_16x16x32_bf16 v[224:227], a[192:195], v[64:67], v[224:227]
    v_add_u32 v25, 0x15400, v25
    ds_read_b128 a[228:231], v25
    v_mfma_f32_16x16x32_bf16 v[228:231], a[192:195], v[68:71], v[228:231]
    ds_read_b64 v[78:79], v19 offset:10240
    ds_read_b128 a[232:235], v24 offset:128
    v_mfma_f32_16x16x32_bf16 v[232:235], a[192:195], v[72:75], v[232:235]
    ds_write_b64 v14, v[36:37]
    v_mfma_f32_16x16x32_bf16 v[236:239], a[196:199], v[56:59], v[236:239]
    ds_read_b64 v[82:83], v19 offset:10752
    ds_read_b64 v[86:87], v19 offset:11264
    v_mfma_f32_16x16x32_bf16 v[240:243], a[196:199], v[60:63], v[240:243]
    ds_read_b64 v[90:91], v19 offset:11776
    ds_read_b64 v[94:95], v19 offset:12288
    v_mfma_f32_16x16x32_bf16 v[244:247], a[196:199], v[64:67], v[244:247]
    ds_read_b128 a[236:239], v25 offset:128
    ds_read_b128 a[240:243], v24 offset:256
    v_mfma_f32_16x16x32_bf16 v[248:251], a[196:199], v[68:71], v[248:251]
    ds_write_b64 v14, v[40:41] offset:512
    v_mfma_f32_16x16x32_bf16 v[252:255], a[196:199], v[72:75], v[252:255]
    v_add_f32 v28, v28, v44
    s_waitcnt lgkmcnt(11)
    v_mfma_f32_16x16x32_bf16 v[56:59], a[224:227], a[0:3], 0
    v_add_f32 v28, v28, v45
    v_add_f32 v28, v28, v46
    v_mfma_f32_16x16x32_bf16 v[60:63], a[224:227], a[4:7], 0
    v_add_f32 v28, v28, v47
    v_cvt_pk_bf16_f32 v44, v44, v45
    v_mfma_f32_16x16x32_bf16 v[64:67], a[224:227], a[8:11], 0
    ds_read_b128 a[244:247], v25 offset:256
    v_cvt_pk_bf16_f32 v45, v46, v47
    v_mfma_f32_16x16x32_bf16 v[68:71], a[224:227], a[12:15], 0
    ds_write_b64 v14, v[44:45] offset:1024
    v_mfma_f32_16x16x32_bf16 v[72:75], a[224:227], a[16:19], 0
    buffer_load_dwordx4 v3, s[32:35], s22 offen offset:1088 nt lds
    s_waitcnt lgkmcnt(12)
    v_mfma_f32_16x16x32_bf16 v[56:59], a[228:231], a[20:23], v[56:59]
    v_fma_f32 v48, v48, s23, v34
    v_fma_f32 v49, v49, s23, v34
    v_mfma_f32_16x16x32_bf16 v[60:63], a[228:231], a[24:27], v[60:63]
    v_fma_f32 v50, v50, s23, v34
    v_fma_f32 v51, v51, s23, v34
    v_mfma_f32_16x16x32_bf16 v[64:67], a[228:231], a[28:31], v[64:67]
    ds_read_b128 a[248:251], v24 offset:384
    v_mfma_f32_16x16x32_bf16 v[68:71], a[228:231], a[32:35], v[68:71]
    v_exp_f32 v48, v48
    v_mfma_f32_16x16x32_bf16 v[72:75], a[228:231], a[36:39], v[72:75]
    v_exp_f32 v49, v49
    s_waitcnt lgkmcnt(11)
    v_mfma_f32_16x16x32_bf16 v[56:59], a[232:235], a[40:43], v[56:59]
    v_exp_f32 v50, v50
    v_mfma_f32_16x16x32_bf16 v[60:63], a[232:235], a[44:47], v[60:63]
    v_exp_f32 v51, v51
    v_mfma_f32_16x16x32_bf16 v[64:67], a[232:235], a[48:51], v[64:67]
    ds_read_b128 a[252:255], v25 offset:384
    v_add_f32 v29, v29, v48
    v_mfma_f32_16x16x32_bf16 v[68:71], a[232:235], a[52:55], v[68:71]
    v_add_f32 v29, v29, v49
    v_add_f32 v29, v29, v50
    v_mfma_f32_16x16x32_bf16 v[72:75], a[232:235], a[56:59], v[72:75]
    buffer_load_dwordx4 v4, s[32:35], s22 offen offset:2176 nt lds
    s_waitcnt lgkmcnt(6)
    v_mfma_f32_16x16x32_bf16 v[56:59], a[236:239], a[60:63], v[56:59]
    v_add_f32 v29, v29, v51
    v_cvt_pk_bf16_f32 v48, v48, v49
    v_mfma_f32_16x16x32_bf16 v[60:63], a[236:239], a[64:67], v[60:63]
    v_cvt_pk_bf16_f32 v49, v50, v51
    v_fma_f32 v52, v52, s23, v35
    v_mfma_f32_16x16x32_bf16 v[64:67], a[236:239], a[68:71], v[64:67]
    ds_read_b64_tr_b16 a[216:217], v10 offset:34816
    ds_read_b64_tr_b16 a[218:219], v12 offset:34816
    v_mfma_f32_16x16x32_bf16 v[68:71], a[236:239], a[72:75], v[68:71]
    ds_write_b64 v14, v[48:49] offset:1536
    v_mfma_f32_16x16x32_bf16 v[72:75], a[236:239], a[76:79], v[72:75]
    v_fma_f32 v53, v53, s23, v35
    s_waitcnt lgkmcnt(8)
    v_mfma_f32_16x16x32_bf16 v[56:59], a[240:243], a[80:83], v[56:59]
    v_fma_f32 v54, v54, s23, v35
    v_fma_f32 v55, v55, s23, v35
    v_mfma_f32_16x16x32_bf16 v[60:63], a[240:243], a[84:87], v[60:63]
    v_exp_f32 v52, v52
    v_mfma_f32_16x16x32_bf16 v[64:67], a[240:243], a[88:91], v[64:67]
    buffer_load_dwordx4 v5, s[32:35], s22 offen offset:3264 nt lds
    ds_read_b64_tr_b16 a[220:221], v11 offset:34816
    v_mfma_f32_16x16x32_bf16 v[68:71], a[240:243], a[92:95], v[68:71]
    ds_read_b64_tr_b16 a[222:223], v13 offset:34816
    v_mfma_f32_16x16x32_bf16 v[72:75], a[240:243], a[96:99], v[72:75]
    v_exp_f32 v53, v53
    s_waitcnt lgkmcnt(8)
    v_mfma_f32_16x16x32_bf16 v[56:59], a[244:247], a[100:103], v[56:59]
    v_exp_f32 v54, v54
    v_mfma_f32_16x16x32_bf16 v[60:63], a[244:247], a[104:107], v[60:63]
    v_exp_f32 v55, v55
    v_mfma_f32_16x16x32_bf16 v[64:67], a[244:247], a[108:111], v[64:67]
    ds_read_b64_tr_b16 a[200:201], v10 offset:34944
    ds_read_b64_tr_b16 a[202:203], v12 offset:34944
    v_mfma_f32_16x16x32_bf16 v[68:71], a[244:247], a[112:115], v[68:71]
    v_add_f32 v30, v30, v52
    v_add_f32 v30, v30, v53
    v_mfma_f32_16x16x32_bf16 v[72:75], a[244:247], a[116:119], v[72:75]
    v_add_f32 v30, v30, v54
    s_waitcnt lgkmcnt(8)
    v_mfma_f32_16x16x32_bf16 v[56:59], a[248:251], a[120:123], v[56:59]
    s_add_u32 m0, s21, 0
    s_mov_b32 s22, 212992
    buffer_load_dwordx4 v2, s[36:39], s22 offen nt lds
    v_mfma_f32_16x16x32_bf16 v[60:63], a[248:251], a[124:127], v[60:63]
    v_add_f32 v30, v30, v55
    v_cvt_pk_bf16_f32 v52, v52, v53
    v_mfma_f32_16x16x32_bf16 v[64:67], a[248:251], a[128:131], v[64:67]
    ds_read_b64_tr_b16 a[204:205], v11 offset:34944
    ds_read_b64_tr_b16 a[206:207], v13 offset:34944
    v_mfma_f32_16x16x32_bf16 v[68:71], a[248:251], a[132:135], v[68:71]
    v_cvt_pk_bf16_f32 v53, v54, v55
    v_mfma_f32_16x16x32_bf16 v[72:75], a[248:251], a[136:139], v[72:75]
    ds_write_b64 v14, v[52:53] offset:2048
    s_waitcnt lgkmcnt(10)
    v_mfma_f32_16x16x32_bf16 v[56:59], a[252:255], a[140:143], v[56:59]
    v_mfma_f32_16x16x32_bf16 v[60:63], a[252:255], a[144:147], v[60:63]
    v_mfma_f32_16x16x32_bf16 v[64:67], a[252:255], a[148:151], v[64:67]
    ds_read_b64_tr_b16 a[208:209], v10 offset:35072
    ds_read_b64_tr_b16 a[210:211], v12 offset:35072
    v_mfma_f32_16x16x32_bf16 v[68:71], a[252:255], a[152:155], v[68:71]
    buffer_load_dwordx4 v3, s[36:39], s22 offen offset:1088 nt lds
    v_mfma_f32_16x16x32_bf16 v[72:75], a[252:255], a[156:159], v[72:75]
    s_waitcnt lgkmcnt(10)
    v_mfma_f32_16x16x32_bf16 v[96:99], a[216:219], v[76:79], v[96:99]
    v_fma_f32 v56, v56, s23, v31
    v_fma_f32 v57, v57, s23, v31
    v_mfma_f32_16x16x32_bf16 v[100:103], a[216:219], v[80:83], v[100:103]
    v_fma_f32 v58, v58, s23, v31
    v_fma_f32 v59, v59, s23, v31
    v_mfma_f32_16x16x32_bf16 v[104:107], a[216:219], v[84:87], v[104:107]
    ds_read_b64_tr_b16 a[212:213], v11 offset:35072
    ds_read_b64_tr_b16 a[214:215], v13 offset:35072
    v_mfma_f32_16x16x32_bf16 v[108:111], a[216:219], v[88:91], v[108:111]
    v_exp_f32 v56, v56
    v_mfma_f32_16x16x32_bf16 v[112:115], a[216:219], v[92:95], v[112:115]
    v_exp_f32 v57, v57
    s_waitcnt lgkmcnt(9)
    v_mfma_f32_16x16x32_bf16 v[116:119], a[220:223], v[76:79], v[116:119]
    v_exp_f32 v58, v58
    v_mfma_f32_16x16x32_bf16 v[120:123], a[220:223], v[80:83], v[120:123]
    buffer_load_dwordx4 v4, s[36:39], s22 offen offset:2176 nt lds
    v_mfma_f32_16x16x32_bf16 v[124:127], a[220:223], v[84:87], v[124:127]
    ds_read_b64_tr_b16 a[160:161], v10 offset:35200
    ds_read_b64_tr_b16 a[162:163], v12 offset:35200
    v_mfma_f32_16x16x32_bf16 v[128:131], a[220:223], v[88:91], v[128:131]
    v_exp_f32 v59, v59
    v_mfma_f32_16x16x32_bf16 v[132:135], a[220:223], v[92:95], v[132:135]
    v_add_f32 v26, v26, v56
    s_waitcnt lgkmcnt(9)
    v_mfma_f32_16x16x32_bf16 v[136:139], a[200:203], v[76:79], v[136:139]
    v_add_f32 v26, v26, v57
    v_add_f32 v26, v26, v58
    v_mfma_f32_16x16x32_bf16 v[140:143], a[200:203], v[80:83], v[140:143]
    v_add_f32 v26, v26, v59
    v_cvt_pk_bf16_f32 v56, v56, v57
    v_mfma_f32_16x16x32_bf16 v[144:147], a[200:203], v[84:87], v[144:147]
    ds_read_b64_tr_b16 a[164:165], v11 offset:35200
    ds_read_b64_tr_b16 a[166:167], v13 offset:35200
    v_mfma_f32_16x16x32_bf16 v[148:151], a[200:203], v[88:91], v[148:151]
    v_cvt_pk_bf16_f32 v57, v58, v59
    v_fma_f32 v60, v60, s23, v32
    v_mfma_f32_16x16x32_bf16 v[152:155], a[200:203], v[92:95], v[152:155]
    buffer_load_dwordx4 v5, s[36:39], s22 offen offset:3264 nt lds
    s_waitcnt lgkmcnt(9)
    v_mfma_f32_16x16x32_bf16 v[156:159], a[204:207], v[76:79], v[156:159]
    v_fma_f32 v61, v61, s23, v32
    v_fma_f32 v62, v62, s23, v32
    v_mfma_f32_16x16x32_bf16 v[160:163], a[204:207], v[80:83], v[160:163]
    v_fma_f32 v63, v63, s23, v32
    v_mfma_f32_16x16x32_bf16 v[164:167], a[204:207], v[84:87], v[164:167]
    v_exp_f32 v60, v60
    v_mfma_f32_16x16x32_bf16 v[168:171], a[204:207], v[88:91], v[168:171]
    v_exp_f32 v61, v61
    v_mfma_f32_16x16x32_bf16 v[172:175], a[204:207], v[92:95], v[172:175]
    v_exp_f32 v62, v62
    s_waitcnt lgkmcnt(6)
    v_mfma_f32_16x16x32_bf16 v[176:179], a[208:211], v[76:79], v[176:179]
    v_exp_f32 v63, v63
    v_mfma_f32_16x16x32_bf16 v[180:183], a[208:211], v[80:83], v[180:183]
    v_add_f32 v27, v27, v60
    v_add_f32 v27, v27, v61
    v_mfma_f32_16x16x32_bf16 v[184:187], a[208:211], v[84:87], v[184:187]
    v_add_f32 v27, v27, v62
    v_add_f32 v27, v27, v63
    v_mfma_f32_16x16x32_bf16 v[188:191], a[208:211], v[88:91], v[188:191]
    v_cvt_pk_bf16_f32 v60, v60, v61
    v_cvt_pk_bf16_f32 v61, v62, v63
    v_mfma_f32_16x16x32_bf16 v[192:195], a[208:211], v[92:95], v[192:195]
    v_fma_f32 v64, v64, s23, v33
    s_waitcnt lgkmcnt(4)
    v_mfma_f32_16x16x32_bf16 v[196:199], a[212:215], v[76:79], v[196:199]
    v_fma_f32 v65, v65, s23, v33
    v_fma_f32 v66, v66, s23, v33
    v_mfma_f32_16x16x32_bf16 v[200:203], a[212:215], v[80:83], v[200:203]
    v_fma_f32 v67, v67, s23, v33
    v_mfma_f32_16x16x32_bf16 v[204:207], a[212:215], v[84:87], v[204:207]
    v_exp_f32 v64, v64
    v_mfma_f32_16x16x32_bf16 v[208:211], a[212:215], v[88:91], v[208:211]
    v_exp_f32 v65, v65
    v_mfma_f32_16x16x32_bf16 v[212:215], a[212:215], v[92:95], v[212:215]
    s_waitcnt vmcnt(8) lgkmcnt(0)
    s_barrier
    v_mfma_f32_16x16x32_bf16 v[216:219], a[160:163], v[76:79], v[216:219]
    v_add_u32 v24, 0xffff7800, v24
    ds_read_b128 a[168:171], v24
    v_mfma_f32_16x16x32_bf16 v[220:223], a[160:163], v[80:83], v[220:223]
    v_add_u32 v25, 0xffff7800, v25
    ds_read_b128 a[172:175], v25
    v_mfma_f32_16x16x32_bf16 v[224:227], a[160:163], v[84:87], v[224:227]
    ds_read_b64 v[38:39], v19
    ds_read_b128 a[176:179], v24 offset:128
    v_mfma_f32_16x16x32_bf16 v[228:231], a[160:163], v[88:91], v[228:231]
    ds_write_b64 v14, v[56:57] offset:10240
    v_mfma_f32_16x16x32_bf16 v[232:235], a[160:163], v[92:95], v[232:235]
    ds_read_b64 v[42:43], v19 offset:512
    ds_read_b64 v[46:47], v19 offset:1024
    v_mfma_f32_16x16x32_bf16 v[236:239], a[164:167], v[76:79], v[236:239]
    ds_read_b64 v[50:51], v19 offset:1536
    ds_read_b64 v[54:55], v19 offset:2048
    v_mfma_f32_16x16x32_bf16 v[240:243], a[164:167], v[80:83], v[240:243]
    ds_read_b128 a[180:183], v25 offset:128
    v_mfma_f32_16x16x32_bf16 v[244:247], a[164:167], v[84:87], v[244:247]
    ds_read_b128 a[184:187], v24 offset:256
    v_mfma_f32_16x16x32_bf16 v[248:251], a[164:167], v[88:91], v[248:251]
    ds_write_b64 v14, v[60:61] offset:10752
    v_mfma_f32_16x16x32_bf16 v[252:255], a[164:167], v[92:95], v[252:255]
    v_exp_f32 v66, v66
    s_waitcnt lgkmcnt(11)
    v_mfma_f32_16x16x32_bf16 v[76:79], a[168:171], a[0:3], 0
    v_exp_f32 v67, v67
    v_mfma_f32_16x16x32_bf16 v[80:83], a[168:171], a[4:7], 0
    v_add_f32 v28, v28, v64
    v_add_f32 v28, v28, v65
    v_mfma_f32_16x16x32_bf16 v[84:87], a[168:171], a[8:11], 0
    ds_read_b128 a[188:191], v25 offset:256
    v_add_f32 v28, v28, v66
    v_mfma_f32_16x16x32_bf16 v[88:91], a[168:171], a[12:15], 0
    v_add_f32 v28, v28, v67
    v_cvt_pk_bf16_f32 v64, v64, v65
    v_mfma_f32_16x16x32_bf16 v[92:95], a[168:171], a[16:19], 0
    v_cvt_pk_bf16_f32 v65, v66, v67
    s_waitcnt lgkmcnt(11)
    v_mfma_f32_16x16x32_bf16 v[76:79], a[172:175], a[20:23], v[76:79]
    ds_write_b64 v14, v[64:65] offset:11264
    v_mfma_f32_16x16x32_bf16 v[80:83], a[172:175], a[24:27], v[80:83]
    v_fma_f32 v68, v68, s23, v34
    v_fma_f32 v69, v69, s23, v34
    v_mfma_f32_16x16x32_bf16 v[84:87], a[172:175], a[28:31], v[84:87]
    ds_read_b128 a[192:195], v24 offset:384
    v_fma_f32 v70, v70, s23, v34
    v_mfma_f32_16x16x32_bf16 v[88:91], a[172:175], a[32:35], v[88:91]
    v_fma_f32 v71, v71, s23, v34
    v_mfma_f32_16x16x32_bf16 v[92:95], a[172:175], a[36:39], v[92:95]
    v_exp_f32 v68, v68
    s_waitcnt lgkmcnt(11)
    v_mfma_f32_16x16x32_bf16 v[76:79], a[176:179], a[40:43], v[76:79]
    v_exp_f32 v69, v69
    v_mfma_f32_16x16x32_bf16 v[80:83], a[176:179], a[44:47], v[80:83]
    v_exp_f32 v70, v70
    v_mfma_f32_16x16x32_bf16 v[84:87], a[176:179], a[48:51], v[84:87]
    ds_read_b128 a[196:199], v25 offset:384
    v_mfma_f32_16x16x32_bf16 v[88:91], a[176:179], a[52:55], v[88:91]
    v_exp_f32 v71, v71
    v_mfma_f32_16x16x32_bf16 v[92:95], a[176:179], a[56:59], v[92:95]
    s_add_u32 m0, s21, 17408
    s_mov_b32 s22, 229376
    buffer_load_dwordx4 v2, s[36:39], s22 offen nt lds
    s_waitcnt lgkmcnt(6)
    v_mfma_f32_16x16x32_bf16 v[76:79], a[180:183], a[60:63], v[76:79]
    v_add_f32 v29, v29, v68
    v_add_f32 v29, v29, v69
    v_mfma_f32_16x16x32_bf16 v[80:83], a[180:183], a[64:67], v[80:83]
    v_add_f32 v29, v29, v70
    v_add_f32 v29, v29, v71
    v_mfma_f32_16x16x32_bf16 v[84:87], a[180:183], a[68:71], v[84:87]
    v_add_u32 v10, 0x15400, v10
    ds_read_b64_tr_b16 a[224:225], v10
    v_mfma_f32_16x16x32_bf16 v[88:91], a[180:183], a[72:75], v[88:91]
    v_add_u32 v12, 0x15400, v12
    ds_read_b64_tr_b16 a[226:227], v12
    v_mfma_f32_16x16x32_bf16 v[92:95], a[180:183], a[76:79], v[92:95]
    v_cvt_pk_bf16_f32 v68, v68, v69
    s_waitcnt lgkmcnt(7)
    v_mfma_f32_16x16x32_bf16 v[76:79], a[184:187], a[80:83], v[76:79]
    v_cvt_pk_bf16_f32 v69, v70, v71
    v_fma_f32 v72, v72, s23, v35
    v_mfma_f32_16x16x32_bf16 v[80:83], a[184:187], a[84:87], v[80:83]
    ds_write_b64 v14, v[68:69] offset:11776
    v_mfma_f32_16x16x32_bf16 v[84:87], a[184:187], a[88:91], v[84:87]
    buffer_load_dwordx4 v3, s[36:39], s22 offen offset:1088 nt lds
    v_add_u32 v11, 0x15400, v11
    ds_read_b64_tr_b16 a[228:229], v11
    v_mfma_f32_16x16x32_bf16 v[88:91], a[184:187], a[92:95], v[88:91]
    v_add_u32 v13, 0x15400, v13
    ds_read_b64_tr_b16 a[230:231], v13
    v_mfma_f32_16x16x32_bf16 v[92:95], a[184:187], a[96:99], v[92:95]
    v_fma_f32 v73, v73, s23, v35
    s_waitcnt lgkmcnt(8)
    v_mfma_f32_16x16x32_bf16 v[76:79], a[188:191], a[100:103], v[76:79]
    v_fma_f32 v74, v74, s23, v35
    v_fma_f32 v75, v75, s23, v35
    v_mfma_f32_16x16x32_bf16 v[80:83], a[188:191], a[104:107], v[80:83]
    v_exp_f32 v72, v72
    v_mfma_f32_16x16x32_bf16 v[84:87], a[188:191], a[108:111], v[84:87]
    ds_read_b64_tr_b16 a[232:233], v10 offset:128
    ds_read_b64_tr_b16 a[234:235], v12 offset:128
    v_mfma_f32_16x16x32_bf16 v[88:91], a[188:191], a[112:115], v[88:91]
    v_exp_f32 v73, v73
    v_mfma_f32_16x16x32_bf16 v[92:95], a[188:191], a[116:119], v[92:95]
    v_exp_f32 v74, v74
    s_waitcnt lgkmcnt(8)
    v_mfma_f32_16x16x32_bf16 v[76:79], a[192:195], a[120:123], v[76:79]
    buffer_load_dwordx4 v4, s[36:39], s22 offen offset:2176 nt lds
    v_mfma_f32_16x16x32_bf16 v[80:83], a[192:195], a[124:127], v[80:83]
    v_exp_f32 v75, v75
    v_mfma_f32_16x16x32_bf16 v[84:87], a[192:195], a[128:131], v[84:87]
    ds_read_b64_tr_b16 a[236:237], v11 offset:128
    ds_read_b64_tr_b16 a[238:239], v13 offset:128
    v_mfma_f32_16x16x32_bf16 v[88:91], a[192:195], a[132:135], v[88:91]
    v_add_f32 v30, v30, v72
    v_add_f32 v30, v30, v73
    v_mfma_f32_16x16x32_bf16 v[92:95], a[192:195], a[136:139], v[92:95]
    v_add_f32 v30, v30, v74
    s_waitcnt lgkmcnt(9)
    v_mfma_f32_16x16x32_bf16 v[76:79], a[196:199], a[140:143], v[76:79]
    v_add_f32 v30, v30, v75
    v_cvt_pk_bf16_f32 v72, v72, v73
    v_mfma_f32_16x16x32_bf16 v[80:83], a[196:199], a[144:147], v[80:83]
    v_cvt_pk_bf16_f32 v73, v74, v75
    v_mfma_f32_16x16x32_bf16 v[84:87], a[196:199], a[148:151], v[84:87]
    ds_read_b64_tr_b16 a[240:241], v10 offset:256
    ds_read_b64_tr_b16 a[242:243], v12 offset:256
    v_mfma_f32_16x16x32_bf16 v[88:91], a[196:199], a[152:155], v[88:91]
    buffer_load_dwordx4 v5, s[36:39], s22 offen offset:3264 nt lds
    v_fma_f32 v76, v76, s23, v31
    v_mfma_f32_16x16x32_bf16 v[92:95], a[196:199], a[156:159], v[92:95]
    ds_write_b64 v14, v[72:73] offset:12288
    s_waitcnt lgkmcnt(10)
    v_mfma_f32_16x16x32_bf16 v[96:99], a[224:227], v[36:39], v[96:99]
    v_fma_f32 v77, v77, s23, v31
    v_fma_f32 v78, v78, s23, v31
    v_mfma_f32_16x16x32_bf16 v[100:103], a[224:227], v[40:43], v[100:103]
    v_fma_f32 v79, v79, s23, v31
    v_mfma_f32_16x16x32_bf16 v[104:107], a[224:227], v[44:47], v[104:107]
    ds_read_b64_tr_b16 a[244:245], v11 offset:256
    ds_read_b64_tr_b16 a[246:247], v13 offset:256
    v_mfma_f32_16x16x32_bf16 v[108:111], a[224:227], v[48:51], v[108:111]
    v_exp_f32 v76, v76
    v_mfma_f32_16x16x32_bf16 v[112:115], a[224:227], v[52:55], v[112:115]
    v_exp_f32 v77, v77
    s_waitcnt lgkmcnt(9)
    v_mfma_f32_16x16x32_bf16 v[116:119], a[228:231], v[36:39], v[116:119]
    v_exp_f32 v78, v78
    v_mfma_f32_16x16x32_bf16 v[120:123], a[228:231], v[40:43], v[120:123]
    v_exp_f32 v79, v79
    v_mfma_f32_16x16x32_bf16 v[124:127], a[228:231], v[44:47], v[124:127]
    ds_read_b64_tr_b16 a[248:249], v10 offset:384
    ds_read_b64_tr_b16 a[250:251], v12 offset:384
    v_mfma_f32_16x16x32_bf16 v[128:131], a[228:231], v[48:51], v[128:131]
    v_add_f32 v26, v26, v76
    v_add_f32 v26, v26, v77
    v_mfma_f32_16x16x32_bf16 v[132:135], a[228:231], v[52:55], v[132:135]
    v_add_f32 v26, v26, v78
    s_waitcnt lgkmcnt(9)
    v_mfma_f32_16x16x32_bf16 v[136:139], a[232:235], v[36:39], v[136:139]
    v_add_f32 v26, v26, v79
    v_cvt_pk_bf16_f32 v76, v76, v77
    v_mfma_f32_16x16x32_bf16 v[140:143], a[232:235], v[40:43], v[140:143]
    v_cvt_pk_bf16_f32 v77, v78, v79
    v_fma_f32 v80, v80, s23, v32
    v_mfma_f32_16x16x32_bf16 v[144:147], a[232:235], v[44:47], v[144:147]
    ds_read_b64_tr_b16 a[252:253], v11 offset:384
    ds_read_b64_tr_b16 a[254:255], v13 offset:384
    v_mfma_f32_16x16x32_bf16 v[148:151], a[232:235], v[48:51], v[148:151]
    v_fma_f32 v81, v81, s23, v32
    v_fma_f32 v82, v82, s23, v32
    v_mfma_f32_16x16x32_bf16 v[152:155], a[232:235], v[52:55], v[152:155]
    s_add_u32 m0, s21, 52224
    s_mov_b32 s22, 245760
    buffer_load_dwordx4 v2, s[36:39], s22 offen nt lds
    s_waitcnt lgkmcnt(9)
    v_mfma_f32_16x16x32_bf16 v[156:159], a[236:239], v[36:39], v[156:159]
    v_fma_f32 v83, v83, s23, v32
    v_mfma_f32_16x16x32_bf16 v[160:163], a[236:239], v[40:43], v[160:163]
    v_exp_f32 v80, v80
    v_mfma_f32_16x16x32_bf16 v[164:167], a[236:239], v[44:47], v[164:167]
    v_exp_f32 v81, v81
    v_mfma_f32_16x16x32_bf16 v[168:171], a[236:239], v[48:51], v[168:171]
    v_exp_f32 v82, v82
    v_mfma_f32_16x16x32_bf16 v[172:175], a[236:239], v[52:55], v[172:175]
    v_exp_f32 v83, v83
    s_waitcnt lgkmcnt(7)
    v_mfma_f32_16x16x32_bf16 v[176:179], a[240:243], v[36:39], v[176:179]
    v_add_f32 v27, v27, v80
    v_add_f32 v27, v27, v81
    v_mfma_f32_16x16x32_bf16 v[180:183], a[240:243], v[40:43], v[180:183]
    v_add_f32 v27, v27, v82
    v_add_f32 v27, v27, v83
    v_mfma_f32_16x16x32_bf16 v[184:187], a[240:243], v[44:47], v[184:187]
    buffer_load_dwordx4 v3, s[36:39], s22 offen offset:1088 nt lds
    v_cvt_pk_bf16_f32 v80, v80, v81
    v_mfma_f32_16x16x32_bf16 v[188:191], a[240:243], v[48:51], v[188:191]
    v_cvt_pk_bf16_f32 v81, v82, v83
    v_fma_f32 v84, v84, s23, v33
    v_mfma_f32_16x16x32_bf16 v[192:195], a[240:243], v[52:55], v[192:195]
    v_fma_f32 v85, v85, s23, v33
    s_waitcnt lgkmcnt(4)
    v_mfma_f32_16x16x32_bf16 v[196:199], a[244:247], v[36:39], v[196:199]
    v_fma_f32 v86, v86, s23, v33
    v_fma_f32 v87, v87, s23, v33
    v_mfma_f32_16x16x32_bf16 v[200:203], a[244:247], v[40:43], v[200:203]
    v_exp_f32 v84, v84
    v_mfma_f32_16x16x32_bf16 v[204:207], a[244:247], v[44:47], v[204:207]
    v_exp_f32 v85, v85
    v_mfma_f32_16x16x32_bf16 v[208:211], a[244:247], v[48:51], v[208:211]
    v_exp_f32 v86, v86
    v_mfma_f32_16x16x32_bf16 v[212:215], a[244:247], v[52:55], v[212:215]
    s_waitcnt vmcnt(6) lgkmcnt(0)
    s_barrier
    v_mfma_f32_16x16x32_bf16 v[216:219], a[248:251], v[36:39], v[216:219]
    ds_read_b128 a[216:219], v24 offset:52224
    buffer_load_dwordx4 v4, s[36:39], s22 offen offset:2176 nt lds
    v_mfma_f32_16x16x32_bf16 v[220:223], a[248:251], v[40:43], v[220:223]
    ds_read_b128 a[220:223], v25 offset:52224
    ds_read_b64 v[58:59], v19 offset:10240
    v_mfma_f32_16x16x32_bf16 v[224:227], a[248:251], v[44:47], v[224:227]
    ds_write_b64 v14, v[76:77]
    v_mfma_f32_16x16x32_bf16 v[228:231], a[248:251], v[48:51], v[228:231]
    ds_read_b128 a[200:203], v24 offset:52352
    ds_read_b64 v[62:63], v19 offset:10752
    v_mfma_f32_16x16x32_bf16 v[232:235], a[248:251], v[52:55], v[232:235]
    ds_read_b64 v[66:67], v19 offset:11264
    ds_read_b64 v[70:71], v19 offset:11776
    v_mfma_f32_16x16x32_bf16 v[236:239], a[252:255], v[36:39], v[236:239]
    ds_read_b64 v[74:75], v19 offset:12288
    ds_read_b128 a[204:207], v25 offset:52352
    v_mfma_f32_16x16x32_bf16 v[240:243], a[252:255], v[40:43], v[240:243]
    ds_write_b64 v14, v[80:81] offset:512
    v_mfma_f32_16x16x32_bf16 v[244:247], a[252:255], v[44:47], v[244:247]
    ds_read_b128 a[208:211], v24 offset:52480
    v_mfma_f32_16x16x32_bf16 v[248:251], a[252:255], v[48:51], v[248:251]
    buffer_load_dwordx4 v5, s[36:39], s22 offen offset:3264 nt lds
    v_mfma_f32_16x16x32_bf16 v[252:255], a[252:255], v[52:55], v[252:255]
    v_exp_f32 v87, v87
    s_waitcnt lgkmcnt(11)
    v_mfma_f32_16x16x32_bf16 v[36:39], a[216:219], a[0:3], 0
    v_add_f32 v28, v28, v84
    v_add_f32 v28, v28, v85
    v_mfma_f32_16x16x32_bf16 v[40:43], a[216:219], a[4:7], 0
    v_add_f32 v28, v28, v86
    v_add_f32 v28, v28, v87
    v_mfma_f32_16x16x32_bf16 v[44:47], a[216:219], a[8:11], 0
    s_add_u32 m0, s60, 69632
    s_add_u32 s22, s89, 0
    buffer_load_dwordx4 v6, s[40:43], s22 offen lds
    v_mfma_f32_16x16x32_bf16 v[48:51], a[216:219], a[12:15], 0
    ds_read_b128 a[212:215], v25 offset:52480
    v_cvt_pk_bf16_f32 v84, v84, v85
    v_mfma_f32_16x16x32_bf16 v[52:55], a[216:219], a[16:19], 0
    v_cvt_pk_bf16_f32 v85, v86, v87
    s_waitcnt lgkmcnt(11)
    v_mfma_f32_16x16x32_bf16 v[36:39], a[220:223], a[20:23], v[36:39]
    ds_write_b64 v14, v[84:85] offset:1024
    v_mfma_f32_16x16x32_bf16 v[40:43], a[220:223], a[24:27], v[40:43]
    buffer_load_dwordx4 v7, s[40:43], s22 offen offset:1024 lds
    v_fma_f32 v88, v88, s23, v34
    v_mfma_f32_16x16x32_bf16 v[44:47], a[220:223], a[28:31], v[44:47]
    ds_read_b128 a[160:163], v24 offset:52608
    v_fma_f32 v89, v89, s23, v34
    v_mfma_f32_16x16x32_bf16 v[48:51], a[220:223], a[32:35], v[48:51]
    v_fma_f32 v90, v90, s23, v34
    v_fma_f32 v91, v91, s23, v34
    v_mfma_f32_16x16x32_bf16 v[52:55], a[220:223], a[36:39], v[52:55]
    v_exp_f32 v88, v88
    s_waitcnt lgkmcnt(10)
    v_mfma_f32_16x16x32_bf16 v[36:39], a[200:203], a[40:43], v[36:39]
    buffer_load_dwordx4 v8, s[40:43], s22 offen offset:2048 lds
    v_mfma_f32_16x16x32_bf16 v[40:43], a[200:203], a[44:47], v[40:43]
    v_exp_f32 v89, v89
    v_mfma_f32_16x16x32_bf16 v[44:47], a[200:203], a[48:51], v[44:47]
    ds_read_b128 a[164:167], v25 offset:52608
    v_mfma_f32_16x16x32_bf16 v[48:51], a[200:203], a[52:55], v[48:51]
    v_exp_f32 v90, v90
    v_mfma_f32_16x16x32_bf16 v[52:55], a[200:203], a[56:59], v[52:55]
    buffer_load_dwordx4 v9, s[40:43], s22 offen offset:3072 lds
    s_waitcnt lgkmcnt(6)
    v_mfma_f32_16x16x32_bf16 v[36:39], a[204:207], a[60:63], v[36:39]
    v_exp_f32 v91, v91
    v_mfma_f32_16x16x32_bf16 v[40:43], a[204:207], a[64:67], v[40:43]
    v_add_f32 v29, v29, v88
    v_add_f32 v29, v29, v89
    v_mfma_f32_16x16x32_bf16 v[44:47], a[204:207], a[68:71], v[44:47]
    v_add_u32 v10, 0xfffeac00, v10
    ds_read_b64_tr_b16 a[168:169], v10
    v_mfma_f32_16x16x32_bf16 v[48:51], a[204:207], a[72:75], v[48:51]
    v_add_u32 v12, 0xfffeac00, v12
    ds_read_b64_tr_b16 a[170:171], v12
    v_mfma_f32_16x16x32_bf16 v[52:55], a[204:207], a[76:79], v[52:55]
    v_add_f32 v29, v29, v90
    s_waitcnt lgkmcnt(6)
    v_mfma_f32_16x16x32_bf16 v[36:39], a[208:211], a[80:83], v[36:39]
    v_add_f32 v29, v29, v91
    v_cvt_pk_bf16_f32 v88, v88, v89
    v_mfma_f32_16x16x32_bf16 v[40:43], a[208:211], a[84:87], v[40:43]
    v_cvt_pk_bf16_f32 v89, v90, v91
    v_fma_f32 v92, v92, s23, v35
    v_mfma_f32_16x16x32_bf16 v[44:47], a[208:211], a[88:91], v[44:47]
    v_add_u32 v11, 0xfffeac00, v11
    ds_read_b64_tr_b16 a[172:173], v11
    v_mfma_f32_16x16x32_bf16 v[48:51], a[208:211], a[92:95], v[48:51]
    v_add_u32 v13, 0xfffeac00, v13
    ds_read_b64_tr_b16 a[174:175], v13
    v_mfma_f32_16x16x32_bf16 v[52:55], a[208:211], a[96:99], v[52:55]
    ds_write_b64 v14, v[88:89] offset:1536
    s_waitcnt lgkmcnt(8)
    v_mfma_f32_16x16x32_bf16 v[36:39], a[212:215], a[100:103], v[36:39]
    v_fma_f32 v93, v93, s23, v35
    v_fma_f32 v94, v94, s23, v35
    v_mfma_f32_16x16x32_bf16 v[40:43], a[212:215], a[104:107], v[40:43]
    v_fma_f32 v95, v95, s23, v35
    v_mfma_f32_16x16x32_bf16 v[44:47], a[212:215], a[108:111], v[44:47]
    ds_read_b64_tr_b16 a[176:177], v10 offset:128
    ds_read_b64_tr_b16 a[178:179], v12 offset:128
    v_mfma_f32_16x16x32_bf16 v[48:51], a[212:215], a[112:115], v[48:51]
    v_exp_f32 v92, v92
    v_mfma_f32_16x16x32_bf16 v[52:55], a[212:215], a[116:119], v[52:55]
    v_exp_f32 v93, v93
    s_waitcnt lgkmcnt(8)
    v_mfma_f32_16x16x32_bf16 v[36:39], a[160:163], a[120:123], v[36:39]
    v_exp_f32 v94, v94
    v_mfma_f32_16x16x32_bf16 v[40:43], a[160:163], a[124:127], v[40:43]
    v_exp_f32 v95, v95
    v_mfma_f32_16x16x32_bf16 v[44:47], a[160:163], a[128:131], v[44:47]
    ds_read_b64_tr_b16 a[180:181], v11 offset:128
    ds_read_b64_tr_b16 a[182:183], v13 offset:128
    v_mfma_f32_16x16x32_bf16 v[48:51], a[160:163], a[132:135], v[48:51]
    v_add_f32 v30, v30, v92
    v_add_f32 v30, v30, v93
    v_mfma_f32_16x16x32_bf16 v[52:55], a[160:163], a[136:139], v[52:55]
    v_add_f32 v30, v30, v94
    s_waitcnt lgkmcnt(9)
    v_mfma_f32_16x16x32_bf16 v[36:39], a[164:167], a[140:143], v[36:39]
    v_add_f32 v30, v30, v95
    v_cvt_pk_bf16_f32 v92, v92, v93
    v_mfma_f32_16x16x32_bf16 v[40:43], a[164:167], a[144:147], v[40:43]
    v_cvt_pk_bf16_f32 v93, v94, v95
    v_mfma_f32_16x16x32_bf16 v[44:47], a[164:167], a[148:151], v[44:47]
    s_nop 2
    v_fma_f32 v36, v36, s23, v31
    v_mfma_f32_16x16x32_bf16 v[48:51], a[164:167], a[152:155], v[48:51]
    v_fma_f32 v37, v37, s23, v31
    v_fma_f32 v38, v38, s23, v31
    v_mfma_f32_16x16x32_bf16 v[52:55], a[164:167], a[156:159], v[52:55]
    v_fma_f32 v39, v39, s23, v31
    s_waitcnt lgkmcnt(7)
    v_mfma_f32_16x16x32_bf16 v[96:99], a[168:171], v[56:59], v[96:99]
    v_exp_f32 v36, v36
    v_mfma_f32_16x16x32_bf16 v[100:103], a[168:171], v[60:63], v[100:103]
    v_exp_f32 v37, v37
    v_mfma_f32_16x16x32_bf16 v[104:107], a[168:171], v[64:67], v[104:107]
    v_exp_f32 v38, v38
    v_mfma_f32_16x16x32_bf16 v[108:111], a[168:171], v[68:71], v[108:111]
    v_exp_f32 v39, v39
    v_add_f32 v26, v26, v36
    v_mfma_f32_16x16x32_bf16 v[112:115], a[168:171], v[72:75], v[112:115]
    v_add_f32 v26, v26, v37
    s_waitcnt lgkmcnt(5)
    v_mfma_f32_16x16x32_bf16 v[116:119], a[172:175], v[56:59], v[116:119]
    v_add_f32 v26, v26, v38
    v_add_f32 v26, v26, v39
    v_mfma_f32_16x16x32_bf16 v[120:123], a[172:175], v[60:63], v[120:123]
    v_cvt_pk_bf16_f32 v36, v36, v37
    v_cvt_pk_bf16_f32 v37, v38, v39
    v_mfma_f32_16x16x32_bf16 v[124:127], a[172:175], v[64:67], v[124:127]
    v_fma_f32 v40, v40, s23, v32
    v_fma_f32 v41, v41, s23, v32
    v_mfma_f32_16x16x32_bf16 v[128:131], a[172:175], v[68:71], v[128:131]
    ds_read_b64_tr_b16 a[184:185], v10 offset:256
    ds_read_b64_tr_b16 a[186:187], v12 offset:256
    v_mfma_f32_16x16x32_bf16 v[132:135], a[172:175], v[72:75], v[132:135]
    v_fma_f32 v42, v42, s23, v32
    s_waitcnt lgkmcnt(4)
    v_mfma_f32_16x16x32_bf16 v[136:139], a[176:179], v[56:59], v[136:139]
    v_fma_f32 v43, v43, s23, v32
    ds_read_b64_tr_b16 a[188:189], v11 offset:256
    v_mfma_f32_16x16x32_bf16 v[140:143], a[176:179], v[60:63], v[140:143]
    v_exp_f32 v40, v40
    v_mfma_f32_16x16x32_bf16 v[144:147], a[176:179], v[64:67], v[144:147]
    v_exp_f32 v41, v41
    v_mfma_f32_16x16x32_bf16 v[148:151], a[176:179], v[68:71], v[148:151]
    v_exp_f32 v42, v42
    v_mfma_f32_16x16x32_bf16 v[152:155], a[176:179], v[72:75], v[152:155]
    ds_read_b64_tr_b16 a[190:191], v13 offset:256
    s_waitcnt lgkmcnt(4)
    v_mfma_f32_16x16x32_bf16 v[156:159], a[180:183], v[56:59], v[156:159]
    v_exp_f32 v43, v43
    v_mfma_f32_16x16x32_bf16 v[160:163], a[180:183], v[60:63], v[160:163]
    v_add_f32 v27, v27, v40
    v_add_f32 v27, v27, v41
    v_mfma_f32_16x16x32_bf16 v[164:167], a[180:183], v[64:67], v[164:167]
    v_add_f32 v27, v27, v42
    v_add_f32 v27, v27, v43
    v_mfma_f32_16x16x32_bf16 v[168:171], a[180:183], v[68:71], v[168:171]
    ds_read_b64_tr_b16 a[192:193], v10 offset:384
    ds_read_b64_tr_b16 a[194:195], v12 offset:384
    v_mfma_f32_16x16x32_bf16 v[172:175], a[180:183], v[72:75], v[172:175]
    v_cvt_pk_bf16_f32 v40, v40, v41
    s_waitcnt lgkmcnt(4)
    v_mfma_f32_16x16x32_bf16 v[176:179], a[184:187], v[56:59], v[176:179]
    ds_read_b64_tr_b16 a[196:197], v11 offset:384
    ds_read_b64_tr_b16 a[198:199], v13 offset:384
    v_mfma_f32_16x16x32_bf16 v[180:183], a[184:187], v[60:63], v[180:183]
    v_cvt_pk_bf16_f32 v41, v42, v43
    v_fma_f32 v44, v44, s23, v33
    v_mfma_f32_16x16x32_bf16 v[184:187], a[184:187], v[64:67], v[184:187]
    ds_write_b64 v14, v[92:93] offset:2048
    v_mfma_f32_16x16x32_bf16 v[188:191], a[184:187], v[68:71], v[188:191]
    v_fma_f32 v45, v45, s23, v33
    v_fma_f32 v46, v46, s23, v33
    v_mfma_f32_16x16x32_bf16 v[192:195], a[184:187], v[72:75], v[192:195]
    v_fma_f32 v47, v47, s23, v33
    s_waitcnt lgkmcnt(5)
    v_mfma_f32_16x16x32_bf16 v[196:199], a[188:191], v[56:59], v[196:199]
    v_exp_f32 v44, v44
    v_mfma_f32_16x16x32_bf16 v[200:203], a[188:191], v[60:63], v[200:203]
    v_exp_f32 v45, v45
    v_mfma_f32_16x16x32_bf16 v[204:207], a[188:191], v[64:67], v[204:207]
    v_exp_f32 v46, v46
    v_mfma_f32_16x16x32_bf16 v[208:211], a[188:191], v[68:71], v[208:211]
    v_exp_f32 v47, v47
    v_mfma_f32_16x16x32_bf16 v[212:215], a[188:191], v[72:75], v[212:215]
    s_waitcnt vmcnt(8) lgkmcnt(0)
    s_barrier
    ds_write_b64 v14, v[36:37] offset:10240
    ds_write_b64 v14, v[40:41] offset:10752
    v_mfma_f32_16x16x32_bf16 v[216:219], a[192:195], v[56:59], v[216:219]
    v_add_f32 v28, v28, v44
    v_add_f32 v28, v28, v45
    v_mfma_f32_16x16x32_bf16 v[220:223], a[192:195], v[60:63], v[220:223]
    ds_read_b64_tr_b16 a[224:225], v10 offset:17408
    ds_read_b64_tr_b16 a[226:227], v12 offset:17408
    v_mfma_f32_16x16x32_bf16 v[224:227], a[192:195], v[64:67], v[224:227]
    ds_read_b64 v[78:79], v19
    v_add_f32 v28, v28, v46
    s_add_u32 m0, s60, 87040
    s_add_u32 s22, s89, 114688
    buffer_load_dwordx4 v6, s[40:43], s22 offen lds
    v_mfma_f32_16x16x32_bf16 v[228:231], a[192:195], v[68:71], v[228:231]
    ds_read_b64 v[82:83], v19 offset:512
    v_add_f32 v28, v28, v47
    v_mfma_f32_16x16x32_bf16 v[232:235], a[192:195], v[72:75], v[232:235]
    ds_read_b64 v[86:87], v19 offset:1024
    v_cvt_pk_bf16_f32 v44, v44, v45
    v_mfma_f32_16x16x32_bf16 v[236:239], a[196:199], v[56:59], v[236:239]
    ds_read_b64 v[90:91], v19 offset:1536
    v_cvt_pk_bf16_f32 v45, v46, v47
    v_mfma_f32_16x16x32_bf16 v[240:243], a[196:199], v[60:63], v[240:243]
    ds_read_b64 v[94:95], v19 offset:2048
    buffer_load_dwordx4 v7, s[40:43], s22 offen offset:1024 lds
    v_mfma_f32_16x16x32_bf16 v[244:247], a[196:199], v[64:67], v[244:247]
    ds_write_b64 v14, v[44:45] offset:11264
    ds_read_b64_tr_b16 a[228:229], v11 offset:17408
    ds_read_b64_tr_b16 a[230:231], v13 offset:17408
    v_fma_f32 v48, v48, s23, v34
    v_mfma_f32_16x16x32_bf16 v[248:251], a[196:199], v[68:71], v[248:251]
    v_fma_f32 v49, v49, s23, v34
    v_fma_f32 v50, v50, s23, v34
    v_mfma_f32_16x16x32_bf16 v[252:255], a[196:199], v[72:75], v[252:255]
    v_fma_f32 v51, v51, s23, v34
    s_waitcnt lgkmcnt(7)
    v_mfma_f32_16x16x32_bf16 v[96:99], a[224:227], v[76:79], v[96:99]
    buffer_load_dwordx4 v8, s[40:43], s22 offen offset:2048 lds
    s_waitcnt lgkmcnt(6)
    v_mfma_f32_16x16x32_bf16 v[100:103], a[224:227], v[80:83], v[100:103]
    v_exp_f32 v48, v48
    s_waitcnt lgkmcnt(5)
    v_mfma_f32_16x16x32_bf16 v[104:107], a[224:227], v[84:87], v[104:107]
    ds_read_b64_tr_b16 a[232:233], v10 offset:17536
    ds_read_b64_tr_b16 a[234:235], v12 offset:17536
    v_exp_f32 v49, v49
    s_waitcnt lgkmcnt(6)
    v_mfma_f32_16x16x32_bf16 v[108:111], a[224:227], v[88:91], v[108:111]
    v_exp_f32 v50, v50
    s_waitcnt lgkmcnt(5)
    v_mfma_f32_16x16x32_bf16 v[112:115], a[224:227], v[92:95], v[112:115]
    v_exp_f32 v51, v51
    buffer_load_dwordx4 v9, s[40:43], s22 offen offset:3072 lds
    s_waitcnt lgkmcnt(2)
    v_mfma_f32_16x16x32_bf16 v[116:119], a[228:231], v[76:79], v[116:119]
    v_add_f32 v29, v29, v48
    v_add_f32 v29, v29, v49
    v_mfma_f32_16x16x32_bf16 v[120:123], a[228:231], v[80:83], v[120:123]
    ds_read_b64_tr_b16 a[236:237], v11 offset:17536
    ds_read_b64_tr_b16 a[238:239], v13 offset:17536
    v_mfma_f32_16x16x32_bf16 v[124:127], a[228:231], v[84:87], v[124:127]
    v_add_f32 v29, v29, v50
    v_add_f32 v29, v29, v51
    v_mfma_f32_16x16x32_bf16 v[128:131], a[228:231], v[88:91], v[128:131]
    v_cvt_pk_bf16_f32 v48, v48, v49
    v_cvt_pk_bf16_f32 v49, v50, v51
    v_mfma_f32_16x16x32_bf16 v[132:135], a[228:231], v[92:95], v[132:135]
    v_lshrrev_b32 v24, 7, v0
    v_mul_u32_u24 v24, 80, v24
    v_and_b32 v25, 15, v0
    v_add_u32 v24, v24, v25
    v_bfe_u32 v25, v0, 6, 1
    v_lshlrev_b32 v25, 2, v25
    v_lshl_add_u32 v21, v24, 3, v25
    s_waitcnt lgkmcnt(2)
    v_mfma_f32_16x16x32_bf16 v[136:139], a[232:235], v[76:79], v[136:139]
    ds_write_b64 v14, v[48:49] offset:11776
    v_mfma_f32_16x16x32_bf16 v[140:143], a[232:235], v[80:83], v[140:143]
    v_fma_f32 v52, v52, s23, v35
    ds_read_b64_tr_b16 a[240:241], v10 offset:17664
    v_mfma_f32_16x16x32_bf16 v[144:147], a[232:235], v[84:87], v[144:147]
    ds_read_b64_tr_b16 a[242:243], v12 offset:17664
    v_fma_f32 v53, v53, s23, v35
    v_mfma_f32_16x16x32_bf16 v[148:151], a[232:235], v[88:91], v[148:151]
    v_fma_f32 v54, v54, s23, v35
    v_fma_f32 v55, v55, s23, v35
    v_mfma_f32_16x16x32_bf16 v[152:155], a[232:235], v[92:95], v[152:155]
    v_exp_f32 v52, v52
    s_waitcnt lgkmcnt(3)
    v_mfma_f32_16x16x32_bf16 v[156:159], a[236:239], v[76:79], v[156:159]
    v_exp_f32 v53, v53
    v_mfma_f32_16x16x32_bf16 v[160:163], a[236:239], v[80:83], v[160:163]
    ds_read_b64_tr_b16 a[244:245], v11 offset:17664
    ds_read_b64_tr_b16 a[246:247], v13 offset:17664
    v_mfma_f32_16x16x32_bf16 v[164:167], a[236:239], v[84:87], v[164:167]
    v_exp_f32 v54, v54
    v_mfma_f32_16x16x32_bf16 v[168:171], a[236:239], v[88:91], v[168:171]
    v_exp_f32 v55, v55
    v_mfma_f32_16x16x32_bf16 v[172:175], a[236:239], v[92:95], v[172:175]
    v_add_f32 v30, v30, v52
    v_and_b32 v24, 15, v0
    s_lshr_b32 s18, s17, 2
    s_mul_i32 s78, s18, 256
    v_lshl_add_u32 v2, v24, 2, s78
    v_bfe_u32 v25, v0, 4, 2
    v_lshl_add_u32 v2, v25, 24, v2
    s_mul_i32 s78, s20, 64
    s_add_u32 s78, s78, s17
    s_lshl_b32 s78, s78, 2
    v_bfe_u32 v25, v0, 0, 6
    v_lshl_add_u32 v3, v25, 24, s78
    v_bfe_u32 v25, v0, 4, 2
    v_mul_u32_u24 v25, 143360, v25
    v_lshl_add_u32 v25, v24, 4, v25
    s_and_b32 s19, s17, 3
    s_mul_i32 s68, s18, 5120
    s_lshl_b32 s78, s19, 10
    s_add_u32 s78, s78, s68
    s_lshl_b32 s79, s20, 8
    s_add_u32 s78, s78, s79
    v_add_u32 v4, s78, v25
    s_lshl_b32 s78, s19, 8
    s_add_u32 s78, s78, s68
    s_mul_i32 s79, s20, 20480
    s_add_u32 s78, s78, s79
    s_add_u32 s78, s78, 4096
    v_add_u32 v5, s78, v25
    s_waitcnt lgkmcnt(2)
    v_mfma_f32_16x16x32_bf16 v[176:179], a[240:243], v[76:79], v[176:179]
    v_add_f32 v30, v30, v53
    v_add_f32 v30, v30, v54
    v_mfma_f32_16x16x32_bf16 v[180:183], a[240:243], v[80:83], v[180:183]
    ds_read_b64_tr_b16 a[248:249], v10 offset:17792
    ds_read_b64_tr_b16 a[250:251], v12 offset:17792
    v_mfma_f32_16x16x32_bf16 v[184:187], a[240:243], v[84:87], v[184:187]
    v_add_f32 v30, v30, v55
    ds_read_b64_tr_b16 a[252:253], v11 offset:17792
    v_mfma_f32_16x16x32_bf16 v[188:191], a[240:243], v[88:91], v[188:191]
    ds_read_b64_tr_b16 a[254:255], v13 offset:17792
    v_cvt_pk_bf16_f32 v52, v52, v53
    v_mfma_f32_16x16x32_bf16 v[192:195], a[240:243], v[92:95], v[192:195]
    v_cvt_pk_bf16_f32 v53, v54, v55
    s_waitcnt lgkmcnt(4)
    v_mfma_f32_16x16x32_bf16 v[196:199], a[244:247], v[76:79], v[196:199]
    ds_write_b64 v14, v[52:53] offset:12288
    v_mfma_f32_16x16x32_bf16 v[200:203], a[244:247], v[80:83], v[200:203]
    v_mfma_f32_16x16x32_bf16 v[204:207], a[244:247], v[84:87], v[204:207]
    v_mfma_f32_16x16x32_bf16 v[208:211], a[244:247], v[88:91], v[208:211]
    v_mfma_f32_16x16x32_bf16 v[212:215], a[244:247], v[92:95], v[212:215]
    s_waitcnt vmcnt(8) lgkmcnt(0)
    s_barrier
    v_mfma_f32_16x16x32_bf16 v[216:219], a[248:251], v[76:79], v[216:219]
    ds_read_b64_tr_b16 a[216:217], v10 offset:52224
    ds_read_b64_tr_b16 a[218:219], v12 offset:52224
    v_mfma_f32_16x16x32_bf16 v[220:223], a[248:251], v[80:83], v[220:223]
    ds_read_b64 v[38:39], v19 offset:10240
    s_add_u32 m0, s60, 104448
    s_add_u32 s22, s90, 0
    buffer_load_dwordx4 v6, s[40:43], s22 offen lds
    v_mfma_f32_16x16x32_bf16 v[224:227], a[248:251], v[84:87], v[224:227]
    ds_read_b64 v[42:43], v19 offset:10752
    ds_read_b64 v[46:47], v19 offset:11264
    v_mfma_f32_16x16x32_bf16 v[228:231], a[248:251], v[88:91], v[228:231]
    ds_read_b64 v[50:51], v19 offset:11776
    ds_read_b64 v[54:55], v19 offset:12288
    v_mfma_f32_16x16x32_bf16 v[232:235], a[248:251], v[92:95], v[232:235]
    buffer_load_dwordx4 v7, s[40:43], s22 offen offset:1024 lds
    ds_read_b64_tr_b16 a[220:221], v11 offset:52224
    v_mfma_f32_16x16x32_bf16 v[236:239], a[252:255], v[76:79], v[236:239]
    ds_read_b64_tr_b16 a[222:223], v13 offset:52224
    ds_read_b64_tr_b16 a[200:201], v10 offset:52352
    v_mfma_f32_16x16x32_bf16 v[240:243], a[252:255], v[80:83], v[240:243]
    ds_read_b64_tr_b16 a[202:203], v12 offset:52352
    ds_read_b64_tr_b16 a[204:205], v11 offset:52352
    v_mfma_f32_16x16x32_bf16 v[244:247], a[252:255], v[84:87], v[244:247]
    buffer_load_dwordx4 v8, s[40:43], s22 offen offset:2048 lds
    ds_read_b64_tr_b16 a[206:207], v13 offset:52352
    v_mfma_f32_16x16x32_bf16 v[248:251], a[252:255], v[88:91], v[248:251]
    ds_read_b64_tr_b16 a[208:209], v10 offset:52480
    ds_read_b64_tr_b16 a[210:211], v12 offset:52480
    v_mfma_f32_16x16x32_bf16 v[252:255], a[252:255], v[92:95], v[252:255]
    v_mov_b32 v31, v26
    s_waitcnt lgkmcnt(12)
    v_mfma_f32_16x16x32_bf16 v[96:99], a[216:219], v[36:39], v[96:99]
    v_mov_b32 v32, v27
    s_waitcnt lgkmcnt(11)
    v_mfma_f32_16x16x32_bf16 v[100:103], a[216:219], v[40:43], v[100:103]
    buffer_load_dwordx4 v9, s[40:43], s22 offen offset:3072 lds
    s_waitcnt lgkmcnt(10)
    v_mfma_f32_16x16x32_bf16 v[104:107], a[216:219], v[44:47], v[104:107]
    ds_read_b64_tr_b16 a[212:213], v11 offset:52480
    s_waitcnt lgkmcnt(10)
    v_mfma_f32_16x16x32_bf16 v[108:111], a[216:219], v[48:51], v[108:111]
    ds_read_b64_tr_b16 a[214:215], v13 offset:52480
    s_waitcnt lgkmcnt(10)
    v_mfma_f32_16x16x32_bf16 v[112:115], a[216:219], v[52:55], v[112:115]
    v_cvt_pk_bf16_f32 v96, v96, v97
    s_waitcnt lgkmcnt(8)
    v_mfma_f32_16x16x32_bf16 v[116:119], a[220:223], v[36:39], v[116:119]
    s_add_u32 m0, s60, 0
    s_add_u32 s22, s90, 114688
    buffer_load_dwordx4 v6, s[40:43], s22 offen lds
    v_mfma_f32_16x16x32_bf16 v[120:123], a[220:223], v[40:43], v[120:123]
    v_cvt_pk_bf16_f32 v97, v98, v99
    v_mov_b32 v33, v28
    v_mfma_f32_16x16x32_bf16 v[124:127], a[220:223], v[44:47], v[124:127]
    ds_read_b64_tr_b16 a[160:161], v10 offset:52608
    ds_read_b64_tr_b16 a[162:163], v12 offset:52608
    v_mfma_f32_16x16x32_bf16 v[128:131], a[220:223], v[48:51], v[128:131]
    v_cvt_pk_bf16_f32 v98, v116, v117
    v_cvt_pk_bf16_f32 v99, v118, v119
    v_mfma_f32_16x16x32_bf16 v[132:135], a[220:223], v[52:55], v[132:135]
    buffer_load_dwordx4 v7, s[40:43], s22 offen offset:1024 lds
    s_waitcnt lgkmcnt(8)
    v_mfma_f32_16x16x32_bf16 v[136:139], a[200:203], v[36:39], v[136:139]
    v_cvt_pk_bf16_f32 v100, v100, v101
    v_cvt_pk_bf16_f32 v101, v102, v103
    v_mfma_f32_16x16x32_bf16 v[140:143], a[200:203], v[40:43], v[140:143]
    v_cvt_pk_bf16_f32 v102, v120, v121
    v_cvt_pk_bf16_f32 v103, v122, v123
    v_mfma_f32_16x16x32_bf16 v[144:147], a[200:203], v[44:47], v[144:147]
    ds_read_b64_tr_b16 a[164:165], v11 offset:52608
    ds_read_b64_tr_b16 a[166:167], v13 offset:52608
    v_mfma_f32_16x16x32_bf16 v[148:151], a[200:203], v[48:51], v[148:151]
    buffer_load_dwordx4 v8, s[40:43], s22 offen offset:2048 lds
    v_cvt_pk_bf16_f32 v104, v104, v105
    v_mfma_f32_16x16x32_bf16 v[152:155], a[200:203], v[52:55], v[152:155]
    v_cvt_pk_bf16_f32 v105, v106, v107
    s_waitcnt lgkmcnt(8)
    v_mfma_f32_16x16x32_bf16 v[156:159], a[204:207], v[36:39], v[156:159]
    v_cvt_pk_bf16_f32 v106, v124, v125
    v_cvt_pk_bf16_f32 v107, v126, v127
    v_mfma_f32_16x16x32_bf16 v[160:163], a[204:207], v[40:43], v[160:163]
    v_cvt_pk_bf16_f32 v108, v108, v109
    v_cvt_pk_bf16_f32 v109, v110, v111
    v_mfma_f32_16x16x32_bf16 v[164:167], a[204:207], v[44:47], v[164:167]
    buffer_load_dwordx4 v9, s[40:43], s22 offen offset:3072 lds
    v_cvt_pk_bf16_f32 v110, v128, v129
    v_mfma_f32_16x16x32_bf16 v[168:171], a[204:207], v[48:51], v[168:171]
    v_cvt_pk_bf16_f32 v111, v130, v131
    v_cvt_pk_bf16_f32 v112, v112, v113
    v_mfma_f32_16x16x32_bf16 v[172:175], a[204:207], v[52:55], v[172:175]
    v_cvt_pk_bf16_f32 v113, v114, v115
    s_waitcnt lgkmcnt(6)
    v_mfma_f32_16x16x32_bf16 v[176:179], a[208:211], v[36:39], v[176:179]
    v_cvt_pk_bf16_f32 v114, v132, v133
    v_cvt_pk_bf16_f32 v115, v134, v135
    v_mfma_f32_16x16x32_bf16 v[180:183], a[208:211], v[40:43], v[180:183]
    v_cvt_pk_bf16_f32 v136, v136, v137
    v_cvt_pk_bf16_f32 v137, v138, v139
    v_mfma_f32_16x16x32_bf16 v[184:187], a[208:211], v[44:47], v[184:187]
    v_cvt_pk_bf16_f32 v138, v156, v157
    v_cvt_pk_bf16_f32 v139, v158, v159
    v_mfma_f32_16x16x32_bf16 v[188:191], a[208:211], v[48:51], v[188:191]
    v_add_u32 v22, 0xfffffc00, v22
    ds_write_b128 v22, v[96:99]
    v_mfma_f32_16x16x32_bf16 v[192:195], a[208:211], v[52:55], v[192:195]
    v_cvt_pk_bf16_f32 v140, v140, v141
    s_waitcnt lgkmcnt(5)
    v_mfma_f32_16x16x32_bf16 v[196:199], a[212:215], v[36:39], v[196:199]
    v_cvt_pk_bf16_f32 v141, v142, v143
    v_cvt_pk_bf16_f32 v142, v160, v161
    v_mfma_f32_16x16x32_bf16 v[200:203], a[212:215], v[40:43], v[200:203]
    v_cvt_pk_bf16_f32 v143, v162, v163
    v_cvt_pk_bf16_f32 v144, v144, v145
    v_mfma_f32_16x16x32_bf16 v[204:207], a[212:215], v[44:47], v[204:207]
    ds_write_b128 v22, v[100:103] offset:1024
    v_cvt_pk_bf16_f32 v145, v146, v147
    v_mfma_f32_16x16x32_bf16 v[208:211], a[212:215], v[48:51], v[208:211]
    v_cvt_pk_bf16_f32 v146, v164, v165
    v_cvt_pk_bf16_f32 v147, v166, v167
    v_mfma_f32_16x16x32_bf16 v[212:215], a[212:215], v[52:55], v[212:215]
    s_waitcnt vmcnt(8) lgkmcnt(0)
    s_barrier
    v_mfma_f32_16x16x32_bf16 v[216:219], a[160:163], v[36:39], v[216:219]
    v_add_u32 v15, 0x11000, v15
    ds_read_b64_tr_b16 a[224:225], v15
    v_mfma_f32_16x16x32_bf16 v[220:223], a[160:163], v[40:43], v[220:223]
    ds_read_b64_tr_b16 a[226:227], v15 offset:2048
    s_add_u32 m0, s60, 17408
    s_add_u32 s22, s91, 0
    buffer_load_dwordx4 v6, s[40:43], s22 offen lds
    v_mfma_f32_16x16x32_bf16 v[224:227], a[160:163], v[44:47], v[224:227]
    v_add_u32 v16, 0x11000, v16
    ds_read_b64_tr_b16 a[228:229], v16
    v_mfma_f32_16x16x32_bf16 v[228:231], a[160:163], v[48:51], v[228:231]
    buffer_load_dwordx4 v7, s[40:43], s22 offen offset:1024 lds
    ds_read_b64_tr_b16 a[230:231], v16 offset:2048
    v_mfma_f32_16x16x32_bf16 v[232:235], a[160:163], v[52:55], v[232:235]
    ds_write_b128 v22, v[104:107] offset:2048
    v_cvt_pk_bf16_f32 v148, v148, v149
    v_mfma_f32_16x16x32_bf16 v[236:239], a[164:167], v[36:39], v[236:239]
    v_cvt_pk_bf16_f32 v149, v150, v151
    v_cvt_pk_bf16_f32 v150, v168, v169
    v_mfma_f32_16x16x32_bf16 v[240:243], a[164:167], v[40:43], v[240:243]
    v_cvt_pk_bf16_f32 v151, v170, v171
    v_cvt_pk_bf16_f32 v152, v152, v153
    v_mfma_f32_16x16x32_bf16 v[244:247], a[164:167], v[44:47], v[244:247]
    buffer_load_dwordx4 v8, s[40:43], s22 offen offset:2048 lds
    ds_read_b64_tr_b16 a[232:233], v15 offset:8192
    v_mfma_f32_16x16x32_bf16 v[248:251], a[164:167], v[48:51], v[248:251]
    ds_write_b128 v22, v[108:111] offset:3072
    v_cvt_pk_bf16_f32 v153, v154, v155
    v_mfma_f32_16x16x32_bf16 v[252:255], a[164:167], v[52:55], v[252:255]
    v_cvt_pk_bf16_f32 v154, v172, v173
    s_waitcnt lgkmcnt(5)
    v_mfma_f32_16x16x32_bf16 v[56:59], a[224:227], v[96:99], 0
    v_cvt_pk_bf16_f32 v155, v174, v175
    v_cvt_pk_bf16_f32 v176, v176, v177
    v_mfma_f32_16x16x32_bf16 v[60:63], a[224:227], v[100:103], 0
    ds_read_b64_tr_b16 a[234:235], v15 offset:10240
    buffer_load_dwordx4 v9, s[40:43], s22 offen offset:3072 lds
    v_mfma_f32_16x16x32_bf16 v[64:67], a[224:227], v[104:107], 0
    ds_write_b128 v22, v[112:115] offset:4096
    v_cvt_pk_bf16_f32 v177, v178, v179
    v_mfma_f32_16x16x32_bf16 v[68:71], a[224:227], v[108:111], 0
    v_cvt_pk_bf16_f32 v178, v196, v197
    v_cvt_pk_bf16_f32 v179, v198, v199
    v_mfma_f32_16x16x32_bf16 v[72:75], a[224:227], v[112:115], 0
    v_cvt_pk_bf16_f32 v180, v180, v181
    s_waitcnt lgkmcnt(5)
    v_mfma_f32_16x16x32_bf16 v[76:79], a[228:231], v[96:99], 0
    ds_read_b64_tr_b16 a[236:237], v16 offset:8192
    ds_read_b64_tr_b16 a[238:239], v16 offset:10240
    v_mfma_f32_16x16x32_bf16 v[80:83], a[228:231], v[100:103], 0
    s_add_u32 m0, s60, 34816
    s_add_u32 s22, s91, 114688
    buffer_load_dwordx4 v6, s[40:43], s22 offen lds
    v_mfma_f32_16x16x32_bf16 v[84:87], a[228:231], v[104:107], 0
    ds_write_b128 v22, v[136:139] offset:22528
    v_cvt_pk_bf16_f32 v181, v182, v183
    v_mfma_f32_16x16x32_bf16 v[88:91], a[228:231], v[108:111], 0
    v_cvt_pk_bf16_f32 v182, v200, v201
    v_cvt_pk_bf16_f32 v183, v202, v203
    v_mfma_f32_16x16x32_bf16 v[92:95], a[228:231], v[112:115], 0
    buffer_load_dwordx4 v7, s[40:43], s22 offen offset:1024 lds
    s_waitcnt lgkmcnt(4)
    v_mfma_f32_16x16x32_bf16 v[56:59], a[232:235], v[136:139], v[56:59]
    ds_read_b64_tr_b16 a[240:241], v15 offset:17408
    ds_read_b64_tr_b16 a[242:243], v15 offset:19456
    v_mfma_f32_16x16x32_bf16 v[60:63], a[232:235], v[140:143], v[60:63]
    ds_write_b128 v22, v[140:143] offset:23552
    v_cvt_pk_bf16_f32 v184, v184, v185
    v_mfma_f32_16x16x32_bf16 v[64:67], a[232:235], v[144:147], v[64:67]
    v_cvt_pk_bf16_f32 v185, v186, v187
    v_cvt_pk_bf16_f32 v186, v204, v205
    v_mfma_f32_16x16x32_bf16 v[68:71], a[232:235], v[148:151], v[68:71]
    buffer_load_dwordx4 v8, s[40:43], s22 offen offset:2048 lds
    v_cvt_pk_bf16_f32 v187, v206, v207
    v_mfma_f32_16x16x32_bf16 v[72:75], a[232:235], v[152:155], v[72:75]
    ds_read_b64_tr_b16 a[244:245], v16 offset:17408
    s_waitcnt lgkmcnt(5)
    v_mfma_f32_16x16x32_bf16 v[76:79], a[236:239], v[136:139], v[76:79]
    ds_read_b64_tr_b16 a[246:247], v16 offset:19456
    v_cvt_pk_bf16_f32 v188, v188, v189
    v_mfma_f32_16x16x32_bf16 v[80:83], a[236:239], v[140:143], v[80:83]
    ds_write_b128 v22, v[144:147] offset:24576
    v_cvt_pk_bf16_f32 v189, v190, v191
    v_mfma_f32_16x16x32_bf16 v[84:87], a[236:239], v[144:147], v[84:87]
    v_cvt_pk_bf16_f32 v190, v208, v209
    v_cvt_pk_bf16_f32 v191, v210, v211
    v_mfma_f32_16x16x32_bf16 v[88:91], a[236:239], v[148:151], v[88:91]
    buffer_load_dwordx4 v9, s[40:43], s22 offen offset:3072 lds
    v_cvt_pk_bf16_f32 v192, v192, v193
    v_mfma_f32_16x16x32_bf16 v[92:95], a[236:239], v[152:155], v[92:95]
    ds_write_b128 v22, v[148:151] offset:25600
    s_waitcnt lgkmcnt(5)
    v_mfma_f32_16x16x32_bf16 v[56:59], a[240:243], v[176:179], v[56:59]
    v_cvt_pk_bf16_f32 v193, v194, v195
    v_cvt_pk_bf16_f32 v194, v212, v213
    v_mfma_f32_16x16x32_bf16 v[60:63], a[240:243], v[180:183], v[60:63]
    v_cvt_pk_bf16_f32 v195, v214, v215
    s_add_u32 m0, s60, 52224
    s_add_u32 s22, s92, 0
    buffer_load_dwordx4 v6, s[40:43], s22 offen lds
    v_mfma_f32_16x16x32_bf16 v[64:67], a[240:243], v[184:187], v[64:67]
    ds_read_b64_tr_b16 a[248:249], v15 offset:25600
    ds_read_b64_tr_b16 a[250:251], v15 offset:27648
    v_mfma_f32_16x16x32_bf16 v[68:71], a[240:243], v[188:191], v[68:71]
    ds_write_b128 v22, v[152:155] offset:26624
    v_cvt_pk_bf16_f32 v216, v216, v217
    v_mfma_f32_16x16x32_bf16 v[72:75], a[240:243], v[192:195], v[72:75]
    v_cvt_pk_bf16_f32 v217, v218, v219
    s_waitcnt lgkmcnt(5)
    v_mfma_f32_16x16x32_bf16 v[76:79], a[244:247], v[176:179], v[76:79]
    v_cvt_pk_bf16_f32 v218, v236, v237
    v_cvt_pk_bf16_f32 v219, v238, v239
    v_mfma_f32_16x16x32_bf16 v[80:83], a[244:247], v[180:183], v[80:83]
    ds_read_b64_tr_b16 a[252:253], v16 offset:25600
    ds_read_b64_tr_b16 a[254:255], v16 offset:27648
    v_mfma_f32_16x16x32_bf16 v[84:87], a[244:247], v[184:187], v[84:87]
    v_cvt_pk_bf16_f32 v220, v220, v221
    v_cvt_pk_bf16_f32 v221, v222, v223
    v_mfma_f32_16x16x32_bf16 v[88:91], a[244:247], v[188:191], v[88:91]
    v_cvt_pk_bf16_f32 v222, v240, v241
    v_cvt_pk_bf16_f32 v223, v242, v243
    buffer_load_dwordx4 v7, s[40:43], s22 offen offset:1024 lds
    v_mfma_f32_16x16x32_bf16 v[92:95], a[244:247], v[192:195], v[92:95]
    s_waitcnt vmcnt(10) lgkmcnt(0)
    s_barrier
    v_cvt_pk_bf16_f32 v224, v224, v225
    v_cvt_pk_bf16_f32 v225, v226, v227
    v_cvt_pk_bf16_f32 v226, v244, v245
    v_cvt_pk_bf16_f32 v227, v246, v247
    v_mfma_f32_16x16x32_bf16 v[56:59], a[248:251], v[216:219], v[56:59]
    v_cvt_pk_bf16_f32 v228, v228, v229
    v_cvt_pk_bf16_f32 v229, v230, v231
    v_cvt_pk_bf16_f32 v230, v248, v249
    v_cvt_pk_bf16_f32 v231, v250, v251
    v_add_u32 v23, 0xfffffc00, v23
    ds_read_b128 a[160:163], v23
    v_mfma_f32_16x16x32_bf16 v[60:63], a[248:251], v[220:223], v[60:63]
    v_cvt_pk_bf16_f32 v232, v232, v233
    v_cvt_pk_bf16_f32 v233, v234, v235
    v_cvt_pk_bf16_f32 v234, v252, v253
    v_cvt_pk_bf16_f32 v235, v254, v255
    ds_read_b128 a[164:167], v23 offset:1024
    v_mfma_f32_16x16x32_bf16 v[64:67], a[248:251], v[224:227], v[64:67]
    ds_read_b64_tr_b16 a[216:217], v15 offset:34816
    ds_read_b64_tr_b16 a[218:219], v15 offset:36864
    ds_read_b128 a[168:171], v23 offset:2048
    buffer_load_dwordx4 v8, s[40:43], s22 offen offset:2048 lds
    v_mfma_f32_16x16x32_bf16 v[68:71], a[248:251], v[228:231], v[68:71]
    ds_read_b128 a[172:175], v23 offset:3072
    ds_read_b128 a[176:179], v23 offset:4096
    v_mfma_f32_16x16x32_bf16 v[72:75], a[248:251], v[232:235], v[72:75]
    ds_read_b128 a[180:183], v23 offset:22528
    ds_read_b128 a[184:187], v23 offset:23552
    v_mfma_f32_16x16x32_bf16 v[76:79], a[252:255], v[216:219], v[76:79]
    buffer_load_dwordx4 v9, s[40:43], s22 offen offset:3072 lds
    ds_read_b64_tr_b16 a[220:221], v16 offset:34816
    v_mfma_f32_16x16x32_bf16 v[80:83], a[252:255], v[220:223], v[80:83]
    ds_read_b64_tr_b16 a[222:223], v16 offset:36864
    ds_read_b128 a[188:191], v23 offset:24576
    v_mfma_f32_16x16x32_bf16 v[84:87], a[252:255], v[224:227], v[84:87]
    ds_read_b128 a[192:195], v23 offset:25600
    ds_read_b128 a[196:199], v23 offset:26624
    v_mfma_f32_16x16x32_bf16 v[88:91], a[252:255], v[228:231], v[88:91]
    ds_read_b64_tr_b16 a[200:201], v15 offset:43008
    ds_read_b64_tr_b16 a[202:203], v15 offset:45056
    v_mfma_f32_16x16x32_bf16 v[92:95], a[252:255], v[232:235], v[92:95]
    ds_read_b64_tr_b16 a[204:205], v16 offset:43008
    s_waitcnt lgkmcnt(13)
    v_mfma_f32_16x16x32_bf16 v[116:119], a[216:219], v[96:99], 0
    ds_read_b64_tr_b16 a[206:207], v16 offset:45056
    v_add_u32 v15, 0xfffef000, v15
    ds_read_b64_tr_b16 a[208:209], v15
    v_mfma_f32_16x16x32_bf16 v[120:123], a[216:219], v[100:103], 0
    ds_read_b64_tr_b16 a[210:211], v15 offset:2048
    v_mov_b32 v34, v29
    v_mfma_f32_16x16x32_bf16 v[124:127], a[216:219], v[104:107], 0
    v_mov_b32 v35, v30
    v_add_u32 v16, 0xfffef000, v16
    ds_read_b64_tr_b16 a[212:213], v16
    v_mfma_f32_16x16x32_bf16 v[128:131], a[216:219], v[108:111], 0
    ds_read_b64_tr_b16 a[214:215], v16 offset:2048
    v_permlane32_swap_b32 v26, v31
    v_mfma_f32_16x16x32_bf16 v[132:135], a[216:219], v[112:115], 0
    v_permlane32_swap_b32 v27, v32
    s_waitcnt lgkmcnt(11)
    v_mfma_f32_16x16x32_bf16 v[156:159], a[220:223], v[96:99], 0
    v_permlane32_swap_b32 v28, v33
    v_permlane32_swap_b32 v29, v34
    v_mfma_f32_16x16x32_bf16 v[160:163], a[220:223], v[100:103], 0
    v_permlane32_swap_b32 v30, v35
    v_add_f32 v26, v26, v31
    v_mfma_f32_16x16x32_bf16 v[164:167], a[220:223], v[104:107], 0
    s_waitcnt lgkmcnt(0)
    s_barrier
    v_mfma_f32_16x16x32_bf16 v[168:171], a[220:223], v[108:111], 0
    ds_write_b128 v22, v[176:179]
    v_add_f32 v27, v27, v32
    v_mfma_f32_16x16x32_bf16 v[172:175], a[220:223], v[112:115], 0
    v_add_f32 v28, v28, v33
    v_add_f32 v29, v29, v34
    v_mfma_f32_16x16x32_bf16 v[116:119], a[200:203], v[136:139], v[116:119]
    v_add_f32 v30, v30, v35
    v_mov_b32 v31, v26
    v_mfma_f32_16x16x32_bf16 v[120:123], a[200:203], v[140:143], v[120:123]
    ds_write_b128 v22, v[180:183] offset:1024
    v_mov_b32 v32, v27
    v_mfma_f32_16x16x32_bf16 v[124:127], a[200:203], v[144:147], v[124:127]
    v_mov_b32 v33, v28
    v_mov_b32 v34, v29
    v_mfma_f32_16x16x32_bf16 v[128:131], a[200:203], v[148:151], v[128:131]
    v_mov_b32 v35, v30
    v_permlane16_swap_b32 v26, v31
    v_mfma_f32_16x16x32_bf16 v[132:135], a[200:203], v[152:155], v[132:135]
    ds_write_b128 v22, v[184:187] offset:2048
    v_permlane16_swap_b32 v27, v32
    v_mfma_f32_16x16x32_bf16 v[156:159], a[204:207], v[136:139], v[156:159]
    v_permlane16_swap_b32 v28, v33
    v_permlane16_swap_b32 v29, v34
    v_mfma_f32_16x16x32_bf16 v[160:163], a[204:207], v[140:143], v[160:163]
    v_permlane16_swap_b32 v30, v35
    v_add_f32 v26, v26, v31
    v_mfma_f32_16x16x32_bf16 v[164:167], a[204:207], v[144:147], v[164:167]
    ds_read_b64_tr_b16 a[224:225], v15 offset:8192
    ds_read_b64_tr_b16 a[226:227], v15 offset:10240
    v_mfma_f32_16x16x32_bf16 v[168:171], a[204:207], v[148:151], v[168:171]
    ds_write_b128 v22, v[188:191] offset:3072
    v_add_f32 v27, v27, v32
    v_mfma_f32_16x16x32_bf16 v[172:175], a[204:207], v[152:155], v[172:175]
    v_add_f32 v28, v28, v33
    v_add_f32 v29, v29, v34
    v_mfma_f32_16x16x32_bf16 v[116:119], a[208:211], v[176:179], v[116:119]
    v_add_f32 v30, v30, v35
    v_mfma_f32_16x16x32_bf16 v[120:123], a[208:211], v[180:183], v[120:123]
    ds_read_b64_tr_b16 a[228:229], v16 offset:8192
    ds_read_b64_tr_b16 a[230:231], v16 offset:10240
    v_mfma_f32_16x16x32_bf16 v[124:127], a[208:211], v[184:187], v[124:127]
    ds_write_b128 v22, v[192:195] offset:4096
    v_mfma_f32_16x16x32_bf16 v[128:131], a[208:211], v[188:191], v[128:131]
    v_mfma_f32_16x16x32_bf16 v[132:135], a[208:211], v[192:195], v[132:135]
    v_mfma_f32_16x16x32_bf16 v[156:159], a[212:215], v[176:179], v[156:159]
    ds_write_b128 v22, v[216:219] offset:22528
    v_mfma_f32_16x16x32_bf16 v[160:163], a[212:215], v[180:183], v[160:163]
    v_mfma_f32_16x16x32_bf16 v[164:167], a[212:215], v[184:187], v[164:167]
    v_mfma_f32_16x16x32_bf16 v[168:171], a[212:215], v[188:191], v[168:171]
    v_add_u32 v17, 0x11000, v17
    ds_read_b64_tr_b16 a[232:233], v17
    v_mfma_f32_16x16x32_bf16 v[172:175], a[212:215], v[192:195], v[172:175]
    ds_read_b64_tr_b16 a[234:235], v17 offset:2048
    s_waitcnt lgkmcnt(7)
    v_mfma_f32_16x16x32_bf16 v[116:119], a[224:227], v[216:219], v[116:119]
    ds_write_b128 v22, v[220:223] offset:23552
    v_mfma_f32_16x16x32_bf16 v[120:123], a[224:227], v[220:223], v[120:123]
    v_mfma_f32_16x16x32_bf16 v[124:127], a[224:227], v[224:227], v[124:127]
    v_mfma_f32_16x16x32_bf16 v[128:131], a[224:227], v[228:231], v[128:131]
    v_add_u32 v18, 0x11000, v18
    ds_read_b64_tr_b16 a[236:237], v18
    v_mfma_f32_16x16x32_bf16 v[132:135], a[224:227], v[232:235], v[132:135]
    ds_read_b64_tr_b16 a[238:239], v18 offset:2048
    s_waitcnt lgkmcnt(7)
    v_mfma_f32_16x16x32_bf16 v[156:159], a[228:231], v[216:219], v[156:159]
    ds_write_b128 v22, v[224:227] offset:24576
    v_mfma_f32_16x16x32_bf16 v[160:163], a[228:231], v[220:223], v[160:163]
    v_mfma_f32_16x16x32_bf16 v[164:167], a[228:231], v[224:227], v[164:167]
    v_mfma_f32_16x16x32_bf16 v[168:171], a[228:231], v[228:231], v[168:171]
    ds_read_b64_tr_b16 a[240:241], v17 offset:8192
    ds_read_b64_tr_b16 a[242:243], v17 offset:10240
    v_mfma_f32_16x16x32_bf16 v[172:175], a[228:231], v[232:235], v[172:175]
    ds_write_b128 v22, v[228:231] offset:25600
    s_waitcnt lgkmcnt(7)
    v_mfma_f32_16x16x32_bf16 v[56:59], a[232:235], a[160:163], v[56:59]
    v_mfma_f32_16x16x32_bf16 v[60:63], a[232:235], a[164:167], v[60:63]
    v_mfma_f32_16x16x32_bf16 v[64:67], a[232:235], a[168:171], v[64:67]
    v_add_u32 v21, 0x22800, v21
    ds_write_b32 v21, v26
    v_mfma_f32_16x16x32_bf16 v[68:71], a[232:235], a[172:175], v[68:71]
    ds_read_b64_tr_b16 a[244:245], v18 offset:8192
    ds_read_b64_tr_b16 a[246:247], v18 offset:10240
    ds_write_b32 v21, v27 offset:128
    v_mfma_f32_16x16x32_bf16 v[72:75], a[232:235], a[176:179], v[72:75]
    ds_write_b32 v21, v28 offset:256
    s_waitcnt lgkmcnt(9)
    v_mfma_f32_16x16x32_bf16 v[76:79], a[236:239], a[160:163], v[76:79]
    ds_write_b32 v21, v29 offset:384
    v_mfma_f32_16x16x32_bf16 v[80:83], a[236:239], a[164:167], v[80:83]
    ds_write_b128 v22, v[232:235] offset:26624
    ds_write_b32 v21, v30 offset:512
    v_mfma_f32_16x16x32_bf16 v[84:87], a[236:239], a[168:171], v[84:87]
    v_mfma_f32_16x16x32_bf16 v[88:91], a[236:239], a[172:175], v[88:91]
    v_mfma_f32_16x16x32_bf16 v[92:95], a[236:239], a[176:179], v[92:95]
    s_waitcnt lgkmcnt(0)
    s_barrier
    v_mfma_f32_16x16x32_bf16 v[56:59], a[240:243], a[180:183], v[56:59]
    ds_read_b128 v[196:199], v23
    v_xor_b32 v21, 4, v21
    v_mfma_f32_16x16x32_bf16 v[60:63], a[240:243], a[184:187], v[60:63]
    ds_read_b128 v[200:203], v23 offset:1024
    ds_read_b32 v31, v21
    v_mfma_f32_16x16x32_bf16 v[64:67], a[240:243], a[188:191], v[64:67]
    ds_read_b64_tr_b16 a[248:249], v17 offset:17408
    ds_read_b64_tr_b16 a[250:251], v17 offset:19456
    ds_read_b128 v[204:207], v23 offset:2048
    s_add_u32 m0, s60, 69632
    s_add_u32 s22, s92, 114688
    buffer_load_dwordx4 v6, s[40:43], s22 offen lds
    v_mfma_f32_16x16x32_bf16 v[68:71], a[240:243], a[192:195], v[68:71]
    ds_read_b128 v[208:211], v23 offset:3072
    ds_read_b32 v32, v21 offset:128
    v_mfma_f32_16x16x32_bf16 v[72:75], a[240:243], a[196:199], v[72:75]
    ds_read_b128 v[212:215], v23 offset:4096
    ds_read_b32 v33, v21 offset:256
    v_mfma_f32_16x16x32_bf16 v[76:79], a[244:247], a[180:183], v[76:79]
    ds_read_b128 v[236:239], v23 offset:22528
    ds_read_b32 v34, v21 offset:384
    v_mfma_f32_16x16x32_bf16 v[80:83], a[244:247], a[184:187], v[80:83]
    ds_read_b128 v[240:243], v23 offset:23552
    ds_read_b64_tr_b16 a[252:253], v18 offset:17408
    v_mfma_f32_16x16x32_bf16 v[84:87], a[244:247], a[188:191], v[84:87]
    ds_read_b64_tr_b16 a[254:255], v18 offset:19456
    ds_read_b128 v[244:247], v23 offset:24576
    ds_read_b32 v35, v21 offset:512
    v_mfma_f32_16x16x32_bf16 v[88:91], a[244:247], a[192:195], v[88:91]
    ds_read_b128 v[248:251], v23 offset:25600
    ds_read_b128 v[252:255], v23 offset:26624
    v_mfma_f32_16x16x32_bf16 v[92:95], a[244:247], a[196:199], v[92:95]
    ds_read_b64_tr_b16 a[216:217], v17 offset:25600
    s_waitcnt lgkmcnt(15)
    v_mfma_f32_16x16x32_bf16 v[56:59], a[248:251], v[196:199], v[56:59]
    ds_read_b64_tr_b16 a[218:219], v17 offset:27648
    buffer_load_dwordx4 v7, s[40:43], s22 offen offset:1024 lds
    v_mfma_f32_16x16x32_bf16 v[60:63], a[248:251], v[200:203], v[60:63]
    ds_read_b64_tr_b16 a[220:221], v18 offset:25600
    s_waitcnt lgkmcnt(15)
    v_mfma_f32_16x16x32_bf16 v[64:67], a[248:251], v[204:207], v[64:67]
    ds_read_b64_tr_b16 a[222:223], v18 offset:27648
    ds_read_b64_tr_b16 a[200:201], v17 offset:34816
    v_mfma_f32_16x16x32_bf16 v[68:71], a[248:251], v[208:211], v[68:71]
    v_add_f32 v26, v26, v31
    s_waitcnt lgkmcnt(15)
    v_mfma_f32_16x16x32_bf16 v[72:75], a[248:251], v[212:215], v[72:75]
    v_add_f32 v27, v27, v32
    s_waitcnt lgkmcnt(9)
    v_mfma_f32_16x16x32_bf16 v[76:79], a[252:255], v[196:199], v[76:79]
    v_add_f32 v28, v28, v33
    v_add_f32 v29, v29, v34
    v_mfma_f32_16x16x32_bf16 v[80:83], a[252:255], v[200:203], v[80:83]
    s_waitcnt lgkmcnt(7)
    v_add_f32 v30, v30, v35
    v_mfma_f32_16x16x32_bf16 v[84:87], a[252:255], v[204:207], v[84:87]
    v_rcp_f32 v26, v26
    v_mfma_f32_16x16x32_bf16 v[88:91], a[252:255], v[208:211], v[88:91]
    v_rcp_f32 v27, v27
    v_mfma_f32_16x16x32_bf16 v[92:95], a[252:255], v[212:215], v[92:95]
    s_waitcnt lgkmcnt(0)
    s_barrier
    v_mfma_f32_16x16x32_bf16 v[56:59], a[216:219], v[236:239], v[56:59]
    v_rcp_f32 v28, v28
    v_mfma_f32_16x16x32_bf16 v[60:63], a[216:219], v[240:243], v[60:63]
    v_rcp_f32 v29, v29
    v_mfma_f32_16x16x32_bf16 v[64:67], a[216:219], v[244:247], v[64:67]
    ds_read_b64_tr_b16 a[202:203], v17 offset:36864
    v_rcp_f32 v30, v30
    s_nop 1
    v_mul_f32 v56, v26, v56
    buffer_load_dwordx4 v8, s[40:43], s22 offen offset:2048 lds
    v_mfma_f32_16x16x32_bf16 v[68:71], a[216:219], v[248:251], v[68:71]
    v_mul_f32 v57, v26, v57
    v_mul_f32 v58, v26, v58
    v_mfma_f32_16x16x32_bf16 v[72:75], a[216:219], v[252:255], v[72:75]
    v_mul_f32 v59, v26, v59
    v_cvt_pk_bf16_f32 v56, v56, v57
    v_mfma_f32_16x16x32_bf16 v[76:79], a[220:223], v[236:239], v[76:79]
    v_cvt_pk_bf16_f32 v57, v58, v59
    ds_read_b64_tr_b16 a[204:205], v18 offset:34816
    v_mfma_f32_16x16x32_bf16 v[80:83], a[220:223], v[240:243], v[80:83]
    ds_read_b64_tr_b16 a[206:207], v18 offset:36864
    ds_read_b64_tr_b16 a[208:209], v17 offset:43008
    v_mfma_f32_16x16x32_bf16 v[84:87], a[220:223], v[244:247], v[84:87]
    s_nop 1
    v_mul_f32 v76, v26, v76
    v_mfma_f32_16x16x32_bf16 v[88:91], a[220:223], v[248:251], v[88:91]
    v_mul_f32 v77, v26, v77
    v_mul_f32 v78, v26, v78
    v_mfma_f32_16x16x32_bf16 v[92:95], a[220:223], v[252:255], v[92:95]
    v_mul_f32 v79, v26, v79
    s_waitcnt lgkmcnt(3)
    v_mfma_f32_16x16x32_bf16 v[116:119], a[200:203], a[160:163], v[116:119]
    v_cvt_pk_bf16_f32 v58, v76, v77
    v_cvt_pk_bf16_f32 v59, v78, v79
    v_mfma_f32_16x16x32_bf16 v[120:123], a[200:203], a[164:167], v[120:123]
    v_mul_f32 v60, v27, v60
    ds_read_b64_tr_b16 a[210:211], v17 offset:45056
    v_mfma_f32_16x16x32_bf16 v[124:127], a[200:203], a[168:171], v[124:127]
    v_mul_f32 v61, v27, v61
    buffer_load_dwordx4 v9, s[40:43], s22 offen offset:3072 lds
    v_mfma_f32_16x16x32_bf16 v[128:131], a[200:203], a[172:175], v[128:131]
    v_mul_f32 v62, v27, v62
    v_mul_f32 v63, v27, v63
    v_mfma_f32_16x16x32_bf16 v[132:135], a[200:203], a[176:179], v[132:135]
    v_cvt_pk_bf16_f32 v60, v60, v61
    s_waitcnt lgkmcnt(2)
    v_mfma_f32_16x16x32_bf16 v[156:159], a[204:207], a[160:163], v[156:159]
    v_cvt_pk_bf16_f32 v61, v62, v63
    v_mul_f32 v80, v27, v80
    v_mfma_f32_16x16x32_bf16 v[160:163], a[204:207], a[164:167], v[160:163]
    buffer_store_dwordx4 v[56:59], v20, s[44:47], s62 offen sc1
    ds_read_b64_tr_b16 a[212:213], v18 offset:43008
    v_mfma_f32_16x16x32_bf16 v[164:167], a[204:207], a[168:171], v[164:167]
    ds_read_b64_tr_b16 a[214:215], v18 offset:45056
    v_mul_f32 v81, v27, v81
    v_mul_f32 v82, v27, v82
    v_mfma_f32_16x16x32_bf16 v[168:171], a[204:207], a[172:175], v[168:171]
    v_mul_f32 v83, v27, v83
    v_cvt_pk_bf16_f32 v62, v80, v81
    v_mfma_f32_16x16x32_bf16 v[172:175], a[204:207], a[176:179], v[172:175]
    v_cvt_pk_bf16_f32 v63, v82, v83
    s_waitcnt lgkmcnt(2)
    v_mfma_f32_16x16x32_bf16 v[116:119], a[208:211], a[180:183], v[116:119]
    v_mul_f32 v64, v28, v64
    v_mul_f32 v65, v28, v65
    v_mfma_f32_16x16x32_bf16 v[120:123], a[208:211], a[184:187], v[120:123]
    v_add_u32 v17, 0xfffef000, v17
    ds_read_b64_tr_b16 a[224:225], v17
    v_mfma_f32_16x16x32_bf16 v[124:127], a[208:211], a[188:191], v[124:127]
    ds_read_b64_tr_b16 a[226:227], v17 offset:2048
    v_mul_f32 v66, v28, v66
    s_add_u32 m0, s60, 87040
    s_add_u32 s22, s93, 0
    buffer_load_dwordx4 v6, s[40:43], s22 offen lds
    v_mfma_f32_16x16x32_bf16 v[128:131], a[208:211], a[192:195], v[128:131]
    v_mul_f32 v67, v28, v67
    v_cvt_pk_bf16_f32 v64, v64, v65
    v_mfma_f32_16x16x32_bf16 v[132:135], a[208:211], a[196:199], v[132:135]
    buffer_store_dwordx4 v[60:63], v20, s[44:47], s62 offen offset:1024 sc1
    v_cvt_pk_bf16_f32 v65, v66, v67
    s_waitcnt lgkmcnt(2)
    v_mfma_f32_16x16x32_bf16 v[156:159], a[212:215], a[180:183], v[156:159]
    v_mul_f32 v84, v28, v84
    v_mul_f32 v85, v28, v85
    v_mfma_f32_16x16x32_bf16 v[160:163], a[212:215], a[184:187], v[160:163]
    v_mul_f32 v86, v28, v86
    v_add_u32 v18, 0xfffef000, v18
    ds_read_b64_tr_b16 a[228:229], v18
    v_mfma_f32_16x16x32_bf16 v[164:167], a[212:215], a[188:191], v[164:167]
    ds_read_b64_tr_b16 a[230:231], v18 offset:2048
    v_mul_f32 v87, v28, v87
    v_mfma_f32_16x16x32_bf16 v[168:171], a[212:215], a[192:195], v[168:171]
    v_cvt_pk_bf16_f32 v66, v84, v85
    v_cvt_pk_bf16_f32 v67, v86, v87
    v_mfma_f32_16x16x32_bf16 v[172:175], a[212:215], a[196:199], v[172:175]
    v_mul_f32 v68, v29, v68
    s_waitcnt lgkmcnt(2)
    v_mfma_f32_16x16x32_bf16 v[116:119], a[224:227], v[196:199], v[116:119]
    v_mul_f32 v69, v29, v69
    v_mul_f32 v70, v29, v70
    v_mfma_f32_16x16x32_bf16 v[120:123], a[224:227], v[200:203], v[120:123]
    ds_read_b64_tr_b16 a[232:233], v17 offset:8192
    ds_read_b64_tr_b16 a[234:235], v17 offset:10240
    v_mfma_f32_16x16x32_bf16 v[124:127], a[224:227], v[204:207], v[124:127]
    v_mul_f32 v71, v29, v71
    v_cvt_pk_bf16_f32 v68, v68, v69
    buffer_load_dwordx4 v7, s[40:43], s22 offen offset:1024 lds
    v_mfma_f32_16x16x32_bf16 v[128:131], a[224:227], v[208:211], v[128:131]
    buffer_store_dwordx4 v[64:67], v20, s[44:47], s62 offen offset:2048 sc1
    ds_read_b64_tr_b16 a[236:237], v18 offset:8192
    ds_read_b64_tr_b16 a[238:239], v18 offset:10240
    v_cvt_pk_bf16_f32 v69, v70, v71
    v_mfma_f32_16x16x32_bf16 v[132:135], a[224:227], v[212:215], v[132:135]
    v_mul_f32 v88, v29, v88
    s_waitcnt lgkmcnt(4)
    v_mfma_f32_16x16x32_bf16 v[156:159], a[228:231], v[196:199], v[156:159]
    v_mul_f32 v89, v29, v89
    v_mul_f32 v90, v29, v90
    v_mfma_f32_16x16x32_bf16 v[160:163], a[228:231], v[200:203], v[160:163]
    v_mul_f32 v91, v29, v91
    v_cvt_pk_bf16_f32 v70, v88, v89
    v_mfma_f32_16x16x32_bf16 v[164:167], a[228:231], v[204:207], v[164:167]
    v_cvt_pk_bf16_f32 v71, v90, v91
    v_mul_f32 v72, v30, v72
    v_mfma_f32_16x16x32_bf16 v[168:171], a[228:231], v[208:211], v[168:171]
    v_mul_f32 v73, v30, v73
    v_mul_f32 v74, v30, v74
    v_mfma_f32_16x16x32_bf16 v[172:175], a[228:231], v[212:215], v[172:175]
    s_waitcnt vmcnt(17) lgkmcnt(0)
    s_barrier
    v_mfma_f32_16x16x32_bf16 v[116:119], a[232:235], v[236:239], v[116:119]
    v_mul_f32 v75, v30, v75
    v_cvt_pk_bf16_f32 v72, v72, v73
    v_mfma_f32_16x16x32_bf16 v[120:123], a[232:235], v[240:243], v[120:123]
    ds_read_b64_tr_b16 a[240:241], v15 offset:17408
    ds_read_b64_tr_b16 a[242:243], v15 offset:19456
    v_mfma_f32_16x16x32_bf16 v[124:127], a[232:235], v[244:247], v[124:127]
    buffer_store_dwordx4 v[68:71], v20, s[44:47], s62 offen offset:3072 sc1
    s_add_u32 s62, s62, 20480
    v_cvt_pk_bf16_f32 v73, v74, v75
    buffer_load_dwordx4 v8, s[40:43], s22 offen offset:2048 lds
    v_mfma_f32_16x16x32_bf16 v[128:131], a[232:235], v[248:251], v[128:131]
    v_mul_f32 v92, v30, v92
    v_mul_f32 v93, v30, v93
    v_mul_f32 v94, v30, v94
    v_mul_f32 v95, v30, v95
    v_cvt_pk_bf16_f32 v74, v92, v93
    v_cvt_pk_bf16_f32 v75, v94, v95
    v_mul_f32 v116, v26, v116
    v_mfma_f32_16x16x32_bf16 v[132:135], a[232:235], v[252:255], v[132:135]
    v_mul_f32 v117, v26, v117
    v_mul_f32 v118, v26, v118
    v_mfma_f32_16x16x32_bf16 v[156:159], a[236:239], v[236:239], v[156:159]
    v_mul_f32 v119, v26, v119
    ds_read_b64_tr_b16 a[244:245], v16 offset:17408
    v_mfma_f32_16x16x32_bf16 v[160:163], a[236:239], v[240:243], v[160:163]
    ds_read_b64_tr_b16 a[246:247], v16 offset:19456
    v_cvt_pk_bf16_f32 v116, v116, v117
    v_mfma_f32_16x16x32_bf16 v[164:167], a[236:239], v[244:247], v[164:167]
    v_cvt_pk_bf16_f32 v117, v118, v119
    ds_read_b64_tr_b16 a[248:249], v17 offset:17408
    v_mfma_f32_16x16x32_bf16 v[168:171], a[236:239], v[248:251], v[168:171]
    v_mul_f32 v156, v26, v156
    v_mul_f32 v157, v26, v157
    v_mfma_f32_16x16x32_bf16 v[172:175], a[236:239], v[252:255], v[172:175]
    v_mul_f32 v158, v26, v158
    s_waitcnt lgkmcnt(3)
    v_mfma_f32_16x16x32_bf16 v[56:59], a[240:243], v[96:99], 0
    ds_read_b64_tr_b16 a[250:251], v17 offset:19456
    v_mul_f32 v159, v26, v159
    v_mfma_f32_16x16x32_bf16 v[60:63], a[240:243], v[100:103], 0
    buffer_store_dwordx4 v[72:75], v20, s[44:47], s63 offen sc1
    s_add_u32 s63, s63, 20480
    v_mfma_f32_16x16x32_bf16 v[64:67], a[240:243], v[104:107], 0
    buffer_load_dwordx4 v9, s[40:43], s22 offen offset:3072 lds
    v_cvt_pk_bf16_f32 v118, v156, v157
    v_mfma_f32_16x16x32_bf16 v[68:71], a[240:243], v[108:111], 0
    v_cvt_pk_bf16_f32 v119, v158, v159
    v_mul_f32 v120, v27, v120
    v_mfma_f32_16x16x32_bf16 v[72:75], a[240:243], v[112:115], 0
    v_mul_f32 v121, v27, v121
    s_waitcnt lgkmcnt(2)
    v_mfma_f32_16x16x32_bf16 v[76:79], a[244:247], v[96:99], 0
    ds_read_b64_tr_b16 a[252:253], v18 offset:17408
    ds_read_b64_tr_b16 a[254:255], v18 offset:19456
    v_mfma_f32_16x16x32_bf16 v[80:83], a[244:247], v[100:103], 0
    v_mul_f32 v122, v27, v122
    v_mul_f32 v123, v27, v123
    v_mfma_f32_16x16x32_bf16 v[84:87], a[244:247], v[104:107], 0
    buffer_store_dwordx4 v[116:119], v20, s[44:47], s62 offen sc1
    v_cvt_pk_bf16_f32 v120, v120, v121
    v_mfma_f32_16x16x32_bf16 v[88:91], a[244:247], v[108:111], 0
    v_cvt_pk_bf16_f32 v121, v122, v123
    v_mul_f32 v160, v27, v160
    v_mfma_f32_16x16x32_bf16 v[92:95], a[244:247], v[112:115], 0
    ds_read_b64_tr_b16 a[216:217], v15 offset:25600
    s_waitcnt lgkmcnt(3)
    v_mfma_f32_16x16x32_bf16 v[56:59], a[248:251], a[160:163], v[56:59]
    ds_read_b64_tr_b16 a[218:219], v15 offset:27648
    v_mul_f32 v161, v27, v161
    v_mfma_f32_16x16x32_bf16 v[60:63], a[248:251], a[164:167], v[60:63]
    s_add_u32 m0, s60, 121856
    s_add_u32 s22, s93, 114688
    buffer_load_dwordx4 v6, s[40:43], s22 offen lds
    v_mfma_f32_16x16x32_bf16 v[64:67], a[248:251], a[168:171], v[64:67]
    v_mul_f32 v162, v27, v162
    v_mul_f32 v163, v27, v163
    v_mfma_f32_16x16x32_bf16 v[68:71], a[248:251], a[172:175], v[68:71]
    v_cvt_pk_bf16_f32 v122, v160, v161
    v_cvt_pk_bf16_f32 v123, v162, v163
    v_mfma_f32_16x16x32_bf16 v[72:75], a[248:251], a[176:179], v[72:75]
    ds_read_b64_tr_b16 a[220:221], v16 offset:25600
    s_waitcnt lgkmcnt(3)
    v_mfma_f32_16x16x32_bf16 v[76:79], a[252:255], a[160:163], v[76:79]
    ds_read_b64_tr_b16 a[222:223], v16 offset:27648
    v_mul_f32 v124, v28, v124
    v_mfma_f32_16x16x32_bf16 v[80:83], a[252:255], a[164:167], v[80:83]
    v_mul_f32 v125, v28, v125
    v_mul_f32 v126, v28, v126
    v_mfma_f32_16x16x32_bf16 v[84:87], a[252:255], a[168:171], v[84:87]
    v_mul_f32 v127, v28, v127
    v_cvt_pk_bf16_f32 v124, v124, v125
    v_mfma_f32_16x16x32_bf16 v[88:91], a[252:255], a[172:175], v[88:91]
    buffer_store_dwordx4 v[120:123], v20, s[44:47], s62 offen offset:1024 sc1
    ds_read_b64_tr_b16 a[200:201], v17 offset:25600
    v_mfma_f32_16x16x32_bf16 v[92:95], a[252:255], a[176:179], v[92:95]
    ds_read_b64_tr_b16 a[202:203], v17 offset:27648
    s_waitcnt lgkmcnt(4)
    v_mfma_f32_16x16x32_bf16 v[56:59], a[216:219], v[136:139], v[56:59]
    ds_read_b64_tr_b16 a[204:205], v18 offset:25600
    ds_read_b64_tr_b16 a[206:207], v18 offset:27648
    v_mfma_f32_16x16x32_bf16 v[60:63], a[216:219], v[140:143], v[60:63]
    v_cvt_pk_bf16_f32 v125, v126, v127
    v_mul_f32 v164, v28, v164
    v_mfma_f32_16x16x32_bf16 v[64:67], a[216:219], v[144:147], v[64:67]
    buffer_load_dwordx4 v7, s[40:43], s22 offen offset:1024 lds
    v_mul_f32 v165, v28, v165
    v_mfma_f32_16x16x32_bf16 v[68:71], a[216:219], v[148:151], v[68:71]
    v_mul_f32 v166, v28, v166
    v_mul_f32 v167, v28, v167
    v_mfma_f32_16x16x32_bf16 v[72:75], a[216:219], v[152:155], v[72:75]
    v_cvt_pk_bf16_f32 v126, v164, v165
    s_waitcnt lgkmcnt(4)
    v_mfma_f32_16x16x32_bf16 v[76:79], a[220:223], v[136:139], v[76:79]
    v_cvt_pk_bf16_f32 v127, v166, v167
    v_mul_f32 v128, v29, v128
    v_mfma_f32_16x16x32_bf16 v[80:83], a[220:223], v[140:143], v[80:83]
    v_mul_f32 v129, v29, v129
    v_mul_f32 v130, v29, v130
    v_mfma_f32_16x16x32_bf16 v[84:87], a[220:223], v[144:147], v[84:87]
    v_mul_f32 v131, v29, v131
    v_cvt_pk_bf16_f32 v128, v128, v129
    v_mfma_f32_16x16x32_bf16 v[88:91], a[220:223], v[148:151], v[88:91]
    v_cvt_pk_bf16_f32 v129, v130, v131
    v_mul_f32 v168, v29, v168
    v_mfma_f32_16x16x32_bf16 v[92:95], a[220:223], v[152:155], v[92:95]
    s_waitcnt vmcnt(21) lgkmcnt(0)
    s_barrier
    v_mfma_f32_16x16x32_bf16 v[56:59], a[200:203], a[180:183], v[56:59]
    ds_read_b64_tr_b16 a[208:209], v15 offset:34816
    ds_read_b64_tr_b16 a[210:211], v15 offset:36864
    v_mfma_f32_16x16x32_bf16 v[60:63], a[200:203], a[184:187], v[60:63]
    buffer_load_dwordx4 v8, s[40:43], s22 offen offset:2048 lds
    ds_read_b64_tr_b16 a[212:213], v16 offset:34816
    v_mfma_f32_16x16x32_bf16 v[64:67], a[200:203], a[188:191], v[64:67]
    buffer_store_dwordx4 v[124:127], v20, s[44:47], s62 offen offset:2048 sc1
    ds_read_b64_tr_b16 a[214:215], v16 offset:36864
    v_mfma_f32_16x16x32_bf16 v[68:71], a[200:203], a[192:195], v[68:71]
    v_mul_f32 v169, v29, v169
    v_mul_f32 v170, v29, v170
    v_mfma_f32_16x16x32_bf16 v[72:75], a[200:203], a[196:199], v[72:75]
    v_mul_f32 v171, v29, v171
    v_cvt_pk_bf16_f32 v130, v168, v169
    v_mfma_f32_16x16x32_bf16 v[76:79], a[204:207], a[180:183], v[76:79]
    v_cvt_pk_bf16_f32 v131, v170, v171
    ds_read_b64_tr_b16 a[224:225], v17 offset:34816
    v_mfma_f32_16x16x32_bf16 v[80:83], a[204:207], a[184:187], v[80:83]
    ds_read_b64_tr_b16 a[226:227], v17 offset:36864
    v_mul_f32 v132, v30, v132
    v_mfma_f32_16x16x32_bf16 v[84:87], a[204:207], a[188:191], v[84:87]
    v_mul_f32 v133, v30, v133
    v_mul_f32 v134, v30, v134
    v_mfma_f32_16x16x32_bf16 v[88:91], a[204:207], a[192:195], v[88:91]
    v_mul_f32 v135, v30, v135
    v_cvt_pk_bf16_f32 v132, v132, v133
    v_mfma_f32_16x16x32_bf16 v[92:95], a[204:207], a[196:199], v[92:95]
    buffer_load_dwordx4 v9, s[40:43], s22 offen offset:3072 lds
    s_waitcnt lgkmcnt(4)
    v_mfma_f32_16x16x32_bf16 v[56:59], a[208:211], v[176:179], v[56:59]
    ds_read_b64_tr_b16 a[228:229], v18 offset:34816
    ds_read_b64_tr_b16 a[230:231], v18 offset:36864
    v_mfma_f32_16x16x32_bf16 v[60:63], a[208:211], v[180:183], v[60:63]
    v_cvt_pk_bf16_f32 v133, v134, v135
    v_mul_f32 v172, v30, v172
    v_mfma_f32_16x16x32_bf16 v[64:67], a[208:211], v[184:187], v[64:67]
    v_mul_f32 v173, v30, v173
    v_mul_f32 v174, v30, v174
    v_mfma_f32_16x16x32_bf16 v[68:71], a[208:211], v[188:191], v[68:71]
    v_mul_f32 v175, v30, v175
    ds_read_b64_tr_b16 a[232:233], v15 offset:43008
    v_mfma_f32_16x16x32_bf16 v[72:75], a[208:211], v[192:195], v[72:75]
    ds_read_b64_tr_b16 a[234:235], v15 offset:45056
    s_waitcnt lgkmcnt(6)
    v_mfma_f32_16x16x32_bf16 v[76:79], a[212:215], v[176:179], v[76:79]
    v_cvt_pk_bf16_f32 v134, v172, v173
    v_cvt_pk_bf16_f32 v135, v174, v175
    v_mfma_f32_16x16x32_bf16 v[80:83], a[212:215], v[180:183], v[80:83]
    ds_read_b64_tr_b16 a[236:237], v16 offset:43008
    ds_read_b64_tr_b16 a[238:239], v16 offset:45056
    v_mfma_f32_16x16x32_bf16 v[84:87], a[212:215], v[184:187], v[84:87]
    buffer_store_dwordx4 v[128:131], v20, s[44:47], s62 offen offset:3072 sc1
    s_add_u32 s62, s62, 20480
    v_mfma_f32_16x16x32_bf16 v[88:91], a[212:215], v[188:191], v[88:91]
    ds_read_b64_tr_b16 a[240:241], v17 offset:43008
    ds_read_b64_tr_b16 a[242:243], v17 offset:45056
    v_mfma_f32_16x16x32_bf16 v[92:95], a[212:215], v[192:195], v[92:95]
    s_waitcnt lgkmcnt(8)
    v_mfma_f32_16x16x32_bf16 v[56:59], a[224:227], v[196:199], v[56:59]
    v_mfma_f32_16x16x32_bf16 v[60:63], a[224:227], v[200:203], v[60:63]
    s_add_u32 m0, s60, 143360
    s_add_u32 s22, s94, 0
    buffer_load_dwordx4 v6, s[40:43], s22 offen lds
    v_mfma_f32_16x16x32_bf16 v[64:67], a[224:227], v[204:207], v[64:67]
    s_waitcnt vmcnt(10)
    v_mov_b32 v25, 1
    buffer_atomic_umax v25, v3, s[52:55], 0 offen sc1
    v_mfma_f32_16x16x32_bf16 v[68:71], a[224:227], v[208:211], v[68:71]
    ds_read_b64_tr_b16 a[244:245], v18 offset:43008
    ds_read_b64_tr_b16 a[246:247], v18 offset:45056
    v_mfma_f32_16x16x32_bf16 v[72:75], a[224:227], v[212:215], v[72:75]
    s_waitcnt lgkmcnt(8)
    v_mfma_f32_16x16x32_bf16 v[76:79], a[228:231], v[196:199], v[76:79]
    v_mfma_f32_16x16x32_bf16 v[80:83], a[228:231], v[200:203], v[80:83]
    v_mfma_f32_16x16x32_bf16 v[84:87], a[228:231], v[204:207], v[84:87]
    v_mfma_f32_16x16x32_bf16 v[88:91], a[228:231], v[208:211], v[88:91]
    v_mfma_f32_16x16x32_bf16 v[92:95], a[228:231], v[212:215], v[92:95]
    buffer_load_dwordx4 v7, s[40:43], s22 offen offset:1024 lds
    s_waitcnt lgkmcnt(6)
    v_mfma_f32_16x16x32_bf16 v[56:59], a[232:235], v[216:219], v[56:59]
    v_mfma_f32_16x16x32_bf16 v[60:63], a[232:235], v[220:223], v[60:63]
    v_mfma_f32_16x16x32_bf16 v[64:67], a[232:235], v[224:227], v[64:67]
    buffer_store_dwordx4 v[132:135], v20, s[44:47], s63 offen sc1
    s_add_u32 s63, s63, 20480
    v_mfma_f32_16x16x32_bf16 v[68:71], a[232:235], v[228:231], v[68:71]
    v_mfma_f32_16x16x32_bf16 v[72:75], a[232:235], v[232:235], v[72:75]
    s_waitcnt lgkmcnt(4)
    v_mfma_f32_16x16x32_bf16 v[76:79], a[236:239], v[216:219], v[76:79]
    v_mfma_f32_16x16x32_bf16 v[80:83], a[236:239], v[220:223], v[80:83]
    v_mfma_f32_16x16x32_bf16 v[84:87], a[236:239], v[224:227], v[84:87]
    v_mfma_f32_16x16x32_bf16 v[88:91], a[236:239], v[228:231], v[88:91]
    v_mfma_f32_16x16x32_bf16 v[92:95], a[236:239], v[232:235], v[92:95]
    s_waitcnt lgkmcnt(0)
    s_barrier
    v_mfma_f32_16x16x32_bf16 v[56:59], a[240:243], v[236:239], v[56:59]
    ds_read_b64_tr_b16 a[248:249], v15 offset:52224
    ds_read_b64_tr_b16 a[250:251], v15 offset:54272
    v_mfma_f32_16x16x32_bf16 v[60:63], a[240:243], v[240:243], v[60:63]
    buffer_load_dwordx4 v8, s[40:43], s22 offen offset:2048 lds
    ds_read_b64_tr_b16 a[252:253], v16 offset:52224
    v_mfma_f32_16x16x32_bf16 v[64:67], a[240:243], v[244:247], v[64:67]
    ds_read_b64_tr_b16 a[254:255], v16 offset:54272
    ds_read_b64_tr_b16 a[216:217], v17 offset:52224
    v_mfma_f32_16x16x32_bf16 v[68:71], a[240:243], v[248:251], v[68:71]
    v_mul_f32 v56, v26, v56
    v_mul_f32 v57, v26, v57
    v_mfma_f32_16x16x32_bf16 v[72:75], a[240:243], v[252:255], v[72:75]
    v_mul_f32 v58, v26, v58
    v_mul_f32 v59, v26, v59
    v_mfma_f32_16x16x32_bf16 v[76:79], a[244:247], v[236:239], v[76:79]
    v_cvt_pk_bf16_f32 v56, v56, v57
    v_cvt_pk_bf16_f32 v57, v58, v59
    v_mfma_f32_16x16x32_bf16 v[80:83], a[244:247], v[240:243], v[80:83]
    ds_read_b64_tr_b16 a[218:219], v17 offset:54272
    ds_read_b64_tr_b16 a[220:221], v18 offset:52224
    v_mfma_f32_16x16x32_bf16 v[84:87], a[244:247], v[244:247], v[84:87]
    ds_read_b64_tr_b16 a[222:223], v18 offset:54272
    ds_read_b64_tr_b16 a[200:201], v15 offset:60416
    v_mfma_f32_16x16x32_bf16 v[88:91], a[244:247], v[248:251], v[88:91]
    v_mul_f32 v76, v26, v76
    v_mul_f32 v77, v26, v77
    v_mfma_f32_16x16x32_bf16 v[92:95], a[244:247], v[252:255], v[92:95]
    v_mul_f32 v78, v26, v78
    s_waitcnt lgkmcnt(7)
    v_mfma_f32_16x16x32_bf16 v[116:119], a[248:251], v[96:99], 0
    v_mul_f32 v79, v26, v79
    buffer_load_dwordx4 v9, s[40:43], s22 offen offset:3072 lds
    v_mfma_f32_16x16x32_bf16 v[120:123], a[248:251], v[100:103], 0
    v_cvt_pk_bf16_f32 v58, v76, v77
    v_cvt_pk_bf16_f32 v59, v78, v79
    v_mfma_f32_16x16x32_bf16 v[124:127], a[248:251], v[104:107], 0
    v_mul_f32 v60, v27, v60
    v_mul_f32 v61, v27, v61
    v_mfma_f32_16x16x32_bf16 v[128:131], a[248:251], v[108:111], 0
    v_mul_f32 v62, v27, v62
    v_mul_f32 v63, v27, v63
    v_mfma_f32_16x16x32_bf16 v[132:135], a[248:251], v[112:115], 0
    buffer_store_dwordx4 v[56:59], v20, s[44:47], s62 offen sc1
    s_waitcnt lgkmcnt(5)
    v_mfma_f32_16x16x32_bf16 v[156:159], a[252:255], v[96:99], 0
    v_cvt_pk_bf16_f32 v60, v60, v61
    v_cvt_pk_bf16_f32 v61, v62, v63
    v_mfma_f32_16x16x32_bf16 v[160:163], a[252:255], v[100:103], 0
    v_mul_f32 v80, v27, v80
    ds_read_b64_tr_b16 a[202:203], v15 offset:62464
    v_mfma_f32_16x16x32_bf16 v[164:167], a[252:255], v[104:107], 0
    v_mul_f32 v81, v27, v81
    v_mul_f32 v82, v27, v82
    v_mfma_f32_16x16x32_bf16 v[168:171], a[252:255], v[108:111], 0
    v_mul_f32 v83, v27, v83
    v_cvt_pk_bf16_f32 v62, v80, v81
    v_mfma_f32_16x16x32_bf16 v[172:175], a[252:255], v[112:115], 0
    s_add_u32 m0, s60, 0
    s_add_u32 s22, s94, 114688
    buffer_load_dwordx4 v6, s[40:43], s22 offen lds
    s_waitcnt lgkmcnt(4)
    v_mfma_f32_16x16x32_bf16 v[116:119], a[216:219], a[160:163], v[116:119]
    v_cvt_pk_bf16_f32 v63, v82, v83
    ds_read_b64_tr_b16 a[204:205], v16 offset:60416
    v_mfma_f32_16x16x32_bf16 v[120:123], a[216:219], a[164:167], v[120:123]
    ds_read_b64_tr_b16 a[206:207], v16 offset:62464
    v_mul_f32 v64, v28, v64
    v_mfma_f32_16x16x32_bf16 v[124:127], a[216:219], a[168:171], v[124:127]
    v_mul_f32 v65, v28, v65
    v_mul_f32 v66, v28, v66
    v_mfma_f32_16x16x32_bf16 v[128:131], a[216:219], a[172:175], v[128:131]
    v_mul_f32 v67, v28, v67
    v_cvt_pk_bf16_f32 v64, v64, v65
    v_mfma_f32_16x16x32_bf16 v[132:135], a[216:219], a[176:179], v[132:135]
    ds_read_b64_tr_b16 a[208:209], v17 offset:60416
    s_waitcnt lgkmcnt(5)
    v_mfma_f32_16x16x32_bf16 v[156:159], a[220:223], a[160:163], v[156:159]
    ds_read_b64_tr_b16 a[210:211], v17 offset:62464
    v_cvt_pk_bf16_f32 v65, v66, v67
    v_mfma_f32_16x16x32_bf16 v[160:163], a[220:223], a[164:167], v[160:163]
    v_mul_f32 v84, v28, v84
    v_mul_f32 v85, v28, v85
    v_mfma_f32_16x16x32_bf16 v[164:167], a[220:223], a[168:171], v[164:167]
    buffer_store_dwordx4 v[60:63], v20, s[44:47], s62 offen offset:1024 sc1
    v_mul_f32 v86, v28, v86
    v_mfma_f32_16x16x32_bf16 v[168:171], a[220:223], a[172:175], v[168:171]
    ds_read_b64_tr_b16 a[212:213], v18 offset:60416
    ds_read_b64_tr_b16 a[214:215], v18 offset:62464
    v_mfma_f32_16x16x32_bf16 v[172:175], a[220:223], a[176:179], v[172:175]
    v_mul_f32 v87, v28, v87
    s_waitcnt lgkmcnt(6)
    v_mfma_f32_16x16x32_bf16 v[116:119], a[200:203], v[136:139], v[116:119]
    v_cvt_pk_bf16_f32 v66, v84, v85
    v_cvt_pk_bf16_f32 v67, v86, v87
    v_mfma_f32_16x16x32_bf16 v[120:123], a[200:203], v[140:143], v[120:123]
    buffer_load_dwordx4 v7, s[40:43], s22 offen offset:1024 lds
    v_mul_f32 v68, v29, v68
    v_mfma_f32_16x16x32_bf16 v[124:127], a[200:203], v[144:147], v[124:127]
    v_mul_f32 v69, v29, v69
    v_add_u32 v15, 0x11000, v15
    ds_read_b64_tr_b16 a[224:225], v15
    v_mfma_f32_16x16x32_bf16 v[128:131], a[200:203], v[148:151], v[128:131]
    ds_read_b64_tr_b16 a[226:227], v15 offset:2048
    v_mul_f32 v70, v29, v70
    v_mfma_f32_16x16x32_bf16 v[132:135], a[200:203], v[152:155], v[132:135]
    v_mul_f32 v71, v29, v71
    s_waitcnt lgkmcnt(6)
    v_mfma_f32_16x16x32_bf16 v[156:159], a[204:207], v[136:139], v[156:159]
    v_cvt_pk_bf16_f32 v68, v68, v69
    v_cvt_pk_bf16_f32 v69, v70, v71
    v_mfma_f32_16x16x32_bf16 v[160:163], a[204:207], v[140:143], v[160:163]
    v_mul_f32 v88, v29, v88
    v_add_u32 v16, 0x11000, v16
    ds_read_b64_tr_b16 a[228:229], v16
    v_mfma_f32_16x16x32_bf16 v[164:167], a[204:207], v[144:147], v[164:167]
    ds_read_b64_tr_b16 a[230:231], v16 offset:2048
    v_mul_f32 v89, v29, v89
    v_mfma_f32_16x16x32_bf16 v[168:171], a[204:207], v[148:151], v[168:171]
    v_mul_f32 v90, v29, v90
    v_mul_f32 v91, v29, v91
    v_mfma_f32_16x16x32_bf16 v[172:175], a[204:207], v[152:155], v[172:175]
    buffer_load_dwordx4 v8, s[40:43], s22 offen offset:2048 lds
    s_waitcnt lgkmcnt(6)
    v_mfma_f32_16x16x32_bf16 v[116:119], a[208:211], a[180:183], v[116:119]
    v_cvt_pk_bf16_f32 v70, v88, v89
    v_cvt_pk_bf16_f32 v71, v90, v91
    v_mfma_f32_16x16x32_bf16 v[120:123], a[208:211], a[184:187], v[120:123]
    v_add_u32 v17, 0x11000, v17
    ds_read_b64_tr_b16 a[232:233], v17
    v_mfma_f32_16x16x32_bf16 v[124:127], a[208:211], a[188:191], v[124:127]
    buffer_store_dwordx4 v[64:67], v20, s[44:47], s62 offen offset:2048 sc1
    ds_read_b64_tr_b16 a[234:235], v17 offset:2048
    v_mfma_f32_16x16x32_bf16 v[128:131], a[208:211], a[192:195], v[128:131]
    v_mul_f32 v72, v30, v72
    v_mul_f32 v73, v30, v73
    v_mfma_f32_16x16x32_bf16 v[132:135], a[208:211], a[196:199], v[132:135]
    v_mul_f32 v74, v30, v74
    s_waitcnt lgkmcnt(6)
    v_mfma_f32_16x16x32_bf16 v[156:159], a[212:215], a[180:183], v[156:159]
    v_mul_f32 v75, v30, v75
    v_cvt_pk_bf16_f32 v72, v72, v73
    v_mfma_f32_16x16x32_bf16 v[160:163], a[212:215], a[184:187], v[160:163]
    v_add_u32 v18, 0x11000, v18
    ds_read_b64_tr_b16 a[236:237], v18
    v_mfma_f32_16x16x32_bf16 v[164:167], a[212:215], a[188:191], v[164:167]
    ds_read_b64_tr_b16 a[238:239], v18 offset:2048
    v_cvt_pk_bf16_f32 v73, v74, v75
    v_mfma_f32_16x16x32_bf16 v[168:171], a[212:215], a[192:195], v[168:171]
    v_mul_f32 v92, v30, v92
    v_mul_f32 v93, v30, v93
    v_mfma_f32_16x16x32_bf16 v[172:175], a[212:215], a[196:199], v[172:175]
    buffer_load_dwordx4 v9, s[40:43], s22 offen offset:3072 lds
    s_waitcnt lgkmcnt(6)
    v_mfma_f32_16x16x32_bf16 v[116:119], a[224:227], v[176:179], v[116:119]
    v_mul_f32 v94, v30, v94
    v_mul_f32 v95, v30, v95
    v_mfma_f32_16x16x32_bf16 v[120:123], a[224:227], v[180:183], v[120:123]
    ds_read_b64_tr_b16 a[240:241], v15 offset:8192
    ds_read_b64_tr_b16 a[242:243], v15 offset:10240
    v_mfma_f32_16x16x32_bf16 v[124:127], a[224:227], v[184:187], v[124:127]
    v_cvt_pk_bf16_f32 v74, v92, v93
    v_cvt_pk_bf16_f32 v75, v94, v95
    v_mfma_f32_16x16x32_bf16 v[128:131], a[224:227], v[188:191], v[128:131]
    ds_read_b64_tr_b16 a[244:245], v16 offset:8192
    ds_read_b64_tr_b16 a[246:247], v16 offset:10240
    v_mfma_f32_16x16x32_bf16 v[132:135], a[224:227], v[192:195], v[132:135]
    s_waitcnt lgkmcnt(8)
    v_mfma_f32_16x16x32_bf16 v[156:159], a[228:231], v[176:179], v[156:159]
    v_mfma_f32_16x16x32_bf16 v[160:163], a[228:231], v[180:183], v[160:163]
    v_mfma_f32_16x16x32_bf16 v[164:167], a[228:231], v[184:187], v[164:167]
    buffer_store_dwordx4 v[68:71], v20, s[44:47], s62 offen offset:3072 sc1
    s_add_u32 s62, s62, 20480
    v_mfma_f32_16x16x32_bf16 v[168:171], a[228:231], v[188:191], v[168:171]
    ds_read_b64_tr_b16 a[248:249], v17 offset:8192
    ds_read_b64_tr_b16 a[250:251], v17 offset:10240
    v_mfma_f32_16x16x32_bf16 v[172:175], a[228:231], v[192:195], v[172:175]
    s_waitcnt lgkmcnt(8)
    v_mfma_f32_16x16x32_bf16 v[116:119], a[232:235], v[196:199], v[116:119]
    v_mfma_f32_16x16x32_bf16 v[120:123], a[232:235], v[200:203], v[120:123]
    s_add_u32 m0, s60, 104448
    s_add_u32 s22, s95, 0
    buffer_load_dwordx4 v6, s[40:43], s22 offen lds
    v_mfma_f32_16x16x32_bf16 v[124:127], a[232:235], v[204:207], v[124:127]
    s_waitcnt vmcnt(11)
    v_mov_b32 v25, 2
    buffer_atomic_umax v25, v3, s[52:55], 0 offen sc1
    v_mfma_f32_16x16x32_bf16 v[128:131], a[232:235], v[208:211], v[128:131]
    v_mov_b32 v24, 0
    buffer_atomic_or v24, v2, s[52:55], 0 offen sc0 sc1
    v_mfma_f32_16x16x32_bf16 v[132:135], a[232:235], v[212:215], v[132:135]
    ds_read_b64_tr_b16 a[252:253], v18 offset:8192
    s_waitcnt lgkmcnt(7)
    v_mfma_f32_16x16x32_bf16 v[156:159], a[236:239], v[196:199], v[156:159]
    ds_read_b64_tr_b16 a[254:255], v18 offset:10240
    v_mfma_f32_16x16x32_bf16 v[160:163], a[236:239], v[200:203], v[160:163]
    v_mfma_f32_16x16x32_bf16 v[164:167], a[236:239], v[204:207], v[164:167]
    v_mfma_f32_16x16x32_bf16 v[168:171], a[236:239], v[208:211], v[168:171]
    v_mfma_f32_16x16x32_bf16 v[172:175], a[236:239], v[212:215], v[172:175]
    buffer_load_dwordx4 v7, s[40:43], s22 offen offset:1024 lds
    s_waitcnt lgkmcnt(6)
    v_mfma_f32_16x16x32_bf16 v[116:119], a[240:243], v[216:219], v[116:119]
    v_mfma_f32_16x16x32_bf16 v[120:123], a[240:243], v[220:223], v[120:123]
    v_mfma_f32_16x16x32_bf16 v[124:127], a[240:243], v[224:227], v[124:127]
    buffer_store_dwordx4 v[72:75], v20, s[44:47], s63 offen sc1
    s_add_u32 s63, s63, 20480
    v_mfma_f32_16x16x32_bf16 v[128:131], a[240:243], v[228:231], v[128:131]
    v_mfma_f32_16x16x32_bf16 v[132:135], a[240:243], v[232:235], v[132:135]
    s_waitcnt lgkmcnt(4)
    v_mfma_f32_16x16x32_bf16 v[156:159], a[244:247], v[216:219], v[156:159]
    v_mfma_f32_16x16x32_bf16 v[160:163], a[244:247], v[220:223], v[160:163]
    v_mfma_f32_16x16x32_bf16 v[164:167], a[244:247], v[224:227], v[164:167]
    v_mfma_f32_16x16x32_bf16 v[168:171], a[244:247], v[228:231], v[168:171]
    v_mfma_f32_16x16x32_bf16 v[172:175], a[244:247], v[232:235], v[172:175]
    s_waitcnt lgkmcnt(0)
    s_barrier
    v_mfma_f32_16x16x32_bf16 v[116:119], a[248:251], v[236:239], v[116:119]
    ds_read_b64_tr_b16 a[216:217], v15 offset:17408
    ds_read_b64_tr_b16 a[218:219], v15 offset:19456
    v_mfma_f32_16x16x32_bf16 v[120:123], a[248:251], v[240:243], v[120:123]
    buffer_load_dwordx4 v8, s[40:43], s22 offen offset:2048 lds
    ds_read_b64_tr_b16 a[220:221], v16 offset:17408
    v_mfma_f32_16x16x32_bf16 v[124:127], a[248:251], v[244:247], v[124:127]
    ds_read_b64_tr_b16 a[222:223], v16 offset:19456
    ds_read_b64_tr_b16 a[200:201], v17 offset:17408
    v_mfma_f32_16x16x32_bf16 v[128:131], a[248:251], v[248:251], v[128:131]
    v_mul_f32 v116, v26, v116
    v_mul_f32 v117, v26, v117
    v_mfma_f32_16x16x32_bf16 v[132:135], a[248:251], v[252:255], v[132:135]
    v_mul_f32 v118, v26, v118
    v_mul_f32 v119, v26, v119
    v_mfma_f32_16x16x32_bf16 v[156:159], a[252:255], v[236:239], v[156:159]
    v_cvt_pk_bf16_f32 v116, v116, v117
    v_cvt_pk_bf16_f32 v117, v118, v119
    v_mfma_f32_16x16x32_bf16 v[160:163], a[252:255], v[240:243], v[160:163]
    ds_read_b64_tr_b16 a[202:203], v17 offset:19456
    ds_read_b64_tr_b16 a[204:205], v18 offset:17408
    v_mfma_f32_16x16x32_bf16 v[164:167], a[252:255], v[244:247], v[164:167]
    ds_read_b64_tr_b16 a[206:207], v18 offset:19456
    ds_read_b64_tr_b16 a[208:209], v15 offset:25600
    v_mfma_f32_16x16x32_bf16 v[168:171], a[252:255], v[248:251], v[168:171]
    v_mul_f32 v156, v26, v156
    v_mul_f32 v157, v26, v157
    v_mfma_f32_16x16x32_bf16 v[172:175], a[252:255], v[252:255], v[172:175]
    v_mul_f32 v158, v26, v158
    s_waitcnt lgkmcnt(7)
    v_mfma_f32_16x16x32_bf16 v[56:59], a[216:219], v[96:99], 0
    v_mul_f32 v159, v26, v159
    buffer_load_dwordx4 v9, s[40:43], s22 offen offset:3072 lds
    v_mfma_f32_16x16x32_bf16 v[60:63], a[216:219], v[100:103], 0
    v_cvt_pk_bf16_f32 v118, v156, v157
    v_cvt_pk_bf16_f32 v119, v158, v159
    v_mfma_f32_16x16x32_bf16 v[64:67], a[216:219], v[104:107], 0
    v_mul_f32 v120, v27, v120
    v_mul_f32 v121, v27, v121
    v_mfma_f32_16x16x32_bf16 v[68:71], a[216:219], v[108:111], 0
    v_mul_f32 v122, v27, v122
    v_mul_f32 v123, v27, v123
    v_mfma_f32_16x16x32_bf16 v[72:75], a[216:219], v[112:115], 0
    buffer_store_dwordx4 v[116:119], v20, s[44:47], s62 offen sc1
    s_waitcnt lgkmcnt(5)
    v_mfma_f32_16x16x32_bf16 v[76:79], a[220:223], v[96:99], 0
    v_cvt_pk_bf16_f32 v120, v120, v121
    v_cvt_pk_bf16_f32 v121, v122, v123
    v_mfma_f32_16x16x32_bf16 v[80:83], a[220:223], v[100:103], 0
    v_mul_f32 v160, v27, v160
    ds_read_b64_tr_b16 a[210:211], v15 offset:27648
    v_mfma_f32_16x16x32_bf16 v[84:87], a[220:223], v[104:107], 0
    v_mul_f32 v161, v27, v161
    v_mul_f32 v162, v27, v162
    v_mfma_f32_16x16x32_bf16 v[88:91], a[220:223], v[108:111], 0
    v_mul_f32 v163, v27, v163
    v_cvt_pk_bf16_f32 v122, v160, v161
    v_mfma_f32_16x16x32_bf16 v[92:95], a[220:223], v[112:115], 0
    s_add_u32 m0, s60, 17408
    s_add_u32 s22, s95, 114688
    buffer_load_dwordx4 v6, s[40:43], s22 offen lds
    s_waitcnt lgkmcnt(4)
    v_mfma_f32_16x16x32_bf16 v[56:59], a[200:203], a[160:163], v[56:59]
    v_cvt_pk_bf16_f32 v123, v162, v163
    ds_read_b64_tr_b16 a[212:213], v16 offset:25600
    v_mfma_f32_16x16x32_bf16 v[60:63], a[200:203], a[164:167], v[60:63]
    ds_read_b64_tr_b16 a[214:215], v16 offset:27648
    v_mul_f32 v124, v28, v124
    v_mfma_f32_16x16x32_bf16 v[64:67], a[200:203], a[168:171], v[64:67]
    v_mul_f32 v125, v28, v125
    v_mul_f32 v126, v28, v126
    v_mfma_f32_16x16x32_bf16 v[68:71], a[200:203], a[172:175], v[68:71]
    v_mul_f32 v127, v28, v127
    v_cvt_pk_bf16_f32 v124, v124, v125
    v_mfma_f32_16x16x32_bf16 v[72:75], a[200:203], a[176:179], v[72:75]
    ds_read_b64_tr_b16 a[224:225], v17 offset:25600
    s_waitcnt lgkmcnt(5)
    v_mfma_f32_16x16x32_bf16 v[76:79], a[204:207], a[160:163], v[76:79]
    ds_read_b64_tr_b16 a[226:227], v17 offset:27648
    v_cvt_pk_bf16_f32 v125, v126, v127
    v_mfma_f32_16x16x32_bf16 v[80:83], a[204:207], a[164:167], v[80:83]
    v_mul_f32 v164, v28, v164
    v_mul_f32 v165, v28, v165
    v_mfma_f32_16x16x32_bf16 v[84:87], a[204:207], a[168:171], v[84:87]
    buffer_store_dwordx4 v[120:123], v20, s[44:47], s62 offen offset:1024 sc1
    v_mul_f32 v166, v28, v166
    v_mfma_f32_16x16x32_bf16 v[88:91], a[204:207], a[172:175], v[88:91]
    ds_read_b64_tr_b16 a[228:229], v18 offset:25600
    ds_read_b64_tr_b16 a[230:231], v18 offset:27648
    v_mfma_f32_16x16x32_bf16 v[92:95], a[204:207], a[176:179], v[92:95]
    v_mul_f32 v167, v28, v167
    s_waitcnt lgkmcnt(6)
    v_mfma_f32_16x16x32_bf16 v[56:59], a[208:211], v[136:139], v[56:59]
    v_cvt_pk_bf16_f32 v126, v164, v165
    v_cvt_pk_bf16_f32 v127, v166, v167
    v_mfma_f32_16x16x32_bf16 v[60:63], a[208:211], v[140:143], v[60:63]
    buffer_load_dwordx4 v7, s[40:43], s22 offen offset:1024 lds
    v_mul_f32 v128, v29, v128
    v_mfma_f32_16x16x32_bf16 v[64:67], a[208:211], v[144:147], v[64:67]
    v_mul_f32 v129, v29, v129
    ds_read_b64_tr_b16 a[232:233], v15 offset:52224
    v_mfma_f32_16x16x32_bf16 v[68:71], a[208:211], v[148:151], v[68:71]
    ds_read_b64_tr_b16 a[234:235], v15 offset:54272
    v_mul_f32 v130, v29, v130
    v_mfma_f32_16x16x32_bf16 v[72:75], a[208:211], v[152:155], v[72:75]
    v_mul_f32 v131, v29, v131
    s_waitcnt lgkmcnt(6)
    v_mfma_f32_16x16x32_bf16 v[76:79], a[212:215], v[136:139], v[76:79]
    v_cvt_pk_bf16_f32 v128, v128, v129
    v_cvt_pk_bf16_f32 v129, v130, v131
    v_mfma_f32_16x16x32_bf16 v[80:83], a[212:215], v[140:143], v[80:83]
    v_mul_f32 v168, v29, v168
    ds_read_b64_tr_b16 a[236:237], v16 offset:52224
    v_mfma_f32_16x16x32_bf16 v[84:87], a[212:215], v[144:147], v[84:87]
    ds_read_b64_tr_b16 a[238:239], v16 offset:54272
    v_mul_f32 v169, v29, v169
    v_mfma_f32_16x16x32_bf16 v[88:91], a[212:215], v[148:151], v[88:91]
    v_mul_f32 v170, v29, v170
    v_mul_f32 v171, v29, v171
    v_mfma_f32_16x16x32_bf16 v[92:95], a[212:215], v[152:155], v[92:95]
    buffer_load_dwordx4 v8, s[40:43], s22 offen offset:2048 lds
    s_waitcnt lgkmcnt(6)
    v_mfma_f32_16x16x32_bf16 v[56:59], a[224:227], a[180:183], v[56:59]
    v_cvt_pk_bf16_f32 v130, v168, v169
    v_cvt_pk_bf16_f32 v131, v170, v171
    v_mfma_f32_16x16x32_bf16 v[60:63], a[224:227], a[184:187], v[60:63]
    ds_read_b64_tr_b16 a[240:241], v17 offset:52224
    ds_read_b64_tr_b16 a[242:243], v17 offset:54272
    v_mfma_f32_16x16x32_bf16 v[64:67], a[224:227], a[188:191], v[64:67]
    buffer_store_dwordx4 v[124:127], v20, s[44:47], s62 offen offset:2048 sc1
    v_mul_f32 v132, v30, v132
    v_mfma_f32_16x16x32_bf16 v[68:71], a[224:227], a[192:195], v[68:71]
    v_mul_f32 v133, v30, v133
    v_mul_f32 v134, v30, v134
    v_mfma_f32_16x16x32_bf16 v[72:75], a[224:227], a[196:199], v[72:75]
    v_mul_f32 v135, v30, v135
    s_waitcnt lgkmcnt(6)
    v_mfma_f32_16x16x32_bf16 v[76:79], a[228:231], a[180:183], v[76:79]
    v_cvt_pk_bf16_f32 v132, v132, v133
    ds_read_b64_tr_b16 a[244:245], v18 offset:52224
    v_mfma_f32_16x16x32_bf16 v[80:83], a[228:231], a[184:187], v[80:83]
    ds_read_b64_tr_b16 a[246:247], v18 offset:54272
    v_cvt_pk_bf16_f32 v133, v134, v135
    v_mfma_f32_16x16x32_bf16 v[84:87], a[228:231], a[188:191], v[84:87]
    v_mul_f32 v172, v30, v172
    v_mul_f32 v173, v30, v173
    v_mfma_f32_16x16x32_bf16 v[88:91], a[228:231], a[192:195], v[88:91]
    v_mul_f32 v174, v30, v174
    v_mul_f32 v175, v30, v175
    v_mfma_f32_16x16x32_bf16 v[92:95], a[228:231], a[196:199], v[92:95]
    buffer_load_dwordx4 v9, s[40:43], s22 offen offset:3072 lds
    s_waitcnt lgkmcnt(6)
    v_mfma_f32_16x16x32_bf16 v[56:59], a[232:235], v[176:179], v[56:59]
    ds_read_b64_tr_b16 a[248:249], v15 offset:60416
    ds_read_b64_tr_b16 a[250:251], v15 offset:62464
    v_mfma_f32_16x16x32_bf16 v[60:63], a[232:235], v[180:183], v[60:63]
    v_cvt_pk_bf16_f32 v134, v172, v173
    v_cvt_pk_bf16_f32 v135, v174, v175
    v_mfma_f32_16x16x32_bf16 v[64:67], a[232:235], v[184:187], v[64:67]
    ds_read_b64_tr_b16 a[252:253], v16 offset:60416
    ds_read_b64_tr_b16 a[254:255], v16 offset:62464
    v_mfma_f32_16x16x32_bf16 v[68:71], a[232:235], v[188:191], v[68:71]
    v_mfma_f32_16x16x32_bf16 v[72:75], a[232:235], v[192:195], v[72:75]
    s_waitcnt lgkmcnt(8)
    v_mfma_f32_16x16x32_bf16 v[76:79], a[236:239], v[176:179], v[76:79]
    v_mfma_f32_16x16x32_bf16 v[80:83], a[236:239], v[180:183], v[80:83]
    v_mfma_f32_16x16x32_bf16 v[84:87], a[236:239], v[184:187], v[84:87]
    buffer_store_dwordx4 v[128:131], v20, s[44:47], s62 offen offset:3072 sc1
    s_add_u32 s62, s62, 20480
    v_mfma_f32_16x16x32_bf16 v[88:91], a[236:239], v[188:191], v[88:91]
    ds_read_b64_tr_b16 a[216:217], v17 offset:60416
    ds_read_b64_tr_b16 a[218:219], v17 offset:62464
    v_mfma_f32_16x16x32_bf16 v[92:95], a[236:239], v[192:195], v[92:95]
    s_waitcnt lgkmcnt(8)
    v_mfma_f32_16x16x32_bf16 v[56:59], a[240:243], v[196:199], v[56:59]
    v_mfma_f32_16x16x32_bf16 v[60:63], a[240:243], v[200:203], v[60:63]
    s_waitcnt vmcnt(10)
    v_mov_b32 v25, 3
    buffer_atomic_umax v25, v3, s[52:55], 0 offen sc1
    v_mfma_f32_16x16x32_bf16 v[64:67], a[240:243], v[204:207], v[64:67]
    v_cmp_gt_u32 vcc, 1, v24
    s_and_b32 s3, vcc_lo, 0xffff
    s_cselect_b32 s84, 0x1000000, 0
    v_mfma_f32_16x16x32_bf16 v[68:71], a[240:243], v[208:211], v[68:71]
    v_mov_b32 v24, 0
    buffer_atomic_or v24, v2, s[52:55], 0 offen sc0 sc1
    v_mfma_f32_16x16x32_bf16 v[72:75], a[240:243], v[212:215], v[72:75]
    s_add_u32 s88, s84, 0
    buffer_load_dwordx4 a[0:3], v4, s[48:51], s88 offen sc1
    s_waitcnt lgkmcnt(6)
    v_mfma_f32_16x16x32_bf16 v[76:79], a[244:247], v[196:199], v[76:79]
    s_add_u32 s88, s84, 573440
    buffer_load_dwordx4 a[4:7], v4, s[48:51], s88 offen sc1
    v_mfma_f32_16x16x32_bf16 v[80:83], a[244:247], v[200:203], v[80:83]
    ds_read_b64_tr_b16 a[220:221], v18 offset:60416
    ds_read_b64_tr_b16 a[222:223], v18 offset:62464
    v_mfma_f32_16x16x32_bf16 v[84:87], a[244:247], v[204:207], v[84:87]
    s_add_u32 s88, s84, 1146880
    buffer_load_dwordx4 a[8:11], v4, s[48:51], s88 offen sc1
    v_mfma_f32_16x16x32_bf16 v[88:91], a[244:247], v[208:211], v[88:91]
    s_add_u32 s88, s84, 1720320
    buffer_load_dwordx4 a[12:15], v4, s[48:51], s88 offen sc1
    v_mfma_f32_16x16x32_bf16 v[92:95], a[244:247], v[212:215], v[92:95]
    s_waitcnt lgkmcnt(6)
    v_mfma_f32_16x16x32_bf16 v[56:59], a[248:251], v[216:219], v[56:59]
    v_mfma_f32_16x16x32_bf16 v[60:63], a[248:251], v[220:223], v[60:63]
    v_mfma_f32_16x16x32_bf16 v[64:67], a[248:251], v[224:227], v[64:67]
    buffer_store_dwordx4 v[132:135], v20, s[44:47], s63 offen sc1
    s_add_u32 s63, s63, 20480
    v_mfma_f32_16x16x32_bf16 v[68:71], a[248:251], v[228:231], v[68:71]
    v_mfma_f32_16x16x32_bf16 v[72:75], a[248:251], v[232:235], v[72:75]
    s_waitcnt lgkmcnt(4)
    v_mfma_f32_16x16x32_bf16 v[76:79], a[252:255], v[216:219], v[76:79]
    v_mfma_f32_16x16x32_bf16 v[80:83], a[252:255], v[220:223], v[80:83]
    v_mfma_f32_16x16x32_bf16 v[84:87], a[252:255], v[224:227], v[84:87]
    v_mfma_f32_16x16x32_bf16 v[88:91], a[252:255], v[228:231], v[88:91]
    v_mfma_f32_16x16x32_bf16 v[92:95], a[252:255], v[232:235], v[92:95]
    s_waitcnt lgkmcnt(0)
    s_barrier
    v_mfma_f32_16x16x32_bf16 v[56:59], a[216:219], v[236:239], v[56:59]
    v_add_u32 v15, 0x12000, v15
    ds_read_b64_tr_b16 a[200:201], v15
    v_mfma_f32_16x16x32_bf16 v[60:63], a[216:219], v[240:243], v[60:63]
    ds_read_b64_tr_b16 a[202:203], v15 offset:2048
    v_add_u32 v16, 0x12000, v16
    ds_read_b64_tr_b16 a[204:205], v16
    v_mfma_f32_16x16x32_bf16 v[64:67], a[216:219], v[244:247], v[64:67]
    ds_read_b64_tr_b16 a[206:207], v16 offset:2048
    v_mul_f32 v56, v26, v56
    v_mfma_f32_16x16x32_bf16 v[68:71], a[216:219], v[248:251], v[68:71]
    v_mul_f32 v57, v26, v57
    v_mul_f32 v58, v26, v58
    v_mfma_f32_16x16x32_bf16 v[72:75], a[216:219], v[252:255], v[72:75]
    v_mul_f32 v59, v26, v59
    v_cvt_pk_bf16_f32 v56, v56, v57
    v_mfma_f32_16x16x32_bf16 v[76:79], a[220:223], v[236:239], v[76:79]
    v_cvt_pk_bf16_f32 v57, v58, v59
    v_add_u32 v17, 0x12000, v17
    ds_read_b64_tr_b16 a[208:209], v17
    v_mfma_f32_16x16x32_bf16 v[80:83], a[220:223], v[240:243], v[80:83]
    ds_read_b64_tr_b16 a[210:211], v17 offset:2048
    v_add_u32 v18, 0x12000, v18
    ds_read_b64_tr_b16 a[212:213], v18
    v_mfma_f32_16x16x32_bf16 v[84:87], a[220:223], v[244:247], v[84:87]
    v_mul_f32 v76, v26, v76
    v_mul_f32 v77, v26, v77
    v_mfma_f32_16x16x32_bf16 v[88:91], a[220:223], v[248:251], v[88:91]
    v_mul_f32 v78, v26, v78
    v_mul_f32 v79, v26, v79
    v_mfma_f32_16x16x32_bf16 v[92:95], a[220:223], v[252:255], v[92:95]
    v_cvt_pk_bf16_f32 v58, v76, v77
    s_waitcnt lgkmcnt(5)
    v_mfma_f32_16x16x32_bf16 v[116:119], a[200:203], v[96:99], 0
    v_cvt_pk_bf16_f32 v59, v78, v79
    v_mul_f32 v60, v27, v60
    v_mfma_f32_16x16x32_bf16 v[120:123], a[200:203], v[100:103], 0
    v_mul_f32 v61, v27, v61
    ds_read_b64_tr_b16 a[214:215], v18 offset:2048
    v_mfma_f32_16x16x32_bf16 v[124:127], a[200:203], v[104:107], 0
    v_mul_f32 v62, v27, v62
    v_mul_f32 v63, v27, v63
    v_mfma_f32_16x16x32_bf16 v[128:131], a[200:203], v[108:111], 0
    buffer_store_dwordx4 v[56:59], v20, s[44:47], s62 offen sc1
    v_cvt_pk_bf16_f32 v60, v60, v61
    v_mfma_f32_16x16x32_bf16 v[132:135], a[200:203], v[112:115], 0
    v_cvt_pk_bf16_f32 v61, v62, v63
    s_waitcnt lgkmcnt(4)
    v_mfma_f32_16x16x32_bf16 v[156:159], a[204:207], v[96:99], 0
    v_mul_f32 v80, v27, v80
    ds_read_b64_tr_b16 a[224:225], v15 offset:8192
    v_mfma_f32_16x16x32_bf16 v[160:163], a[204:207], v[100:103], 0
    ds_read_b64_tr_b16 a[226:227], v15 offset:10240
    v_mul_f32 v81, v27, v81
    v_mfma_f32_16x16x32_bf16 v[164:167], a[204:207], v[104:107], 0
    v_mul_f32 v82, v27, v82
    v_mul_f32 v83, v27, v83
    v_mfma_f32_16x16x32_bf16 v[168:171], a[204:207], v[108:111], 0
    v_cvt_pk_bf16_f32 v62, v80, v81
    v_cvt_pk_bf16_f32 v63, v82, v83
    v_mfma_f32_16x16x32_bf16 v[172:175], a[204:207], v[112:115], 0
    ds_read_b64_tr_b16 a[228:229], v16 offset:8192
    s_waitcnt lgkmcnt(5)
    v_mfma_f32_16x16x32_bf16 v[116:119], a[208:211], a[160:163], v[116:119]
    ds_read_b64_tr_b16 a[230:231], v16 offset:10240
    v_mul_f32 v64, v28, v64
    v_mfma_f32_16x16x32_bf16 v[120:123], a[208:211], a[164:167], v[120:123]
    v_mul_f32 v65, v28, v65
    v_mul_f32 v66, v28, v66
    v_mfma_f32_16x16x32_bf16 v[124:127], a[208:211], a[168:171], v[124:127]
    v_mul_f32 v67, v28, v67
    v_cvt_pk_bf16_f32 v64, v64, v65
    v_mfma_f32_16x16x32_bf16 v[128:131], a[208:211], a[172:175], v[128:131]
    ds_read_b64_tr_b16 a[232:233], v17 offset:8192
    ds_read_b64_tr_b16 a[234:235], v17 offset:10240
    v_mfma_f32_16x16x32_bf16 v[132:135], a[208:211], a[176:179], v[132:135]
    v_cvt_pk_bf16_f32 v65, v66, v67
    s_waitcnt lgkmcnt(6)
    v_mfma_f32_16x16x32_bf16 v[156:159], a[212:215], a[160:163], v[156:159]
    v_mul_f32 v84, v28, v84
    v_mul_f32 v85, v28, v85
    v_mfma_f32_16x16x32_bf16 v[160:163], a[212:215], a[164:167], v[160:163]
    v_mul_f32 v86, v28, v86
    ds_read_b64_tr_b16 a[236:237], v18 offset:8192
    v_mfma_f32_16x16x32_bf16 v[164:167], a[212:215], a[168:171], v[164:167]
    buffer_store_dwordx4 v[60:63], v20, s[44:47], s62 offen offset:1024 sc1
    ds_read_b64_tr_b16 a[238:239], v18 offset:10240
    v_mfma_f32_16x16x32_bf16 v[168:171], a[212:215], a[172:175], v[168:171]
    v_mul_f32 v87, v28, v87
    v_cvt_pk_bf16_f32 v66, v84, v85
    v_mfma_f32_16x16x32_bf16 v[172:175], a[212:215], a[176:179], v[172:175]
    v_cvt_pk_bf16_f32 v67, v86, v87
    s_waitcnt lgkmcnt(6)
    v_mfma_f32_16x16x32_bf16 v[116:119], a[224:227], v[136:139], v[116:119]
    v_mul_f32 v68, v29, v68
    v_mul_f32 v69, v29, v69
    v_mfma_f32_16x16x32_bf16 v[120:123], a[224:227], v[140:143], v[120:123]
    v_add_u32 v15, 0xfffdd000, v15
    ds_read_b64_tr_b16 a[240:241], v15
    v_mfma_f32_16x16x32_bf16 v[124:127], a[224:227], v[144:147], v[124:127]
    ds_read_b64_tr_b16 a[242:243], v15 offset:2048
    v_mul_f32 v70, v29, v70
    v_mfma_f32_16x16x32_bf16 v[128:131], a[224:227], v[148:151], v[128:131]
    v_mul_f32 v71, v29, v71
    v_cvt_pk_bf16_f32 v68, v68, v69
    v_mfma_f32_16x16x32_bf16 v[132:135], a[224:227], v[152:155], v[132:135]
    v_cvt_pk_bf16_f32 v69, v70, v71
    s_waitcnt lgkmcnt(6)
    v_mfma_f32_16x16x32_bf16 v[156:159], a[228:231], v[136:139], v[156:159]
    v_mul_f32 v88, v29, v88
    v_add_u32 v16, 0xfffdd000, v16
    ds_read_b64_tr_b16 a[244:245], v16
    v_mfma_f32_16x16x32_bf16 v[160:163], a[228:231], v[140:143], v[160:163]
    ds_read_b64_tr_b16 a[246:247], v16 offset:2048
    v_mul_f32 v89, v29, v89
    v_mfma_f32_16x16x32_bf16 v[164:167], a[228:231], v[144:147], v[164:167]
    v_mul_f32 v90, v29, v90
    v_mul_f32 v91, v29, v91
    v_mfma_f32_16x16x32_bf16 v[168:171], a[228:231], v[148:151], v[168:171]
    v_cvt_pk_bf16_f32 v70, v88, v89
    v_cvt_pk_bf16_f32 v71, v90, v91
    v_mfma_f32_16x16x32_bf16 v[172:175], a[228:231], v[152:155], v[172:175]
    v_add_u32 v17, 0xfffdd000, v17
    ds_read_b64_tr_b16 a[248:249], v17
    s_waitcnt lgkmcnt(7)
    v_mfma_f32_16x16x32_bf16 v[116:119], a[232:235], a[180:183], v[116:119]
    ds_read_b64_tr_b16 a[250:251], v17 offset:2048
    v_mul_f32 v72, v30, v72
    v_mfma_f32_16x16x32_bf16 v[120:123], a[232:235], a[184:187], v[120:123]
    v_mul_f32 v73, v30, v73
    v_mul_f32 v74, v30, v74
    v_mfma_f32_16x16x32_bf16 v[124:127], a[232:235], a[188:191], v[124:127]
    buffer_store_dwordx4 v[64:67], v20, s[44:47], s62 offen offset:2048 sc1
    v_mul_f32 v75, v30, v75
    v_mfma_f32_16x16x32_bf16 v[128:131], a[232:235], a[192:195], v[128:131]
    v_cvt_pk_bf16_f32 v72, v72, v73
    v_add_u32 v18, 0xfffdd000, v18
    ds_read_b64_tr_b16 a[252:253], v18
    v_mfma_f32_16x16x32_bf16 v[132:135], a[232:235], a[196:199], v[132:135]
    ds_read_b64_tr_b16 a[254:255], v18 offset:2048
    s_waitcnt lgkmcnt(8)
    v_mfma_f32_16x16x32_bf16 v[156:159], a[236:239], a[180:183], v[156:159]
    v_cvt_pk_bf16_f32 v73, v74, v75
    v_mul_f32 v92, v30, v92
    v_mfma_f32_16x16x32_bf16 v[160:163], a[236:239], a[184:187], v[160:163]
    v_mul_f32 v93, v30, v93
    v_mul_f32 v94, v30, v94
    v_mfma_f32_16x16x32_bf16 v[164:167], a[236:239], a[188:191], v[164:167]
    v_mul_f32 v95, v30, v95
    ds_read_b64_tr_b16 a[216:217], v15 offset:8192
    v_mfma_f32_16x16x32_bf16 v[168:171], a[236:239], a[192:195], v[168:171]
    ds_read_b64_tr_b16 a[218:219], v15 offset:10240
    v_cvt_pk_bf16_f32 v74, v92, v93
    v_mfma_f32_16x16x32_bf16 v[172:175], a[236:239], a[196:199], v[172:175]
    v_cvt_pk_bf16_f32 v75, v94, v95
    s_waitcnt lgkmcnt(8)
    v_mfma_f32_16x16x32_bf16 v[116:119], a[240:243], v[176:179], v[116:119]
    v_mfma_f32_16x16x32_bf16 v[120:123], a[240:243], v[180:183], v[120:123]
    v_mfma_f32_16x16x32_bf16 v[124:127], a[240:243], v[184:187], v[124:127]
    ds_read_b64_tr_b16 a[220:221], v16 offset:8192
    ds_read_b64_tr_b16 a[222:223], v16 offset:10240
    v_mfma_f32_16x16x32_bf16 v[128:131], a[240:243], v[188:191], v[128:131]
    v_mfma_f32_16x16x32_bf16 v[132:135], a[240:243], v[192:195], v[132:135]
    s_waitcnt lgkmcnt(8)
    v_mfma_f32_16x16x32_bf16 v[156:159], a[244:247], v[176:179], v[156:159]
    v_mfma_f32_16x16x32_bf16 v[160:163], a[244:247], v[180:183], v[160:163]
    v_mfma_f32_16x16x32_bf16 v[164:167], a[244:247], v[184:187], v[164:167]
    buffer_store_dwordx4 v[68:71], v20, s[44:47], s62 offen offset:3072 sc1
    s_add_u32 s62, s62, 20480
    v_mfma_f32_16x16x32_bf16 v[168:171], a[244:247], v[188:191], v[168:171]
    ds_read_b64_tr_b16 a[200:201], v17 offset:8192
    ds_read_b64_tr_b16 a[202:203], v17 offset:10240
    v_mfma_f32_16x16x32_bf16 v[172:175], a[244:247], v[192:195], v[172:175]
    s_waitcnt lgkmcnt(8)
    v_mfma_f32_16x16x32_bf16 v[116:119], a[248:251], v[196:199], v[116:119]
    v_mfma_f32_16x16x32_bf16 v[120:123], a[248:251], v[200:203], v[120:123]
    s_waitcnt vmcnt(4)
    v_mov_b32 v25, 4
    buffer_atomic_umax v25, v3, s[52:55], 0 offen sc1
    v_mfma_f32_16x16x32_bf16 v[124:127], a[248:251], v[204:207], v[124:127]
    v_cmp_gt_u32 vcc, 2, v24
    s_and_b32 s3, vcc_lo, 0xffff
    s_cselect_b32 s85, 0x1000000, 0
    v_mfma_f32_16x16x32_bf16 v[128:131], a[248:251], v[208:211], v[128:131]
    v_mov_b32 v24, 0
    buffer_atomic_or v24, v2, s[52:55], 0 offen sc0 sc1
    v_mfma_f32_16x16x32_bf16 v[132:135], a[248:251], v[212:215], v[132:135]
    s_add_u32 s88, s85, 20480
    buffer_load_dwordx4 a[16:19], v4, s[48:51], s88 offen sc1
    s_waitcnt lgkmcnt(6)
    v_mfma_f32_16x16x32_bf16 v[156:159], a[252:255], v[196:199], v[156:159]
    s_add_u32 s88, s85, 593920
    buffer_load_dwordx4 a[20:23], v4, s[48:51], s88 offen sc1
    v_mfma_f32_16x16x32_bf16 v[160:163], a[252:255], v[200:203], v[160:163]
    ds_read_b64_tr_b16 a[204:205], v18 offset:8192
    ds_read_b64_tr_b16 a[206:207], v18 offset:10240
    v_mfma_f32_16x16x32_bf16 v[164:167], a[252:255], v[204:207], v[164:167]
    s_add_u32 s88, s85, 1167360
    buffer_load_dwordx4 a[24:27], v4, s[48:51], s88 offen sc1
    v_mfma_f32_16x16x32_bf16 v[168:171], a[252:255], v[208:211], v[168:171]
    s_add_u32 s88, s85, 1740800
    buffer_load_dwordx4 a[28:31], v4, s[48:51], s88 offen sc1
    v_mfma_f32_16x16x32_bf16 v[172:175], a[252:255], v[212:215], v[172:175]
    s_waitcnt lgkmcnt(6)
    v_mfma_f32_16x16x32_bf16 v[116:119], a[216:219], v[216:219], v[116:119]
    v_mfma_f32_16x16x32_bf16 v[120:123], a[216:219], v[220:223], v[120:123]
    v_mfma_f32_16x16x32_bf16 v[124:127], a[216:219], v[224:227], v[124:127]
    buffer_store_dwordx4 v[72:75], v20, s[44:47], s63 offen sc1
    s_add_u32 s63, s63, 20480
    v_mfma_f32_16x16x32_bf16 v[128:131], a[216:219], v[228:231], v[128:131]
    v_mfma_f32_16x16x32_bf16 v[132:135], a[216:219], v[232:235], v[132:135]
    s_waitcnt lgkmcnt(4)
    v_mfma_f32_16x16x32_bf16 v[156:159], a[220:223], v[216:219], v[156:159]
    v_mfma_f32_16x16x32_bf16 v[160:163], a[220:223], v[220:223], v[160:163]
    v_mfma_f32_16x16x32_bf16 v[164:167], a[220:223], v[224:227], v[164:167]
    v_mfma_f32_16x16x32_bf16 v[168:171], a[220:223], v[228:231], v[168:171]
    v_mfma_f32_16x16x32_bf16 v[172:175], a[220:223], v[232:235], v[172:175]
    s_waitcnt lgkmcnt(0)
    s_barrier
    v_mfma_f32_16x16x32_bf16 v[116:119], a[200:203], v[236:239], v[116:119]
    v_add_u32 v15, 0x19800, v15
    ds_read_b64_tr_b16 a[208:209], v15
    v_mfma_f32_16x16x32_bf16 v[120:123], a[200:203], v[240:243], v[120:123]
    ds_read_b64_tr_b16 a[210:211], v15 offset:2048
    v_add_u32 v16, 0x19800, v16
    ds_read_b64_tr_b16 a[212:213], v16
    v_mfma_f32_16x16x32_bf16 v[124:127], a[200:203], v[244:247], v[124:127]
    ds_read_b64_tr_b16 a[214:215], v16 offset:2048
    v_mul_f32 v116, v26, v116
    v_mfma_f32_16x16x32_bf16 v[128:131], a[200:203], v[248:251], v[128:131]
    v_mul_f32 v117, v26, v117
    v_mul_f32 v118, v26, v118
    v_mfma_f32_16x16x32_bf16 v[132:135], a[200:203], v[252:255], v[132:135]
    v_mul_f32 v119, v26, v119
    v_cvt_pk_bf16_f32 v116, v116, v117
    v_mfma_f32_16x16x32_bf16 v[156:159], a[204:207], v[236:239], v[156:159]
    v_cvt_pk_bf16_f32 v117, v118, v119
    v_add_u32 v17, 0x19800, v17
    ds_read_b64_tr_b16 a[224:225], v17
    v_mfma_f32_16x16x32_bf16 v[160:163], a[204:207], v[240:243], v[160:163]
    ds_read_b64_tr_b16 a[226:227], v17 offset:2048
    v_add_u32 v18, 0x19800, v18
    ds_read_b64_tr_b16 a[228:229], v18
    v_mfma_f32_16x16x32_bf16 v[164:167], a[204:207], v[244:247], v[164:167]
    v_mul_f32 v156, v26, v156
    v_mul_f32 v157, v26, v157
    v_mfma_f32_16x16x32_bf16 v[168:171], a[204:207], v[248:251], v[168:171]
    v_mul_f32 v158, v26, v158
    v_mul_f32 v159, v26, v159
    v_mfma_f32_16x16x32_bf16 v[172:175], a[204:207], v[252:255], v[172:175]
    v_cvt_pk_bf16_f32 v118, v156, v157
    s_waitcnt lgkmcnt(5)
    v_mfma_f32_16x16x32_bf16 v[56:59], a[208:211], v[96:99], 0
    v_cvt_pk_bf16_f32 v119, v158, v159
    v_mul_f32 v120, v27, v120
    v_mfma_f32_16x16x32_bf16 v[60:63], a[208:211], v[100:103], 0
    v_mul_f32 v121, v27, v121
    ds_read_b64_tr_b16 a[230:231], v18 offset:2048
    v_mfma_f32_16x16x32_bf16 v[64:67], a[208:211], v[104:107], 0
    v_mul_f32 v122, v27, v122
    v_mul_f32 v123, v27, v123
    v_mfma_f32_16x16x32_bf16 v[68:71], a[208:211], v[108:111], 0
    buffer_store_dwordx4 v[116:119], v20, s[44:47], s62 offen sc1
    v_cvt_pk_bf16_f32 v120, v120, v121
    v_mfma_f32_16x16x32_bf16 v[72:75], a[208:211], v[112:115], 0
    v_cvt_pk_bf16_f32 v121, v122, v123
    s_waitcnt lgkmcnt(4)
    v_mfma_f32_16x16x32_bf16 v[76:79], a[212:215], v[96:99], 0
    v_mul_f32 v160, v27, v160
    ds_read_b64_tr_b16 a[232:233], v15 offset:8192
    v_mfma_f32_16x16x32_bf16 v[80:83], a[212:215], v[100:103], 0
    ds_read_b64_tr_b16 a[234:235], v15 offset:10240
    v_mul_f32 v161, v27, v161
    v_mfma_f32_16x16x32_bf16 v[84:87], a[212:215], v[104:107], 0
    v_mul_f32 v162, v27, v162
    v_mul_f32 v163, v27, v163
    v_mfma_f32_16x16x32_bf16 v[88:91], a[212:215], v[108:111], 0
    v_cvt_pk_bf16_f32 v122, v160, v161
    v_cvt_pk_bf16_f32 v123, v162, v163
    v_mfma_f32_16x16x32_bf16 v[92:95], a[212:215], v[112:115], 0
    ds_read_b64_tr_b16 a[236:237], v16 offset:8192
    s_waitcnt lgkmcnt(5)
    v_mfma_f32_16x16x32_bf16 v[56:59], a[224:227], a[160:163], v[56:59]
    ds_read_b64_tr_b16 a[238:239], v16 offset:10240
    v_mul_f32 v124, v28, v124
    v_mfma_f32_16x16x32_bf16 v[60:63], a[224:227], a[164:167], v[60:63]
    v_mul_f32 v125, v28, v125
    v_mul_f32 v126, v28, v126
    v_mfma_f32_16x16x32_bf16 v[64:67], a[224:227], a[168:171], v[64:67]
    v_mul_f32 v127, v28, v127
    v_cvt_pk_bf16_f32 v124, v124, v125
    v_mfma_f32_16x16x32_bf16 v[68:71], a[224:227], a[172:175], v[68:71]
    ds_read_b64_tr_b16 a[240:241], v17 offset:8192
    ds_read_b64_tr_b16 a[242:243], v17 offset:10240
    v_mfma_f32_16x16x32_bf16 v[72:75], a[224:227], a[176:179], v[72:75]
    v_cvt_pk_bf16_f32 v125, v126, v127
    s_waitcnt lgkmcnt(6)
    v_mfma_f32_16x16x32_bf16 v[76:79], a[228:231], a[160:163], v[76:79]
    v_mul_f32 v164, v28, v164
    v_mul_f32 v165, v28, v165
    v_mfma_f32_16x16x32_bf16 v[80:83], a[228:231], a[164:167], v[80:83]
    v_mul_f32 v166, v28, v166
    ds_read_b64_tr_b16 a[244:245], v18 offset:8192
    v_mfma_f32_16x16x32_bf16 v[84:87], a[228:231], a[168:171], v[84:87]
    buffer_store_dwordx4 v[120:123], v20, s[44:47], s62 offen offset:1024 sc1
    ds_read_b64_tr_b16 a[246:247], v18 offset:10240
    v_mfma_f32_16x16x32_bf16 v[88:91], a[228:231], a[172:175], v[88:91]
    v_mul_f32 v167, v28, v167
    v_cvt_pk_bf16_f32 v126, v164, v165
    v_mfma_f32_16x16x32_bf16 v[92:95], a[228:231], a[176:179], v[92:95]
    v_cvt_pk_bf16_f32 v127, v166, v167
    s_waitcnt lgkmcnt(6)
    v_mfma_f32_16x16x32_bf16 v[56:59], a[232:235], v[136:139], v[56:59]
    v_mul_f32 v128, v29, v128
    v_mul_f32 v129, v29, v129
    v_mfma_f32_16x16x32_bf16 v[60:63], a[232:235], v[140:143], v[60:63]
    v_add_u32 v15, 0xfffeac00, v15
    ds_read_b64_tr_b16 a[248:249], v15
    v_mfma_f32_16x16x32_bf16 v[64:67], a[232:235], v[144:147], v[64:67]
    ds_read_b64_tr_b16 a[250:251], v15 offset:2048
    v_mul_f32 v130, v29, v130
    v_mfma_f32_16x16x32_bf16 v[68:71], a[232:235], v[148:151], v[68:71]
    v_mul_f32 v131, v29, v131
    v_cvt_pk_bf16_f32 v128, v128, v129
    v_mfma_f32_16x16x32_bf16 v[72:75], a[232:235], v[152:155], v[72:75]
    v_cvt_pk_bf16_f32 v129, v130, v131
    s_waitcnt lgkmcnt(6)
    v_mfma_f32_16x16x32_bf16 v[76:79], a[236:239], v[136:139], v[76:79]
    v_mul_f32 v168, v29, v168
    v_add_u32 v17, 0xfffeac00, v17
    ds_read_b64_tr_b16 a[252:253], v17
    v_mfma_f32_16x16x32_bf16 v[80:83], a[236:239], v[140:143], v[80:83]
    ds_read_b64_tr_b16 a[254:255], v17 offset:2048
    v_mul_f32 v169, v29, v169
    v_mfma_f32_16x16x32_bf16 v[84:87], a[236:239], v[144:147], v[84:87]
    v_mul_f32 v170, v29, v170
    v_mul_f32 v171, v29, v171
    v_mfma_f32_16x16x32_bf16 v[88:91], a[236:239], v[148:151], v[88:91]
    v_cvt_pk_bf16_f32 v130, v168, v169
    v_cvt_pk_bf16_f32 v131, v170, v171
    v_mfma_f32_16x16x32_bf16 v[92:95], a[236:239], v[152:155], v[92:95]
    ds_read_b64_tr_b16 a[216:217], v15 offset:8192
    s_waitcnt lgkmcnt(7)
    v_mfma_f32_16x16x32_bf16 v[56:59], a[240:243], a[180:183], v[56:59]
    ds_read_b64_tr_b16 a[218:219], v15 offset:10240
    v_mul_f32 v132, v30, v132
    v_mfma_f32_16x16x32_bf16 v[60:63], a[240:243], a[184:187], v[60:63]
    v_mul_f32 v133, v30, v133
    v_mul_f32 v134, v30, v134
    v_mfma_f32_16x16x32_bf16 v[64:67], a[240:243], a[188:191], v[64:67]
    buffer_store_dwordx4 v[124:127], v20, s[44:47], s62 offen offset:2048 sc1
    v_mul_f32 v135, v30, v135
    v_mfma_f32_16x16x32_bf16 v[68:71], a[240:243], a[192:195], v[68:71]
    v_cvt_pk_bf16_f32 v132, v132, v133
    ds_read_b64_tr_b16 a[220:221], v17 offset:8192
    v_mfma_f32_16x16x32_bf16 v[72:75], a[240:243], a[196:199], v[72:75]
    ds_read_b64_tr_b16 a[222:223], v17 offset:10240
    s_waitcnt lgkmcnt(8)
    v_mfma_f32_16x16x32_bf16 v[76:79], a[244:247], a[180:183], v[76:79]
    v_cvt_pk_bf16_f32 v133, v134, v135
    v_mul_f32 v172, v30, v172
    v_mfma_f32_16x16x32_bf16 v[80:83], a[244:247], a[184:187], v[80:83]
    v_mul_f32 v173, v30, v173
    v_mul_f32 v174, v30, v174
    v_mfma_f32_16x16x32_bf16 v[84:87], a[244:247], a[188:191], v[84:87]
    v_mul_f32 v175, v30, v175
    v_add_u32 v16, 0xfffeac00, v16
    ds_read_b64_tr_b16 a[200:201], v16
    v_mfma_f32_16x16x32_bf16 v[88:91], a[244:247], a[192:195], v[88:91]
    ds_read_b64_tr_b16 a[202:203], v16 offset:2048
    v_cvt_pk_bf16_f32 v134, v172, v173
    v_mfma_f32_16x16x32_bf16 v[92:95], a[244:247], a[196:199], v[92:95]
    v_cvt_pk_bf16_f32 v135, v174, v175
    s_waitcnt lgkmcnt(8)
    v_mfma_f32_16x16x32_bf16 v[56:59], a[248:251], v[176:179], v[56:59]
    v_mfma_f32_16x16x32_bf16 v[60:63], a[248:251], v[180:183], v[60:63]
    v_mfma_f32_16x16x32_bf16 v[64:67], a[248:251], v[184:187], v[64:67]
    v_add_u32 v18, 0xfffeac00, v18
    ds_read_b64_tr_b16 a[204:205], v18
    v_mfma_f32_16x16x32_bf16 v[68:71], a[248:251], v[188:191], v[68:71]
    ds_read_b64_tr_b16 a[206:207], v18 offset:2048
    v_mfma_f32_16x16x32_bf16 v[72:75], a[248:251], v[192:195], v[72:75]
    s_waitcnt lgkmcnt(8)
    v_mfma_f32_16x16x32_bf16 v[56:59], a[252:255], v[196:199], v[56:59]
    v_mfma_f32_16x16x32_bf16 v[60:63], a[252:255], v[200:203], v[60:63]
    v_mfma_f32_16x16x32_bf16 v[64:67], a[252:255], v[204:207], v[64:67]
    buffer_store_dwordx4 v[128:131], v20, s[44:47], s62 offen offset:3072 sc1
    s_add_u32 s62, s62, 20480
    v_mfma_f32_16x16x32_bf16 v[68:71], a[252:255], v[208:211], v[68:71]
    ds_read_b64_tr_b16 a[208:209], v16 offset:8192
    ds_read_b64_tr_b16 a[210:211], v16 offset:10240
    v_mfma_f32_16x16x32_bf16 v[72:75], a[252:255], v[212:215], v[72:75]
    s_waitcnt lgkmcnt(8)
    v_mfma_f32_16x16x32_bf16 v[56:59], a[216:219], v[216:219], v[56:59]
    v_mfma_f32_16x16x32_bf16 v[60:63], a[216:219], v[220:223], v[60:63]
    s_waitcnt vmcnt(4)
    v_mov_b32 v25, 5
    buffer_atomic_umax v25, v3, s[52:55], 0 offen sc1
    v_mfma_f32_16x16x32_bf16 v[64:67], a[216:219], v[224:227], v[64:67]
    v_cmp_gt_u32 vcc, 3, v24
    s_and_b32 s3, vcc_lo, 0xffff
    s_cselect_b32 s86, 0x1000000, 0
    v_mfma_f32_16x16x32_bf16 v[68:71], a[216:219], v[228:231], v[68:71]
    v_mov_b32 v24, 0
    buffer_atomic_or v24, v2, s[52:55], 0 offen sc0 sc1
    v_mfma_f32_16x16x32_bf16 v[72:75], a[216:219], v[232:235], v[72:75]
    s_add_u32 s88, s86, 40960
    buffer_load_dwordx4 a[32:35], v4, s[48:51], s88 offen sc1
    s_waitcnt lgkmcnt(6)
    v_mfma_f32_16x16x32_bf16 v[56:59], a[220:223], v[236:239], v[56:59]
    s_add_u32 s88, s86, 614400
    buffer_load_dwordx4 a[36:39], v4, s[48:51], s88 offen sc1
    v_mfma_f32_16x16x32_bf16 v[60:63], a[220:223], v[240:243], v[60:63]
    ds_read_b64_tr_b16 a[212:213], v18 offset:8192
    ds_read_b64_tr_b16 a[214:215], v18 offset:10240
    v_mfma_f32_16x16x32_bf16 v[64:67], a[220:223], v[244:247], v[64:67]
    s_add_u32 s88, s86, 1187840
    buffer_load_dwordx4 a[40:43], v4, s[48:51], s88 offen sc1
    v_mfma_f32_16x16x32_bf16 v[68:71], a[220:223], v[248:251], v[68:71]
    s_add_u32 s88, s86, 1761280
    buffer_load_dwordx4 a[44:47], v4, s[48:51], s88 offen sc1
    v_mfma_f32_16x16x32_bf16 v[72:75], a[220:223], v[252:255], v[72:75]
    s_waitcnt lgkmcnt(6)
    v_mfma_f32_16x16x32_bf16 v[76:79], a[200:203], v[176:179], v[76:79]
    v_mul_f32 v56, v26, v56
    v_mul_f32 v57, v26, v57
    v_mfma_f32_16x16x32_bf16 v[80:83], a[200:203], v[180:183], v[80:83]
    v_mul_f32 v58, v26, v58
    v_mul_f32 v59, v26, v59
    v_mfma_f32_16x16x32_bf16 v[84:87], a[200:203], v[184:187], v[84:87]
    v_cvt_pk_bf16_f32 v56, v56, v57
    v_cvt_pk_bf16_f32 v57, v58, v59
    v_mfma_f32_16x16x32_bf16 v[88:91], a[200:203], v[188:191], v[88:91]
    v_mul_f32 v60, v27, v60
    v_mul_f32 v61, v27, v61
    v_mfma_f32_16x16x32_bf16 v[92:95], a[200:203], v[192:195], v[92:95]
    v_mul_f32 v62, v27, v62
    s_waitcnt lgkmcnt(4)
    v_mfma_f32_16x16x32_bf16 v[76:79], a[204:207], v[196:199], v[76:79]
    v_mul_f32 v63, v27, v63
    v_cvt_pk_bf16_f32 v60, v60, v61
    v_mfma_f32_16x16x32_bf16 v[80:83], a[204:207], v[200:203], v[80:83]
    buffer_store_dwordx4 v[132:135], v20, s[44:47], s63 offen sc1
    s_add_u32 s63, s63, 20480
    v_cvt_pk_bf16_f32 v61, v62, v63
    v_mfma_f32_16x16x32_bf16 v[84:87], a[204:207], v[204:207], v[84:87]
    v_mul_f32 v64, v28, v64
    v_mul_f32 v65, v28, v65
    v_mfma_f32_16x16x32_bf16 v[88:91], a[204:207], v[208:211], v[88:91]
    v_mul_f32 v66, v28, v66
    v_mul_f32 v67, v28, v67
    v_mfma_f32_16x16x32_bf16 v[92:95], a[204:207], v[212:215], v[92:95]
    v_cvt_pk_bf16_f32 v64, v64, v65
    s_waitcnt lgkmcnt(2)
    v_mfma_f32_16x16x32_bf16 v[76:79], a[208:211], v[216:219], v[76:79]
    v_cvt_pk_bf16_f32 v65, v66, v67
    v_mul_f32 v68, v29, v68
    v_mfma_f32_16x16x32_bf16 v[80:83], a[208:211], v[220:223], v[80:83]
    v_mul_f32 v69, v29, v69
    v_mul_f32 v70, v29, v70
    v_mfma_f32_16x16x32_bf16 v[84:87], a[208:211], v[224:227], v[84:87]
    v_mul_f32 v71, v29, v71
    v_cvt_pk_bf16_f32 v68, v68, v69
    v_mfma_f32_16x16x32_bf16 v[88:91], a[208:211], v[228:231], v[88:91]
    v_cvt_pk_bf16_f32 v69, v70, v71
    v_mul_f32 v72, v30, v72
    v_mfma_f32_16x16x32_bf16 v[92:95], a[208:211], v[232:235], v[92:95]
    v_mul_f32 v73, v30, v73
    s_waitcnt lgkmcnt(0)
    v_mfma_f32_16x16x32_bf16 v[76:79], a[212:215], v[236:239], v[76:79]
    v_mul_f32 v74, v30, v74
    v_mul_f32 v75, v30, v75
    v_mfma_f32_16x16x32_bf16 v[80:83], a[212:215], v[240:243], v[80:83]
    v_cvt_pk_bf16_f32 v72, v72, v73
    v_cvt_pk_bf16_f32 v73, v74, v75
    v_mfma_f32_16x16x32_bf16 v[84:87], a[212:215], v[244:247], v[84:87]
    v_mfma_f32_16x16x32_bf16 v[88:91], a[212:215], v[248:251], v[88:91]
    v_mfma_f32_16x16x32_bf16 v[92:95], a[212:215], v[252:255], v[92:95]
    v_mul_f32 v76, v26, v76
    v_mul_f32 v77, v26, v77
    v_mul_f32 v78, v26, v78
    v_mul_f32 v79, v26, v79
    v_cvt_pk_bf16_f32 v58, v76, v77
    v_cvt_pk_bf16_f32 v59, v78, v79
    buffer_store_dwordx4 v[56:59], v20, s[44:47], s62 offen sc1
    v_mul_f32 v80, v27, v80
    v_mul_f32 v81, v27, v81
    v_mul_f32 v82, v27, v82
    v_mul_f32 v83, v27, v83
    v_cvt_pk_bf16_f32 v62, v80, v81
    v_cvt_pk_bf16_f32 v63, v82, v83
    buffer_store_dwordx4 v[60:63], v20, s[44:47], s62 offen offset:1024 sc1
    v_mul_f32 v84, v28, v84
    v_mul_f32 v85, v28, v85
    v_mul_f32 v86, v28, v86
    v_mul_f32 v87, v28, v87
    v_cvt_pk_bf16_f32 v66, v84, v85
    v_cvt_pk_bf16_f32 v67, v86, v87
    buffer_store_dwordx4 v[64:67], v20, s[44:47], s62 offen offset:2048 sc1
    v_mul_f32 v88, v29, v88
    v_mul_f32 v89, v29, v89
    v_mul_f32 v90, v29, v90
    v_mul_f32 v91, v29, v91
    v_cvt_pk_bf16_f32 v70, v88, v89
    v_cvt_pk_bf16_f32 v71, v90, v91
    buffer_store_dwordx4 v[68:71], v20, s[44:47], s62 offen offset:3072 sc1
    v_mul_f32 v92, v30, v92
    v_mul_f32 v93, v30, v93
    v_mul_f32 v94, v30, v94
    v_mul_f32 v95, v30, v95
    v_cvt_pk_bf16_f32 v74, v92, v93
    v_cvt_pk_bf16_f32 v75, v94, v95
    buffer_store_dwordx4 v[72:75], v20, s[44:47], s63 offen sc1
    s_waitcnt vmcnt(5)
    v_mov_b32 v25, 6
    buffer_atomic_umax v25, v3, s[52:55], 0 offen sc1
    v_cmp_gt_u32 vcc, 4, v24
    s_and_b32 s3, vcc_lo, 0xffff
    s_cselect_b32 s87, 0x1000000, 0
    v_mov_b32 v24, 0
    buffer_atomic_or v24, v2, s[52:55], 0 offen sc0 sc1
    s_add_u32 s88, s87, 61440
    buffer_load_dwordx4 a[48:51], v4, s[48:51], s88 offen sc1
    s_add_u32 s88, s87, 634880
    buffer_load_dwordx4 a[52:55], v4, s[48:51], s88 offen sc1
    s_add_u32 s88, s87, 1208320
    buffer_load_dwordx4 a[56:59], v4, s[48:51], s88 offen sc1
    s_add_u32 s88, s87, 1781760
    buffer_load_dwordx4 a[60:63], v4, s[48:51], s88 offen sc1
    s_add_u32 s88, s87, 0
    buffer_load_dwordx4 a[112:115], v5, s[48:51], s88 offen sc1
    s_add_u32 s88, s87, 573440
    buffer_load_dwordx4 a[116:119], v5, s[48:51], s88 offen sc1
    s_add_u32 s88, s87, 1146880
    buffer_load_dwordx4 a[120:123], v5, s[48:51], s88 offen sc1
    s_add_u32 s88, s87, 1720320
    buffer_load_dwordx4 a[124:127], v5, s[48:51], s88 offen sc1
    v_and_b32 v36, 15, v0
    v_mov_b32 v37, 0x3f80
    v_mov_b32 v38, 0x3f800000
    v_cmp_eq_u32 vcc, 0, v36
    s_nop 1
    v_cndmask_b32 v44, 0, v37, vcc
    v_cmp_eq_u32 vcc, 1, v36
    s_nop 1
    v_cndmask_b32 v44, v44, v38, vcc
    v_cmp_eq_u32 vcc, 2, v36
    s_nop 1
    v_cndmask_b32 v45, 0, v37, vcc
    v_cmp_eq_u32 vcc, 3, v36
    s_nop 1
    v_cndmask_b32 v45, v45, v38, vcc
    v_cmp_eq_u32 vcc, 4, v36
    s_nop 1
    v_cndmask_b32 v46, 0, v37, vcc
    v_cmp_eq_u32 vcc, 5, v36
    s_nop 1
    v_cndmask_b32 v46, v46, v38, vcc
    v_cmp_eq_u32 vcc, 6, v36
    s_nop 1
    v_cndmask_b32 v47, 0, v37, vcc
    v_cmp_eq_u32 vcc, 7, v36
    s_nop 1
    v_cndmask_b32 v47, v47, v38, vcc
    v_bfe_u32 v37, v0, 4, 2
    s_lshr_b32 s18, s17, 2
    s_and_b32 s19, s17, 3
    v_lshrrev_b32 v38, 2, v36
    v_mul_u32_u24 v38, 896, v38
    v_and_b32 v36, 3, v36
    v_lshl_add_u32 v38, v36, 3, v38
    v_and_b32 v36, 1, v37
    v_lshl_add_u32 v38, v36, 5, v38
    v_lshrrev_b32 v36, 1, v37
    v_lshl_add_u32 v38, v36, 24, v38
    s_lshr_b32 s68, s18, 1
    s_mul_i32 s68, s68, 71680
    s_and_b32 s78, s18, 1
    s_lshl_b32 s78, s78, 6
    s_add_u32 s68, s68, s78
    s_lshl_b32 s78, s19, 2
    s_add_u32 s78, s78, s20
    s_mul_i32 s78, s78, 3584
    s_add_u32 s78, s78, s68
    v_add_u32 v39, s78, v38
    s_mul_i32 s78, s19, 3584
    s_add_u32 s78, s78, s68
    s_add_u32 s78, s78, 57344
    v_add_u32 v40, s78, v38
    s_mov_b32 s97, s89
    s_cmp_eq_u32 s20, 1
    s_cselect_b32 s97, s90, s97
    s_cmp_eq_u32 s20, 2
    s_cselect_b32 s97, s91, s97
    s_cmp_eq_u32 s20, 3
    s_cselect_b32 s97, s92, s97
    s_mov_b32 s98, s93
    s_cmp_eq_u32 s20, 1
    s_cselect_b32 s98, s94, s98
    s_cmp_eq_u32 s20, 2
    s_cselect_b32 s98, s95, s98
    s_cmp_eq_u32 s20, 3
    s_cselect_b32 s78, 0x1000000, 0
    v_add_u32 v41, s78, v5
    v_add_u32 v42, s78, v40
    s_waitcnt vmcnt(10)
    v_mov_b32 v25, 7
    buffer_atomic_umax v25, v3, s[52:55], 0 offen sc1
    s_mov_b32 s69, 0
    s_waitcnt vmcnt(9)
    s_cmp_eq_u32 s84, 0
    s_cbranch_scc1 S_n0
S_c0:
    v_cmp_gt_u32 vcc, 1, v24
    s_and_b32 s3, vcc_lo, 0xffff
    s_cbranch_scc0 S_go0
    v_mov_b32 v24, 0
    buffer_atomic_or v24, v2, s[52:55], 0 offen sc0 sc1
    s_waitcnt vmcnt(0)
    s_add_u32 s69, s69, 1
    s_cmp_gt_u32 s69, 200000
    s_cbranch_scc1 S_end
    s_branch S_c0
S_go0:
    s_mov_b32 s22, 0
    buffer_load_dwordx4 a[0:3], v4, s[48:51], s22 offen sc1
    s_mov_b32 s22, 573440
    buffer_load_dwordx4 a[4:7], v4, s[48:51], s22 offen sc1
    s_mov_b32 s22, 1146880
    buffer_load_dwordx4 a[8:11], v4, s[48:51], s22 offen sc1
    s_mov_b32 s22, 1720320
    buffer_load_dwordx4 a[12:15], v4, s[48:51], s22 offen sc1
S_n0:
    s_cmp_eq_u32 s85, 0
    s_cbranch_scc1 S_n1
S_c1:
    v_cmp_gt_u32 vcc, 2, v24
    s_and_b32 s3, vcc_lo, 0xffff
    s_cbranch_scc0 S_go1
    v_mov_b32 v24, 0
    buffer_atomic_or v24, v2, s[52:55], 0 offen sc0 sc1
    s_waitcnt vmcnt(0)
    s_add_u32 s69, s69, 1
    s_cmp_gt_u32 s69, 200000
    s_cbranch_scc1 S_end
    s_branch S_c1
S_go1:
    s_mov_b32 s22, 20480
    buffer_load_dwordx4 a[16:19], v4, s[48:51], s22 offen sc1
    s_mov_b32 s22, 593920
    buffer_load_dwordx4 a[20:23], v4, s[48:51], s22 offen sc1
    s_mov_b32 s22, 1167360
    buffer_load_dwordx4 a[24:27], v4, s[48:51], s22 offen sc1
    s_mov_b32 s22, 1740800
    buffer_load_dwordx4 a[28:31], v4, s[48:51], s22 offen sc1
S_n1:
    s_cmp_eq_u32 s86, 0
    s_cbranch_scc1 S_n2
S_c2:
    v_cmp_gt_u32 vcc, 3, v24
    s_and_b32 s3, vcc_lo, 0xffff
    s_cbranch_scc0 S_go2
    v_mov_b32 v24, 0
    buffer_atomic_or v24, v2, s[52:55], 0 offen sc0 sc1
    s_waitcnt vmcnt(0)
    s_add_u32 s69, s69, 1
    s_cmp_gt_u32 s69, 200000
    s_cbranch_scc1 S_end
    s_branch S_c2
S_go2:
    s_mov_b32 s22, 40960
    buffer_load_dwordx4 a[32:35], v4, s[48:51], s22 offen sc1
    s_mov_b32 s22, 614400
    buffer_load_dwordx4 a[36:39], v4, s[48:51], s22 offen sc1
    s_mov_b32 s22, 1187840
    buffer_load_dwordx4 a[40:43], v4, s[48:51], s22 offen sc1
    s_mov_b32 s22, 1761280
    buffer_load_dwordx4 a[44:47], v4, s[48:51], s22 offen sc1
S_n2:
    s_cmp_eq_u32 s87, 0
    s_cbranch_scc1 S_n3
S_c3:
    v_cmp_gt_u32 vcc, 4, v24
    s_and_b32 s3, vcc_lo, 0xffff
    s_cbranch_scc0 S_go3
    v_mov_b32 v24, 0
    buffer_atomic_or v24, v2, s[52:55], 0 offen sc0 sc1
    s_waitcnt vmcnt(0)
    s_add_u32 s69, s69, 1
    s_cmp_gt_u32 s69, 200000
    s_cbranch_scc1 S_end
    s_branch S_c3
S_go3:
    s_mov_b32 s22, 61440
    s_waitcnt vmcnt(20)
    buffer_load_dwordx4 a[48:51], v4, s[48:51], s22 offen sc1
    s_mov_b32 s22, 634880
    s_waitcnt vmcnt(20)
    buffer_load_dwordx4 a[52:55], v4, s[48:51], s22 offen sc1
    s_mov_b32 s22, 1208320
    s_waitcnt vmcnt(20)
    buffer_load_dwordx4 a[56:59], v4, s[48:51], s22 offen sc1
    s_mov_b32 s22, 1781760
    s_waitcnt vmcnt(20)
    buffer_load_dwordx4 a[60:63], v4, s[48:51], s22 offen sc1
    s_mov_b32 s22, 0
    s_waitcnt vmcnt(20)
    buffer_load_dwordx4 a[112:115], v5, s[48:51], s22 offen sc1
    s_mov_b32 s22, 573440
    s_waitcnt vmcnt(20)
    buffer_load_dwordx4 a[116:119], v5, s[48:51], s22 offen sc1
    s_mov_b32 s22, 1146880
    s_waitcnt vmcnt(20)
    buffer_load_dwordx4 a[120:123], v5, s[48:51], s22 offen sc1
    s_mov_b32 s22, 1720320
    s_waitcnt vmcnt(20)
    buffer_load_dwordx4 a[124:127], v5, s[48:51], s22 offen sc1
S_n3:
S_c4:
    v_cmp_gt_u32 vcc, 5, v24
    s_and_b32 s3, vcc_lo, 0xffff
    s_cbranch_scc0 S_go4
    v_mov_b32 v24, 0
    buffer_atomic_or v24, v2, s[52:55], 0 offen sc0 sc1
    s_waitcnt vmcnt(0)
    s_add_u32 s69, s69, 1
    s_cmp_gt_u32 s69, 200000
    s_cbranch_scc1 S_end
    s_branch S_c4
S_go4:
    s_mov_b32 s22, 81920
    buffer_load_dwordx4 a[64:67], v4, s[48:51], s22 offen sc1
    s_mov_b32 s22, 655360
    buffer_load_dwordx4 a[68:71], v4, s[48:51], s22 offen sc1
    s_mov_b32 s22, 1228800
    buffer_load_dwordx4 a[72:75], v4, s[48:51], s22 offen sc1
    s_mov_b32 s22, 1802240
    buffer_load_dwordx4 a[76:79], v4, s[48:51], s22 offen sc1
S_c5:
    v_cmp_gt_u32 vcc, 6, v24
    s_and_b32 s3, vcc_lo, 0xffff
    s_cbranch_scc0 S_go5
    v_mov_b32 v24, 0
    buffer_atomic_or v24, v2, s[52:55], 0 offen sc0 sc1
    s_waitcnt vmcnt(0)
    s_add_u32 s69, s69, 1
    s_cmp_gt_u32 s69, 200000
    s_cbranch_scc1 S_end
    s_branch S_c5
S_go5:
    s_mov_b32 s22, 102400
    buffer_load_dwordx4 a[80:83], v4, s[48:51], s22 offen sc1
    s_mov_b32 s22, 675840
    buffer_load_dwordx4 a[84:87], v4, s[48:51], s22 offen sc1
    s_mov_b32 s22, 1249280
    buffer_load_dwordx4 a[88:91], v4, s[48:51], s22 offen sc1
    s_mov_b32 s22, 1822720
    buffer_load_dwordx4 a[92:95], v4, s[48:51], s22 offen sc1
S_c6:
    v_cmp_gt_u32 vcc, 7, v24
    s_and_b32 s3, vcc_lo, 0xffff
    s_cbranch_scc0 S_go6
    v_mov_b32 v24, 0
    buffer_atomic_or v24, v2, s[52:55], 0 offen sc0 sc1
    s_waitcnt vmcnt(0)
    s_add_u32 s69, s69, 1
    s_cmp_gt_u32 s69, 200000
    s_cbranch_scc1 S_end
    s_branch S_c6
S_go6:
    s_mov_b32 s22, 122880
    buffer_load_dwordx4 a[96:99], v4, s[48:51], s22 offen sc1
    s_mov_b32 s22, 696320
    buffer_load_dwordx4 a[100:103], v4, s[48:51], s22 offen sc1
    s_mov_b32 s22, 1269760
    buffer_load_dwordx4 a[104:107], v4, s[48:51], s22 offen sc1
    s_mov_b32 s22, 1843200
    buffer_load_dwordx4 a[108:111], v4, s[48:51], s22 offen sc1
    s_mov_b32 s22, 81920
    buffer_load_dwordx4 a[128:131], v41, s[48:51], s22 offen sc1
    s_mov_b32 s22, 655360
    buffer_load_dwordx4 a[132:135], v41, s[48:51], s22 offen sc1
    s_mov_b32 s22, 1228800
    buffer_load_dwordx4 a[136:139], v41, s[48:51], s22 offen sc1
    s_mov_b32 s22, 1802240
    buffer_load_dwordx4 a[140:143], v41, s[48:51], s22 offen sc1
    s_waitcnt vmcnt(16)
    v_mfma_f32_16x16x32_bf16 v[96:99], v[44:47], a[0:3], 0
    v_mfma_f32_16x16x32_bf16 v[96:99], v[44:47], a[4:7], v[96:99]
    v_mfma_f32_16x16x32_bf16 v[96:99], v[44:47], a[8:11], v[96:99]
    v_mfma_f32_16x16x32_bf16 v[96:99], v[44:47], a[12:15], v[96:99]
    v_mfma_f32_16x16x32_bf16 v[100:103], v[44:47], a[16:19], 0
    v_mfma_f32_16x16x32_bf16 v[100:103], v[44:47], a[20:23], v[100:103]
    v_mfma_f32_16x16x32_bf16 v[100:103], v[44:47], a[24:27], v[100:103]
    v_mfma_f32_16x16x32_bf16 v[100:103], v[44:47], a[28:31], v[100:103]
    v_mfma_f32_16x16x32_bf16 v[104:107], v[44:47], a[32:35], 0
    v_mfma_f32_16x16x32_bf16 v[104:107], v[44:47], a[36:39], v[104:107]
    v_mfma_f32_16x16x32_bf16 v[104:107], v[44:47], a[40:43], v[104:107]
    v_mfma_f32_16x16x32_bf16 v[104:107], v[44:47], a[44:47], v[104:107]
    v_cvt_pk_bf16_f32 v96, v96, v97
    v_cvt_pk_bf16_f32 v97, v98, v99
    buffer_store_dwordx2 v[96:97], v39, s[64:67], s89 offen sc1
    v_mfma_f32_16x16x32_bf16 v[108:111], v[44:47], a[48:51], 0
    v_mfma_f32_16x16x32_bf16 v[108:111], v[44:47], a[52:55], v[108:111]
    v_mfma_f32_16x16x32_bf16 v[108:111], v[44:47], a[56:59], v[108:111]
    v_mfma_f32_16x16x32_bf16 v[108:111], v[44:47], a[60:63], v[108:111]
    v_cvt_pk_bf16_f32 v100, v100, v101
    v_cvt_pk_bf16_f32 v101, v102, v103
    buffer_store_dwordx2 v[100:101], v39, s[64:67], s90 offen sc1
    v_mfma_f32_16x16x32_bf16 v[124:127], v[44:47], a[112:115], 0
    v_mfma_f32_16x16x32_bf16 v[124:127], v[44:47], a[116:119], v[124:127]
    v_mfma_f32_16x16x32_bf16 v[124:127], v[44:47], a[120:123], v[124:127]
    v_mfma_f32_16x16x32_bf16 v[124:127], v[44:47], a[124:127], v[124:127]
    v_cvt_pk_bf16_f32 v104, v104, v105
    v_cvt_pk_bf16_f32 v105, v106, v107
    buffer_store_dwordx2 v[104:105], v39, s[64:67], s91 offen sc1
    s_waitcnt vmcnt(18)
    v_mfma_f32_16x16x32_bf16 v[112:115], v[44:47], a[64:67], 0
    s_waitcnt vmcnt(17)
    v_mfma_f32_16x16x32_bf16 v[112:115], v[44:47], a[68:71], v[112:115]
    s_waitcnt vmcnt(16)
    v_mfma_f32_16x16x32_bf16 v[112:115], v[44:47], a[72:75], v[112:115]
    s_waitcnt vmcnt(15)
    v_mfma_f32_16x16x32_bf16 v[112:115], v[44:47], a[76:79], v[112:115]
    v_cvt_pk_bf16_f32 v108, v108, v109
    v_cvt_pk_bf16_f32 v109, v110, v111
    buffer_store_dwordx2 v[108:109], v39, s[64:67], s92 offen sc1
    s_waitcnt vmcnt(15)
    v_mfma_f32_16x16x32_bf16 v[116:119], v[44:47], a[80:83], 0
    s_waitcnt vmcnt(14)
    v_mfma_f32_16x16x32_bf16 v[116:119], v[44:47], a[84:87], v[116:119]
    s_waitcnt vmcnt(13)
    v_mfma_f32_16x16x32_bf16 v[116:119], v[44:47], a[88:91], v[116:119]
    s_waitcnt vmcnt(12)
    v_mfma_f32_16x16x32_bf16 v[116:119], v[44:47], a[92:95], v[116:119]
    v_cvt_pk_bf16_f32 v124, v124, v125
    v_cvt_pk_bf16_f32 v125, v126, v127
    buffer_store_dwordx2 v[124:125], v40, s[64:67], s97 offen sc1
    v_cvt_pk_bf16_f32 v112, v112, v113
    v_cvt_pk_bf16_f32 v113, v114, v115
    buffer_store_dwordx2 v[112:113], v39, s[64:67], s93 offen sc1
    s_nop 1
    v_cvt_pk_bf16_f32 v116, v116, v117
    v_cvt_pk_bf16_f32 v117, v118, v119
    buffer_store_dwordx2 v[116:117], v39, s[64:67], s94 offen sc1
    s_waitcnt vmcnt(14)
    v_mfma_f32_16x16x32_bf16 v[120:123], v[44:47], a[96:99], 0
    s_waitcnt vmcnt(13)
    v_mfma_f32_16x16x32_bf16 v[120:123], v[44:47], a[100:103], v[120:123]
    s_waitcnt vmcnt(12)
    v_mfma_f32_16x16x32_bf16 v[120:123], v[44:47], a[104:107], v[120:123]
    s_waitcnt vmcnt(11)
    v_mfma_f32_16x16x32_bf16 v[120:123], v[44:47], a[108:111], v[120:123]
    s_waitcnt vmcnt(10)
    v_mfma_f32_16x16x32_bf16 v[128:131], v[44:47], a[128:131], 0
    s_waitcnt vmcnt(9)
    v_mfma_f32_16x16x32_bf16 v[128:131], v[44:47], a[132:135], v[128:131]
    s_waitcnt vmcnt(8)
    v_mfma_f32_16x16x32_bf16 v[128:131], v[44:47], a[136:139], v[128:131]
    s_waitcnt vmcnt(7)
    v_mfma_f32_16x16x32_bf16 v[128:131], v[44:47], a[140:143], v[128:131]
    v_cvt_pk_bf16_f32 v120, v120, v121
    v_cvt_pk_bf16_f32 v121, v122, v123
    buffer_store_dwordx2 v[120:121], v39, s[64:67], s95 offen sc1
    s_nop 4
    v_cvt_pk_bf16_f32 v128, v128, v129
    v_cvt_pk_bf16_f32 v129, v130, v131
    buffer_store_dwordx2 v[128:129], v42, s[64:67], s98 offen sc1
S_end:
    s_endpgm
.section .rodata,"a"
.p2align 6
.amdhsa_kernel standalone__mha_block_cached__near_ridge_kernel
  .amdhsa_next_free_vgpr 512
  .amdhsa_next_free_sgpr 102
  .amdhsa_accum_offset 256
  .amdhsa_group_segment_fixed_size 0
  .amdhsa_kernarg_size 64
  .amdhsa_user_sgpr_count 2
  .amdhsa_user_sgpr_kernarg_segment_ptr 1
  .amdhsa_system_sgpr_workgroup_id_x 1
.end_amdhsa_kernel
```
